```python
import torch

def _softmax(x, axis=-1):
    return torch.softmax(x, dim=axis)
def _gelu(x):
    return torch.nn.functional.gelu(x, approximate="tanh")
def _silu(x):
    return torch.nn.functional.silu(x)
def _sigmoid(x):
    return torch.sigmoid(x)
def _layernorm(x, axis=-1, eps=1e-5):
    m = x.mean(dim=axis, keepdim=True)
    v = x.var(dim=axis, keepdim=True, unbiased=False)
    return (x - m) / torch.sqrt(v + eps)
def _scatter_add(tgt, idx, src, axis=0):
    return tgt.clone().index_add_(axis, idx, src)
def _segment_sum(src, seg, n):
    out = torch.zeros((n,) + src.shape[1:], dtype=src.dtype)
    return out.index_add_(0, seg, src)
def _pad(x, pw):
    flat = tuple(v for pair in reversed(pw) for v in pair)
    return torch.nn.functional.pad(x, flat)

kernel_name = 'interleave_layers__linear_kernel_hedgehog__dense_activation_squared_relu__prompt'

def setup_inputs():

    _w = (lambda a: (lambda t: t.to(torch.bfloat16) if t.is_floating_point() else t)(torch.as_tensor(a)))
    def _A_setup():
        B, S, D, H = 1, 2048, 640, 32
        Dh = D // H
        return {
            "x": _w((lambda *s: torch.randn(*s, dtype=torch.bfloat16) * 0.05)(B, S, D)),
            "wqkv": _w((lambda *s: torch.randn(*s, dtype=torch.bfloat16) * 0.2)(D, 3 * D)),
            "w_phi": _w((lambda *s: torch.randn(*s, dtype=torch.bfloat16) * 0.2)(H, Dh, Dh) * (Dh ** -0.5)),
            "wo": _w((lambda *s: torch.randn(*s, dtype=torch.bfloat16) * 0.05)(D, D)),
        }
    _A_in = _A_setup()

    def _B_setup():
        B, S, D, F = 1, 2048, 640, 1536
        return {
            "x": _w((lambda *s: torch.randn(*s, dtype=torch.bfloat16) * 0.05)(B, S, D)),
            "w1": _w((lambda *s: torch.randn(*s, dtype=torch.bfloat16) * 0.05)(D, F)),
            "b1": _w((lambda *s: torch.randn(*s, dtype=torch.bfloat16) * 0.2)(F)),
            "w2": _w((lambda *s: torch.randn(*s, dtype=torch.bfloat16) * 0.05)(F, D)),
            "b2": _w((lambda *s: torch.randn(*s, dtype=torch.bfloat16) * 0.8)(D)),
        }
    _B_in = _B_setup()

    return {
        "A_x": _A_in["x"],
        "A_wqkv": _A_in["wqkv"],
        "A_w_phi": _A_in["w_phi"],
        "A_wo": _A_in["wo"],
        "B_x": _B_in["x"],
        "B_w1": _B_in["w1"],
        "B_b1": _B_in["b1"],
        "B_w2": _B_in["w2"],
        "B_b2": _B_in["b2"],
    }

def reference(A_x, A_wqkv, A_w_phi, A_wo, B_x, B_w1, B_b1, B_w2, B_b2):
    def _A_ref(x, wqkv, w_phi, wo):
        B, S, D = x.shape
        H = 32; Dh = D // H
        qkv = (lambda x, *d: x.permute(*d))((x @ wqkv).reshape(B, S, 3, H, Dh), 2, 0, 3, 1, 4)
        q, k, v = qkv[0], qkv[1], qkv[2]
        pq = torch.einsum("bhsd,hdf->bhsf", q, w_phi)
        pk = torch.einsum("bhsd,hdf->bhsf", k, w_phi)
        phi_q = torch.concatenate([_softmax(pq, axis=-1), _softmax(-pq, axis=-1)], axis=-1)
        phi_k = torch.concatenate([_softmax(pk, axis=-1), _softmax(-pk, axis=-1)], axis=-1)
        kv = torch.einsum("bhsf,bhsd->bhfd", phi_k, v)
        z  = torch.einsum("bhsf->bhf", phi_k)
        num = torch.einsum("bhqf,bhfd->bhqd", phi_q, kv)
        den = torch.einsum("bhqf,bhf->bhq", phi_q, z)[..., None] + 1e-6
        o = num / den
        return (lambda x, *d: x.permute(*d))(o, 0, 2, 1, 3).reshape(B, S, D) @ wo

    def _B_ref(x, w1, b1, w2, b2):
        h = torch.einsum("bsd,df->bsf", x, w1) + b1
        zero = torch.zeros_like(h)
        r = torch.where(h > zero, h, zero)
        h = r * r
        out = torch.einsum("bsf,fd->bsd", h, w2) + b2
        return out

    x = A_x
    x = x + _A_ref(_layernorm(x, axis=-1), A_wqkv, A_w_phi, A_wo)
    x = x + _B_ref(_layernorm(x, axis=-1), B_w1, B_b1, B_w2, B_b2)
    x = x + _A_ref(_layernorm(x, axis=-1), A_wqkv, A_w_phi, A_wo)
    x = x + _B_ref(_layernorm(x, axis=-1), B_w1, B_b1, B_w2, B_b2)
    return x
```

```asm
; @launch grid=(256,1,1) block=(256,1,1) lds=163840
.amdgcn_target "amdgcn-amd-amdhsa--gfx950"
.text
.globl interleave_layers__linear_kernel_hedgehog__dense_activation_squared_relu__prompt_kernel
.p2align 8
.type interleave_layers__linear_kernel_hedgehog__dense_activation_squared_relu__prompt_kernel,@function
interleave_layers__linear_kernel_hedgehog__dense_activation_squared_relu__prompt_kernel:
 s_cmp_ge_u32 s2, 256
 s_cbranch_scc1 Lend
 s_getpc_b64 s[44:45]
Lpc:
 s_load_dwordx16 s[64:79], s[0:1], 0
 s_load_dwordx8 s[80:87], s[0:1], 64
 s_lshr_b32 s49, s2, 3
 v_lshrrev_b32 v44, 6, v0
 v_and_b32 v45, 3, v0
 v_lshl_add_u32 v45, v44, 2, v45
 s_lshl_b32 s46, s49, 4
 v_add_u32 v45, s46, v45
 v_lshlrev_b32 v45, 7, v45
 v_min_u32 v45, Lfast_end-Lpc, v45
 s_mov_b64 exec, 15
 global_load_dword v46, v45, s[44:45]
 s_mov_b64 exec, -1
 v_readfirstlane_b32 s3, v44
 v_and_b32 v47, 63, v0
 v_and_b32 v50, 31, v0
 v_bfe_u32 v51, v0, 5, 1
 s_and_b32 s48, s2, 7
 v_mul_u32_u24 v52, 205, v47
 v_lshrrev_b32 v52, 11, v52
 v_mul_u32_u24 v53, 1120, v52
 v_lshl_add_u32 v53, v47, 4, v53
 s_cmp_lt_u32 s2, 160
 s_cselect_b32 s88, 0, 1073741824
 v_mov_b32 v54, 1073741824
 v_cmp_gt_u32 vcc, 60, v47
 v_add_u32 v53, s88, v53
 s_nop 0
 v_cndmask_b32 v53, v54, v53, vcc
 s_mul_i32 s55, s48, 20
 s_add_u32 s55, s55, s49
 s_and_b32 s56, s55, 7
 s_lshr_b32 s55, s55, 3
 s_lshl_b32 s89, s55, 2
 s_add_u32 s89, s89, s3
 s_mul_i32 s89, s89, 30720
 s_mul_i32 s90, s56, 160
 s_add_u32 s89, s89, s90
 s_lshl_b32 s56, s56, 2
 s_add_u32 s56, s56, s3
 s_mul_i32 s90, s3, 4160
 v_and_b32 v55, 7, v47
 v_lshrrev_b32 v56, 3, v47
 v_mul_u32_u24 v63, 1280, v56
 v_lshl_add_u32 v57, v55, 4, v63
 s_lshl_b32 s93, s48, 5
 s_add_u32 s93, s93, s49
 s_mul_i32 s94, s93, 10240
 s_lshl_b32 s95, s3, 7
 s_add_u32 s94, s94, s95
 s_cmp_lt_u32 s3, 2
 s_cselect_b32 s95, 0, 1073741824
 v_add_u32 v58, s95, v57
 v_and_b32 v59, 19, v50
 v_bfe_u32 v60, v50, 2, 1
 v_lshl_add_u32 v59, v60, 3, v59
 v_bfe_u32 v61, v50, 3, 1
 v_lshl_add_u32 v59, v61, 2, v59
 v_mul_u32_u24 v61, 40, v59
 v_cmp_gt_u32 vcc, 20, v59
 s_lshl_b32 s53, s48, 2
 s_add_u32 s54, s53, s3
 v_cndmask_b32 v61, v54, v61, vcc
 v_lshl_add_u32 v62, v51, 30, v61
 v_lshl_add_u32 v61, v51, 4, v61
 s_mul_i32 s91, s56, 800
 s_waitcnt lgkmcnt(0)
 s_mov_b32 s20, s66
 s_and_b32 s21, s67, 0xffff
 s_mov_b32 s22, 2457600
 s_mov_b32 s23, 0x20000
 s_mov_b32 m0, s90
 s_add_u32 s90, s90, 1040
 buffer_load_dwordx4 v53, s[20:23], s89 offen nt lds
 s_add_u32 s89, s89, 7680
 s_mov_b32 m0, s90
 s_add_u32 s90, s90, 1040
 buffer_load_dwordx4 v53, s[20:23], s89 offen nt lds
 s_add_u32 s89, s89, 7680
 s_mov_b32 m0, s90
 s_add_u32 s90, s90, 1040
 buffer_load_dwordx4 v53, s[20:23], s89 offen nt lds
 s_add_u32 s89, s89, 7680
 s_mov_b32 m0, s90
 s_add_u32 s90, s90, 1040
 buffer_load_dwordx4 v53, s[20:23], s89 offen nt lds
 s_add_u32 s89, s89, 7680
 s_mov_b32 s24, s68
 s_and_b32 s25, s69, 0xffff
 s_mov_b32 s26, 25600
 s_mov_b32 s27, 0x20000
 buffer_load_dwordx4 v[80:83], v61, s[24:27], s91 offen
 buffer_load_dwordx2 v[84:85], v62, s[24:27], s91 offen offset:32
 s_mov_b32 s40, s64
 s_and_b32 s41, s65, 0xffff
 s_mov_b32 s42, 2621440
 s_mov_b32 s43, 0x20000
 buffer_load_dwordx4 v[88:91], v57, s[40:43], s94 offen
 buffer_load_dwordx4 v[92:95], v57, s[40:43], s94 offen offset:512
 buffer_load_dwordx4 v[96:99], v58, s[40:43], s94 offen offset:1024
 s_add_u32 s46, s86, 7782400
 s_addc_u32 s47, s87, 0
 s_load_dword s52, s[46:47], 0
 s_mov_b32 s4, s86
 s_and_b32 s5, s87, 0xffff
 s_mov_b32 s6, 47185920
 s_mov_b32 s7, 0x20000
 s_mov_b32 s8, s82
 s_and_b32 s9, s83, 0xffff
 s_mov_b32 s10, 2621440
 s_mov_b32 s11, 0x20000
 s_mov_b32 s12, s80
 s_and_b32 s13, s81, 0xffff
 s_mov_b32 s14, 1280
 s_mov_b32 s15, 0x20000
 s_mov_b32 s28, s70
 s_and_b32 s29, s71, 0xffff
 s_mov_b32 s30, 819200
 s_mov_b32 s31, 0x20000
 s_mov_b32 s16, s74
 s_and_b32 s17, s75, 0xffff
 s_mov_b32 s18, 1966080
 s_mov_b32 s19, 0x20000
 s_mov_b32 s36, s78
 s_and_b32 s37, s79, 0xffff
 s_mov_b32 s38, 1966080
 s_mov_b32 s39, 0x20000
 s_mov_b32 s32, s76
 s_and_b32 s33, s77, 0xffff
 s_mov_b32 s34, 3072
 s_mov_b32 s35, 0x20000
 v_and_b32 v48, 15, v47
 v_lshrrev_b32 v49, 4, v47
 v_lshlrev_b32 v0, 4, v47
 s_lshr_b32 s50, s2, 6
 s_and_b32 s51, s49, 7
 s_add_u32 s53, s53, s50
 s_lshr_b32 s58, s51, 1
 s_mul_i32 s58, s58, 5
 s_and_b32 s59, s51, 1
 s_mul_i32 s57, s59, 3
 s_add_u32 s57, s57, s58
 s_add_u32 s58, s58, 2
 s_mov_b32 s60, 0x3f80
 s_mov_b32 s61, 0x3f800000
 s_lshr_b32 s80, s93, 1
 s_lshl_b32 s80, s80, 2
 s_add_u32 s80, s80, s3
 s_lshl_b32 s80, s80, 1
 s_add_u32 s80, s80, s59
 s_lshl_b32 s80, s80, 7
 s_add_u32 s80, s80, 24641536
 s_mul_i32 s81, s56, 221184
 s_add_u32 s81, s81, 40108032
 s_lshl_b32 s82, s55, 12
 s_add_u32 s81, s81, s82
 s_mul_i32 s82, s56, 5120
 s_lshl_b32 s83, s55, 8
 s_add_u32 s82, s82, s83
 s_add_u32 s82, s82, 7405568
 v_add_u32 v100, s88, v0
 v_lshl_add_u32 v101, v47, 2, s88
 v_and_b32 v219, 3, v47
 v_bfe_u32 v218, v47, 2, 2
 v_lshl_add_u32 v218, v49, 3, v218
 v_lshlrev_b32 v220, 8, v218
 s_lshl_b32 s95, s3, 6
 v_add_u32 v220, s95, v220
 s_sub_u32 s96, s2, 156
 s_cselect_b32 s88, 1073741824, 0
 s_cselect_b32 s96, 0, s96
 s_mul_i32 s91, s96, 13108
 s_lshr_b32 s91, s91, 16
 s_mul_i32 s92, s91, 5
 s_sub_u32 s92, s96, s92
 s_mul_i32 s89, s91, 13108
 s_lshr_b32 s89, s89, 16
 s_mul_i32 s90, s89, 5
 s_sub_u32 s90, s91, s90
 s_mul_i32 s93, s89, 160
 s_mul_i32 s95, s90, 40
 s_cmp_eq_u32 s90, 4
 s_cselect_b32 s95, 8, s95
 s_cselect_b32 s94, 20, 4
 s_cselect_b32 s96, 40, 10
 s_cselect_b32 s90, 8, 0
 s_mul_i32 s96, s96, s3
 s_add_u32 s93, s93, s95
 s_add_u32 s93, s93, s96
 s_add_u32 s94, s94, s93
 v_mul_u32_u24 v52, s90, v51
 v_add_u32 v52, v52, v49
 s_mul_i32 s93, s93, 1280
 s_mul_i32 s94, s94, 1280
 s_lshl_b32 s95, s92, 8
 s_add_u32 s93, s93, s95
 s_add_u32 s94, s94, s95
 s_sub_u32 s94, s94, 1024
 v_mul_u32_u24 v52, 1280, v52
 v_lshl_add_u32 v52, v48, 4, v52
 v_add_u32 v52, s88, v52
 s_lshl_b32 s95, s3, 11
 s_add_u32 m0, s95, 38912
 s_lshl_b32 s92, s92, 2
 buffer_load_dwordx4 v52, s[28:31], s93 offen nt lds
 buffer_load_dwordx4 v52, s[28:31], s94 offen offset:1024 nt lds
 s_add_u32 s92, s92, s3
 s_mul_i32 s89, s92, 13108
 s_lshr_b32 s89, s89, 16
 s_mul_i32 s96, s89, 5
 s_sub_u32 s96, s92, s96
 s_cmp_eq_u32 s96, 2
 s_cselect_b32 s92, 3, 4
 s_cselect_b32 s95, 32, 8
 s_mov_b32 s85, 102400
 s_cselect_b32 s85, s85, 1024
 v_lshl_add_u32 v212, v219, s92, v220
 v_add_u32 v213, s95, v212
 v_add_u32 v208, s88, v0
 s_lshl_b32 s89, s89, 1
 s_sub_u32 s92, s96, 3
 s_cmp_gt_u32 s96, 2
 s_cselect_b32 s92, s92, s96
 s_addc_u32 s89, s89, 0
 s_mul_i32 s89, s89, 102400
 s_lshl_b32 s92, s92, 11
 s_add_u32 s89, s89, s92
 s_mul_i32 s92, s91, 5120
 s_add_u32 s89, s89, s92
 s_add_u32 s84, s89, 6553600
 s_add_u32 s85, s85, s84
 s_sub_u32 s91, s49, 12
 s_cselect_b32 s88, 1073741824, 0
 s_cselect_b32 s91, 0, s91
 s_lshl_b32 s92, s91, 2
 s_add_u32 s92, s92, s3
 s_mul_i32 s92, s92, 24576
 s_mul_i32 s93, s48, 384
 s_add_u32 s92, s92, s93
 s_mul_i32 s93, s3, 3072
 s_add_u32 m0, s93, 18432
 v_add_u32 v52, 0, v47
 v_mul_u32_u24 v52, 171, v52
 v_lshrrev_b32 v52, 12, v52
 v_mul_u32_u24 v52, 2688, v52
 v_add3_u32 v52, v52, v0, s88
 buffer_load_dwordx4 v52, s[16:19], s92 offen nt lds
 v_add_u32 v52, 64, v47
 v_mul_u32_u24 v52, 171, v52
 v_lshrrev_b32 v52, 12, v52
 v_mul_u32_u24 v52, 2688, v52
 v_add3_u32 v52, v52, v0, s88
 buffer_load_dwordx4 v52, s[16:19], s92 offen offset:1024 nt lds
 v_add_u32 v52, 128, v47
 v_mul_u32_u24 v52, 171, v52
 v_lshrrev_b32 v52, 12, v52
 v_mul_u32_u24 v52, 2688, v52
 v_add3_u32 v52, v52, v0, s88
 buffer_load_dwordx4 v52, s[16:19], s92 offen offset:2048 nt lds
 v_mul_u32_u24 v216, 384, v218
 s_mul_i32 s93, s3, 96
 v_add_u32 v216, s93, v216
 v_lshl_add_u32 v217, v219, 3, v216
 v_lshl_add_u32 v216, v219, 4, v216
 v_add_u32 v210, s88, v0
 v_lshl_add_u32 v211, v47, 2, s88
 s_mul_i32 s78, s54, 221184
 s_mul_i32 s79, s91, 3072
 s_add_u32 s78, s78, s79
 s_add_u32 s78, s78, 40206336
 s_mul_i32 s79, s54, 5120
 s_lshl_b32 s91, s91, 8
 s_add_u32 s79, s79, s91
 s_add_u32 s79, s79, 7569408
 s_cmp_lt_u32 s2, 240
 s_cselect_b32 s88, 0, 1073741824
 s_cselect_b32 s96, s2, 0
 s_mul_i32 s91, s96, 13108
 s_lshr_b32 s91, s91, 16
 s_mul_i32 s92, s91, 5
 s_sub_u32 s92, s96, s92
 s_mul_i32 s89, s91, 21846
 s_lshr_b32 s89, s89, 16
 s_mul_i32 s90, s89, 3
 s_sub_u32 s90, s91, s90
 s_mul_i32 s93, s89, 96
 s_mul_i32 s95, s90, 24
 s_cmp_eq_u32 s90, 1
 s_cselect_b32 s95, 32, s95
 s_cselect_b32 s94, 32, 0
 s_add_u32 s93, s93, s95
 s_lshr_b32 s95, s3, 1
 s_mul_i32 s94, s94, s95
 s_add_u32 s93, s93, s94
 s_lshl_b32 s95, s3, 3
 s_add_u32 s93, s93, s95
 s_add_u32 s94, s93, 4
 v_mov_b32 v52, v49
 s_mul_i32 s93, s93, 1280
 s_mul_i32 s94, s94, 1280
 s_lshl_b32 s95, s92, 8
 s_add_u32 s93, s93, s95
 s_add_u32 s94, s94, s95
 s_sub_u32 s94, s94, 1024
 v_mul_u32_u24 v52, 1280, v52
 v_lshl_add_u32 v52, v48, 4, v52
 v_add_u32 v52, s88, v52
 s_lshl_b32 s95, s3, 11
 s_add_u32 m0, s95, 30720
 s_lshl_b32 s92, s92, 2
 buffer_load_dwordx4 v52, s[36:39], s93 offen nt lds
 buffer_load_dwordx4 v52, s[36:39], s94 offen offset:1024 nt lds
 s_add_u32 s92, s92, s3
 s_mul_i32 s89, s92, 13108
 s_lshr_b32 s89, s89, 16
 s_mul_i32 s96, s89, 5
 s_sub_u32 s96, s92, s96
 s_cmp_eq_u32 s96, 2
 s_cselect_b32 s92, 3, 4
 s_cselect_b32 s95, 32, 8
 s_mov_b32 s87, 884736
 s_cselect_b32 s87, s87, 1024
 v_lshl_add_u32 v214, v219, s92, v220
 v_add_u32 v215, s95, v214
 v_add_u32 v209, s88, v0
 s_lshl_b32 s89, s89, 1
 s_sub_u32 s92, s96, 3
 s_cmp_gt_u32 s96, 2
 s_cselect_b32 s92, s92, s96
 s_addc_u32 s89, s89, 0
 s_mul_i32 s89, s89, 884736
 s_lshl_b32 s92, s92, 11
 s_add_u32 s89, s89, s92
 s_mul_i32 s92, s91, 5120
 s_add_u32 s89, s89, s92
 s_add_u32 s86, s89, 40267776
 s_add_u32 s87, s87, s86
 s_mul_i32 s89, s91, 5462
 s_lshr_b32 s89, s89, 16
 s_mul_i32 s90, s89, 12
 s_sub_u32 s90, s91, s90
 s_mul_i32 s89, s89, 159744
 s_add_u32 s86, s86, s89
 s_add_u32 s87, s87, s89
 v_lshlrev_b32 v52, 7, v47
 buffer_load_dword v222, v52, s[12:15], 0 offen
 v_lshlrev_b32 v52, 12, v49
 s_lshl_b32 s89, s54, 7
 s_add_u32 s89, s89, 7733248
 buffer_load_dword v222, v52, s[4:7], s89 offen sc1
 v_lshrrev_b32 v52, 2, v48
 v_lshl_add_u32 v52, v52, 3, v219
 v_lshlrev_b32 v52, 1, v52
 v_lshlrev_b32 v221, 1, v48
 s_mul_i32 s89, s49, 96
 buffer_load_ushort a250, v52, s[32:35], s89 offen
 buffer_load_ushort a251, v52, s[32:35], s89 offen offset:8
 buffer_load_ushort a252, v221, s[32:35], s89 offen offset:64
 v_lshrrev_b32 v52, 3, v50
 v_and_b32 v53, 3, v50
 v_lshl_add_u32 v52, v52, 2, v53
 v_mul_u32_u24 v60, 10, v60
 v_add_u32 v60, v60, v52
 v_and_b32 v53, 1, v50
 v_lshlrev_b32 v53, 4, v53
 v_lshlrev_b32 v53, v53, s60
 v_lshlrev_b32 v61, 2, v51
 v_subrev_u32 v57, 0, v60
 v_lshrrev_b32 v57, 1, v57
 v_subrev_u32 v58, 0, v52
 v_cmp_gt_u32 vcc, 10, v58
 v_cmp_eq_u32 s[46:47], 0, v51
 s_nop 0
 v_cndmask_b32 v57, 32, v57, vcc
 v_sub_u32 v58, v57, v61
 v_cndmask_b32 v57, 32, v57, s[46:47]
 v_cmp_eq_u32 s[20:21], 0, v58
 v_cmp_eq_u32 s[22:23], 1, v58
 v_cmp_eq_u32 s[24:25], 2, v58
 v_cndmask_b32 v112, 0, v53, s[20:21]
 v_cndmask_b32 v113, 0, v53, s[22:23]
 v_cndmask_b32 v114, 0, v53, s[24:25]
 v_cmp_eq_u32 s[20:21], 3, v58
 v_cmp_eq_u32 s[22:23], 8, v57
 v_cmp_eq_u32 s[24:25], 9, v57
 v_cndmask_b32 v115, 0, v53, s[20:21]
 v_cndmask_b32 v116, 0, v53, s[22:23]
 v_cndmask_b32 v117, 0, v53, s[24:25]
 v_subrev_u32 v57, 10, v60
 v_lshrrev_b32 v57, 1, v57
 v_subrev_u32 v58, 10, v52
 v_cmp_gt_u32 vcc, 6, v58
 v_cmp_eq_u32 s[46:47], 1, v51
 s_nop 0
 v_cndmask_b32 v57, 32, v57, vcc
 v_sub_u32 v58, v57, v61
 v_cndmask_b32 v57, 32, v57, s[46:47]
 v_cmp_eq_u32 s[20:21], 0, v58
 v_cmp_eq_u32 s[22:23], 1, v58
 v_cmp_eq_u32 s[24:25], 2, v58
 v_cndmask_b32 v120, 0, v53, s[20:21]
 v_cndmask_b32 v121, 0, v53, s[22:23]
 v_cndmask_b32 v122, 0, v53, s[24:25]
 v_cmp_eq_u32 s[20:21], 3, v58
 v_cmp_eq_u32 s[22:23], 8, v57
 v_cmp_eq_u32 s[24:25], 9, v57
 v_cndmask_b32 v123, 0, v53, s[20:21]
 v_cndmask_b32 v128, 0, v53, s[22:23]
 v_cndmask_b32 v129, 0, v53, s[24:25]
 v_subrev_u32 v57, 4, v60
 v_lshrrev_b32 v57, 1, v57
 v_subrev_u32 v58, 10, v52
 v_cmp_gt_u32 vcc, 4, v58
 v_cmp_eq_u32 s[46:47], 1, v51
 s_nop 0
 v_cndmask_b32 v57, 32, v57, vcc
 v_sub_u32 v58, v57, v61
 v_cndmask_b32 v57, 32, v57, s[46:47]
 v_cmp_eq_u32 s[20:21], 0, v58
 v_cmp_eq_u32 s[22:23], 1, v58
 v_cmp_eq_u32 s[24:25], 2, v58
 v_cndmask_b32 v124, 0, v53, s[20:21]
 v_cndmask_b32 v125, 0, v53, s[22:23]
 v_cndmask_b32 v126, 0, v53, s[24:25]
 v_cmp_eq_u32 s[20:21], 3, v58
 v_cmp_eq_u32 s[22:23], 8, v57
 v_cmp_eq_u32 s[24:25], 9, v57
 v_cndmask_b32 v127, 0, v53, s[20:21]
 v_cndmask_b32 v130, 0, v53, s[22:23]
 v_cndmask_b32 v131, 0, v53, s[24:25]
 v_mov_b32 v136, 0x3f803f80
 v_mov_b32 v137, 0x3f803f80
 v_mov_b32 v138, 0x3f803f80
 v_mov_b32 v139, 0x3f803f80
 v_lshrrev_b32 v57, 1, v59
 v_mul_u32_u24 v57, 1040, v57
 v_and_b32 v58, 1, v59
 v_mul_u32_u24 v58, 480, v58
 s_mul_i32 s89, s3, 40
 v_add3_u32 v57, v57, v58, s89
 v_mul_u32_u24 v58, 160, v51
 v_add_u32 v59, v57, v58
 v_add_u32 v58, v59, v58
 v_lshl_add_u32 v57, v51, 4, v57
 v_and_b32 v61, 3, v55
 v_lshlrev_b32 v60, 7, v61
 v_lshl_add_u32 v60, v56, 4, v60
 s_lshl_b32 s89, s3, 2
 s_add_u32 s89, s89, 17408
 v_add_u32 v60, s89, v60
 v_cmp_eq_u32 s[20:21], 0, v61
 v_cmp_eq_u32 s[22:23], 2, v61
 v_lshlrev_b32 v102, 2, v50
 s_lshl_b32 s89, s3, 7
 s_add_u32 s89, s89, 17408
 v_add_u32 v103, s89, v102
 v_lshl_add_u32 v102, v51, 30, v102
 v_lshrrev_b32 v61, 4, v47
 v_and_b32 v62, 7, v47
 v_xor_b32 v61, v61, v62
 v_lshrrev_b32 v63, 3, v47
 v_mul_u32_u24 v63, 1280, v63
 v_lshl_add_u32 v16, v61, 4, v63
 v_xor_b32 v61, 4, v61
 v_lshl_add_u32 v17, v61, 4, v63
 v_add_u32 v17, 9216, v17
 v_xor_b32 v61, 4, v61
 v_lshl_add_u32 v18, v61, 4, v63
 v_add_u32 v18, 18432, v18
 v_xor_b32 v61, 4, v61
 v_lshl_add_u32 v19, v61, 4, v63
 v_add_u32 v19, 27648, v19
 s_mul_i32 s44, s54, 81920
 s_lshl_b32 s45, s3, 12
 s_add_u32 s45, s45, 49152
 v_bfe_u32 v61, v50, 1, 3
 v_xor_b32 v61, v61, v51
 v_lshl_add_u32 v63, v50, 7, s45
 v_xor_b32 v62, 0, v61
 v_lshl_add_u32 v20, v62, 4, v63
 v_add_u32 v24, 0x10000, v20
 v_xor_b32 v62, 2, v61
 v_lshl_add_u32 v21, v62, 4, v63
 v_add_u32 v25, 0x10000, v21
 v_xor_b32 v62, 4, v61
 v_lshl_add_u32 v22, v62, 4, v63
 v_add_u32 v26, 0x10000, v22
 v_xor_b32 v62, 6, v61
 v_lshl_add_u32 v23, v62, 4, v63
 v_add_u32 v27, 0x10000, v23
 v_mov_b32 v62, 0
 v_mov_b32 v63, 0
 s_waitcnt vmcnt(16)
 v_mfma_f32_32x32x16_bf16 v[144:159], v[80:83], v[112:115], 0
 s_waitcnt vmcnt(15)
 s_nop 8
 v_mfma_f32_32x32x8_bf16 v[144:159], v[84:85], v[116:117], v[144:159]
 s_barrier
 ds_read2_b64 v[72:75], v57 offset0:40 offset1:41
 ds_read2_b64 v[68:71], v57 offset0:20 offset1:21
 ds_read2_b64 v[64:67], v57 offset0:0 offset1:1
 ds_read_b64 v[76:77], v59 offset:192
 ds_read_b64 v[78:79], v58 offset:32
 s_nop 5
 v_cvt_pk_bf16_f32 v132, v144, v145
 v_cvt_pk_bf16_f32 v133, v146, v147
 v_cvt_pk_bf16_f32 v134, v148, v149
 v_cvt_pk_bf16_f32 v135, v150, v151
 v_cvt_pk_bf16_f32 v61, v152, v153
 v_or_b32 v128, v128, v61
 v_or_b32 v130, v130, v61
 v_cvt_pk_bf16_f32 v61, v154, v155
 v_or_b32 v129, v129, v61
 v_or_b32 v131, v131, v61
 s_waitcnt lgkmcnt(0)
 v_mfma_f32_32x32x16_bf16 v[144:159], v[72:75], v[120:123], 0
 v_mfma_f32_32x32x16_bf16 v[160:175], v[72:75], v[124:127], 0
 v_mfma_f32_32x32x16_bf16 v[144:159], v[68:71], v[132:135], v[144:159]
 v_mfma_f32_32x32x16_bf16 v[160:175], v[64:67], v[132:135], v[160:175]
 s_nop 8
 v_mfma_f32_32x32x8_bf16 v[144:159], v[76:77], v[128:129], v[144:159]
 v_mfma_f32_32x32x8_bf16 v[160:175], v[78:79], v[130:131], v[160:175]
 s_nop 10
 v_cvt_pk_bf16_f32 v176, v144, v145
 v_cvt_pk_bf16_f32 v177, v146, v147
 v_cvt_pk_bf16_f32 v178, v148, v149
 v_cvt_pk_bf16_f32 v179, v150, v151
 buffer_store_dwordx4 v[176:179], v100, s[4:7], s81 offen sc1
 v_cvt_pk_bf16_f32 v180, v152, v153
 v_cvt_pk_bf16_f32 v181, v154, v155
 v_cvt_pk_bf16_f32 v182, v156, v157
 v_cvt_pk_bf16_f32 v183, v158, v159
 buffer_store_dwordx4 v[180:183], v100, s[4:7], s81 offen offset:2048 sc1
 v_mfma_f32_32x32x16_bf16 v[144:159], v[136:139], v[176:179], 0
 v_mfma_f32_32x32x16_bf16 v[144:159], v[136:139], v[180:183], v[144:159]
 v_cvt_pk_bf16_f32 v184, v160, v161
 v_cvt_pk_bf16_f32 v185, v162, v163
 v_cvt_pk_bf16_f32 v186, v164, v165
 v_cvt_pk_bf16_f32 v187, v166, v167
 buffer_store_dwordx4 v[184:187], v100, s[4:7], s81 offen offset:1024 sc1
 v_cvt_pk_bf16_f32 v188, v168, v169
 v_cvt_pk_bf16_f32 v189, v170, v171
 v_cvt_pk_bf16_f32 v190, v172, v173
 v_cvt_pk_bf16_f32 v191, v174, v175
 buffer_store_dwordx4 v[188:191], v100, s[4:7], s81 offen offset:3072 sc1
 v_mfma_f32_32x32x16_bf16 v[160:175], v[136:139], v[184:187], 0
 v_mfma_f32_32x32x16_bf16 v[160:175], v[136:139], v[188:191], v[160:175]
 s_waitcnt vmcnt(18)
 v_dot2c_f32_bf16 v62, v136, v88
 v_dot2c_f32_bf16 v63, v88, v88
 v_dot2c_f32_bf16 v62, v136, v89
 v_dot2c_f32_bf16 v63, v89, v89
 v_dot2c_f32_bf16 v62, v136, v90
 v_dot2c_f32_bf16 v63, v90, v90
 v_dot2c_f32_bf16 v62, v136, v91
 v_dot2c_f32_bf16 v63, v91, v91
 s_waitcnt vmcnt(17)
 v_dot2c_f32_bf16 v62, v136, v92
 v_dot2c_f32_bf16 v63, v92, v92
 v_dot2c_f32_bf16 v62, v136, v93
 v_dot2c_f32_bf16 v63, v93, v93
 v_dot2c_f32_bf16 v62, v136, v94
 v_dot2c_f32_bf16 v63, v94, v94
 v_dot2c_f32_bf16 v62, v136, v95
 v_dot2c_f32_bf16 v63, v95, v95
 s_waitcnt vmcnt(16)
 v_dot2c_f32_bf16 v62, v136, v96
 v_dot2c_f32_bf16 v63, v96, v96
 v_dot2c_f32_bf16 v62, v136, v97
 v_dot2c_f32_bf16 v63, v97, v97
 v_dot2c_f32_bf16 v62, v136, v98
 v_dot2c_f32_bf16 v63, v98, v98
 v_dot2c_f32_bf16 v62, v136, v99
 v_dot2c_f32_bf16 v63, v99, v99
 v_cmp_eq_u32 vcc, 1, v51
 s_nop 1
 v_cndmask_b32 v55, v144, v160, vcc
 buffer_store_dword v55, v101, s[4:7], s82 offen sc1
 v_add_f32_dpp v62, v62, v62 quad_perm:[1,0,3,2] row_mask:0xf bank_mask:0xf
 v_add_f32_dpp v63, v63, v63 quad_perm:[1,0,3,2] row_mask:0xf bank_mask:0xf
 s_nop 0
 v_add_f32_dpp v62, v62, v62 quad_perm:[2,3,0,1] row_mask:0xf bank_mask:0xf
 v_add_f32_dpp v63, v63, v63 quad_perm:[2,3,0,1] row_mask:0xf bank_mask:0xf
 s_nop 0
 v_add_f32_dpp v62, v62, v62 row_half_mirror row_mask:0xf bank_mask:0xf
 v_add_f32_dpp v63, v63, v63 row_half_mirror row_mask:0xf bank_mask:0xf
 v_cndmask_b32 v62, 0, v62, s[20:21]
 v_cndmask_b32 v62, v62, v63, s[22:23]
 ds_write_b32 v60, v62
 s_waitcnt vmcnt(15)
 s_waitcnt lgkmcnt(0)
 s_barrier
 ds_read_b32 v62, v103
 ds_read_b64_tr_b16 v[64:65], v212 offset:38912
 ds_read_b64_tr_b16 v[66:67], v212 offset:39936
 ds_read_b64_tr_b16 v[68:69], v213 offset:38912
 ds_read_b64_tr_b16 v[70:71], v213 offset:39936
 s_waitcnt lgkmcnt(4)
 buffer_store_dword v62, v102, s[4:7], s80 offen sc1
 s_waitcnt lgkmcnt(2)
 buffer_store_dwordx4 v[64:67], v208, s[4:7], s84 offen sc1
 s_waitcnt lgkmcnt(0)
 buffer_store_dwordx4 v[68:71], v208, s[4:7], s85 offen sc1
 s_add_u32 s46, s44, 0
 s_add_u32 m0, s45, 0
 s_nop 0
 buffer_load_dwordx4 v16, s[40:43], s46 offen lds
 s_add_u32 m0, s45, 0
 s_nop 0
 buffer_load_dwordx4 v17, s[40:43], s46 offen offset:1024 lds
 s_add_u32 m0, s45, 0
 s_nop 0
 buffer_load_dwordx4 v18, s[40:43], s46 offen offset:2048 lds
 s_add_u32 m0, s45, 0
 s_nop 0
 buffer_load_dwordx4 v19, s[40:43], s46 offen offset:3072 lds
 s_add_u32 s46, s44, 40960
 s_add_u32 m0, s45, 16384
 s_nop 0
 buffer_load_dwordx4 v16, s[40:43], s46 offen lds
 s_add_u32 m0, s45, 16384
 s_nop 0
 buffer_load_dwordx4 v17, s[40:43], s46 offen offset:1024 lds
 s_add_u32 m0, s45, 16384
 s_nop 0
 buffer_load_dwordx4 v18, s[40:43], s46 offen offset:2048 lds
 s_add_u32 m0, s45, 16384
 s_nop 0
 buffer_load_dwordx4 v19, s[40:43], s46 offen offset:3072 lds
 s_add_u32 s46, s44, 128
 s_add_u32 m0, s45, 32768
 s_nop 0
 buffer_load_dwordx4 v16, s[40:43], s46 offen lds
 s_add_u32 m0, s45, 32768
 s_nop 0
 buffer_load_dwordx4 v17, s[40:43], s46 offen offset:1024 lds
 s_add_u32 m0, s45, 32768
 s_nop 0
 buffer_load_dwordx4 v18, s[40:43], s46 offen offset:2048 lds
 s_add_u32 m0, s45, 32768
 s_nop 0
 buffer_load_dwordx4 v19, s[40:43], s46 offen offset:3072 lds
 s_getreg_b32 s97, hwreg(HW_REG_XCC_ID, 0, 4)
 s_add_u32 s56, s52, 11
 v_mov_b32 v56, s56
 v_mov_b32 v57, s97
 v_mov_b32 v58, s56
 v_mov_b32 v59, s97
 s_lshl_b32 s89, s2, 7
 s_add_u32 s89, s89, 7749632
 s_cmp_eq_u32 s3, 0
 s_cselect_b32 s90, 0, 1073741824
 v_add_u32 v55, s90, v0
 s_waitcnt vmcnt(12)
 s_barrier
 s_mov_b64 exec, 0xff
 buffer_store_dwordx4 v[56:59], v55, s[4:7], s89 offen sc1
 s_mov_b64 exec, -1
 ds_read_b64_tr_b16 v[184:185], v216 offset:18432
 ds_read_b64_tr_b16 v[186:187], v216 offset:19968
 ds_read_b64_tr_b16 v[188:189], v216 offset:18440
 ds_read_b64_tr_b16 v[190:191], v216 offset:19976
 ds_read_b64_tr_b16 v[192:193], v217 offset:18496
 ds_read_b64_tr_b16 v[194:195], v217 offset:20032
 ds_read_b64_tr_b16 v[196:197], v214 offset:30720
 ds_read_b64_tr_b16 v[198:199], v214 offset:31744
 ds_read_b64_tr_b16 v[200:201], v215 offset:30720
 ds_read_b64_tr_b16 v[202:203], v215 offset:31744
 s_waitcnt lgkmcnt(8)
 v_mfma_f32_16x16x32_bf16 v[144:147], v[136:139], v[184:187], 0
 s_waitcnt lgkmcnt(6)
 v_mfma_f32_16x16x32_bf16 v[148:151], v[136:139], v[188:191], 0
 s_waitcnt lgkmcnt(4)
 v_mfma_f32_16x16x32_bf16 v[152:155], v[136:139], v[192:195], 0
 v_cmp_eq_u32 vcc, 1, v49
 v_cmp_eq_u32 s[20:21], 2, v49
 s_waitcnt lgkmcnt(0)
 s_barrier
 s_nop 1
 v_cndmask_b32 v204, v144, v148, vcc
 s_nop 0
 v_cndmask_b32 v204, v204, v152, s[20:21]
 s_waitcnt vmcnt(1)
 buffer_store_dwordx4 v[184:187], v210, s[4:7], s78 offen sc1
 buffer_store_dwordx4 v[188:191], v210, s[4:7], s78 offen offset:1024 sc1
 buffer_store_dwordx4 v[192:195], v210, s[4:7], s78 offen offset:2048 sc1
 buffer_store_dwordx4 v[196:199], v209, s[4:7], s86 offen sc1
 buffer_store_dwordx4 v[200:203], v209, s[4:7], s87 offen sc1
 buffer_store_dword v204, v211, s[4:7], s79 offen sc1
 ds_read_b128 a[0:3], v20
 ds_read_b128 a[8:11], v21
 ds_read_b128 a[16:19], v22
 ds_read_b128 a[24:27], v23
 ds_read_b128 a[4:7], v20 offset:16384
 ds_read_b128 a[12:15], v21 offset:16384
 ds_read_b128 a[20:23], v22 offset:16384
 ds_read_b128 a[28:31], v23 offset:16384
 ds_read_b128 a[32:35], v20 offset:32768
 ds_read_b128 a[40:43], v21 offset:32768
 ds_read_b128 a[48:51], v22 offset:32768
 ds_read_b128 a[56:59], v23 offset:32768
 s_waitcnt lgkmcnt(0)
 s_add_u32 s46, s44, 41088
 s_add_u32 m0, s45, 0
 s_nop 0
 buffer_load_dwordx4 v16, s[40:43], s46 offen lds
 s_add_u32 m0, s45, 0
 s_nop 0
 buffer_load_dwordx4 v17, s[40:43], s46 offen offset:1024 lds
 s_add_u32 m0, s45, 0
 s_nop 0
 buffer_load_dwordx4 v18, s[40:43], s46 offen offset:2048 lds
 s_add_u32 m0, s45, 0
 s_nop 0
 buffer_load_dwordx4 v19, s[40:43], s46 offen offset:3072 lds
 s_add_u32 s46, s44, 256
 s_add_u32 m0, s45, 16384
 s_nop 0
 buffer_load_dwordx4 v16, s[40:43], s46 offen lds
 s_add_u32 m0, s45, 16384
 s_nop 0
 buffer_load_dwordx4 v17, s[40:43], s46 offen offset:1024 lds
 s_add_u32 m0, s45, 16384
 s_nop 0
 buffer_load_dwordx4 v18, s[40:43], s46 offen offset:2048 lds
 s_add_u32 m0, s45, 16384
 s_nop 0
 buffer_load_dwordx4 v19, s[40:43], s46 offen offset:3072 lds
 s_add_u32 s46, s44, 41216
 s_add_u32 m0, s45, 32768
 s_nop 0
 buffer_load_dwordx4 v16, s[40:43], s46 offen lds
 s_add_u32 m0, s45, 32768
 s_nop 0
 buffer_load_dwordx4 v17, s[40:43], s46 offen offset:1024 lds
 s_add_u32 m0, s45, 32768
 s_nop 0
 buffer_load_dwordx4 v18, s[40:43], s46 offen offset:2048 lds
 s_add_u32 m0, s45, 32768
 s_nop 0
 buffer_load_dwordx4 v19, s[40:43], s46 offen offset:3072 lds
 s_add_u32 s46, s44, 384
 s_add_u32 m0, s45, 49152
 s_nop 0
 buffer_load_dwordx4 v16, s[40:43], s46 offen lds
 s_add_u32 m0, s45, 49152
 s_nop 0
 buffer_load_dwordx4 v17, s[40:43], s46 offen offset:1024 lds
 s_add_u32 m0, s45, 49152
 s_nop 0
 buffer_load_dwordx4 v18, s[40:43], s46 offen offset:2048 lds
 s_add_u32 m0, s45, 49152
 s_nop 0
 buffer_load_dwordx4 v19, s[40:43], s46 offen offset:3072 lds
 s_add_u32 s46, s44, 41344
 s_add_u32 m0, s45, 65536
 s_nop 0
 buffer_load_dwordx4 v16, s[40:43], s46 offen lds
 s_add_u32 m0, s45, 65536
 s_nop 0
 buffer_load_dwordx4 v17, s[40:43], s46 offen offset:1024 lds
 s_add_u32 m0, s45, 65536
 s_nop 0
 buffer_load_dwordx4 v18, s[40:43], s46 offen offset:2048 lds
 s_add_u32 m0, s45, 65536
 s_nop 0
 buffer_load_dwordx4 v19, s[40:43], s46 offen offset:3072 lds
 s_add_u32 s46, s44, 512
 s_add_u32 m0, s45, 81920
 s_nop 0
 buffer_load_dwordx4 v16, s[40:43], s46 offen lds
 s_add_u32 m0, s45, 81920
 s_nop 0
 buffer_load_dwordx4 v17, s[40:43], s46 offen offset:1024 lds
 s_add_u32 m0, s45, 81920
 s_nop 0
 buffer_load_dwordx4 v18, s[40:43], s46 offen offset:2048 lds
 s_add_u32 m0, s45, 81920
 s_nop 0
 buffer_load_dwordx4 v19, s[40:43], s46 offen offset:3072 lds
 s_add_u32 s46, s44, 41472
 s_add_u32 m0, s45, 98304
 s_nop 0
 buffer_load_dwordx4 v16, s[40:43], s46 offen lds
 s_add_u32 m0, s45, 98304
 s_nop 0
 buffer_load_dwordx4 v17, s[40:43], s46 offen offset:1024 lds
 s_add_u32 m0, s45, 98304
 s_nop 0
 buffer_load_dwordx4 v18, s[40:43], s46 offen offset:2048 lds
 s_add_u32 m0, s45, 98304
 s_nop 0
 buffer_load_dwordx4 v19, s[40:43], s46 offen offset:3072 lds
 v_add_u32 v1, 0x10000, v0
 v_add_u32 v2, 0x20000, v0
 s_mul_i32 s91, s3, 5120
 v_add_u32 v3, s91, v2
 s_xor_b32 s91, s3, 2
 s_mul_i32 s91, s91, 5120
 v_add_u32 v4, s91, v2
 s_and_b32 s91, s3, 2
 s_mul_i32 s91, s91, 5120
 s_and_b32 s92, s3, 1
 s_lshl_b32 s92, s92, 7
 s_add_u32 s91, s91, s92
 v_and_b32 v52, 0xfffffb7f, v2
 v_add_u32 v52, s91, v52
 v_bfe_u32 v60, v47, 3, 1
 v_lshl_add_u32 v5, v60, 11, v52
 v_lshl_add_u32 v6, v60, 3, v52
 v_and_b32 v52, 1, v49
 v_lshlrev_b32 v60, 4, v48
 v_mul_u32_u24 v7, 49152, v52
 v_lshl_add_u32 v61, v51, 8, v60
 v_add_u32 v7, v7, v61
 v_mul_u32_u24 v8, 20480, v52
 v_add_u32 v8, v8, v60
 v_lshl_add_u32 v8, v51, 8, v8
 v_mul_u32_u24 v9, 20480, v49
 v_add_u32 v9, v9, v60
 v_subrev_u32 v60, 8, v50
 v_cmp_lt_u32 vcc, 27, v50
 s_nop 1
 v_subb_co_u32 v60, vcc, v60, 0, vcc
 v_cmp_gt_u32 vcc, 22, v60
 v_mul_u32_u24 v62, 22, v51
 s_nop 0
 v_cndmask_b32 v61, 0, v60, vcc
 v_add_lshl_u32 v11, v61, v62, 4
 v_cmp_ne_u32 s[20:21], 27, v50
 s_and_b64 vcc, vcc, s[20:21]
 v_cndmask_b32 v10, v54, v11, vcc
 v_bfe_u32 v61, v50, 2, 1
 v_cmp_eq_u32 vcc, v61, v51
 v_bfe_u32 v62, v50, 1, 1
 v_lshrrev_b32 v60, 3, v50
 v_cndmask_b32 v61, 0, v53, vcc
 v_lshl_add_u32 v62, v60, 1, v62
 v_cmp_eq_u32 s[20:21], 0, v62
 v_cmp_eq_u32 s[22:23], 1, v62
 v_cmp_eq_u32 s[24:25], 2, v62
 v_cmp_eq_u32 s[26:27], 3, v62
 v_cndmask_b32 v36, 0, v61, s[20:21]
 v_cndmask_b32 v37, 0, v61, s[22:23]
 v_cndmask_b32 v38, 0, v61, s[24:25]
 v_cndmask_b32 v39, 0, v61, s[26:27]
 v_cmp_eq_u32 s[20:21], 4, v62
 v_cmp_eq_u32 s[22:23], 5, v62
 v_cmp_eq_u32 s[24:25], 6, v62
 v_cmp_eq_u32 s[26:27], 7, v62
 v_cndmask_b32 v40, 0, v61, s[20:21]
 v_cndmask_b32 v41, 0, v61, s[22:23]
 v_cndmask_b32 v42, 0, v61, s[24:25]
 v_cndmask_b32 v43, 0, v61, s[26:27]
 s_lshr_b32 s91, s49, 2
 s_lshl_b32 s92, s3, 3
 s_add_u32 s92, s92, s91
 v_min_u32 v52, 4, v48
 v_lshl_add_u32 v53, v52, 5, s92
 v_mul_u32_u24 v60, 205, v53
 v_lshrrev_b32 v60, 12, v60
 v_mul_u32_u24 v60, 159, v60
 v_lshlrev_b32 v53, 3, v53
 v_sub_u32 v53, v53, v60
 s_sub_u32 s93, s57, s59
 v_and_b32 v60, 1, v47
 v_lshl_add_u32 v60, v60, 1, s93
 v_lshrrev_b32 v60, 2, v60
 v_lshrrev_b32 v61, 1, v48
 v_min_u32 v61, 4, v61
 s_mul_i32 s93, s3, 25
 s_add_u32 s93, s93, 156
 v_mul_u32_u24 v61, 5, v61
 v_add3_u32 v61, v61, v60, s93
 v_cmp_eq_u32 vcc, 3, v49
 v_cmp_eq_u32 s[20:21], 1, v51
 v_lshl_add_u32 v62, v50, 3, s48
 v_cndmask_b32 v53, v53, v61, vcc
 v_cndmask_b32 v53, v62, v53, s[20:21]
 v_lshlrev_b32 v14, 7, v53
 s_mul_i32 s92, s3, 40
 s_add_u32 s92, s92, s91
 s_add_u32 s92, s92, 96
 v_lshl_add_u32 v52, v52, 3, s92
 v_lshrrev_b32 v61, 1, v50
 v_min_u32 v61, 11, v61
 s_mul_i32 s93, s3, 60
 v_mul_u32_u24 v61, 5, v61
 v_add3_u32 v61, v61, v60, s93
 v_cndmask_b32 v52, v52, v61, s[20:21]
 s_lshl_b32 s92, s54, 3
 v_and_or_b32 v61, v47, 7, s92
 v_cmp_eq_u32 vcc, 1, v49
 s_nop 1
 v_cndmask_b32 v52, v52, v61, vcc
 v_lshlrev_b32 v205, 7, v52
 s_mul_i32 s90, s53, 81920
 s_lshl_b32 s91, s58, 1
 s_add_u32 s91, s91, s59
 s_mul_i32 s62, s3, 10240
 v_bfe_u32 v52, v0, 4, 3
 v_mul_u32_u24 v52, 1280, v52
 v_bfe_u32 v54, v0, 7, 1
 v_lshl_add_u32 v52, v54, 6, v52
 v_bfe_u32 v54, v0, 8, 2
 v_lshl_add_u32 v52, v54, 4, v52
 v_bfe_u32 v53, v0, 4, 3
 v_mul_u32_u24 v53, 1280, v53
 v_bfe_u32 v54, v0, 7, 1
 v_lshl_add_u32 v53, v54, 2, v53
 v_bfe_u32 v54, v0, 8, 2
 v_lshl_add_u32 v53, v54, 3, v53
 s_add_u32 s90, s90, s62
 s_lshl_b32 s91, s91, 5
 s_add_u32 s91, s91, s90
 s_lshl_b32 s62, s57, 6
 s_add_u32 s90, s90, s62
 buffer_load_dwordx4 v[28:31], v52, s[40:43], s90 offen
 buffer_load_dword v128, v53, s[40:43], s91 offen
 s_add_u32 s90, s90, 40960
 s_add_u32 s91, s91, 40960
 buffer_load_dwordx4 v[32:35], v52, s[40:43], s90 offen
 buffer_load_dword v129, v53, s[40:43], s91 offen
 s_mov_b32 s89, 7749632
 s_mov_b32 s55, 0
Lpoll_1:
 buffer_load_dwordx2 v[12:13], v14, s[4:7], s89 offen sc1
 s_add_u32 s55, s55, 1
 s_cmp_gt_u32 s55, 0x80000
 s_cbranch_scc1 Lend
 s_waitcnt vmcnt(0)
 v_cmp_ne_u32 vcc, s56, v12
 s_cbranch_vccnz Lpoll_1
 v_cmp_ne_u32 vcc, s97, v13
 s_waitcnt lgkmcnt(0)
 s_cmp_lg_u32 vcc_lo, 0
 s_cbranch_scc1 Lslow
 s_mul_i32 s16, s54, 81920
 s_add_u32 s16, s16, 0
 s_lshl_b32 s17, s54, 12
 s_add_u32 s17, s17, 24641536
 s_mul_i32 s33, s49, 221184
 s_add_u32 s33, s33, 40108032
 s_lshl_b32 s34, s3, 12
 s_add_u32 s33, s33, s34
 s_mov_b32 m0, s34
 s_nop 0
 buffer_load_dwordx4 v0, s[4:7], s33 offen sc1  lds
 s_mov_b32 m0, s34
 s_nop 0
 buffer_load_dwordx4 v0, s[4:7], s33 offen offset:1024 sc1  lds
 s_mov_b32 m0, s34
 s_nop 0
 buffer_load_dwordx4 v0, s[4:7], s33 offen offset:2048 sc1  lds
 s_mov_b32 m0, s34
 s_nop 0
 buffer_load_dwordx4 v0, s[4:7], s33 offen offset:3072 sc1  lds
 s_add_u32 s33, s33, 16384
 s_add_u32 s34, s34, 16384
 s_mov_b32 m0, s34
 s_nop 0
 buffer_load_dwordx4 v0, s[4:7], s33 offen sc1  lds
 s_mov_b32 m0, s34
 s_nop 0
 buffer_load_dwordx4 v0, s[4:7], s33 offen offset:1024 sc1  lds
 s_mov_b32 m0, s34
 s_nop 0
 buffer_load_dwordx4 v0, s[4:7], s33 offen offset:2048 sc1  lds
 s_mov_b32 m0, s34
 s_nop 0
 buffer_load_dwordx4 v0, s[4:7], s33 offen offset:3072 sc1  lds
 s_add_u32 s33, s33, 16384
 s_add_u32 s34, s34, 16384
 ds_read_b128 a[36:39], v20
 ds_read_b128 a[44:47], v21
 ds_read_b128 a[52:55], v22
 ds_read_b128 a[60:63], v23
 ds_read_b128 a[64:67], v20 offset:16384
 ds_read_b128 a[72:75], v21 offset:16384
 ds_read_b128 a[80:83], v22 offset:16384
 ds_read_b128 a[88:91], v23 offset:16384
 ds_read_b128 a[68:71], v20 offset:32768
 ds_read_b128 a[76:79], v21 offset:32768
 ds_read_b128 a[84:87], v22 offset:32768
 ds_read_b128 a[92:95], v23 offset:32768
 ds_read_b128 a[96:99], v20 offset:49152
 ds_read_b128 a[104:107], v21 offset:49152
 ds_read_b128 a[112:115], v22 offset:49152
 ds_read_b128 a[120:123], v23 offset:49152
 ds_read_b128 a[100:103], v24
 ds_read_b128 a[108:111], v25
 ds_read_b128 a[116:119], v26
 ds_read_b128 a[124:127], v27
 ds_read_b128 a[128:131], v24 offset:16384
 ds_read_b128 a[136:139], v25 offset:16384
 ds_read_b128 a[144:147], v26 offset:16384
 ds_read_b128 a[152:155], v27 offset:16384
 ds_read_b128 a[132:135], v24 offset:32768
 ds_read_b128 a[140:143], v25 offset:32768
 ds_read_b128 a[148:151], v26 offset:32768
 ds_read_b128 a[156:159], v27 offset:32768
 s_mul_i32 s18, s51, 102400
 s_mul_i32 s19, s3, 25600
 s_add_u32 s18, s18, s19
 s_add_u32 s18, s18, 6553600
 s_mul_i32 s20, s54, 196608
 s_add_u32 s20, s20, 18350080
 s_mul_i32 s21, s50, 5120
 s_add_u32 s20, s20, s21
 s_lshr_b32 s22, s51, 1
 s_lshl_b32 s22, s22, 5
 s_add_u32 s22, s22, s59
 s_lshl_b32 s22, s22, 3
 s_add_u32 s22, s22, s20
 s_add_u32 s22, s22, 4096
 s_lshl_b32 s21, s51, 9
 s_add_u32 s20, s20, s21
 s_add_u32 s21, s20, 40960
 s_lshl_b32 s23, s54, 7
 s_add_u32 s23, s23, 7737344
 s_lshl_b32 s24, s49, 2
 s_add_u32 s23, s23, s24
 s_add_u32 s24, s24, s3
 s_mul_i32 s24, s24, 6144
 s_add_u32 s24, s24, 8388608
 s_xor_b32 s25, s48, 1
 s_mul_i32 s25, s25, 768
 s_add_u32 s25, s25, s24
 s_xor_b32 s26, s48, 2
 s_mul_i32 s26, s26, 768
 s_add_u32 s26, s26, s24
 s_xor_b32 s27, s48, 3
 s_mul_i32 s27, s27, 768
 s_add_u32 s27, s27, s24
 s_xor_b32 s28, s48, 4
 s_mul_i32 s28, s28, 768
 s_add_u32 s28, s28, s24
 s_xor_b32 s29, s48, 5
 s_mul_i32 s29, s29, 768
 s_add_u32 s29, s29, s24
 s_xor_b32 s30, s48, 6
 s_mul_i32 s30, s30, 768
 s_add_u32 s30, s30, s24
 s_xor_b32 s31, s48, 7
 s_mul_i32 s31, s31, 768
 s_add_u32 s31, s31, s24
 s_mul_i32 s32, s48, 768
 s_add_u32 s24, s24, s32
 s_waitcnt lgkmcnt(0)
 s_add_u32 s46, s44, 640
 s_add_u32 m0, s45, 32768
 s_nop 0
 buffer_load_dwordx4 v16, s[40:43], s46 offen lds
 s_add_u32 m0, s45, 32768
 s_nop 0
 buffer_load_dwordx4 v17, s[40:43], s46 offen offset:1024 lds
 s_add_u32 m0, s45, 32768
 s_nop 0
 buffer_load_dwordx4 v18, s[40:43], s46 offen offset:2048 lds
 s_add_u32 m0, s45, 32768
 s_nop 0
 buffer_load_dwordx4 v19, s[40:43], s46 offen offset:3072 lds
 s_waitcnt vmcnt(8)
 s_barrier
 ds_read_b128 v[224:227], v0
 ds_read_b128 v[228:231], v0 offset:1024
 ds_read_b128 v[232:235], v0 offset:2048
 ds_read_b128 v[236:239], v0 offset:3072
 ds_read_b128 v[240:243], v0 offset:4096
 s_waitcnt lgkmcnt(4)
 v_mfma_f32_32x32x16_bf16 v[44:59], v[224:227], a[0:3], 0
 s_mov_b32 m0, s34
 s_nop 0
 buffer_load_dwordx4 v0, s[4:7], s33 offen sc1  lds
 ds_read_b128 v[244:247], v0 offset:5120
 s_add_u32 s56, s52, 12
 v_mov_b32 v12, s56
 v_mov_b32 v13, s56
 v_mov_b32 v14, s56
 v_mfma_f32_32x32x16_bf16 v[60:75], v[224:227], a[4:7], 0
 s_add_u32 s46, s44, 41600
 s_add_u32 m0, s45, 49152
 s_nop 0
 buffer_load_dwordx4 v16, s[40:43], s46 offen lds
 v_mov_b32 v15, s56
 s_lshl_b32 s39, s2, 7
 s_add_u32 s39, s39, 7798784
 s_cmp_eq_u32 s3, 0
 s_cselect_b32 s36, 0, 1073741824
 s_waitcnt lgkmcnt(4)
 v_mfma_f32_32x32x16_bf16 v[76:91], v[228:231], a[0:3], 0
 ds_read_b128 v[248:251], v0 offset:6144
 v_add_u32 v166, s36, v0
 s_mov_b64 exec, 0xff
 buffer_store_dwordx4 v[12:15], v166, s[4:7], s39 offen sc1
 s_mov_b64 exec, -1
 s_mov_b32 s39, 7798784
 s_mul_i32 s47, s51, 884736
 v_mfma_f32_32x32x16_bf16 v[92:107], v[228:231], a[4:7], 0
 s_add_u32 m0, s45, 49152
 s_nop 0
 buffer_load_dwordx4 v17, s[40:43], s46 offen offset:1024 lds
 s_mul_i32 s36, s3, 221184
 s_add_u32 s47, s47, s36
 s_add_u32 s47, s47, 40288256
 s_waitcnt lgkmcnt(4)
 v_mfma_f32_32x32x16_bf16 v[44:59], v[232:235], a[8:11], v[44:59]
 ds_read_b128 v[252:255], v0 offset:7168
 v_mfma_f32_32x32x16_bf16 v[60:75], v[232:235], a[12:15], v[60:75]
 s_add_u32 m0, s45, 49152
 s_nop 0
 buffer_load_dwordx4 v18, s[40:43], s46 offen offset:2048 lds
 s_waitcnt lgkmcnt(4)
 v_mfma_f32_32x32x16_bf16 v[76:91], v[236:239], a[8:11], v[76:91]
 ds_read_b128 v[224:227], v0 offset:8192
 v_mfma_f32_32x32x16_bf16 v[92:107], v[236:239], a[12:15], v[92:107]
 s_add_u32 m0, s45, 49152
 s_nop 0
 buffer_load_dwordx4 v19, s[40:43], s46 offen offset:3072 lds
 s_waitcnt lgkmcnt(4)
 v_mfma_f32_32x32x16_bf16 v[44:59], v[240:243], a[16:19], v[44:59]
 s_mov_b32 m0, s34
 s_nop 0
 buffer_load_dwordx4 v0, s[4:7], s33 offen offset:1024 sc1  lds
 ds_read_b128 v[228:231], v0 offset:9216
 v_mfma_f32_32x32x16_bf16 v[60:75], v[240:243], a[20:23], v[60:75]
 s_waitcnt lgkmcnt(4)
 v_mfma_f32_32x32x16_bf16 v[76:91], v[244:247], a[16:19], v[76:91]
 ds_read_b128 v[232:235], v0 offset:10240
 v_mfma_f32_32x32x16_bf16 v[92:107], v[244:247], a[20:23], v[92:107]
 s_waitcnt lgkmcnt(4)
 v_mfma_f32_32x32x16_bf16 v[44:59], v[248:251], a[24:27], v[44:59]
 ds_read_b128 v[236:239], v0 offset:11264
 v_mfma_f32_32x32x16_bf16 v[60:75], v[248:251], a[28:31], v[60:75]
 s_waitcnt vmcnt(7)
 ds_read_b128 a[160:163], v20 offset:32768
 s_add_u32 s46, s44, 768
 s_add_u32 m0, s45, 65536
 s_nop 0
 buffer_load_dwordx4 v16, s[40:43], s46 offen lds
 s_waitcnt lgkmcnt(5)
 v_mfma_f32_32x32x16_bf16 v[76:91], v[252:255], a[24:27], v[76:91]
 ds_read_b128 a[168:171], v21 offset:32768
 ds_read_b128 v[240:243], v0 offset:12288
 v_mfma_f32_32x32x16_bf16 v[92:107], v[252:255], a[28:31], v[92:107]
 ds_read_b128 a[176:179], v22 offset:32768
 s_add_u32 m0, s45, 65536
 s_nop 0
 buffer_load_dwordx4 v17, s[40:43], s46 offen offset:1024 lds
 s_waitcnt lgkmcnt(7)
 v_mfma_f32_32x32x16_bf16 v[44:59], v[224:227], a[32:35], v[44:59]
 s_mov_b32 m0, s34
 s_nop 0
 buffer_load_dwordx4 v0, s[4:7], s33 offen offset:2048 sc1  lds
 ds_read_b128 a[184:187], v23 offset:32768
 ds_read_b128 v[244:247], v0 offset:13312
 v_mfma_f32_32x32x16_bf16 v[60:75], v[224:227], a[36:39], v[60:75]
 s_add_u32 m0, s45, 65536
 s_nop 0
 buffer_load_dwordx4 v18, s[40:43], s46 offen offset:2048 lds
 s_waitcnt lgkmcnt(8)
 v_mfma_f32_32x32x16_bf16 v[76:91], v[228:231], a[32:35], v[76:91]
 ds_read_b128 v[248:251], v0 offset:14336
 v_mfma_f32_32x32x16_bf16 v[92:107], v[228:231], a[36:39], v[92:107]
 s_add_u32 m0, s45, 65536
 s_nop 0
 buffer_load_dwordx4 v19, s[40:43], s46 offen offset:3072 lds
 s_waitcnt lgkmcnt(8)
 v_mfma_f32_32x32x16_bf16 v[44:59], v[232:235], a[40:43], v[44:59]
 ds_read_b128 v[252:255], v0 offset:15360
 v_mfma_f32_32x32x16_bf16 v[60:75], v[232:235], a[44:47], v[60:75]
 s_waitcnt lgkmcnt(8)
 v_mfma_f32_32x32x16_bf16 v[76:91], v[236:239], a[40:43], v[76:91]
 s_barrier
 ds_read_b128 v[224:227], v0 offset:16384
 v_mfma_f32_32x32x16_bf16 v[92:107], v[236:239], a[44:47], v[92:107]
 s_waitcnt lgkmcnt(6)
 v_mfma_f32_32x32x16_bf16 v[44:59], v[240:243], a[48:51], v[44:59]
 s_mov_b32 m0, s34
 s_nop 0
 buffer_load_dwordx4 v0, s[4:7], s33 offen offset:3072 sc1  lds
 s_add_u32 s33, s33, 16384
 s_add_u32 s34, s34, 16384
 ds_read_b128 v[228:231], v0 offset:17408
 v_mfma_f32_32x32x16_bf16 v[60:75], v[240:243], a[52:55], v[60:75]
 s_waitcnt vmcnt(7)
 ds_read_b128 a[164:167], v20 offset:49152
 s_waitcnt lgkmcnt(6)
 s_add_u32 s46, s44, 41728
 s_add_u32 m0, s45, 32768
 s_nop 0
 buffer_load_dwordx4 v16, s[40:43], s46 offen lds
 s_waitcnt lgkmcnt(5)
 v_mfma_f32_32x32x16_bf16 v[76:91], v[244:247], a[48:51], v[76:91]
 ds_read_b128 a[172:175], v21 offset:49152
 ds_read_b128 v[232:235], v0 offset:18432
 v_mfma_f32_32x32x16_bf16 v[92:107], v[244:247], a[52:55], v[92:107]
 ds_read_b128 a[180:183], v22 offset:49152
 s_add_u32 m0, s45, 32768
 s_nop 0
 buffer_load_dwordx4 v17, s[40:43], s46 offen offset:1024 lds
 s_waitcnt lgkmcnt(7)
 v_mfma_f32_32x32x16_bf16 v[44:59], v[248:251], a[56:59], v[44:59]
 ds_read_b128 a[188:191], v23 offset:49152
 ds_read_b128 v[236:239], v0 offset:19456
 v_mfma_f32_32x32x16_bf16 v[60:75], v[248:251], a[60:63], v[60:75]
 s_add_u32 m0, s45, 32768
 s_nop 0
 buffer_load_dwordx4 v18, s[40:43], s46 offen offset:2048 lds
 s_waitcnt lgkmcnt(8)
 v_mfma_f32_32x32x16_bf16 v[76:91], v[252:255], a[56:59], v[76:91]
 ds_read_b128 v[240:243], v0 offset:20480
 s_mul_i32 s35, s49, 5120
 s_mul_i32 s36, s3, 1280
 s_add_u32 s35, s35, s36
 s_add_u32 s35, s35, 7405568
 s_add_u32 m0, s36, 143360
 v_lshrrev_b32 v164, 2, v0
 buffer_load_dwordx4 v0, s[4:7], s35 offen sc1 lds
 buffer_load_dword v164, s[4:7], s35 offen offset:1024 sc1 lds
 v_mfma_f32_32x32x16_bf16 v[92:107], v[252:255], a[60:63], v[92:107]
 s_add_u32 m0, s45, 32768
 s_nop 0
 buffer_load_dwordx4 v19, s[40:43], s46 offen offset:3072 lds
 s_waitcnt lgkmcnt(8)
 v_mfma_f32_32x32x16_bf16 v[44:59], v[224:227], a[64:67], v[44:59]
 s_mov_b32 m0, s34
 s_nop 0
 buffer_load_dwordx4 v0, s[4:7], s33 offen sc1  lds
 ds_read_b128 v[244:247], v0 offset:21504
 v_mfma_f32_32x32x16_bf16 v[60:75], v[224:227], a[68:71], v[60:75]
 s_waitcnt lgkmcnt(8)
 v_mfma_f32_32x32x16_bf16 v[76:91], v[228:231], a[64:67], v[76:91]
 ds_read_b128 v[248:251], v0 offset:22528
 v_mfma_f32_32x32x16_bf16 v[92:107], v[228:231], a[68:71], v[92:107]
 s_waitcnt lgkmcnt(6)
 v_mfma_f32_32x32x16_bf16 v[44:59], v[232:235], a[72:75], v[44:59]
 ds_read_b128 v[252:255], v0 offset:23552
 v_mfma_f32_32x32x16_bf16 v[60:75], v[232:235], a[76:79], v[60:75]
 s_waitcnt vmcnt(8)
 ds_read_b128 a[192:195], v24
 s_waitcnt lgkmcnt(6)
 s_add_u32 s46, s44, 896
 s_add_u32 m0, s45, 49152
 s_nop 0
 buffer_load_dwordx4 v16, s[40:43], s46 offen lds
 s_waitcnt lgkmcnt(5)
 v_mfma_f32_32x32x16_bf16 v[76:91], v[236:239], a[72:75], v[76:91]
 ds_read_b128 a[200:203], v25
 ds_read_b128 v[224:227], v0 offset:24576
 v_mfma_f32_32x32x16_bf16 v[92:107], v[236:239], a[76:79], v[92:107]
 ds_read_b128 a[208:211], v26
 s_add_u32 m0, s45, 49152
 s_nop 0
 buffer_load_dwordx4 v17, s[40:43], s46 offen offset:1024 lds
 s_waitcnt lgkmcnt(7)
 v_mfma_f32_32x32x16_bf16 v[44:59], v[240:243], a[80:83], v[44:59]
 s_mov_b32 m0, s34
 s_nop 0
 buffer_load_dwordx4 v0, s[4:7], s33 offen offset:1024 sc1  lds
 ds_read_b128 a[216:219], v27
 ds_read_b128 v[228:231], v0 offset:25600
 v_mfma_f32_32x32x16_bf16 v[60:75], v[240:243], a[84:87], v[60:75]
 s_add_u32 m0, s45, 49152
 s_nop 0
 buffer_load_dwordx4 v18, s[40:43], s46 offen offset:2048 lds
 s_waitcnt lgkmcnt(8)
 v_mfma_f32_32x32x16_bf16 v[76:91], v[244:247], a[80:83], v[76:91]
 ds_read_b128 v[232:235], v0 offset:26624
 v_mfma_f32_32x32x16_bf16 v[92:107], v[244:247], a[84:87], v[92:107]
 s_add_u32 m0, s45, 49152
 s_nop 0
 buffer_load_dwordx4 v19, s[40:43], s46 offen offset:3072 lds
 s_waitcnt lgkmcnt(8)
 v_mfma_f32_32x32x16_bf16 v[44:59], v[248:251], a[88:91], v[44:59]
 ds_read_b128 v[236:239], v0 offset:27648
 v_mfma_f32_32x32x16_bf16 v[60:75], v[248:251], a[92:95], v[60:75]
 s_waitcnt lgkmcnt(8)
 v_mfma_f32_32x32x16_bf16 v[76:91], v[252:255], a[88:91], v[76:91]
 ds_read_b128 v[240:243], v0 offset:28672
 v_mfma_f32_32x32x16_bf16 v[92:107], v[252:255], a[92:95], v[92:107]
 s_waitcnt lgkmcnt(6)
 v_mfma_f32_32x32x16_bf16 v[44:59], v[224:227], a[96:99], v[44:59]
 s_mov_b32 m0, s34
 s_nop 0
 buffer_load_dwordx4 v0, s[4:7], s33 offen offset:2048 sc1  lds
 ds_read_b128 v[244:247], v0 offset:29696
 v_mfma_f32_32x32x16_bf16 v[60:75], v[224:227], a[100:103], v[60:75]
 s_waitcnt vmcnt(7)
 ds_read_b128 a[196:199], v20 offset:32768
 s_waitcnt lgkmcnt(6)
 s_add_u32 s46, s44, 41856
 s_add_u32 m0, s45, 65536
 s_nop 0
 buffer_load_dwordx4 v16, s[40:43], s46 offen lds
 s_waitcnt lgkmcnt(5)
 v_mfma_f32_32x32x16_bf16 v[76:91], v[228:231], a[96:99], v[76:91]
 ds_read_b128 a[204:207], v21 offset:32768
 ds_read_b128 v[248:251], v0 offset:30720
 v_mfma_f32_32x32x16_bf16 v[92:107], v[228:231], a[100:103], v[92:107]
 ds_read_b128 a[212:215], v22 offset:32768
 s_add_u32 m0, s45, 65536
 s_nop 0
 buffer_load_dwordx4 v17, s[40:43], s46 offen offset:1024 lds
 s_waitcnt lgkmcnt(7)
 v_mfma_f32_32x32x16_bf16 v[44:59], v[232:235], a[104:107], v[44:59]
 ds_read_b128 a[220:223], v23 offset:32768
 ds_read_b128 v[252:255], v0 offset:31744
 v_mfma_f32_32x32x16_bf16 v[60:75], v[232:235], a[108:111], v[60:75]
 s_add_u32 m0, s45, 65536
 s_nop 0
 buffer_load_dwordx4 v18, s[40:43], s46 offen offset:2048 lds
 s_waitcnt lgkmcnt(8)
 v_mfma_f32_32x32x16_bf16 v[76:91], v[236:239], a[104:107], v[76:91]
 s_barrier
 ds_read_b128 v[224:227], v0 offset:32768
 v_mfma_f32_32x32x16_bf16 v[92:107], v[236:239], a[108:111], v[92:107]
 s_add_u32 m0, s45, 65536
 s_nop 0
 buffer_load_dwordx4 v19, s[40:43], s46 offen offset:3072 lds
 s_waitcnt lgkmcnt(8)
 v_mfma_f32_32x32x16_bf16 v[44:59], v[240:243], a[112:115], v[44:59]
 s_mov_b32 m0, s34
 s_nop 0
 buffer_load_dwordx4 v0, s[4:7], s33 offen offset:3072 sc1  lds
 s_add_u32 s33, s33, 16384
 s_add_u32 s34, s34, 16384
 ds_read_b128 v[228:231], v0 offset:33792
 v_mfma_f32_32x32x16_bf16 v[60:75], v[240:243], a[116:119], v[60:75]
 s_waitcnt lgkmcnt(8)
 v_mfma_f32_32x32x16_bf16 v[76:91], v[244:247], a[112:115], v[76:91]
 ds_read_b128 v[232:235], v0 offset:34816
 v_mfma_f32_32x32x16_bf16 v[92:107], v[244:247], a[116:119], v[92:107]
 s_waitcnt lgkmcnt(6)
 v_mfma_f32_32x32x16_bf16 v[44:59], v[248:251], a[120:123], v[44:59]
 ds_read_b128 v[236:239], v0 offset:35840
 buffer_load_dwordx4 v[144:147], v0, s[4:7], s17 offen sc1
 v_mfma_f32_32x32x16_bf16 v[60:75], v[248:251], a[124:127], v[60:75]
 s_waitcnt vmcnt(7)
 ds_read_b128 a[224:227], v20 offset:49152
 s_waitcnt lgkmcnt(6)
 s_add_u32 s46, s44, 1024
 s_add_u32 m0, s45, 32768
 s_nop 0
 buffer_load_dwordx4 v16, s[40:43], s46 offen lds
 s_waitcnt lgkmcnt(5)
 v_mfma_f32_32x32x16_bf16 v[76:91], v[252:255], a[120:123], v[76:91]
 ds_read_b128 a[232:235], v21 offset:49152
 ds_read_b128 v[240:243], v0 offset:36864
 v_mfma_f32_32x32x16_bf16 v[92:107], v[252:255], a[124:127], v[92:107]
 ds_read_b128 a[0:3], v22 offset:49152
 s_add_u32 m0, s45, 32768
 s_nop 0
 buffer_load_dwordx4 v17, s[40:43], s46 offen offset:1024 lds
 s_waitcnt lgkmcnt(7)
 v_mfma_f32_32x32x16_bf16 v[44:59], v[224:227], a[128:131], v[44:59]
 s_mov_b32 m0, s34
 s_nop 0
 buffer_load_dwordx4 v0, s[4:7], s33 offen sc1  lds
 ds_read_b128 a[8:11], v23 offset:49152
 ds_read_b128 v[244:247], v0 offset:37888
 buffer_load_dwordx4 v[148:151], v0, s[4:7], s17 offen offset:1024 sc1
 v_mfma_f32_32x32x16_bf16 v[60:75], v[224:227], a[132:135], v[60:75]
 s_add_u32 m0, s45, 32768
 s_nop 0
 buffer_load_dwordx4 v18, s[40:43], s46 offen offset:2048 lds
 s_waitcnt lgkmcnt(8)
 v_mfma_f32_32x32x16_bf16 v[76:91], v[228:231], a[128:131], v[76:91]
 ds_read_b128 v[248:251], v0 offset:38912
 v_mfma_f32_32x32x16_bf16 v[92:107], v[228:231], a[132:135], v[92:107]
 s_add_u32 m0, s45, 32768
 s_nop 0
 buffer_load_dwordx4 v19, s[40:43], s46 offen offset:3072 lds
 s_waitcnt lgkmcnt(8)
 v_mfma_f32_32x32x16_bf16 v[44:59], v[232:235], a[136:139], v[44:59]
 ds_read_b128 v[252:255], v0 offset:39936
 buffer_load_dwordx4 v[152:155], v0, s[4:7], s17 offen offset:2048 sc1
 v_mfma_f32_32x32x16_bf16 v[60:75], v[232:235], a[140:143], v[60:75]
 s_waitcnt lgkmcnt(8)
 v_mfma_f32_32x32x16_bf16 v[76:91], v[236:239], a[136:139], v[76:91]
 ds_read_b128 v[224:227], v0 offset:40960
 v_mfma_f32_32x32x16_bf16 v[92:107], v[236:239], a[140:143], v[92:107]
 s_waitcnt lgkmcnt(6)
 v_mfma_f32_32x32x16_bf16 v[44:59], v[240:243], a[144:147], v[44:59]
 s_mov_b32 m0, s34
 s_nop 0
 buffer_load_dwordx4 v0, s[4:7], s33 offen offset:1024 sc1  lds
 ds_read_b128 v[228:231], v0 offset:41984
 buffer_load_dwordx4 v[156:159], v0, s[4:7], s17 offen offset:3072 sc1
 v_mfma_f32_32x32x16_bf16 v[60:75], v[240:243], a[148:151], v[60:75]
 s_waitcnt vmcnt(11)
 ds_read_b128 a[228:231], v24
 s_waitcnt lgkmcnt(6)
 s_add_u32 s46, s44, 41984
 s_add_u32 m0, s45, 49152
 s_nop 0
 buffer_load_dwordx4 v16, s[40:43], s46 offen lds
 s_waitcnt lgkmcnt(5)
 v_mfma_f32_32x32x16_bf16 v[76:91], v[244:247], a[144:147], v[76:91]
 ds_read_b128 a[236:239], v25
 ds_read_b128 v[232:235], v0 offset:43008
 v_mfma_f32_32x32x16_bf16 v[92:107], v[244:247], a[148:151], v[92:107]
 ds_read_b128 a[4:7], v26
 s_add_u32 m0, s45, 49152
 s_nop 0
 buffer_load_dwordx4 v17, s[40:43], s46 offen offset:1024 lds
 s_waitcnt lgkmcnt(7)
 v_mfma_f32_32x32x16_bf16 v[44:59], v[248:251], a[152:155], v[44:59]
 ds_read_b128 a[12:15], v27
 ds_read_b128 v[236:239], v0 offset:44032
 v_mfma_f32_32x32x16_bf16 v[60:75], v[248:251], a[156:159], v[60:75]
 s_add_u32 m0, s45, 49152
 s_nop 0
 buffer_load_dwordx4 v18, s[40:43], s46 offen offset:2048 lds
 s_waitcnt lgkmcnt(8)
 v_mfma_f32_32x32x16_bf16 v[76:91], v[252:255], a[152:155], v[76:91]
 ds_read_b128 v[240:243], v0 offset:45056
 v_mfma_f32_32x32x16_bf16 v[92:107], v[252:255], a[156:159], v[92:107]
 s_add_u32 m0, s45, 49152
 s_nop 0
 buffer_load_dwordx4 v19, s[40:43], s46 offen offset:3072 lds
 s_waitcnt lgkmcnt(8)
 v_mfma_f32_32x32x16_bf16 v[44:59], v[224:227], a[160:163], v[44:59]
 s_mov_b32 m0, s34
 s_nop 0
 buffer_load_dwordx4 v0, s[4:7], s33 offen offset:2048 sc1  lds
 ds_read_b128 v[244:247], v0 offset:46080
 v_mfma_f32_32x32x16_bf16 v[60:75], v[224:227], a[164:167], v[60:75]
 s_waitcnt lgkmcnt(8)
 v_mfma_f32_32x32x16_bf16 v[76:91], v[228:231], a[160:163], v[76:91]
 ds_read_b128 v[248:251], v0 offset:47104
 v_mfma_f32_32x32x16_bf16 v[92:107], v[228:231], a[164:167], v[92:107]
 s_waitcnt lgkmcnt(6)
 v_mfma_f32_32x32x16_bf16 v[44:59], v[232:235], a[168:171], v[44:59]
 ds_read_b128 v[252:255], v0 offset:48128
 v_mfma_f32_32x32x16_bf16 v[60:75], v[232:235], a[172:175], v[60:75]
 s_waitcnt vmcnt(8)
 ds_read_b128 a[16:19], v20 offset:32768
 s_waitcnt lgkmcnt(6)
 s_add_u32 s46, s44, 1152
 s_add_u32 m0, s45, 65536
 s_nop 0
 buffer_load_dwordx4 v16, s[40:43], s46 offen lds
 s_waitcnt lgkmcnt(5)
 v_mfma_f32_32x32x16_bf16 v[76:91], v[236:239], a[168:171], v[76:91]
 s_barrier
 ds_read_b128 a[24:27], v21 offset:32768
 ds_read_b128 v[224:227], v0 offset:49152
 v_mfma_f32_32x32x16_bf16 v[92:107], v[236:239], a[172:175], v[92:107]
 ds_read_b128 a[32:35], v22 offset:32768
 s_add_u32 m0, s45, 65536
 s_nop 0
 buffer_load_dwordx4 v17, s[40:43], s46 offen offset:1024 lds
 s_waitcnt lgkmcnt(7)
 v_mfma_f32_32x32x16_bf16 v[44:59], v[240:243], a[176:179], v[44:59]
 s_mov_b32 m0, s34
 s_nop 0
 buffer_load_dwordx4 v0, s[4:7], s33 offen offset:3072 sc1  lds
 s_add_u32 s33, s33, 16384
 s_add_u32 s34, s34, 16384
 ds_read_b128 a[40:43], v23 offset:32768
 ds_read_b128 v[228:231], v0 offset:50176
 v_lshrrev_b32 v165, 2, v0
 v_add_u32 v165, 143360, v165
 v_mfma_f32_32x32x16_bf16 v[60:75], v[240:243], a[180:183], v[60:75]
 s_add_u32 m0, s45, 65536
 s_nop 0
 buffer_load_dwordx4 v18, s[40:43], s46 offen offset:2048 lds
 ds_read2st64_b32 v[108:109], v165 offset0:0 offset1:1
 s_waitcnt lgkmcnt(9)
 v_mfma_f32_32x32x16_bf16 v[76:91], v[244:247], a[176:179], v[76:91]
 ds_read_b128 v[232:235], v0 offset:51200
 ds_read2st64_b32 v[110:111], v165 offset0:2 offset1:3
 ds_read2st64_b32 v[112:113], v165 offset0:4 offset1:5
 v_mfma_f32_32x32x16_bf16 v[92:107], v[244:247], a[180:183], v[92:107]
 s_add_u32 m0, s45, 65536
 s_nop 0
 buffer_load_dwordx4 v19, s[40:43], s46 offen offset:3072 lds
 ds_read2st64_b32 v[114:115], v165 offset0:6 offset1:7
 s_waitcnt lgkmcnt(12)
 v_mfma_f32_32x32x16_bf16 v[44:59], v[248:251], a[184:187], v[44:59]
 ds_read_b128 v[236:239], v0 offset:52224
 ds_read2st64_b32 v[116:117], v165 offset0:8 offset1:9
 s_waitcnt lgkmcnt(6)
 v_add_f32 v108, v108, v109
 v_mfma_f32_32x32x16_bf16 v[60:75], v[248:251], a[188:191], v[60:75]
 s_waitcnt lgkmcnt(4)
 v_add_f32 v108, v108, v110
 v_mfma_f32_32x32x16_bf16 v[76:91], v[252:255], a[184:187], v[76:91]
 ds_read_b128 v[240:243], v0 offset:53248
 v_add_f32 v108, v108, v111
 s_waitcnt lgkmcnt(4)
 v_add_f32 v108, v108, v112
 v_mfma_f32_32x32x16_bf16 v[92:107], v[252:255], a[188:191], v[92:107]
 v_add_f32 v108, v108, v113
 v_mfma_f32_32x32x16_bf16 v[44:59], v[224:227], a[192:195], v[44:59]
 ds_read_b128 v[244:247], v0 offset:54272
 s_waitcnt lgkmcnt(4)
 v_add_f32 v108, v108, v114
 v_add_f32 v108, v108, v115
 v_mfma_f32_32x32x16_bf16 v[60:75], v[224:227], a[196:199], v[60:75]
 s_waitcnt vmcnt(6)
 ds_read_b128 a[20:23], v20 offset:49152
 s_add_u32 s46, s44, 42112
 s_add_u32 m0, s45, 32768
 s_nop 0
 buffer_load_dwordx4 v16, s[40:43], s46 offen lds
 s_waitcnt lgkmcnt(3)
 v_add_f32 v108, v108, v116
 v_mfma_f32_32x32x16_bf16 v[76:91], v[228:231], a[192:195], v[76:91]
 ds_read_b128 a[28:31], v21 offset:49152
 ds_read_b128 v[248:251], v0 offset:55296
 v_add_f32 v108, v108, v117
 ds_read2st64_b32 v[110:111], v165 offset0:10 offset1:11
 v_mfma_f32_32x32x16_bf16 v[92:107], v[228:231], a[196:199], v[92:107]
 ds_read_b128 a[36:39], v22 offset:49152
 s_add_u32 m0, s45, 32768
 s_nop 0
 buffer_load_dwordx4 v17, s[40:43], s46 offen offset:1024 lds
 ds_read2st64_b32 v[112:113], v165 offset0:12 offset1:13
 v_mfma_f32_32x32x16_bf16 v[44:59], v[232:235], a[200:203], v[44:59]
 ds_read_b128 a[44:47], v23 offset:49152
 ds_read_b128 v[252:255], v0 offset:56320
 ds_read2st64_b32 v[114:115], v165 offset0:14 offset1:15
 ds_read2st64_b32 v[116:117], v165 offset0:16 offset1:17
 v_mfma_f32_32x32x16_bf16 v[60:75], v[232:235], a[204:207], v[60:75]
 s_add_u32 m0, s45, 32768
 s_nop 0
 buffer_load_dwordx4 v18, s[40:43], s46 offen offset:2048 lds
 s_waitcnt lgkmcnt(6)
 v_add_f32 v108, v108, v110
 v_mfma_f32_32x32x16_bf16 v[76:91], v[236:239], a[200:203], v[76:91]
 ds_read_b128 v[224:227], v0 offset:57344
 v_add_f32 v108, v108, v111
 s_waitcnt lgkmcnt(5)
 v_add_f32 v108, v108, v112
 v_mfma_f32_32x32x16_bf16 v[92:107], v[236:239], a[204:207], v[92:107]
 s_add_u32 m0, s45, 32768
 s_nop 0
 buffer_load_dwordx4 v19, s[40:43], s46 offen offset:3072 lds
 v_add_f32 v108, v108, v113
 v_mfma_f32_32x32x16_bf16 v[44:59], v[240:243], a[208:211], v[44:59]
 ds_read_b128 v[228:231], v0 offset:58368
 s_waitcnt lgkmcnt(3)
 v_add_f32 v108, v108, v114
 v_add_f32 v108, v108, v115
 buffer_load_dword v12, v205, s[4:7], s39 offen sc1
 v_mfma_f32_32x32x16_bf16 v[60:75], v[240:243], a[212:215], v[60:75]
 s_waitcnt lgkmcnt(2)
 v_add_f32 v108, v108, v116
 v_mfma_f32_32x32x16_bf16 v[76:91], v[244:247], a[208:211], v[76:91]
 ds_read_b128 v[232:235], v0 offset:59392
 v_add_f32 v108, v108, v117
 ds_read2st64_b32 v[110:111], v165 offset0:18 offset1:19
 v_mfma_f32_32x32x16_bf16 v[92:107], v[244:247], a[212:215], v[92:107]
 s_waitcnt lgkmcnt(0)
 v_add_f32 v108, v108, v110
 v_mfma_f32_32x32x16_bf16 v[44:59], v[248:251], a[216:219], v[44:59]
 ds_read_b128 v[236:239], v0 offset:60416
 v_add_f32 v108, v108, v111
 v_cvt_pk_bf16_f32 v109, v108, v108
 v_mfma_f32_32x32x16_bf16 v[60:75], v[248:251], a[220:223], v[60:75]
 s_waitcnt vmcnt(5)
 ds_read_b128 a[48:51], v24
 v_lshlrev_b32 v109, 16, v109
 v_mfma_f32_32x32x16_bf16 v[76:91], v[252:255], a[216:219], v[76:91]
 ds_read_b128 a[56:59], v25
 ds_read_b128 v[240:243], v0 offset:61440
 v_sub_f32 v110, v108, v109
 v_cvt_pk_bf16_f32 v108, v109, v110
 v_mfma_f32_32x32x16_bf16 v[92:107], v[252:255], a[220:223], v[92:107]
 ds_read_b128 a[64:67], v26
 v_cmp_gt_u32 vcc, 512, v0
 v_mfma_f32_32x32x16_bf16 v[44:59], v[224:227], a[224:227], v[44:59]
 ds_read_b128 a[72:75], v27
 ds_read_b128 v[244:247], v0 offset:62464
 v_cndmask_b32 v109, 0, v108, vcc
 v_cndmask_b32 v110, v108, 0, vcc
 v_mfma_f32_32x32x16_bf16 v[60:75], v[224:227], a[228:231], v[60:75]
 v_accvgpr_write_b32 a240, v109
 v_mfma_f32_32x32x16_bf16 v[76:91], v[228:231], a[224:227], v[76:91]
 ds_read_b128 v[248:251], v0 offset:63488
 v_accvgpr_write_b32 a241, v109
 v_accvgpr_write_b32 a242, v110
 v_mfma_f32_32x32x16_bf16 v[92:107], v[228:231], a[228:231], v[92:107]
 v_accvgpr_write_b32 a243, v110
 v_mfma_f32_32x32x16_bf16 v[44:59], v[232:235], a[232:235], v[44:59]
 ds_read_b128 v[252:255], v0 offset:64512
 v_mfma_f32_32x32x16_bf16 v[60:75], v[232:235], a[236:239], v[60:75]
 s_waitcnt lgkmcnt(8)
 v_mfma_f32_32x32x16_bf16 v[76:91], v[236:239], a[232:235], v[76:91]
 s_barrier
 ds_read_b128 v[224:227], v1
 v_mfma_f32_32x32x16_bf16 v[92:107], v[236:239], a[236:239], v[92:107]
 v_add_f32 v144, v144, v145
 v_add_f32 v148, v148, v149
 s_waitcnt lgkmcnt(6)
 v_mfma_f32_32x32x16_bf16 v[44:59], v[240:243], a[0:3], v[44:59]
 ds_read_b128 v[228:231], v1 offset:1024
 v_add_f32 v144, v144, v146
 s_lshl_b32 s62, s48, 5
 s_add_u32 s62, s62, s49
 s_lshl_b32 s62, s62, 2
 s_add_u32 s62, s62, s3
 v_lshlrev_b32 v165, 3, v0
 s_mul_i32 s63, s62, 2560
 s_add_u32 s63, s63, 0
 s_mov_b32 exec_lo, 0xfffff
 s_mov_b32 exec_hi, 0x0
 buffer_load_dword v164, v165, s[8:11], s63 offen sc1
 s_mov_b64 exec, -1
 v_mfma_f32_32x32x16_bf16 v[60:75], v[240:243], a[4:7], v[60:75]
 s_waitcnt vmcnt(2)
 ds_read_b128 a[52:55], v20 offset:32768
 v_add_f32 v148, v148, v150
 v_add_f32 v144, v144, v147
 s_waitcnt lgkmcnt(5)
 v_mfma_f32_32x32x16_bf16 v[76:91], v[244:247], a[0:3], v[76:91]
 ds_read_b128 a[60:63], v21 offset:32768
 ds_read_b128 v[232:235], v1 offset:2048
 v_add_f32 v148, v148, v151
 s_waitcnt vmcnt(1)
 v_cmp_ne_u32 vcc, s56, v12
 s_cbranch_vccnz Lretry_2
Lback_3:
 v_mfma_f32_32x32x16_bf16 v[92:107], v[244:247], a[4:7], v[92:107]
 ds_read_b128 a[68:71], v22 offset:32768
 v_permlane16_swap_b32 v144, v148
 v_add_f32 v144, v144, v148
 buffer_load_dwordx4 v[176:179], v0, s[4:7], s18 offen sc1
 s_waitcnt lgkmcnt(7)
 v_mfma_f32_32x32x16_bf16 v[44:59], v[248:251], a[8:11], v[44:59]
 ds_read_b128 a[76:79], v23 offset:32768
 ds_read_b128 v[236:239], v1 offset:3072
 v_mov_b32 v145, v144
 v_mfma_f32_32x32x16_bf16 v[60:75], v[248:251], a[12:15], v[60:75]
 s_nop 0
 v_permlane32_swap_b32 v144, v145
 v_mul_f32 v144, 0xbacccccd, v144
 s_waitcnt lgkmcnt(8)
 v_mfma_f32_32x32x16_bf16 v[76:91], v[252:255], a[8:11], v[76:91]
 ds_read_b128 v[240:243], v1 offset:4096
 v_mul_f32 v145, 0x3acccccd, v145
 buffer_load_dwordx4 v[180:183], v0, s[4:7], s18 offen offset:1024 sc1
 v_mfma_f32_32x32x16_bf16 v[92:107], v[252:255], a[12:15], v[92:107]
 v_fma_f32 v145, -v144, v144, v145
 v_max_f32 v145, 0, v145
 s_waitcnt lgkmcnt(8)
 v_mfma_f32_32x32x16_bf16 v[44:59], v[224:227], a[16:19], v[44:59]
 ds_read_b128 v[244:247], v1 offset:5120
 v_add_f32 v145, 0x3727c5ac, v145
 v_mfma_f32_32x32x16_bf16 v[60:75], v[224:227], a[20:23], v[60:75]
 v_rsq_f32 v146, v145
 v_cvt_pk_bf16_f32 v160, v144, v144
 buffer_load_dwordx4 v[184:187], v0, s[4:7], s18 offen offset:2048 sc1
 s_waitcnt lgkmcnt(8)
 v_mfma_f32_32x32x16_bf16 v[76:91], v[228:231], a[16:19], v[76:91]
 ds_read_b128 v[248:251], v1 offset:6144
 v_lshlrev_b32 v147, 16, v160
 v_mfma_f32_32x32x16_bf16 v[92:107], v[228:231], a[20:23], v[92:107]
 v_sub_f32 v147, v144, v147
 v_cvt_pk_bf16_f32 v161, v147, v147
 s_waitcnt lgkmcnt(6)
 v_mfma_f32_32x32x16_bf16 v[44:59], v[232:235], a[24:27], v[44:59]
 ds_read_b128 v[252:255], v1 offset:7168
 v_mov_b32 v170, v146
 buffer_load_dwordx4 v[188:191], v0, s[4:7], s18 offen offset:3072 sc1
 s_add_u32 s18, s18, 4096
 v_mfma_f32_32x32x16_bf16 v[60:75], v[232:235], a[28:31], v[60:75]
 v_mul_f32 v168, 0x3fb8aa3b, v146
 v_mul_f32 v169, 0xbfb8aa3b, v146
 s_waitcnt lgkmcnt(4)
 v_mfma_f32_32x32x16_bf16 v[76:91], v[236:239], a[24:27], v[76:91]
 ds_read_b128 v[224:227], v1 offset:8192
 v_add_f32 v152, v152, v153
 v_mfma_f32_32x32x16_bf16 v[92:107], v[236:239], a[28:31], v[92:107]
 v_add_f32 v156, v156, v157
 v_add_f32 v152, v152, v154
 buffer_load_dwordx4 v[192:195], v0, s[4:7], s18 offen sc1
 s_waitcnt lgkmcnt(4)
 v_mfma_f32_32x32x16_bf16 v[44:59], v[240:243], a[32:35], v[44:59]
 ds_read_b128 v[228:231], v1 offset:9216
 v_add_f32 v156, v156, v158
 v_mfma_f32_32x32x16_bf16 v[60:75], v[240:243], a[36:39], v[60:75]
 v_add_f32 v152, v152, v155
 v_add_f32 v156, v156, v159
 s_waitcnt lgkmcnt(4)
 v_mfma_f32_32x32x16_bf16 v[76:91], v[244:247], a[32:35], v[76:91]
 ds_read_b128 v[232:235], v1 offset:10240
 v_permlane16_swap_b32 v152, v156
 buffer_load_dwordx4 v[196:199], v0, s[4:7], s18 offen offset:1024 sc1
 v_mfma_f32_32x32x16_bf16 v[92:107], v[244:247], a[36:39], v[92:107]
 v_add_f32 v152, v152, v156
 v_mov_b32 v153, v152
 s_waitcnt lgkmcnt(4)
 v_mfma_f32_32x32x16_bf16 v[44:59], v[248:251], a[40:43], v[44:59]
 ds_read_b128 v[236:239], v1 offset:11264
 v_permlane32_swap_b32 v152, v153
 v_mfma_f32_32x32x16_bf16 v[60:75], v[248:251], a[44:47], v[60:75]
 v_mul_f32 v152, 0xbacccccd, v152
 v_mul_f32 v153, 0x3acccccd, v153
 buffer_load_dwordx4 v[200:203], v0, s[4:7], s18 offen offset:2048 sc1
 s_waitcnt lgkmcnt(4)
 v_mfma_f32_32x32x16_bf16 v[76:91], v[252:255], a[40:43], v[76:91]
 ds_read_b128 v[240:243], v1 offset:12288
 v_fma_f32 v153, -v152, v152, v153
 v_mfma_f32_32x32x16_bf16 v[92:107], v[252:255], a[44:47], v[92:107]
 v_max_f32 v153, 0, v153
 v_add_f32 v153, 0x3727c5ac, v153
 s_waitcnt lgkmcnt(4)
 v_mfma_f32_32x32x16_bf16 v[44:59], v[224:227], a[48:51], v[44:59]
 ds_read_b128 v[244:247], v1 offset:13312
 v_rsq_f32 v154, v153
 buffer_load_dwordx4 v[204:207], v0, s[4:7], s18 offen offset:3072 sc1
 s_add_u32 s18, s18, 4096
 v_mfma_f32_32x32x16_bf16 v[60:75], v[224:227], a[52:55], v[60:75]
 v_cvt_pk_bf16_f32 v162, v152, v152
 v_lshlrev_b32 v155, 16, v162
 s_waitcnt lgkmcnt(4)
 v_mfma_f32_32x32x16_bf16 v[76:91], v[228:231], a[48:51], v[76:91]
 ds_read_b128 v[248:251], v1 offset:14336
 v_sub_f32 v155, v152, v155
 v_mfma_f32_32x32x16_bf16 v[92:107], v[228:231], a[52:55], v[92:107]
 v_cvt_pk_bf16_f32 v163, v155, v155
 v_mov_b32 v174, v154
 buffer_load_dwordx4 v[208:211], v0, s[4:7], s18 offen sc1
 s_waitcnt lgkmcnt(4)
 v_mfma_f32_32x32x16_bf16 v[44:59], v[232:235], a[56:59], v[44:59]
 ds_read_b128 v[252:255], v1 offset:15360
 v_mul_f32 v172, 0x3fb8aa3b, v154
 v_mfma_f32_32x32x16_bf16 v[60:75], v[232:235], a[60:63], v[60:75]
 v_mul_f32 v173, 0xbfb8aa3b, v154
 s_waitcnt lgkmcnt(4)
 v_mfma_f32_32x32x16_bf16 v[76:91], v[236:239], a[56:59], v[76:91]
 buffer_load_dwordx4 v[212:215], v0, s[4:7], s18 offen offset:1024 sc1
 v_mfma_f32_32x32x16_bf16 v[92:107], v[236:239], a[60:63], v[92:107]
 s_waitcnt lgkmcnt(3)
 v_mfma_f32_32x32x16_bf16 v[44:59], v[240:243], a[64:67], v[44:59]
 v_mfma_f32_32x32x16_bf16 v[60:75], v[240:243], a[68:71], v[60:75]
 buffer_load_dwordx4 v[216:219], v0, s[4:7], s18 offen offset:2048 sc1
 s_waitcnt lgkmcnt(2)
 v_mfma_f32_32x32x16_bf16 v[76:91], v[244:247], a[64:67], v[76:91]
 v_mfma_f32_32x32x16_bf16 v[92:107], v[244:247], a[68:71], v[92:107]
 s_waitcnt lgkmcnt(1)
 v_mfma_f32_32x32x16_bf16 v[44:59], v[248:251], a[72:75], v[44:59]
 buffer_load_dwordx4 v[220:223], v0, s[4:7], s18 offen offset:3072 sc1
 s_add_u32 s18, s18, 4096
 v_mfma_f32_32x32x16_bf16 v[60:75], v[248:251], a[76:79], v[60:75]
 s_waitcnt lgkmcnt(0)
 v_mfma_f32_32x32x16_bf16 v[76:91], v[252:255], a[72:75], v[76:91]
 v_mfma_f32_32x32x16_bf16 v[92:107], v[252:255], a[76:79], v[92:107]
 s_barrier
 s_mul_i32 s37, s49, 221184
 s_mul_i32 s38, s3, 15360
 s_add_u32 s37, s37, s38
 s_add_u32 s37, s37, 40206336
 s_add_u32 s38, s38, 81920
 v_mfma_f32_32x32x8_bf16 v[44:59], a[240:241], v[160:161], v[44:59]
 v_lshlrev_b32 v16, 16, v28
 v_and_b32 v17, 0xffff0000, v28
 v_lshlrev_b32 v18, 16, v29
 v_and_b32 v19, 0xffff0000, v29
 v_lshlrev_b32 v20, 16, v30
 v_and_b32 v21, 0xffff0000, v30
 v_lshlrev_b32 v22, 16, v31
 v_and_b32 v23, 0xffff0000, v31
 v_lshlrev_b32 v24, 16, v128
 v_and_b32 v25, 0xffff0000, v128
 v_mfma_f32_32x32x8_bf16 v[76:91], a[242:243], v[160:161], v[76:91]
 v_lshlrev_b32 v26, 16, v32
 v_and_b32 v27, 0xffff0000, v32
 v_lshlrev_b32 v28, 16, v33
 v_and_b32 v29, 0xffff0000, v33
 v_lshlrev_b32 v30, 16, v34
 v_and_b32 v31, 0xffff0000, v34
 v_lshlrev_b32 v32, 16, v35
 v_and_b32 v33, 0xffff0000, v35
 v_lshlrev_b32 v34, 16, v129
 v_and_b32 v35, 0xffff0000, v129
 v_mfma_f32_32x32x8_bf16 v[60:75], a[240:241], v[162:163], v[60:75]
 v_mfma_f32_32x32x8_bf16 v[92:107], a[242:243], v[162:163], v[92:107]
 v_mov_b32 v143, s60
 v_max3_f32 v12, v44, v45, v46
 buffer_load_dwordx2 v[164:165], v8, s[4:7], s20 offen sc1
 v_max3_f32 v13, -v44, -v45, -v46
 v_max3_f32 v12, v12, v47, v48
 v_max3_f32 v13, v13, -v47, -v48
 v_max3_f32 v12, v12, v49, v50
 v_max3_f32 v13, v13, -v49, -v50
 v_max3_f32 v12, v12, v51, v52
 v_max3_f32 v13, v13, -v51, -v52
 v_max_f32 v12, v12, v53
 v_max_f32 v13, v13, -v53
 s_nop 1
 v_permlane32_swap_b32 v12, v13
 buffer_load_dwordx2 v[164:165], v8, s[4:7], s21 offen sc1
 v_max_f32 v12, v12, v13
 v_mul_f32 v13, v12, v169
 v_mul_f32 v12, v12, v169
 s_nop 1
 v_permlane32_swap_b32 v12, v13
 v_pk_fma_f32 v[108:109], v[44:45], v[168:169], v[12:13] op_sel:[0,0,0] op_sel_hi:[0,1,1]
 v_pk_fma_f32 v[110:111], v[44:45], v[168:169], v[12:13] op_sel:[1,0,0] op_sel_hi:[1,1,1]
 v_pk_fma_f32 v[112:113], v[46:47], v[168:169], v[12:13] op_sel:[0,0,0] op_sel_hi:[0,1,1]
 v_pk_fma_f32 v[114:115], v[46:47], v[168:169], v[12:13] op_sel:[1,0,0] op_sel_hi:[1,1,1]
 v_pk_fma_f32 v[116:117], v[48:49], v[168:169], v[12:13] op_sel:[0,0,0] op_sel_hi:[0,1,1]
 v_pk_fma_f32 v[118:119], v[48:49], v[168:169], v[12:13] op_sel:[1,0,0] op_sel_hi:[1,1,1]
 buffer_load_dwordx2 v[164:165], v9, s[4:7], s22 offen sc1
 v_pk_fma_f32 v[120:121], v[50:51], v[168:169], v[12:13] op_sel:[0,0,0] op_sel_hi:[0,1,1]
 v_pk_fma_f32 v[122:123], v[50:51], v[168:169], v[12:13] op_sel:[1,0,0] op_sel_hi:[1,1,1]
 v_pk_fma_f32 v[124:125], v[52:53], v[168:169], v[12:13] op_sel:[0,0,0] op_sel_hi:[0,1,1]
 v_pk_fma_f32 v[126:127], v[52:53], v[168:169], v[12:13] op_sel:[1,0,0] op_sel_hi:[1,1,1]
 v_exp_f32 v108, v108
 v_exp_f32 v109, v109
 v_exp_f32 v110, v110
 v_exp_f32 v111, v111
 v_exp_f32 v112, v112
 v_exp_f32 v113, v113
 v_exp_f32 v114, v114
 buffer_load_dwordx4 v[224:227], v0, s[4:7], s18 offen sc1
 v_exp_f32 v115, v115
 v_exp_f32 v116, v116
 v_exp_f32 v117, v117
 v_exp_f32 v118, v118
 v_exp_f32 v119, v119
 v_exp_f32 v120, v120
 v_exp_f32 v121, v121
 v_exp_f32 v122, v122
 v_exp_f32 v123, v123
 v_exp_f32 v124, v124
 buffer_load_dwordx4 v[228:231], v0, s[4:7], s18 offen offset:1024 sc1
 v_exp_f32 v125, v125
 v_exp_f32 v126, v126
 v_exp_f32 v127, v127
 v_pk_add_f32 v[14:15], v[108:109], v[110:111]
 v_pk_add_f32 v[14:15], v[14:15], v[112:113]
 v_pk_add_f32 v[14:15], v[14:15], v[114:115]
 v_pk_add_f32 v[14:15], v[14:15], v[116:117]
 v_pk_add_f32 v[14:15], v[14:15], v[118:119]
 v_pk_add_f32 v[14:15], v[14:15], v[120:121]
 v_pk_add_f32 v[14:15], v[14:15], v[122:123]
 v_pk_add_f32 v[14:15], v[14:15], v[124:125]
 buffer_load_dwordx4 v[232:235], v0, s[4:7], s18 offen offset:2048 sc1
 v_pk_add_f32 v[14:15], v[14:15], v[126:127]
 s_nop 1
 v_permlane32_swap_b32 v14, v15
 v_add_f32 v14, v14, v15
 v_rcp_f32 v14, v14
 s_nop 0
 v_mov_b32 v15, v14
 s_nop 1
 v_permlane32_swap_b32 v14, v15
 v_pk_mul_f32 v[108:109], v[108:109], v[14:15]
 v_cvt_pk_bf16_f32 v128, v108, v109
 v_pk_mul_f32 v[110:111], v[110:111], v[14:15]
 v_cvt_pk_bf16_f32 v129, v110, v111
 buffer_load_dwordx4 v[236:239], v0, s[4:7], s18 offen offset:3072 sc1
 s_add_u32 s18, s18, 4096
 v_pk_mul_f32 v[112:113], v[112:113], v[14:15]
 v_cvt_pk_bf16_f32 v130, v112, v113
 v_pk_mul_f32 v[114:115], v[114:115], v[14:15]
 v_cvt_pk_bf16_f32 v131, v114, v115
 v_pk_mul_f32 v[116:117], v[116:117], v[14:15]
 v_cvt_pk_bf16_f32 v132, v116, v117
 v_pk_mul_f32 v[118:119], v[118:119], v[14:15]
 v_cvt_pk_bf16_f32 v133, v118, v119
 v_pk_mul_f32 v[120:121], v[120:121], v[14:15]
 v_cvt_pk_bf16_f32 v134, v120, v121
 buffer_load_dwordx4 v[240:243], v0, s[4:7], s18 offen sc1
 v_pk_mul_f32 v[122:123], v[122:123], v[14:15]
 v_cvt_pk_bf16_f32 v135, v122, v123
 v_pk_mul_f32 v[124:125], v[124:125], v[14:15]
 v_cvt_pk_bf16_f32 v136, v124, v125
 v_pk_mul_f32 v[126:127], v[126:127], v[14:15]
 v_cvt_pk_bf16_f32 v137, v126, v127
 v_mfma_f32_32x32x16_bf16 v[108:123], v[128:131], v[36:39], 0
 v_mfma_f32_32x32x16_bf16 v[108:123], v[132:135], v[40:43], v[108:123]
 v_mul_f32 v54, v54, v170
 v_mul_f32 v55, v55, v170
 v_cvt_pk_bf16_f32 v138, v54, v55
 buffer_load_dwordx4 v[244:247], v0, s[4:7], s18 offen offset:1024 sc1
 v_mul_f32 v56, v56, v170
 v_mul_f32 v57, v57, v170
 v_cvt_pk_bf16_f32 v139, v56, v57
 v_mul_f32 v58, v58, v170
 v_mul_f32 v59, v59, v170
 v_cvt_pk_bf16_f32 v140, v58, v59
 v_mul_f32 v86, v86, v170
 v_mul_f32 v87, v87, v170
 v_cvt_pk_bf16_f32 v141, v86, v87
 v_mul_f32 v88, v88, v170
 buffer_load_dwordx4 v[248:251], v0, s[4:7], s18 offen offset:2048 sc1
 v_mul_f32 v89, v89, v170
 v_cvt_pk_bf16_f32 v142, v88, v89
 v_mfma_f32_32x32x16_bf16 v[44:59], v[136:139], v[36:39], 0
 s_nop 0
 v_mfma_f32_32x32x16_bf16 v[44:59], v[140:143], v[40:43], v[44:59]
 v_cvt_pk_bf16_f32 v128, v108, v109
 v_cvt_pk_bf16_f32 v129, v110, v111
 v_cvt_pk_bf16_f32 v130, v112, v113
 v_cvt_pk_bf16_f32 v131, v114, v115
 v_cvt_pk_bf16_f32 v132, v116, v117
 v_cvt_pk_bf16_f32 v133, v118, v119
 v_cvt_pk_bf16_f32 v134, v120, v121
 buffer_load_dwordx4 v[252:255], v0, s[4:7], s18 offen offset:3072 sc1
 s_add_u32 s18, s18, 4096
 v_cvt_pk_bf16_f32 v135, v122, v123
 s_nop 1
 v_cvt_pk_bf16_f32 v136, v44, v45
 v_cvt_pk_bf16_f32 v137, v46, v47
 v_cvt_pk_bf16_f32 v138, v48, v49
 v_cvt_pk_bf16_f32 v139, v50, v51
 v_cvt_pk_bf16_f32 v140, v52, v53
 v_cvt_pk_bf16_f32 v141, v54, v55
 v_cvt_pk_bf16_f32 v142, v56, v57
 v_cvt_pk_bf16_f32 v143, v58, v59
 v_mfma_f32_32x32x16_bf16 v[144:159], v[128:131], v[136:139], 0
 buffer_load_dwordx4 a[80:83], v0, s[4:7], s47 offen sc1
 v_mfma_f32_32x32x16_bf16 v[144:159], v[132:135], v[140:143], v[144:159]
 v_mfma_f32_32x32x16_bf16 v[44:59], v[136:139], v[136:139], 0
 v_mfma_f32_32x32x16_bf16 v[44:59], v[140:143], v[140:143], v[44:59]
 v_mov_b32 v143, s60
 v_max3_f32 v12, v60, v61, v62
 v_max3_f32 v13, -v60, -v61, -v62
 v_max3_f32 v12, v12, v63, v64
 v_max3_f32 v13, v13, -v63, -v64
 v_max3_f32 v12, v12, v65, v66
 v_max3_f32 v13, v13, -v65, -v66
 s_mov_b32 m0, s38
 s_nop 0
 buffer_load_dwordx4 v0, s[4:7], s37 offen sc1  lds
 v_max3_f32 v12, v12, v67, v68
 v_max3_f32 v13, v13, -v67, -v68
 v_max_f32 v12, v12, v69
 v_max_f32 v13, v13, -v69
 s_nop 1
 v_permlane32_swap_b32 v12, v13
 v_max_f32 v12, v12, v13
 v_mul_f32 v13, v12, v173
 v_mul_f32 v12, v12, v173
 s_nop 1
 v_permlane32_swap_b32 v12, v13
 v_pk_fma_f32 v[108:109], v[60:61], v[172:173], v[12:13] op_sel:[0,0,0] op_sel_hi:[0,1,1]
 v_pk_fma_f32 v[110:111], v[60:61], v[172:173], v[12:13] op_sel:[1,0,0] op_sel_hi:[1,1,1]
 buffer_load_dwordx4 a[84:87], v0, s[4:7], s47 offen offset:1024 sc1
 v_pk_fma_f32 v[112:113], v[62:63], v[172:173], v[12:13] op_sel:[0,0,0] op_sel_hi:[0,1,1]
 v_pk_fma_f32 v[114:115], v[62:63], v[172:173], v[12:13] op_sel:[1,0,0] op_sel_hi:[1,1,1]
 v_pk_fma_f32 v[116:117], v[64:65], v[172:173], v[12:13] op_sel:[0,0,0] op_sel_hi:[0,1,1]
 v_pk_fma_f32 v[118:119], v[64:65], v[172:173], v[12:13] op_sel:[1,0,0] op_sel_hi:[1,1,1]
 v_pk_fma_f32 v[120:121], v[66:67], v[172:173], v[12:13] op_sel:[0,0,0] op_sel_hi:[0,1,1]
 v_pk_fma_f32 v[122:123], v[66:67], v[172:173], v[12:13] op_sel:[1,0,0] op_sel_hi:[1,1,1]
 v_pk_fma_f32 v[124:125], v[68:69], v[172:173], v[12:13] op_sel:[0,0,0] op_sel_hi:[0,1,1]
 v_pk_fma_f32 v[126:127], v[68:69], v[172:173], v[12:13] op_sel:[1,0,0] op_sel_hi:[1,1,1]
 v_exp_f32 v108, v108
 v_exp_f32 v109, v109
 buffer_load_dwordx4 a[88:91], v0, s[4:7], s47 offen offset:2048 sc1
 v_exp_f32 v110, v110
 v_exp_f32 v111, v111
 v_exp_f32 v112, v112
 v_exp_f32 v113, v113
 v_exp_f32 v114, v114
 v_exp_f32 v115, v115
 v_exp_f32 v116, v116
 v_exp_f32 v117, v117
 v_exp_f32 v118, v118
 v_exp_f32 v119, v119
 v_exp_f32 v120, v120
 buffer_load_dwordx4 a[92:95], v0, s[4:7], s47 offen offset:3072 sc1
 s_add_u32 s47, s47, 4096
 v_exp_f32 v121, v121
 v_exp_f32 v122, v122
 v_exp_f32 v123, v123
 v_exp_f32 v124, v124
 v_exp_f32 v125, v125
 v_exp_f32 v126, v126
 v_exp_f32 v127, v127
 v_pk_add_f32 v[14:15], v[108:109], v[110:111]
 v_pk_add_f32 v[14:15], v[14:15], v[112:113]
 v_pk_add_f32 v[14:15], v[14:15], v[114:115]
 s_mov_b32 m0, s38
 s_nop 0
 buffer_load_dwordx4 v0, s[4:7], s37 offen offset:1024 sc1  lds
 v_pk_add_f32 v[14:15], v[14:15], v[116:117]
 v_pk_add_f32 v[14:15], v[14:15], v[118:119]
 v_pk_add_f32 v[14:15], v[14:15], v[120:121]
 v_pk_add_f32 v[14:15], v[14:15], v[122:123]
 v_pk_add_f32 v[14:15], v[14:15], v[124:125]
 v_pk_add_f32 v[14:15], v[14:15], v[126:127]
 s_nop 1
 v_permlane32_swap_b32 v14, v15
 v_add_f32 v14, v14, v15
 v_rcp_f32 v14, v14
 s_nop 0
 v_mov_b32 v15, v14
 buffer_load_dwordx4 a[96:99], v0, s[4:7], s47 offen sc1
 s_nop 0
 v_permlane32_swap_b32 v14, v15
 v_pk_mul_f32 v[108:109], v[108:109], v[14:15]
 v_cvt_pk_bf16_f32 v128, v108, v109
 v_pk_mul_f32 v[110:111], v[110:111], v[14:15]
 v_cvt_pk_bf16_f32 v129, v110, v111
 v_pk_mul_f32 v[112:113], v[112:113], v[14:15]
 v_cvt_pk_bf16_f32 v130, v112, v113
 v_pk_mul_f32 v[114:115], v[114:115], v[14:15]
 v_cvt_pk_bf16_f32 v131, v114, v115
 v_pk_mul_f32 v[116:117], v[116:117], v[14:15]
 v_cvt_pk_bf16_f32 v132, v116, v117
 buffer_load_dwordx4 a[100:103], v0, s[4:7], s47 offen offset:1024 sc1
 v_pk_mul_f32 v[118:119], v[118:119], v[14:15]
 v_cvt_pk_bf16_f32 v133, v118, v119
 v_pk_mul_f32 v[120:121], v[120:121], v[14:15]
 v_cvt_pk_bf16_f32 v134, v120, v121
 v_pk_mul_f32 v[122:123], v[122:123], v[14:15]
 v_cvt_pk_bf16_f32 v135, v122, v123
 v_pk_mul_f32 v[124:125], v[124:125], v[14:15]
 v_cvt_pk_bf16_f32 v136, v124, v125
 v_pk_mul_f32 v[126:127], v[126:127], v[14:15]
 v_cvt_pk_bf16_f32 v137, v126, v127
 buffer_load_dwordx4 a[104:107], v0, s[4:7], s47 offen offset:2048 sc1
 v_mfma_f32_32x32x16_bf16 v[108:123], v[128:131], v[36:39], 0
 v_mfma_f32_32x32x16_bf16 v[108:123], v[132:135], v[40:43], v[108:123]
 v_mul_f32 v70, v70, v174
 v_mul_f32 v71, v71, v174
 v_cvt_pk_bf16_f32 v138, v70, v71
 v_mul_f32 v72, v72, v174
 v_mul_f32 v73, v73, v174
 v_cvt_pk_bf16_f32 v139, v72, v73
 v_mul_f32 v74, v74, v174
 v_mul_f32 v75, v75, v174
 v_cvt_pk_bf16_f32 v140, v74, v75
 s_mov_b32 m0, s38
 s_nop 0
 buffer_load_dwordx4 v0, s[4:7], s37 offen offset:2048 sc1  lds
 v_mul_f32 v102, v102, v174
 v_mul_f32 v103, v103, v174
 v_cvt_pk_bf16_f32 v141, v102, v103
 v_mul_f32 v104, v104, v174
 v_mul_f32 v105, v105, v174
 v_cvt_pk_bf16_f32 v142, v104, v105
 v_mfma_f32_32x32x16_bf16 v[60:75], v[136:139], v[36:39], 0
 s_nop 0
 v_mfma_f32_32x32x16_bf16 v[60:75], v[140:143], v[40:43], v[60:75]
 v_cvt_pk_bf16_f32 v128, v108, v109
 v_cvt_pk_bf16_f32 v129, v110, v111
 buffer_load_dwordx4 a[108:111], v0, s[4:7], s47 offen offset:3072 sc1
 s_add_u32 s47, s47, 4096
 v_cvt_pk_bf16_f32 v130, v112, v113
 v_cvt_pk_bf16_f32 v131, v114, v115
 v_cvt_pk_bf16_f32 v132, v116, v117
 v_cvt_pk_bf16_f32 v133, v118, v119
 v_cvt_pk_bf16_f32 v134, v120, v121
 v_cvt_pk_bf16_f32 v135, v122, v123
 s_nop 1
 v_cvt_pk_bf16_f32 v136, v60, v61
 v_cvt_pk_bf16_f32 v137, v62, v63
 v_cvt_pk_bf16_f32 v138, v64, v65
 v_cvt_pk_bf16_f32 v139, v66, v67
 v_cvt_pk_bf16_f32 v140, v68, v69
 v_cvt_pk_bf16_f32 v141, v70, v71
 v_cvt_pk_bf16_f32 v142, v72, v73
 v_cvt_pk_bf16_f32 v143, v74, v75
 v_mfma_f32_32x32x16_bf16 v[144:159], v[128:131], v[136:139], v[144:159]
 s_nop 0
 v_mfma_f32_32x32x16_bf16 v[144:159], v[132:135], v[140:143], v[144:159]
 v_mfma_f32_32x32x16_bf16 v[44:59], v[136:139], v[136:139], v[44:59]
 v_mfma_f32_32x32x16_bf16 v[44:59], v[140:143], v[140:143], v[44:59]
 s_lshl_b32 s33, s3, 10
 v_add_u32 v13, s33, v2
 s_lshl_b32 s33, s3, 2
 v_add_u32 v14, s33, v2
 s_add_u32 s56, s52, 9
 v_mov_b32 v131, s56
 s_nop 3
 ds_write_b128 v3, v[144:147] offset:12288
 ds_write_b128 v3, v[148:151] offset:13312
 ds_write_b128 v3, v[152:155] offset:14336
 ds_write_b128 v3, v[156:159] offset:15360
 ds_write_b128 v3, v[44:47] offset:16384
 s_waitcnt lgkmcnt(0)
 s_barrier
 ds_read_b128 v[108:111], v13 offset:12288
 ds_read_b32 v124, v14 offset:16384
 ds_read_b128 v[112:115], v13 offset:17408
 ds_read_b32 v125, v14 offset:21504
 ds_read_b128 v[116:119], v13 offset:22528
 ds_read_b32 v126, v14 offset:26624
 ds_read_b128 v[120:123], v13 offset:27648
 ds_read_b32 v127, v14 offset:31744
 s_waitcnt lgkmcnt(5)
 v_pk_add_f32 v[108:109], v[108:109], v[112:113]
 v_pk_add_f32 v[110:111], v[110:111], v[114:115]
 s_waitcnt lgkmcnt(1)
 v_pk_add_f32 v[116:117], v[116:117], v[120:121]
 v_pk_add_f32 v[118:119], v[118:119], v[122:123]
 s_waitcnt lgkmcnt(0)
 v_pk_add_f32 v[124:125], v[124:125], v[126:127]
 v_pk_add_f32 v[108:109], v[108:109], v[116:117]
 v_pk_add_f32 v[110:111], v[110:111], v[118:119]
 v_add_f32 v124, v124, v125
 v_cvt_pk_bf16_f32 v128, v108, v109
 v_cvt_pk_bf16_f32 v129, v110, v111
 v_cvt_pk_bf16_f32 v130, v124, 0
 buffer_store_dwordx4 v[128:131], v10, s[4:7], s24 offen sc1
 s_barrier
 v_max3_f32 v12, v76, v77, v78
 buffer_load_dwordx4 v[144:147], v0, s[4:7], s18 offen sc1
 v_max3_f32 v13, -v76, -v77, -v78
 v_max3_f32 v12, v12, v79, v80
 v_max3_f32 v13, v13, -v79, -v80
 v_max3_f32 v12, v12, v81, v82
 v_max3_f32 v13, v13, -v81, -v82
 v_max3_f32 v12, v12, v83, v84
 v_max3_f32 v13, v13, -v83, -v84
 v_max_f32 v12, v12, v85
 v_max_f32 v13, v13, -v85
 buffer_load_dwordx4 v[148:151], v0, s[4:7], s18 offen offset:1024 sc1
 s_nop 0
 v_permlane32_swap_b32 v12, v13
 v_max_f32 v12, v12, v13
 v_mul_f32 v13, v12, v169
 v_mul_f32 v12, v12, v169
 s_nop 1
 v_permlane32_swap_b32 v12, v13
 v_pk_fma_f32 v[108:109], v[76:77], v[168:169], v[12:13] op_sel:[0,0,0] op_sel_hi:[0,1,1]
 v_pk_fma_f32 v[110:111], v[76:77], v[168:169], v[12:13] op_sel:[1,0,0] op_sel_hi:[1,1,1]
 v_pk_fma_f32 v[112:113], v[78:79], v[168:169], v[12:13] op_sel:[0,0,0] op_sel_hi:[0,1,1]
 v_pk_fma_f32 v[114:115], v[78:79], v[168:169], v[12:13] op_sel:[1,0,0] op_sel_hi:[1,1,1]
 buffer_load_dwordx4 v[152:155], v0, s[4:7], s18 offen offset:2048 sc1
 v_pk_fma_f32 v[116:117], v[80:81], v[168:169], v[12:13] op_sel:[0,0,0] op_sel_hi:[0,1,1]
 v_pk_fma_f32 v[118:119], v[80:81], v[168:169], v[12:13] op_sel:[1,0,0] op_sel_hi:[1,1,1]
 v_pk_fma_f32 v[120:121], v[82:83], v[168:169], v[12:13] op_sel:[0,0,0] op_sel_hi:[0,1,1]
 v_pk_fma_f32 v[122:123], v[82:83], v[168:169], v[12:13] op_sel:[1,0,0] op_sel_hi:[1,1,1]
 v_pk_fma_f32 v[124:125], v[84:85], v[168:169], v[12:13] op_sel:[0,0,0] op_sel_hi:[0,1,1]
 v_pk_fma_f32 v[126:127], v[84:85], v[168:169], v[12:13] op_sel:[1,0,0] op_sel_hi:[1,1,1]
 v_exp_f32 v108, v108
 v_exp_f32 v109, v109
 v_exp_f32 v110, v110
 buffer_load_dwordx4 v[156:159], v0, s[4:7], s18 offen offset:3072 sc1
 s_add_u32 s18, s18, 4096
 v_exp_f32 v111, v111
 v_exp_f32 v112, v112
 v_exp_f32 v113, v113
 v_exp_f32 v114, v114
 v_exp_f32 v115, v115
 v_exp_f32 v116, v116
 v_exp_f32 v117, v117
 v_exp_f32 v118, v118
 v_exp_f32 v119, v119
 buffer_load_dwordx4 v[160:163], v0, s[4:7], s18 offen sc1
 v_exp_f32 v120, v120
 v_exp_f32 v121, v121
 v_exp_f32 v122, v122
 v_exp_f32 v123, v123
 v_exp_f32 v124, v124
 v_exp_f32 v125, v125
 v_exp_f32 v126, v126
 v_exp_f32 v127, v127
 v_pk_add_f32 v[14:15], v[108:109], v[110:111]
 v_pk_add_f32 v[14:15], v[14:15], v[112:113]
 buffer_load_dwordx4 a[112:115], v0, s[4:7], s47 offen sc1
 v_pk_add_f32 v[14:15], v[14:15], v[114:115]
 v_pk_add_f32 v[14:15], v[14:15], v[116:117]
 v_pk_add_f32 v[14:15], v[14:15], v[118:119]
 v_pk_add_f32 v[14:15], v[14:15], v[120:121]
 v_pk_add_f32 v[14:15], v[14:15], v[122:123]
 v_pk_add_f32 v[14:15], v[14:15], v[124:125]
 v_pk_add_f32 v[14:15], v[14:15], v[126:127]
 s_nop 1
 v_permlane32_swap_b32 v14, v15
 v_add_f32 v14, v14, v15
 buffer_load_dwordx4 a[116:119], v0, s[4:7], s47 offen offset:1024 sc1
 v_rcp_f32 v14, v14
 s_nop 0
 v_mov_b32 v15, v14
 s_nop 1
 v_permlane32_swap_b32 v14, v15
 v_pk_mul_f32 v[108:109], v[108:109], v[14:15]
 v_cvt_pk_bf16_f32 v76, v108, v109
 v_pk_mul_f32 v[110:111], v[110:111], v[14:15]
 v_cvt_pk_bf16_f32 v77, v110, v111
 v_pk_mul_f32 v[112:113], v[112:113], v[14:15]
 v_cvt_pk_bf16_f32 v78, v112, v113
 s_mov_b32 m0, s38
 s_nop 0
 buffer_load_dwordx4 v0, s[4:7], s37 offen offset:3072 sc1  lds
 s_add_u32 s37, s37, 4096
 s_add_u32 s38, s38, 4096
 v_pk_mul_f32 v[114:115], v[114:115], v[14:15]
 v_cvt_pk_bf16_f32 v79, v114, v115
 v_pk_mul_f32 v[116:117], v[116:117], v[14:15]
 v_cvt_pk_bf16_f32 v80, v116, v117
 v_pk_mul_f32 v[118:119], v[118:119], v[14:15]
 v_cvt_pk_bf16_f32 v81, v118, v119
 v_pk_mul_f32 v[120:121], v[120:121], v[14:15]
 v_cvt_pk_bf16_f32 v82, v120, v121
 v_pk_mul_f32 v[122:123], v[122:123], v[14:15]
 buffer_load_dwordx4 a[120:123], v0, s[4:7], s47 offen offset:2048 sc1
 v_cvt_pk_bf16_f32 v83, v122, v123
 v_pk_mul_f32 v[124:125], v[124:125], v[14:15]
 v_cvt_pk_bf16_f32 v84, v124, v125
 v_pk_mul_f32 v[126:127], v[126:127], v[14:15]
 v_cvt_pk_bf16_f32 v85, v126, v127
 v_max3_f32 v12, v92, v93, v94
 v_max3_f32 v13, -v92, -v93, -v94
 v_max3_f32 v12, v12, v95, v96
 v_max3_f32 v13, v13, -v95, -v96
 buffer_load_dwordx4 a[124:127], v0, s[4:7], s47 offen offset:3072 sc1
 s_add_u32 s47, s47, 4096
 v_max3_f32 v12, v12, v97, v98
 v_max3_f32 v13, v13, -v97, -v98
 v_max3_f32 v12, v12, v99, v100
 v_max3_f32 v13, v13, -v99, -v100
 v_max_f32 v12, v12, v101
 v_max_f32 v13, v13, -v101
 s_nop 1
 v_permlane32_swap_b32 v12, v13
 v_max_f32 v12, v12, v13
 v_mul_f32 v13, v12, v173
 v_mul_f32 v12, v12, v173
 buffer_load_dwordx4 a[128:131], v0, s[4:7], s47 offen sc1
 s_nop 0
 v_permlane32_swap_b32 v12, v13
 v_pk_fma_f32 v[108:109], v[92:93], v[172:173], v[12:13] op_sel:[0,0,0] op_sel_hi:[0,1,1]
 v_pk_fma_f32 v[110:111], v[92:93], v[172:173], v[12:13] op_sel:[1,0,0] op_sel_hi:[1,1,1]
 v_pk_fma_f32 v[112:113], v[94:95], v[172:173], v[12:13] op_sel:[0,0,0] op_sel_hi:[0,1,1]
 v_pk_fma_f32 v[114:115], v[94:95], v[172:173], v[12:13] op_sel:[1,0,0] op_sel_hi:[1,1,1]
 v_pk_fma_f32 v[116:117], v[96:97], v[172:173], v[12:13] op_sel:[0,0,0] op_sel_hi:[0,1,1]
 v_pk_fma_f32 v[118:119], v[96:97], v[172:173], v[12:13] op_sel:[1,0,0] op_sel_hi:[1,1,1]
 v_pk_fma_f32 v[120:121], v[98:99], v[172:173], v[12:13] op_sel:[0,0,0] op_sel_hi:[0,1,1]
 v_pk_fma_f32 v[122:123], v[98:99], v[172:173], v[12:13] op_sel:[1,0,0] op_sel_hi:[1,1,1]
 buffer_load_dwordx4 a[132:135], v0, s[4:7], s47 offen offset:1024 sc1
 v_pk_fma_f32 v[124:125], v[100:101], v[172:173], v[12:13] op_sel:[0,0,0] op_sel_hi:[0,1,1]
 v_pk_fma_f32 v[126:127], v[100:101], v[172:173], v[12:13] op_sel:[1,0,0] op_sel_hi:[1,1,1]
 v_exp_f32 v108, v108
 v_exp_f32 v109, v109
 v_exp_f32 v110, v110
 v_exp_f32 v111, v111
 v_exp_f32 v112, v112
 v_exp_f32 v113, v113
 v_exp_f32 v114, v114
 s_mov_b32 m0, s38
 s_nop 0
 buffer_load_dwordx4 v0, s[4:7], s37 offen sc1  lds
 v_exp_f32 v115, v115
 v_exp_f32 v116, v116
 v_exp_f32 v117, v117
 v_exp_f32 v118, v118
 v_exp_f32 v119, v119
 v_exp_f32 v120, v120
 v_exp_f32 v121, v121
 v_exp_f32 v122, v122
 v_exp_f32 v123, v123
 buffer_load_dwordx4 a[136:139], v0, s[4:7], s47 offen offset:2048 sc1
 v_exp_f32 v124, v124
 v_exp_f32 v125, v125
 v_exp_f32 v126, v126
 v_exp_f32 v127, v127
 v_pk_add_f32 v[14:15], v[108:109], v[110:111]
 v_pk_add_f32 v[14:15], v[14:15], v[112:113]
 v_pk_add_f32 v[14:15], v[14:15], v[114:115]
 v_pk_add_f32 v[14:15], v[14:15], v[116:117]
 v_pk_add_f32 v[14:15], v[14:15], v[118:119]
 buffer_load_dwordx4 a[140:143], v0, s[4:7], s47 offen offset:3072 sc1
 s_add_u32 s47, s47, 4096
 v_pk_add_f32 v[14:15], v[14:15], v[120:121]
 v_pk_add_f32 v[14:15], v[14:15], v[122:123]
 v_pk_add_f32 v[14:15], v[14:15], v[124:125]
 v_pk_add_f32 v[14:15], v[14:15], v[126:127]
 s_nop 1
 v_permlane32_swap_b32 v14, v15
 v_add_f32 v14, v14, v15
 v_rcp_f32 v14, v14
 s_nop 0
 v_mov_b32 v15, v14
 s_nop 1
 v_permlane32_swap_b32 v14, v15
 v_pk_mul_f32 v[108:109], v[108:109], v[14:15]
 v_cvt_pk_bf16_f32 v92, v108, v109
 v_pk_mul_f32 v[110:111], v[110:111], v[14:15]
 v_cvt_pk_bf16_f32 v93, v110, v111
 v_pk_mul_f32 v[112:113], v[112:113], v[14:15]
 v_cvt_pk_bf16_f32 v94, v112, v113
 v_pk_mul_f32 v[114:115], v[114:115], v[14:15]
 v_cvt_pk_bf16_f32 v95, v114, v115
 v_pk_mul_f32 v[116:117], v[116:117], v[14:15]
 v_cvt_pk_bf16_f32 v96, v116, v117
 v_pk_mul_f32 v[118:119], v[118:119], v[14:15]
 v_cvt_pk_bf16_f32 v97, v118, v119
 v_pk_mul_f32 v[120:121], v[120:121], v[14:15]
 v_cvt_pk_bf16_f32 v98, v120, v121
 v_pk_mul_f32 v[122:123], v[122:123], v[14:15]
 v_cvt_pk_bf16_f32 v99, v122, v123
 v_pk_mul_f32 v[124:125], v[124:125], v[14:15]
 v_cvt_pk_bf16_f32 v100, v124, v125
 v_pk_mul_f32 v[126:127], v[126:127], v[14:15]
 v_cvt_pk_bf16_f32 v101, v126, v127
 s_lshr_b32 s33, s3, 1
 s_lshl_b32 s33, s33, 10
 s_and_b32 s34, s3, 1
 s_lshl_b32 s34, s34, 3
 s_add_u32 s33, s33, s34
 v_add_u32 v118, s33, v2
 v_lshrrev_b32 v119, 1, v0
 v_add_u32 v119, 145408, v119
 s_lshl_b32 s33, s3, 1
 v_add_u32 v120, s33, v119
 s_mov_b32 s55, 0
Lkv_5:
 buffer_load_dwordx4 v[44:47], v11, s[4:7], s25 offen sc1
 buffer_load_dwordx4 v[48:51], v11, s[4:7], s26 offen sc1
 buffer_load_dwordx4 v[52:55], v11, s[4:7], s27 offen sc1
 buffer_load_dwordx4 v[56:59], v11, s[4:7], s28 offen sc1
 buffer_load_dwordx4 v[60:63], v11, s[4:7], s29 offen sc1
 buffer_load_dwordx4 v[64:67], v11, s[4:7], s30 offen sc1
 buffer_load_dwordx4 v[68:71], v11, s[4:7], s31 offen sc1
 s_add_u32 s55, s55, 1
 s_cmp_gt_u32 s55, 0x40000
 s_cbranch_scc1 Lend
 v_lshlrev_b32 v108, 16, v128
 v_and_b32 v109, 0xffff0000, v128
 v_lshlrev_b32 v110, 16, v129
 v_and_b32 v111, 0xffff0000, v129
 v_lshlrev_b32 v112, 16, v130
 v_mov_b32 v12, 0
 s_waitcnt vmcnt(6)
 v_dot2c_f32_bf16 v108, s60, v44
 v_dot2c_f32_bf16 v109, s61, v44
 v_dot2c_f32_bf16 v110, s60, v45
 v_dot2c_f32_bf16 v111, s61, v45
 v_dot2c_f32_bf16 v112, s60, v46
 v_bitop3_b32 v12, v12, v47, s56 bitop3:0xf6
 s_waitcnt vmcnt(5)
 v_dot2c_f32_bf16 v108, s60, v48
 v_dot2c_f32_bf16 v109, s61, v48
 v_dot2c_f32_bf16 v110, s60, v49
 v_dot2c_f32_bf16 v111, s61, v49
 v_dot2c_f32_bf16 v112, s60, v50
 v_bitop3_b32 v12, v12, v51, s56 bitop3:0xf6
 s_waitcnt vmcnt(4)
 v_dot2c_f32_bf16 v108, s60, v52
 v_dot2c_f32_bf16 v109, s61, v52
 v_dot2c_f32_bf16 v110, s60, v53
 v_dot2c_f32_bf16 v111, s61, v53
 v_dot2c_f32_bf16 v112, s60, v54
 v_bitop3_b32 v12, v12, v55, s56 bitop3:0xf6
 s_waitcnt vmcnt(3)
 v_dot2c_f32_bf16 v108, s60, v56
 v_dot2c_f32_bf16 v109, s61, v56
 v_dot2c_f32_bf16 v110, s60, v57
 v_dot2c_f32_bf16 v111, s61, v57
 v_dot2c_f32_bf16 v112, s60, v58
 v_bitop3_b32 v12, v12, v59, s56 bitop3:0xf6
 s_waitcnt vmcnt(2)
 v_dot2c_f32_bf16 v108, s60, v60
 v_dot2c_f32_bf16 v109, s61, v60
 v_dot2c_f32_bf16 v110, s60, v61
 v_dot2c_f32_bf16 v111, s61, v61
 v_dot2c_f32_bf16 v112, s60, v62
 v_bitop3_b32 v12, v12, v63, s56 bitop3:0xf6
 s_waitcnt vmcnt(1)
 v_dot2c_f32_bf16 v108, s60, v64
 v_dot2c_f32_bf16 v109, s61, v64
 v_dot2c_f32_bf16 v110, s60, v65
 v_dot2c_f32_bf16 v111, s61, v65
 v_dot2c_f32_bf16 v112, s60, v66
 v_bitop3_b32 v12, v12, v67, s56 bitop3:0xf6
 s_waitcnt vmcnt(0)
 v_dot2c_f32_bf16 v108, s60, v68
 v_dot2c_f32_bf16 v109, s61, v68
 v_dot2c_f32_bf16 v110, s60, v69
 v_dot2c_f32_bf16 v111, s61, v69
 v_dot2c_f32_bf16 v112, s60, v70
 v_bitop3_b32 v12, v12, v71, s56 bitop3:0xf6
 v_cmp_ne_u32 vcc, 0, v12
 s_cbranch_vccnz Lkv_5
 buffer_load_dwordx4 a[144:147], v0, s[4:7], s47 offen sc1
 buffer_load_dwordx4 a[148:151], v0, s[4:7], s47 offen offset:1024 sc1
 s_mov_b32 m0, s38
 s_nop 0
 buffer_load_dwordx4 v0, s[4:7], s37 offen offset:1024 sc1  lds
 buffer_load_dwordx4 a[152:155], v0, s[4:7], s47 offen offset:2048 sc1
 buffer_load_dwordx4 a[156:159], v0, s[4:7], s47 offen offset:3072 sc1
 s_add_u32 s47, s47, 4096
 buffer_load_dwordx4 a[160:163], v0, s[4:7], s47 offen sc1
 buffer_load_dwordx4 a[164:167], v0, s[4:7], s47 offen offset:1024 sc1
 s_mov_b32 m0, s38
 s_nop 0
 buffer_load_dwordx4 v0, s[4:7], s37 offen offset:2048 sc1  lds
 buffer_load_dwordx4 a[168:171], v0, s[4:7], s47 offen offset:2048 sc1
 buffer_load_dwordx4 a[172:175], v0, s[4:7], s47 offen offset:3072 sc1
 s_add_u32 s47, s47, 4096
 v_cvt_pk_bf16_f32 v114, v108, v109
 v_cvt_pk_bf16_f32 v115, v110, v111
 v_cvt_pk_bf16_f32 v116, v112, v112
 ds_write_b64 v118, v[114:115] offset:12288
 ds_write_b16 v120, v116
 s_mul_i32 s24, s53, 196608
 s_add_u32 s24, s24, 18350080
 s_mul_i32 s25, s3, 5120
 s_add_u32 s24, s24, s25
 s_lshr_b32 s26, s3, 1
 s_mul_i32 s26, s26, 20480
 s_add_u32 s25, s24, 20480
 s_sub_u32 s25, s25, s26
 s_waitcnt lgkmcnt(0)
 s_barrier
 ds_read_b64 v[136:137], v119
 ds_read_b128 v[128:131], v2 offset:12288
 ds_read_b128 v[132:135], v2 offset:13312
 s_add_u32 s24, s24, s26
 s_add_u32 s26, s24, 40960
 s_add_u32 s27, s25, 40960
 s_lshl_b32 s28, s53, 7
 s_add_u32 s28, s28, 7737344
 s_lshl_b32 s62, s3, 5
 s_add_u32 s28, s28, s62
 v_lshrrev_b32 v172, 2, v0
 v_and_b32 v171, 28, v172
 v_and_b32 v172, 124, v172
 s_waitcnt lgkmcnt(2)
 v_mfma_f32_32x32x8_bf16 v[44:59], v[136:137], v[84:85], 0
 v_mfma_f32_32x32x8_bf16 v[60:75], v[136:137], v[100:101], 0
 s_waitcnt lgkmcnt(1)
 s_nop 7
 v_mfma_f32_32x32x16_bf16 v[44:59], v[128:131], v[76:79], v[44:59]
 s_waitcnt lgkmcnt(0)
 v_mfma_f32_32x32x16_bf16 v[44:59], v[132:135], v[80:83], v[44:59]
 v_mfma_f32_32x32x16_bf16 v[60:75], v[128:131], v[92:95], v[60:75]
 v_mfma_f32_32x32x16_bf16 v[60:75], v[132:135], v[96:99], v[60:75]
 s_nop 9
 v_add_f32 v58, 0x358637bd, v58
 v_rcp_f32 v58, v58
 s_nop 0
 v_mul_f32 v48, v48, v58
 v_mul_f32 v49, v49, v58
 v_mul_f32 v50, v50, v58
 v_mul_f32 v51, v51, v58
 v_mul_f32 v52, v52, v58
 v_mul_f32 v53, v53, v58
 v_mul_f32 v54, v54, v58
 v_mul_f32 v55, v55, v58
 v_mul_f32 v56, v56, v58
 v_mul_f32 v57, v57, v58
 v_cvt_pk_bf16_f32 v108, v48, v49
 v_cvt_pk_bf16_f32 v109, v50, v51
 v_cvt_pk_bf16_f32 v110, v52, v53
 v_cvt_pk_bf16_f32 v111, v54, v55
 v_cvt_pk_bf16_f32 v116, v56, v57
 buffer_store_dwordx4 v[108:111], v8, s[4:7], s20 offen
 v_add_f32 v74, 0x358637bd, v74
 v_rcp_f32 v74, v74
 s_nop 0
 v_pk_mul_f32 v[64:65], v[64:65], v[74:75] op_sel_hi:[1,0]
 v_pk_mul_f32 v[66:67], v[66:67], v[74:75] op_sel_hi:[1,0]
 v_pk_mul_f32 v[68:69], v[68:69], v[74:75] op_sel_hi:[1,0]
 v_pk_mul_f32 v[70:71], v[70:71], v[74:75] op_sel_hi:[1,0]
 v_pk_mul_f32 v[72:73], v[72:73], v[74:75] op_sel_hi:[1,0]
 v_cvt_pk_bf16_f32 v112, v64, v65
 v_cvt_pk_bf16_f32 v113, v66, v67
 v_cvt_pk_bf16_f32 v114, v68, v69
 v_cvt_pk_bf16_f32 v115, v70, v71
 v_cvt_pk_bf16_f32 v117, v72, v73
 buffer_store_dwordx4 v[112:115], v8, s[4:7], s21 offen
 s_nop 0
 v_permlane32_swap_b32 v116, v117
 buffer_store_dwordx2 v[116:117], v9, s[4:7], s22 offen
 s_mul_i32 s29, s53, 81920
 s_lshl_b32 s30, s58, 1
 s_add_u32 s30, s30, s59
 s_lshr_b32 s62, s3, 1
 s_mul_i32 s62, s62, 20224
 s_lshl_b32 s63, s3, 7
 s_add_u32 s62, s62, s63
 s_add_u32 s62, s62, 0
 v_bfe_u32 v168, v0, 4, 3
 v_mul_u32_u24 v168, 16, v168
 v_bfe_u32 v14, v0, 7, 1
 v_lshl_add_u32 v168, v14, 10, v168
 v_bfe_u32 v14, v0, 8, 2
 v_lshl_add_u32 v168, v14, 8, v168
 v_bfe_u32 v169, v0, 4, 3
 v_mul_u32_u24 v169, 16, v169
 v_bfe_u32 v14, v0, 7, 1
 v_lshl_add_u32 v169, v14, 2, v169
 v_bfe_u32 v14, v0, 8, 1
 v_lshl_add_u32 v169, v14, 3, v169
 v_bfe_u32 v14, v0, 9, 1
 v_lshl_add_u32 v169, v14, 8, v169
 s_add_u32 s29, s29, s62
 s_lshl_b32 s30, s30, 9
 s_add_u32 s30, s30, s29
 s_lshl_b32 s62, s57, 10
 s_add_u32 s29, s29, s62
 v_bfe_u32 v170, v0, 4, 3
 v_mul_u32_u24 v170, 16, v170
 v_bfe_u32 v14, v0, 7, 1
 v_lshl_add_u32 v170, v14, 30, v170
 v_bfe_u32 v14, v0, 8, 1
 v_lshl_add_u32 v170, v14, 29, v170
 v_bfe_u32 v14, v0, 9, 1
 v_lshl_add_u32 v170, v14, 9, v170
 s_lshl_b32 s31, s53, 2
 s_lshr_b32 s62, s3, 1
 s_add_u32 s31, s31, s62
 s_lshl_b32 s31, s31, 2
 s_lshr_b32 s62, s51, 2
 s_add_u32 s31, s31, s62
 s_lshl_b32 s31, s31, 1
 s_and_b32 s62, s3, 1
 s_add_u32 s31, s31, s62
 s_lshl_b32 s31, s31, 5
 s_and_b32 s62, s51, 3
 s_add_u32 s31, s31, s62
 s_lshl_b32 s31, s31, 2
 s_add_u32 s31, s31, 24641536
 s_lshl_b32 s32, s53, 3
 s_add_u32 s32, s32, s51
 s_lshl_b32 s32, s32, 2
 s_add_u32 s32, s32, s3
 s_lshl_b32 s32, s32, 2
 s_add_u32 s32, s32, 7733248
 v_mov_b32 v12, 1
 v_add_u32 v12, s52, v12
 s_waitcnt vmcnt(0)
 s_mov_b64 exec, 1
 buffer_store_dword v12, v0, s[4:7], s23 offen
 s_mov_b64 exec, -1
 s_add_u32 s62, s29, 40960
 s_add_u32 s63, s30, 40960
 buffer_load_dwordx4 a[176:179], v0, s[4:7], s47 offen sc1
 buffer_load_dwordx4 a[180:183], v0, s[4:7], s47 offen offset:1024 sc1
 s_mov_b32 m0, s38
 s_nop 0
 buffer_load_dwordx4 v0, s[4:7], s37 offen offset:3072 sc1  lds
 s_add_u32 s37, s37, 4096
 s_add_u32 s38, s38, 4096
 buffer_load_dwordx4 a[184:187], v0, s[4:7], s47 offen offset:2048 sc1
 buffer_load_dwordx4 a[188:191], v0, s[4:7], s47 offen offset:3072 sc1
 s_add_u32 s47, s47, 4096
 buffer_load_dwordx4 a[192:195], v0, s[4:7], s47 offen sc1
 buffer_load_dwordx4 a[196:199], v0, s[4:7], s47 offen offset:1024 sc1
 s_mov_b32 m0, s38
 s_nop 0
 buffer_load_dwordx4 v0, s[4:7], s37 offen sc1  lds
 buffer_load_dwordx4 a[200:203], v0, s[4:7], s47 offen offset:2048 sc1
 buffer_load_dwordx4 a[204:207], v0, s[4:7], s47 offen offset:3072 sc1
 s_add_u32 s47, s47, 4096
 s_add_u32 s56, s52, 1
 s_mov_b32 s55, 0
Lpoll_6:
 buffer_load_dword v12, v171, s[4:7], s28 offen sc1
 s_add_u32 s55, s55, 1
 s_cmp_gt_u32 s55, 0x80000
 s_cbranch_scc1 Lend
 s_waitcnt vmcnt(0)
 v_cmp_ne_u32 vcc, s56, v12
 s_cbranch_vccnz Lpoll_6
 buffer_load_dwordx4 v[44:47], v0, s[4:7], s24 offen sc1
 buffer_load_dwordx4 v[48:51], v0, s[4:7], s24 offen offset:1024 sc1
 buffer_load_dwordx4 v[52:55], v0, s[4:7], s24 offen offset:2048 sc1
 buffer_load_dwordx4 v[56:59], v0, s[4:7], s24 offen offset:3072 sc1
 s_add_u32 s24, s24, 4096
 buffer_load_dwordx4 v[60:63], v0, s[4:7], s24 offen sc1
 s_mul_i32 s16, s54, 81920
 s_add_u32 s16, s16, 0
 s_add_u32 s17, s16, 20480
 s_add_u32 s18, s16, 40960
 s_add_u32 s19, s16, 61440
 s_lshl_b32 s20, s54, 12
 s_add_u32 s20, s20, 24641536
 s_waitcnt vmcnt(4)
 v_mfma_f32_16x16x32_bf16 v[84:87], v[176:179], v[44:47], 0
 buffer_load_dwordx4 v[64:67], v0, s[4:7], s25 offen sc1
 v_mfma_f32_16x16x32_bf16 v[88:91], v[180:183], v[44:47], 0
 v_mfma_f32_16x16x32_bf16 v[92:95], v[184:187], v[44:47], 0
 buffer_load_dwordx4 a[208:211], v0, s[4:7], s47 offen sc1
 v_mfma_f32_16x16x32_bf16 v[96:99], v[188:191], v[44:47], 0
 v_mfma_f32_16x16x32_bf16 v[100:103], v[192:195], v[44:47], 0
 s_waitcnt vmcnt(5)
 v_mfma_f32_16x16x32_bf16 v[84:87], v[196:199], v[48:51], v[84:87]
 buffer_load_dwordx4 v[68:71], v0, s[4:7], s25 offen offset:1024 sc1
 s_mov_b32 m0, s38
 s_nop 0
 buffer_load_dwordx4 v0, s[4:7], s37 offen offset:1024 sc1  lds
 v_mfma_f32_16x16x32_bf16 v[88:91], v[200:203], v[48:51], v[88:91]
 v_mfma_f32_16x16x32_bf16 v[92:95], v[204:207], v[48:51], v[92:95]
 v_mfma_f32_16x16x32_bf16 v[96:99], v[208:211], v[48:51], v[96:99]
 buffer_load_dwordx4 a[212:215], v0, s[4:7], s47 offen offset:1024 sc1
 v_mfma_f32_16x16x32_bf16 v[100:103], v[212:215], v[48:51], v[100:103]
 s_waitcnt vmcnt(7)
 v_mfma_f32_16x16x32_bf16 v[84:87], v[216:219], v[52:55], v[84:87]
 buffer_load_dwordx4 v[72:75], v0, s[4:7], s25 offen offset:2048 sc1
 v_mfma_f32_16x16x32_bf16 v[88:91], v[220:223], v[52:55], v[88:91]
 s_mov_b32 m0, s38
 s_nop 0
 buffer_load_dwordx4 v0, s[4:7], s37 offen offset:2048 sc1  lds
 v_mfma_f32_16x16x32_bf16 v[92:95], v[224:227], v[52:55], v[92:95]
 v_mfma_f32_16x16x32_bf16 v[96:99], v[228:231], v[52:55], v[96:99]
 v_mfma_f32_16x16x32_bf16 v[100:103], v[232:235], v[52:55], v[100:103]
 s_waitcnt vmcnt(8)
 v_mfma_f32_16x16x32_bf16 v[84:87], v[236:239], v[56:59], v[84:87]
 buffer_load_dwordx4 v[76:79], v0, s[4:7], s25 offen offset:3072 sc1
 s_add_u32 s25, s25, 4096
 buffer_load_dwordx4 a[216:219], v0, s[4:7], s47 offen offset:2048 sc1
 v_mfma_f32_16x16x32_bf16 v[88:91], v[240:243], v[56:59], v[88:91]
 v_mfma_f32_16x16x32_bf16 v[92:95], v[244:247], v[56:59], v[92:95]
 v_mfma_f32_16x16x32_bf16 v[96:99], v[248:251], v[56:59], v[96:99]
 s_mov_b32 m0, s38
 s_nop 0
 buffer_load_dwordx4 v0, s[4:7], s37 offen offset:3072 sc1  lds
 s_add_u32 s37, s37, 4096
 s_add_u32 s38, s38, 4096
 v_mfma_f32_16x16x32_bf16 v[100:103], v[252:255], v[56:59], v[100:103]
 s_waitcnt vmcnt(10)
 v_mfma_f32_16x16x32_bf16 v[84:87], v[144:147], v[60:63], v[84:87]
 buffer_load_dwordx4 v[80:83], v0, s[4:7], s25 offen sc1
 v_mfma_f32_16x16x32_bf16 v[88:91], v[148:151], v[60:63], v[88:91]
 buffer_load_dwordx4 a[220:223], v0, s[4:7], s47 offen offset:3072 sc1
 s_add_u32 s47, s47, 4096
 v_mfma_f32_16x16x32_bf16 v[92:95], v[152:155], v[60:63], v[92:95]
 v_mfma_f32_16x16x32_bf16 v[96:99], v[156:159], v[60:63], v[96:99]
 v_mfma_f32_16x16x32_bf16 v[100:103], v[160:163], v[60:63], v[100:103]
 s_waitcnt vmcnt(11)
 v_mfma_f32_16x16x32_bf16 v[104:107], v[176:179], v[64:67], 0
 buffer_load_dwordx4 v[44:47], v0, s[4:7], s26 offen sc1
 buffer_load_dwordx4 a[224:227], v0, s[4:7], s47 offen sc1
 v_mfma_f32_16x16x32_bf16 v[108:111], v[180:183], v[64:67], 0
 s_waitcnt lgkmcnt(0)
 s_barrier
 v_mfma_f32_16x16x32_bf16 v[112:115], v[184:187], v[64:67], 0
 ds_write_b128 v3, v[84:87] offset:12288
 v_mfma_f32_16x16x32_bf16 v[116:119], v[188:191], v[64:67], 0
 s_mov_b32 m0, s38
 s_nop 0
 buffer_load_dwordx4 v0, s[4:7], s37 offen sc1  lds
 v_mfma_f32_16x16x32_bf16 v[120:123], v[192:195], v[64:67], 0
 s_waitcnt vmcnt(12)
 v_mfma_f32_16x16x32_bf16 v[104:107], v[196:199], v[68:71], v[104:107]
 buffer_load_dwordx4 v[48:51], v0, s[4:7], s26 offen offset:1024 sc1
 v_mfma_f32_16x16x32_bf16 v[108:111], v[200:203], v[68:71], v[108:111]
 ds_write_b128 v3, v[88:91] offset:13312
 buffer_load_dwordx4 a[228:231], v0, s[4:7], s47 offen offset:1024 sc1
 v_mfma_f32_16x16x32_bf16 v[112:115], v[204:207], v[68:71], v[112:115]
 v_mfma_f32_16x16x32_bf16 v[116:119], v[208:211], v[68:71], v[116:119]
 ds_write_b128 v3, v[92:95] offset:14336
 v_mfma_f32_16x16x32_bf16 v[120:123], v[212:215], v[68:71], v[120:123]
 s_mov_b32 m0, s38
 s_nop 0
 buffer_load_dwordx4 v0, s[4:7], s37 offen offset:1024 sc1  lds
 s_waitcnt vmcnt(12)
 v_mfma_f32_16x16x32_bf16 v[104:107], v[216:219], v[72:75], v[104:107]
 buffer_load_dwordx4 v[52:55], v0, s[4:7], s26 offen offset:2048 sc1
 v_mfma_f32_16x16x32_bf16 v[108:111], v[220:223], v[72:75], v[108:111]
 ds_write_b128 v3, v[96:99] offset:15360
 v_mfma_f32_16x16x32_bf16 v[112:115], v[224:227], v[72:75], v[112:115]
 v_mfma_f32_16x16x32_bf16 v[116:119], v[228:231], v[72:75], v[116:119]
 ds_write_b128 v3, v[100:103] offset:16384
 buffer_load_dwordx4 a[232:235], v0, s[4:7], s47 offen offset:2048 sc1
 v_mfma_f32_16x16x32_bf16 v[120:123], v[232:235], v[72:75], v[120:123]
 s_waitcnt vmcnt(12)
 v_mfma_f32_16x16x32_bf16 v[104:107], v[236:239], v[76:79], v[104:107]
 buffer_load_dwordx4 v[56:59], v0, s[4:7], s26 offen offset:3072 sc1
 s_add_u32 s26, s26, 4096
 v_mfma_f32_16x16x32_bf16 v[108:111], v[240:243], v[76:79], v[108:111]
 s_mov_b32 m0, s38
 s_nop 0
 buffer_load_dwordx4 v0, s[4:7], s37 offen offset:2048 sc1  lds
 v_mfma_f32_16x16x32_bf16 v[112:115], v[244:247], v[76:79], v[112:115]
 v_mfma_f32_16x16x32_bf16 v[116:119], v[248:251], v[76:79], v[116:119]
 s_waitcnt lgkmcnt(0)
 s_barrier
 v_mfma_f32_16x16x32_bf16 v[120:123], v[252:255], v[76:79], v[120:123]
 ds_read_b128 v[124:127], v5 offset:12288
 buffer_load_dwordx4 a[236:239], v0, s[4:7], s47 offen offset:3072 sc1
 s_sub_u32 s47, s47, 57344
 s_waitcnt vmcnt(12)
 v_mfma_f32_16x16x32_bf16 v[104:107], v[144:147], v[80:83], v[104:107]
 ds_read_b128 v[128:131], v5 offset:13312
 buffer_load_dwordx4 v[60:63], v0, s[4:7], s26 offen sc1
 v_mfma_f32_16x16x32_bf16 v[108:111], v[148:151], v[80:83], v[108:111]
 ds_read_b64 v[132:133], v6 offset:16384
 v_mfma_f32_16x16x32_bf16 v[112:115], v[152:155], v[80:83], v[112:115]
 ds_read_b128 v[134:137], v5 offset:17408
 v_mfma_f32_16x16x32_bf16 v[116:119], v[156:159], v[80:83], v[116:119]
 ds_read_b128 v[138:141], v5 offset:18432
 v_mfma_f32_16x16x32_bf16 v[120:123], v[160:163], v[80:83], v[120:123]
 ds_read_b64 v[142:143], v6 offset:21504
 s_waitcnt lgkmcnt(0)
 s_barrier
 ds_write_b128 v4, v[104:107] offset:12288
 v_pk_add_f32 v[16:17], v[16:17], v[124:125]
 v_pk_add_f32 v[18:19], v[18:19], v[126:127]
 v_pk_add_f32 v[20:21], v[20:21], v[128:129]
 ds_write_b128 v4, v[108:111] offset:13312
 v_pk_add_f32 v[22:23], v[22:23], v[130:131]
 v_pk_add_f32 v[24:25], v[24:25], v[132:133]
 v_pk_add_f32 v[16:17], v[16:17], v[134:135]
 ds_write_b128 v4, v[112:115] offset:14336
 v_pk_add_f32 v[18:19], v[18:19], v[136:137]
 v_pk_add_f32 v[20:21], v[20:21], v[138:139]
 v_pk_add_f32 v[22:23], v[22:23], v[140:141]
 ds_write_b128 v4, v[116:119] offset:15360
 v_pk_add_f32 v[24:25], v[24:25], v[142:143]
 buffer_load_dwordx4 v[64:67], v0, s[4:7], s27 offen sc1
 buffer_load_dwordx4 v[68:71], v0, s[4:7], s27 offen offset:1024 sc1
 ds_write_b128 v4, v[120:123] offset:16384
 buffer_load_dwordx4 v[72:75], v0, s[4:7], s27 offen offset:2048 sc1
 buffer_load_dwordx4 v[76:79], v0, s[4:7], s27 offen offset:3072 sc1
 s_add_u32 s27, s27, 4096
 buffer_load_dwordx4 v[80:83], v0, s[4:7], s27 offen sc1
 s_waitcnt lgkmcnt(0)
 s_barrier
 ds_read_b128 v[124:127], v5 offset:12288
 ds_read_b128 v[128:131], v5 offset:13312
 ds_read_b64 v[132:133], v6 offset:16384
 ds_read_b128 v[134:137], v5 offset:17408
 ds_read_b128 v[138:141], v5 offset:18432
 ds_read_b64 v[142:143], v6 offset:21504
 s_waitcnt lgkmcnt(5)
 v_pk_add_f32 v[16:17], v[16:17], v[124:125]
 v_pk_add_f32 v[18:19], v[18:19], v[126:127]
 s_waitcnt lgkmcnt(4)
 v_pk_add_f32 v[20:21], v[20:21], v[128:129]
 v_pk_add_f32 v[22:23], v[22:23], v[130:131]
 s_waitcnt lgkmcnt(3)
 v_pk_add_f32 v[24:25], v[24:25], v[132:133]
 s_waitcnt lgkmcnt(2)
 v_pk_add_f32 v[16:17], v[16:17], v[134:135]
 v_pk_add_f32 v[18:19], v[18:19], v[136:137]
 s_waitcnt lgkmcnt(1)
 v_pk_add_f32 v[20:21], v[20:21], v[138:139]
 v_pk_add_f32 v[22:23], v[22:23], v[140:141]
 s_waitcnt lgkmcnt(0)
 v_pk_add_f32 v[24:25], v[24:25], v[142:143]
 v_cvt_pk_bf16_f32 v124, v16, v17
 v_cvt_pk_bf16_f32 v125, v18, v19
 v_cvt_pk_bf16_f32 v126, v20, v21
 v_cvt_pk_bf16_f32 v127, v22, v23
 v_cvt_pk_bf16_f32 v128, v24, v25
 buffer_store_dwordx4 v[124:127], v168, s[8:11], s29 offen
 buffer_store_dword v128, v169, s[8:11], s30 offen
 v_pk_add_f32 v[130:131], v[16:17], v[18:19]
 v_pk_mul_f32 v[132:133], v[16:17], v[16:17]
 v_pk_fma_f32 v[132:133], v[18:19], v[18:19], v[132:133]
 v_pk_add_f32 v[130:131], v[130:131], v[20:21]
 v_pk_fma_f32 v[132:133], v[20:21], v[20:21], v[132:133]
 v_pk_add_f32 v[130:131], v[130:131], v[22:23]
 v_pk_fma_f32 v[132:133], v[22:23], v[22:23], v[132:133]
 v_pk_add_f32 v[130:131], v[130:131], v[24:25]
 v_pk_fma_f32 v[132:133], v[24:25], v[24:25], v[132:133]
 v_add_f32 v130, v130, v131
 v_add_f32 v132, v132, v133
 s_nop 1
 v_permlane32_swap_b32 v130, v132
 v_add_f32 v131, v130, v132
 v_add_f32 v130, v130, v132
 s_nop 1
 v_permlane16_swap_b32 v130, v131
 v_add_f32 v130, v130, v131
 s_nop 1
 v_add_f32_dpp v130, v130, v130 row_ror:8 row_mask:0xf bank_mask:0xf
 buffer_store_dword v130, v170, s[4:7], s31 offen
 s_add_u32 s29, s29, 40960
 s_add_u32 s30, s30, 40960
 s_add_u32 s31, s31, 2048
 s_waitcnt vmcnt(19)
 v_mfma_f32_16x16x32_bf16 v[84:87], v[176:179], v[44:47], 0
 buffer_load_dwordx4 a[0:3], v0, s[4:7], s47 offen sc1
 v_mfma_f32_16x16x32_bf16 v[88:91], v[180:183], v[44:47], 0
 v_mfma_f32_16x16x32_bf16 v[92:95], v[184:187], v[44:47], 0
 v_mfma_f32_16x16x32_bf16 v[96:99], v[188:191], v[44:47], 0
 buffer_load_dwordx4 a[4:7], v0, s[4:7], s47 offen offset:1024 sc1
 v_mfma_f32_16x16x32_bf16 v[100:103], v[192:195], v[44:47], 0
 s_waitcnt vmcnt(18)
 v_mfma_f32_16x16x32_bf16 v[84:87], v[196:199], v[48:51], v[84:87]
 v_mfma_f32_16x16x32_bf16 v[88:91], v[200:203], v[48:51], v[88:91]
 buffer_load_dwordx4 a[8:11], v0, s[4:7], s47 offen offset:2048 sc1
 v_mfma_f32_16x16x32_bf16 v[92:95], v[204:207], v[48:51], v[92:95]
 v_mfma_f32_16x16x32_bf16 v[96:99], v[208:211], v[48:51], v[96:99]
 v_mfma_f32_16x16x32_bf16 v[100:103], v[212:215], v[48:51], v[100:103]
 s_waitcnt vmcnt(16)
 v_mfma_f32_16x16x32_bf16 v[84:87], v[216:219], v[52:55], v[84:87]
 buffer_load_dwordx4 a[12:15], v0, s[4:7], s47 offen offset:3072 sc1
 s_add_u32 s47, s47, 4096
 v_mfma_f32_16x16x32_bf16 v[88:91], v[220:223], v[52:55], v[88:91]
 v_mfma_f32_16x16x32_bf16 v[92:95], v[224:227], v[52:55], v[92:95]
 v_mfma_f32_16x16x32_bf16 v[96:99], v[228:231], v[52:55], v[96:99]
 buffer_load_dwordx4 a[16:19], v0, s[4:7], s47 offen sc1
 v_mfma_f32_16x16x32_bf16 v[100:103], v[232:235], v[52:55], v[100:103]
 s_waitcnt vmcnt(16)
 v_mfma_f32_16x16x32_bf16 v[84:87], v[236:239], v[56:59], v[84:87]
 v_mfma_f32_16x16x32_bf16 v[88:91], v[240:243], v[56:59], v[88:91]
 buffer_load_dwordx4 a[20:23], v0, s[4:7], s47 offen offset:1024 sc1
 v_mfma_f32_16x16x32_bf16 v[92:95], v[244:247], v[56:59], v[92:95]
 v_mfma_f32_16x16x32_bf16 v[96:99], v[248:251], v[56:59], v[96:99]
 v_mfma_f32_16x16x32_bf16 v[100:103], v[252:255], v[56:59], v[100:103]
 s_waitcnt vmcnt(14)
 v_mfma_f32_16x16x32_bf16 v[84:87], v[144:147], v[60:63], v[84:87]
 buffer_load_dwordx4 a[24:27], v0, s[4:7], s47 offen offset:2048 sc1
 v_mfma_f32_16x16x32_bf16 v[88:91], v[148:151], v[60:63], v[88:91]
 v_mfma_f32_16x16x32_bf16 v[92:95], v[152:155], v[60:63], v[92:95]
 v_mfma_f32_16x16x32_bf16 v[96:99], v[156:159], v[60:63], v[96:99]
 buffer_load_dwordx4 a[28:31], v0, s[4:7], s47 offen offset:3072 sc1
 s_add_u32 s47, s47, 4096
 v_mfma_f32_16x16x32_bf16 v[100:103], v[160:163], v[60:63], v[100:103]
 v_mov_b32 v15, 2
 v_add_u32 v15, s52, v15
 s_waitcnt vmcnt(8)
 s_mov_b64 exec, 1
 buffer_store_dword v15, v0, s[4:7], s32 offen
 s_mov_b64 exec, -1
 s_add_u32 s32, s32, 12288
 v_mfma_f32_16x16x32_bf16 v[104:107], v[176:179], v[64:67], 0
 v_mfma_f32_16x16x32_bf16 v[108:111], v[180:183], v[64:67], 0
 s_waitcnt lgkmcnt(0)
 s_barrier
 buffer_load_dwordx4 a[32:35], v0, s[4:7], s47 offen sc1
 v_mfma_f32_16x16x32_bf16 v[112:115], v[184:187], v[64:67], 0
 ds_write_b128 v3, v[84:87] offset:12288
 v_mfma_f32_16x16x32_bf16 v[116:119], v[188:191], v[64:67], 0
 v_mfma_f32_16x16x32_bf16 v[120:123], v[192:195], v[64:67], 0
 v_mfma_f32_16x16x32_bf16 v[104:107], v[196:199], v[68:71], v[104:107]
 buffer_load_dwordx4 a[36:39], v0, s[4:7], s47 offen offset:1024 sc1
 v_mfma_f32_16x16x32_bf16 v[108:111], v[200:203], v[68:71], v[108:111]
 ds_write_b128 v3, v[88:91] offset:13312
 v_mfma_f32_16x16x32_bf16 v[112:115], v[204:207], v[68:71], v[112:115]
 v_mfma_f32_16x16x32_bf16 v[116:119], v[208:211], v[68:71], v[116:119]
 ds_write_b128 v3, v[92:95] offset:14336
 buffer_load_dwordx4 a[40:43], v0, s[4:7], s47 offen offset:2048 sc1
 v_mfma_f32_16x16x32_bf16 v[120:123], v[212:215], v[68:71], v[120:123]
 v_mfma_f32_16x16x32_bf16 v[104:107], v[216:219], v[72:75], v[104:107]
 v_mfma_f32_16x16x32_bf16 v[108:111], v[220:223], v[72:75], v[108:111]
 ds_write_b128 v3, v[96:99] offset:15360
 buffer_load_dwordx4 a[44:47], v0, s[4:7], s47 offen offset:3072 sc1
 s_add_u32 s47, s47, 4096
 v_mfma_f32_16x16x32_bf16 v[112:115], v[224:227], v[72:75], v[112:115]
 v_mfma_f32_16x16x32_bf16 v[116:119], v[228:231], v[72:75], v[116:119]
 ds_write_b128 v3, v[100:103] offset:16384
 v_mfma_f32_16x16x32_bf16 v[120:123], v[232:235], v[72:75], v[120:123]
 v_mfma_f32_16x16x32_bf16 v[104:107], v[236:239], v[76:79], v[104:107]
 v_mfma_f32_16x16x32_bf16 v[108:111], v[240:243], v[76:79], v[108:111]
 v_mfma_f32_16x16x32_bf16 v[112:115], v[244:247], v[76:79], v[112:115]
 v_mfma_f32_16x16x32_bf16 v[116:119], v[248:251], v[76:79], v[116:119]
 s_waitcnt lgkmcnt(0)
 s_barrier
 v_mfma_f32_16x16x32_bf16 v[120:123], v[252:255], v[76:79], v[120:123]
 ds_read_b128 v[124:127], v5 offset:12288
 v_mfma_f32_16x16x32_bf16 v[104:107], v[144:147], v[80:83], v[104:107]
 ds_read_b128 v[128:131], v5 offset:13312
 v_mfma_f32_16x16x32_bf16 v[108:111], v[148:151], v[80:83], v[108:111]
 ds_read_b64 v[132:133], v6 offset:16384
 s_lshl_b32 s33, s54, 7
 s_add_u32 s33, s33, 7733248
 s_add_u32 s56, s52, 2
 buffer_load_dword v12, v172, s[4:7], s33 offen sc1
 v_mfma_f32_16x16x32_bf16 v[112:115], v[152:155], v[80:83], v[112:115]
 ds_read_b128 v[134:137], v5 offset:17408
 v_mfma_f32_16x16x32_bf16 v[116:119], v[156:159], v[80:83], v[116:119]
 ds_read_b128 v[138:141], v5 offset:18432
 v_mfma_f32_16x16x32_bf16 v[120:123], v[160:163], v[80:83], v[120:123]
 ds_read_b64 v[142:143], v6 offset:21504
 s_waitcnt lgkmcnt(0)
 s_barrier
 ds_write_b128 v4, v[104:107] offset:12288
 v_pk_add_f32 v[26:27], v[26:27], v[124:125]
 v_pk_add_f32 v[28:29], v[28:29], v[126:127]
 v_pk_add_f32 v[30:31], v[30:31], v[128:129]
 ds_write_b128 v4, v[108:111] offset:13312
 v_pk_add_f32 v[32:33], v[32:33], v[130:131]
 v_pk_add_f32 v[34:35], v[34:35], v[132:133]
 v_pk_add_f32 v[26:27], v[26:27], v[134:135]
 ds_write_b128 v4, v[112:115] offset:14336
 v_pk_add_f32 v[28:29], v[28:29], v[136:137]
 v_pk_add_f32 v[30:31], v[30:31], v[138:139]
 v_pk_add_f32 v[32:33], v[32:33], v[140:141]
 ds_write_b128 v4, v[116:119] offset:15360
 v_pk_add_f32 v[34:35], v[34:35], v[142:143]
 ds_read_b128 v[176:179], v1 offset:16384
 ds_read_b128 v[180:183], v1 offset:17408
 s_waitcnt vmcnt(0)
 v_cmp_ne_u32 vcc, s56, v12
 s_cbranch_vccz Lgate_7
 s_mov_b32 s55, 0
Lpoll_8:
 buffer_load_dword v12, v172, s[4:7], s33 offen sc1
 s_add_u32 s55, s55, 1
 s_cmp_gt_u32 s55, 0x80000
 s_cbranch_scc1 Lend
 s_waitcnt vmcnt(0)
 v_cmp_ne_u32 vcc, s56, v12
 s_cbranch_vccnz Lpoll_8
Lgate_7:
 s_add_u32 s33, s33, 12288
 buffer_load_dwordx4 v[44:47], v0, s[8:11], s16 offen sc1
 buffer_load_dwordx4 v[48:51], v0, s[8:11], s17 offen sc1
 ds_write_b128 v4, v[120:123] offset:16384
 buffer_load_dwordx4 v[52:55], v0, s[8:11], s16 offen offset:1024 sc1
 buffer_load_dwordx4 v[56:59], v0, s[8:11], s17 offen offset:1024 sc1
 buffer_load_dwordx4 v[60:63], v0, s[8:11], s16 offen offset:2048 sc1
 buffer_load_dwordx4 v[64:67], v0, s[8:11], s17 offen offset:2048 sc1
 buffer_load_dwordx4 v[68:71], v0, s[8:11], s16 offen offset:3072 sc1
 s_add_u32 s16, s16, 4096
 ds_read_b128 v[184:187], v1 offset:18432
 ds_read_b128 v[188:191], v1 offset:19456
 ds_read_b128 v[192:195], v1 offset:20480
 s_waitcnt lgkmcnt(0)
 s_barrier
 ds_read_b128 v[124:127], v5 offset:12288
 ds_read_b128 v[128:131], v5 offset:13312
 ds_read_b64 v[132:133], v6 offset:16384
 ds_read_b128 v[134:137], v5 offset:17408
 ds_read_b128 v[138:141], v5 offset:18432
 ds_read_b64 v[142:143], v6 offset:21504
 buffer_load_dwordx4 v[72:75], v0, s[8:11], s17 offen offset:3072 sc1
 s_add_u32 s17, s17, 4096
 buffer_load_dwordx4 v[76:79], v0, s[8:11], s16 offen sc1
 buffer_load_dwordx4 v[80:83], v0, s[8:11], s17 offen sc1
 s_waitcnt vmcnt(9)
 v_mfma_f32_16x16x32_bf16 v[212:215], v[176:179], v[44:47], 0
 v_mfma_f32_16x16x32_bf16 v[216:219], v[180:183], v[44:47], 0
 ds_read_b128 v[196:199], v1 offset:21504
 v_mfma_f32_16x16x32_bf16 v[220:223], v[184:187], v[44:47], 0
 s_waitcnt lgkmcnt(6)
 v_add_f32 v26, v26, v124
 v_add_f32 v27, v27, v125
 s_waitcnt vmcnt(8)
 v_mfma_f32_16x16x32_bf16 v[224:227], v[176:179], v[48:51], 0
 ds_read_b128 v[200:203], v1 offset:22528
 v_add_f32 v28, v28, v126
 v_add_f32 v29, v29, v127
 s_waitcnt lgkmcnt(6)
 v_add_f32 v30, v30, v128
 v_mfma_f32_16x16x32_bf16 v[228:231], v[180:183], v[48:51], 0
 v_add_f32 v31, v31, v129
 v_add_f32 v32, v32, v130
 v_add_f32 v33, v33, v131
 v_mfma_f32_16x16x32_bf16 v[232:235], v[184:187], v[48:51], 0
 ds_read_b128 v[204:207], v1 offset:23552
 s_waitcnt lgkmcnt(6)
 v_add_f32 v34, v34, v132
 v_add_f32 v35, v35, v133
 s_waitcnt vmcnt(7) lgkmcnt(2)
 v_mfma_f32_16x16x32_bf16 v[212:215], v[188:191], v[52:55], v[212:215]
 v_add_f32 v26, v26, v134
 v_add_f32 v27, v27, v135
 v_add_f32 v28, v28, v136
 v_mfma_f32_16x16x32_bf16 v[216:219], v[192:195], v[52:55], v[216:219]
 ds_read_b128 v[208:211], v1 offset:24576
 v_add_f32 v29, v29, v137
 v_add_f32 v30, v30, v138
 v_add_f32 v31, v31, v139
 v_mfma_f32_16x16x32_bf16 v[220:223], v[196:199], v[52:55], v[220:223]
 v_add_f32 v32, v32, v140
 v_add_f32 v33, v33, v141
 s_waitcnt vmcnt(6)
 v_mfma_f32_16x16x32_bf16 v[224:227], v[188:191], v[56:59], v[224:227]
 ds_read_b128 v[176:179], v1 offset:25600
 buffer_load_dwordx4 v[44:47], v0, s[8:11], s16 offen offset:1024 sc1
 v_add_f32 v34, v34, v142
 v_add_f32 v35, v35, v143
 v_mfma_f32_16x16x32_bf16 v[228:231], v[192:195], v[56:59], v[228:231]
 v_cvt_pk_bf16_f32 v124, v26, v27
 v_cvt_pk_bf16_f32 v125, v28, v29
 v_cvt_pk_bf16_f32 v126, v30, v31
 v_mfma_f32_16x16x32_bf16 v[232:235], v[196:199], v[56:59], v[232:235]
 ds_read_b128 v[180:183], v1 offset:26624
 v_cvt_pk_bf16_f32 v127, v32, v33
 v_cvt_pk_bf16_f32 v128, v34, v35
 s_waitcnt vmcnt(6) lgkmcnt(2)
 v_mfma_f32_16x16x32_bf16 v[212:215], v[200:203], v[60:63], v[212:215]
 buffer_load_dwordx4 v[48:51], v0, s[8:11], s17 offen offset:1024 sc1
 v_mfma_f32_16x16x32_bf16 v[216:219], v[204:207], v[60:63], v[216:219]
 ds_read_b128 v[184:187], v1 offset:27648
 v_mfma_f32_16x16x32_bf16 v[220:223], v[208:211], v[60:63], v[220:223]
 buffer_load_dwordx4 v[236:239], v0, s[4:7], s20 offen sc1
 s_waitcnt vmcnt(7)
 v_mfma_f32_16x16x32_bf16 v[224:227], v[200:203], v[64:67], v[224:227]
 ds_read_b128 v[188:191], v1 offset:28672
 buffer_load_dwordx4 v[52:55], v0, s[8:11], s16 offen offset:2048 sc1
 v_mfma_f32_16x16x32_bf16 v[228:231], v[204:207], v[64:67], v[228:231]
 buffer_store_dwordx4 v[124:127], v168, s[8:11], s29 offen
 v_mfma_f32_16x16x32_bf16 v[232:235], v[208:211], v[64:67], v[232:235]
 ds_read_b128 v[192:195], v1 offset:29696
 buffer_store_dword v128, v169, s[8:11], s30 offen
 s_waitcnt vmcnt(9) lgkmcnt(2)
 v_mfma_f32_16x16x32_bf16 v[212:215], v[176:179], v[68:71], v[212:215]
 buffer_load_dwordx4 v[56:59], v0, s[8:11], s17 offen offset:2048 sc1
 v_add_f32 v130, v26, v27
 v_mul_f32 v132, v26, v26
 v_mfma_f32_16x16x32_bf16 v[216:219], v[180:183], v[68:71], v[216:219]
 ds_read_b128 v[196:199], v1 offset:30720
 v_fmac_f32 v132, v27, v27
 v_add_f32 v130, v130, v28
 v_fmac_f32 v132, v28, v28
 v_mfma_f32_16x16x32_bf16 v[220:223], v[184:187], v[68:71], v[220:223]
 buffer_load_dwordx4 v[240:243], v0, s[4:7], s20 offen offset:1024 sc1
 v_add_f32 v130, v130, v29
 s_waitcnt vmcnt(10)
 v_mfma_f32_16x16x32_bf16 v[224:227], v[176:179], v[72:75], v[224:227]
 ds_read_b128 v[200:203], v1 offset:31744
 buffer_load_dwordx4 v[60:63], v0, s[8:11], s16 offen offset:3072 sc1
 s_add_u32 s16, s16, 4096
 v_fmac_f32 v132, v29, v29
 v_mfma_f32_16x16x32_bf16 v[228:231], v[180:183], v[72:75], v[228:231]
 v_add_f32 v130, v130, v30
 v_fmac_f32 v132, v30, v30
 v_add_f32 v130, v130, v31
 v_mfma_f32_16x16x32_bf16 v[232:235], v[184:187], v[72:75], v[232:235]
 ds_read_b128 v[204:207], v1 offset:32768
 v_fmac_f32 v132, v31, v31
 v_add_f32 v130, v130, v32
 s_waitcnt vmcnt(10) lgkmcnt(2)
 v_mfma_f32_16x16x32_bf16 v[212:215], v[188:191], v[76:79], v[212:215]
 buffer_load_dwordx4 v[64:67], v0, s[8:11], s17 offen offset:3072 sc1
 s_add_u32 s17, s17, 4096
 v_fmac_f32 v132, v32, v32
 s_barrier
 s_mul_i32 s22, s49, 5120
 s_mul_i32 s23, s3, 1280
 s_add_u32 s22, s22, s23
 s_add_u32 s22, s22, 7569408
 s_add_u32 m0, s23, 143360
 v_lshrrev_b32 v13, 2, v0
 buffer_load_dwordx4 v0, s[4:7], s22 offen sc1 lds
 buffer_load_dword v13, s[4:7], s22 offen offset:1024 sc1 lds
 v_mfma_f32_16x16x32_bf16 v[216:219], v[192:195], v[76:79], v[216:219]
 ds_read_b128 v[208:211], v1 offset:33792
 v_add_f32 v130, v130, v33
 v_fmac_f32 v132, v33, v33
 v_add_f32 v130, v130, v34
 v_mfma_f32_16x16x32_bf16 v[220:223], v[196:199], v[76:79], v[220:223]
 v_fmac_f32 v132, v34, v34
 v_add_f32 v130, v130, v35
 s_mul_i32 s35, s54, 196608
 s_waitcnt vmcnt(12)
 v_mfma_f32_16x16x32_bf16 v[224:227], v[188:191], v[80:83], v[224:227]
 ds_read_b128 v[176:179], v1 offset:34816
 buffer_load_dwordx4 v[68:71], v0, s[8:11], s16 offen sc1
 v_fmac_f32 v132, v35, v35
 s_add_u32 s35, s35, 18350080
 v_mfma_f32_16x16x32_bf16 v[228:231], v[192:195], v[80:83], v[228:231]
 v_permlane32_swap_b32 v130, v132
 v_add_f32 v131, v130, v132
 s_lshr_b32 s34, s49, 1
 v_mfma_f32_16x16x32_bf16 v[232:235], v[196:199], v[80:83], v[232:235]
 ds_read_b128 v[180:183], v1 offset:35840
 v_add_f32 v130, v130, v132
 s_mul_i32 s34, s34, 3072
 s_waitcnt vmcnt(12) lgkmcnt(2)
 v_mfma_f32_16x16x32_bf16 v[212:215], v[200:203], v[44:47], v[212:215]
 buffer_load_dwordx4 v[72:75], v0, s[8:11], s17 offen sc1
 v_permlane16_swap_b32 v130, v131
 buffer_load_dwordx4 a[48:51], v0, s[4:7], s47 offen sc1
 v_mfma_f32_16x16x32_bf16 v[216:219], v[204:207], v[44:47], v[216:219]
 ds_read_b128 v[184:187], v1 offset:36864
 v_add_f32 v130, v130, v131
 s_nop 1
 v_add_f32_dpp v130, v130, v130 row_ror:8 row_mask:0xf bank_mask:0xf
 s_add_u32 s35, s35, s34
 v_mfma_f32_16x16x32_bf16 v[220:223], v[208:211], v[44:47], v[220:223]
 buffer_store_dword v130, v170, s[4:7], s31 offen
 s_lshl_b32 s34, s59, 11
 s_waitcnt vmcnt(14)
 v_mfma_f32_16x16x32_bf16 v[224:227], v[200:203], v[48:51], v[224:227]
 ds_read_b128 v[188:191], v1 offset:37888
 buffer_load_dwordx4 v[76:79], v0, s[8:11], s16 offen offset:1024 sc1
 s_add_u32 s34, s34, s35
 s_lshl_b32 s36, s59, 9
 v_mfma_f32_16x16x32_bf16 v[228:231], v[204:207], v[48:51], v[228:231]
 s_add_u32 s35, s35, s36
 s_lshl_b32 s36, s54, 7
 s_add_u32 s36, s36, 7737344
 s_lshl_b32 s21, s49, 2
 v_mfma_f32_16x16x32_bf16 v[232:235], v[208:211], v[48:51], v[232:235]
 ds_read_b128 v[192:195], v1 offset:38912
 s_add_u32 s36, s36, s21
 s_mul_i32 s24, s53, 196608
 s_waitcnt vmcnt(13) lgkmcnt(2)
 v_mfma_f32_16x16x32_bf16 v[212:215], v[176:179], v[52:55], v[212:215]
 buffer_load_dwordx4 v[80:83], v0, s[8:11], s17 offen offset:1024 sc1
 s_add_u32 s24, s24, 18350080
 s_mul_i32 s25, s3, 12288
 s_add_u32 s24, s24, s25
 v_mfma_f32_16x16x32_bf16 v[216:219], v[180:183], v[52:55], v[216:219]
 ds_read_b128 v[196:199], v1 offset:39936
 s_lshr_b32 s26, s3, 1
 s_mul_i32 s26, s26, 49152
 s_add_u32 s25, s24, 49152
 v_mfma_f32_16x16x32_bf16 v[220:223], v[184:187], v[52:55], v[220:223]
 buffer_load_dwordx4 a[52:55], v0, s[4:7], s47 offen offset:1024 sc1
 s_sub_u32 s25, s25, s26
 s_add_u32 s24, s24, s26
 s_waitcnt vmcnt(12)
 v_mfma_f32_16x16x32_bf16 v[224:227], v[176:179], v[56:59], v[224:227]
 ds_read_b128 v[200:203], v1 offset:40960
 buffer_load_dwordx4 v[44:47], v0, s[8:11], s16 offen offset:2048 sc1
 s_add_u32 s26, s24, 98304
 s_add_u32 s27, s25, 98304
 v_mfma_f32_16x16x32_bf16 v[228:231], v[180:183], v[56:59], v[228:231]
 s_mov_b32 s44, 0
 s_mov_b32 s45, 0xffff0000
 v_mfma_f32_16x16x32_bf16 v[232:235], v[184:187], v[56:59], v[232:235]
 ds_read_b128 v[204:207], v1 offset:41984
 s_waitcnt vmcnt(11) lgkmcnt(2)
 v_mfma_f32_16x16x32_bf16 v[212:215], v[188:191], v[60:63], v[212:215]
 buffer_load_dwordx4 v[48:51], v0, s[8:11], s17 offen offset:2048 sc1
 v_mfma_f32_16x16x32_bf16 v[216:219], v[192:195], v[60:63], v[216:219]
 ds_read_b128 v[208:211], v1 offset:43008
 v_mfma_f32_16x16x32_bf16 v[220:223], v[196:199], v[60:63], v[220:223]
 s_waitcnt vmcnt(11)
 v_mfma_f32_16x16x32_bf16 v[224:227], v[188:191], v[64:67], v[224:227]
 ds_read_b128 v[176:179], v1 offset:44032
 buffer_load_dwordx4 v[52:55], v0, s[8:11], s16 offen offset:3072 sc1
 s_add_u32 s16, s16, 4096
 v_mfma_f32_16x16x32_bf16 v[228:231], v[192:195], v[64:67], v[228:231]
 v_mfma_f32_16x16x32_bf16 v[232:235], v[196:199], v[64:67], v[232:235]
 ds_read_b128 v[180:183], v1 offset:45056
 buffer_load_dwordx4 a[56:59], v0, s[4:7], s47 offen offset:2048 sc1
 s_waitcnt vmcnt(10) lgkmcnt(2)
 v_mfma_f32_16x16x32_bf16 v[212:215], v[200:203], v[68:71], v[212:215]
 buffer_load_dwordx4 v[56:59], v0, s[8:11], s17 offen offset:3072 sc1
 s_add_u32 s17, s17, 4096
 v_mov_b32 v15, 2
 v_add_u32 v15, s52, v15
 s_waitcnt vmcnt(8)
 s_mov_b64 exec, 1
 buffer_store_dword v15, v0, s[4:7], s32 offen
 s_mov_b64 exec, -1
 v_mfma_f32_16x16x32_bf16 v[216:219], v[204:207], v[68:71], v[216:219]
 ds_read_b128 v[184:187], v1 offset:46080
 v_mfma_f32_16x16x32_bf16 v[220:223], v[208:211], v[68:71], v[220:223]
 v_mfma_f32_16x16x32_bf16 v[224:227], v[200:203], v[72:75], v[224:227]
 ds_read_b128 v[188:191], v1 offset:47104
 buffer_load_dwordx4 v[60:63], v0, s[8:11], s16 offen sc1
 v_mfma_f32_16x16x32_bf16 v[228:231], v[204:207], v[72:75], v[228:231]
 v_mfma_f32_16x16x32_bf16 v[232:235], v[208:211], v[72:75], v[232:235]
 ds_read_b128 v[192:195], v1 offset:48128
 s_waitcnt vmcnt(9) lgkmcnt(2)
 v_mfma_f32_16x16x32_bf16 v[212:215], v[176:179], v[76:79], v[212:215]
 buffer_load_dwordx4 v[64:67], v0, s[8:11], s17 offen sc1
 v_mfma_f32_16x16x32_bf16 v[216:219], v[180:183], v[76:79], v[216:219]
 ds_read_b128 v[196:199], v1 offset:49152
 v_mfma_f32_16x16x32_bf16 v[220:223], v[184:187], v[76:79], v[220:223]
 buffer_load_dwordx4 a[60:63], v0, s[4:7], s47 offen offset:3072 sc1
 s_add_u32 s47, s47, 4096
 s_waitcnt vmcnt(10)
 v_mfma_f32_16x16x32_bf16 v[224:227], v[176:179], v[80:83], v[224:227]
 ds_read_b128 v[200:203], v1 offset:50176
 buffer_load_dwordx4 v[68:71], v0, s[8:11], s16 offen offset:1024 sc1
 v_mfma_f32_16x16x32_bf16 v[228:231], v[180:183], v[80:83], v[228:231]
 v_mfma_f32_16x16x32_bf16 v[232:235], v[184:187], v[80:83], v[232:235]
 ds_read_b128 v[204:207], v1 offset:51200
 s_waitcnt vmcnt(9) lgkmcnt(2)
 v_mfma_f32_16x16x32_bf16 v[212:215], v[188:191], v[44:47], v[212:215]
 buffer_load_dwordx4 v[72:75], v0, s[8:11], s17 offen offset:1024 sc1
 v_mfma_f32_16x16x32_bf16 v[216:219], v[192:195], v[44:47], v[216:219]
 ds_read_b128 v[208:211], v1 offset:52224
 v_mfma_f32_16x16x32_bf16 v[220:223], v[196:199], v[44:47], v[220:223]
 s_waitcnt vmcnt(9)
 v_mfma_f32_16x16x32_bf16 v[224:227], v[188:191], v[48:51], v[224:227]
 ds_read_b128 v[176:179], v1 offset:53248
 buffer_load_dwordx4 v[76:79], v0, s[8:11], s16 offen offset:2048 sc1
 v_mfma_f32_16x16x32_bf16 v[228:231], v[192:195], v[48:51], v[228:231]
 v_mfma_f32_16x16x32_bf16 v[232:235], v[196:199], v[48:51], v[232:235]
 ds_read_b128 v[180:183], v1 offset:54272
 buffer_load_dwordx4 a[64:67], v0, s[4:7], s47 offen sc1
 s_waitcnt vmcnt(10) lgkmcnt(2)
 v_mfma_f32_16x16x32_bf16 v[212:215], v[200:203], v[52:55], v[212:215]
 buffer_load_dwordx4 v[80:83], v0, s[8:11], s17 offen offset:2048 sc1
 v_mfma_f32_16x16x32_bf16 v[216:219], v[204:207], v[52:55], v[216:219]
 ds_read_b128 v[184:187], v1 offset:55296
 v_mfma_f32_16x16x32_bf16 v[220:223], v[208:211], v[52:55], v[220:223]
 s_waitcnt vmcnt(9)
 v_mfma_f32_16x16x32_bf16 v[224:227], v[200:203], v[56:59], v[224:227]
 ds_read_b128 v[188:191], v1 offset:56320
 buffer_load_dwordx4 v[44:47], v0, s[8:11], s16 offen offset:3072 sc1
 s_add_u32 s16, s16, 4096
 v_mfma_f32_16x16x32_bf16 v[228:231], v[204:207], v[56:59], v[228:231]
 s_barrier
 v_mfma_f32_16x16x32_bf16 v[232:235], v[208:211], v[56:59], v[232:235]
 ds_read_b128 v[192:195], v1 offset:57344
 buffer_load_dwordx2 v[104:105], v0, s[4:7], s34 offen sc1
 s_waitcnt vmcnt(9) lgkmcnt(2)
 v_mfma_f32_16x16x32_bf16 v[212:215], v[176:179], v[60:63], v[212:215]
 buffer_load_dwordx4 v[48:51], v0, s[8:11], s17 offen offset:3072 sc1
 s_add_u32 s17, s17, 4096
 v_mfma_f32_16x16x32_bf16 v[216:219], v[180:183], v[60:63], v[216:219]
 ds_read_b128 v[196:199], v1 offset:58368
 buffer_load_dwordx4 a[68:71], v0, s[4:7], s47 offen offset:1024 sc1
 s_add_u32 s23, s34, 49152
 buffer_load_dwordx2 v[104:105], v0, s[4:7], s23 offen sc1
 v_mfma_f32_16x16x32_bf16 v[220:223], v[184:187], v[60:63], v[220:223]
 s_waitcnt vmcnt(11)
 v_mfma_f32_16x16x32_bf16 v[224:227], v[176:179], v[64:67], v[224:227]
 ds_read_b128 v[200:203], v1 offset:59392
 buffer_load_dwordx4 v[52:55], v0, s[8:11], s16 offen sc1
 buffer_load_dwordx2 v[104:105], v7, s[4:7], s35 offen offset:1024 sc1
 v_mfma_f32_16x16x32_bf16 v[228:231], v[180:183], v[64:67], v[228:231]
 v_mfma_f32_16x16x32_bf16 v[232:235], v[184:187], v[64:67], v[232:235]
 ds_read_b128 v[204:207], v1 offset:60416
 s_waitcnt vmcnt(11) lgkmcnt(2)
 v_mfma_f32_16x16x32_bf16 v[212:215], v[188:191], v[68:71], v[212:215]
 buffer_load_dwordx4 v[56:59], v0, s[8:11], s17 offen sc1
 v_mfma_f32_16x16x32_bf16 v[216:219], v[192:195], v[68:71], v[216:219]
 ds_read_b128 v[208:211], v1 offset:61440
 v_mfma_f32_16x16x32_bf16 v[220:223], v[196:199], v[68:71], v[220:223]
 v_lshrrev_b32 v13, 2, v0
 v_add_u32 v13, 143360, v13
 ds_read2st64_b32 v[84:85], v13 offset0:0 offset1:1
 s_waitcnt vmcnt(11)
 v_mfma_f32_16x16x32_bf16 v[224:227], v[188:191], v[72:75], v[224:227]
 ds_read_b128 v[176:179], v1 offset:62464
 buffer_load_dwordx4 v[60:63], v0, s[8:11], s16 offen offset:1024 sc1
 ds_read2st64_b32 v[86:87], v13 offset0:2 offset1:3
 ds_read2st64_b32 v[88:89], v13 offset0:4 offset1:5
 v_mfma_f32_16x16x32_bf16 v[228:231], v[192:195], v[72:75], v[228:231]
 buffer_load_dwordx4 a[72:75], v0, s[4:7], s47 offen offset:2048 sc1
 ds_read2st64_b32 v[90:91], v13 offset0:6 offset1:7
 ds_read2st64_b32 v[92:93], v13 offset0:8 offset1:9
 s_waitcnt lgkmcnt(5)
 v_add_f32 v84, v84, v85
 v_mfma_f32_16x16x32_bf16 v[232:235], v[196:199], v[72:75], v[232:235]
 ds_read_b128 v[180:183], v1 offset:63488
 s_waitcnt lgkmcnt(4)
 v_add_f32 v84, v84, v86
 v_add_f32 v84, v84, v87
 s_waitcnt vmcnt(12)
 v_mfma_f32_16x16x32_bf16 v[212:215], v[200:203], v[76:79], v[212:215]
 s_add_u32 s56, s52, 2
 buffer_load_dword v12, v172, s[4:7], s33 offen sc1
 buffer_load_dwordx4 v[64:67], v0, s[8:11], s17 offen offset:1024 sc1
 s_waitcnt lgkmcnt(3)
 v_add_f32 v84, v84, v88
 v_mfma_f32_16x16x32_bf16 v[216:219], v[204:207], v[76:79], v[216:219]
 ds_read_b128 v[184:187], v1 offset:64512
 v_add_f32 v84, v84, v89
 s_waitcnt lgkmcnt(3)
 v_add_f32 v84, v84, v90
 v_add_f32 v84, v84, v91
 v_mfma_f32_16x16x32_bf16 v[220:223], v[208:211], v[76:79], v[220:223]
 s_waitcnt lgkmcnt(2)
 v_add_f32 v84, v84, v92
 v_add_f32 v84, v84, v93
 ds_read2st64_b32 v[86:87], v13 offset0:10 offset1:11
 s_waitcnt vmcnt(12)
 v_mfma_f32_16x16x32_bf16 v[224:227], v[200:203], v[80:83], v[224:227]
 ds_read_b128 v[188:191], v2
 buffer_load_dwordx4 v[68:71], v0, s[8:11], s16 offen offset:2048 sc1
 ds_read2st64_b32 v[88:89], v13 offset0:12 offset1:13
 ds_read2st64_b32 v[90:91], v13 offset0:14 offset1:15
 v_mfma_f32_16x16x32_bf16 v[228:231], v[204:207], v[80:83], v[228:231]
 ds_read2st64_b32 v[92:93], v13 offset0:16 offset1:17
 s_waitcnt lgkmcnt(4)
 v_add_f32 v84, v84, v86
 v_add_f32 v84, v84, v87
 s_waitcnt lgkmcnt(2)
 v_add_f32 v84, v84, v88
 v_mfma_f32_16x16x32_bf16 v[232:235], v[208:211], v[80:83], v[232:235]
 ds_read_b128 v[192:195], v2 offset:1024
 v_add_f32 v84, v84, v89
 s_waitcnt lgkmcnt(2)
 v_add_f32 v84, v84, v90
 s_waitcnt vmcnt(12)
 v_mfma_f32_16x16x32_bf16 v[212:215], v[176:179], v[44:47], v[212:215]
 buffer_load_dwordx4 v[72:75], v0, s[8:11], s17 offen offset:2048 sc1
 v_add_f32 v84, v84, v91
 s_waitcnt lgkmcnt(1)
 v_add_f32 v84, v84, v92
 v_add_f32 v84, v84, v93
 v_mfma_f32_16x16x32_bf16 v[216:219], v[180:183], v[44:47], v[216:219]
 ds_read_b128 v[196:199], v2 offset:2048
 buffer_load_dwordx4 a[76:79], v0, s[4:7], s47 offen offset:3072 sc1
 s_add_u32 s47, s47, 4096
 ds_read2st64_b32 v[86:87], v13 offset0:18 offset1:19
 v_mfma_f32_16x16x32_bf16 v[220:223], v[184:187], v[44:47], v[220:223]
 s_waitcnt lgkmcnt(0)
 v_add_f32 v84, v84, v86
 v_add_f32 v84, v84, v87
 v_cvt_pk_bf16_f32 v85, v84, v84
 s_waitcnt vmcnt(12)
 v_mfma_f32_16x16x32_bf16 v[224:227], v[176:179], v[48:51], v[224:227]
 ds_read_b128 v[200:203], v2 offset:3072
 buffer_load_dwordx4 v[76:79], v0, s[8:11], s16 offen offset:3072 sc1
 s_add_u32 s16, s16, 4096
 v_lshlrev_b32 v85, 16, v85
 v_mfma_f32_16x16x32_bf16 v[228:231], v[180:183], v[48:51], v[228:231]
 v_sub_f32 v86, v84, v85
 v_cvt_pk_bf16_f32 v84, v85, v86
 v_lshrrev_b32 v85, 8, v0
 v_cmp_eq_u32 s[22:23], 0, v85
 v_mfma_f32_16x16x32_bf16 v[232:235], v[184:187], v[48:51], v[232:235]
 ds_read_b128 v[204:207], v2 offset:4096
 v_accvgpr_read_b32 v87, a250
 v_cndmask_b32 v86, 0, v84, s[22:23]
 s_waitcnt vmcnt(10)
 v_mfma_f32_16x16x32_bf16 v[212:215], v[188:191], v[52:55], v[212:215]
 buffer_load_dwordx4 v[80:83], v0, s[8:11], s17 offen offset:3072 sc1
 s_add_u32 s17, s17, 4096
 v_cndmask_b32 v86, v86, v87, s[44:45]
 v_accvgpr_write_b32 a244, v86
 v_mfma_f32_16x16x32_bf16 v[216:219], v[192:195], v[52:55], v[216:219]
 ds_read_b128 v[208:211], v2 offset:5120
 v_accvgpr_write_b32 a245, v86
 v_cmp_eq_u32 s[22:23], 1, v85
 v_accvgpr_read_b32 v87, a251
 v_mfma_f32_16x16x32_bf16 v[220:223], v[196:199], v[52:55], v[220:223]
 s_waitcnt vmcnt(6)
 v_cmp_ne_u32 vcc, s56, v12
 s_cbranch_vccnz Lretry_9
Lback_10:
 v_cndmask_b32 v86, 0, v84, s[22:23]
 v_mfma_f32_16x16x32_bf16 v[224:227], v[188:191], v[56:59], v[224:227]
 ds_read_b128 v[176:179], v2 offset:6144
 buffer_load_dwordx4 v[44:47], v0, s[8:11], s18 offen sc1
 v_cndmask_b32 v86, v86, v87, s[44:45]
 v_accvgpr_write_b32 a246, v86
 v_mfma_f32_16x16x32_bf16 v[228:231], v[192:195], v[56:59], v[228:231]
 v_accvgpr_write_b32 a247, v86
 v_cmp_eq_u32 s[22:23], 2, v85
 v_accvgpr_read_b32 v87, a252
 s_nop 0
 v_cndmask_b32 v86, 0, v84, s[22:23]
 v_mfma_f32_16x16x32_bf16 v[232:235], v[196:199], v[56:59], v[232:235]
 ds_read_b128 v[180:183], v2 offset:7168
 v_cndmask_b32 v86, v86, v87, s[44:45]
 v_accvgpr_write_b32 a248, v86
 s_waitcnt lgkmcnt(2)
 v_mfma_f32_16x16x32_bf16 v[212:215], v[200:203], v[60:63], v[212:215]
 buffer_load_dwordx4 v[48:51], v0, s[8:11], s19 offen sc1
 v_accvgpr_write_b32 a249, v86
 v_add_f32 v236, v236, v237
 v_add_f32 v240, v240, v241
 v_mfma_f32_16x16x32_bf16 v[216:219], v[204:207], v[60:63], v[216:219]
 ds_read_b128 v[184:187], v2 offset:8192
 v_add_f32 v236, v236, v238
 v_add_f32 v240, v240, v242
 v_add_f32 v236, v236, v239
 v_mfma_f32_16x16x32_bf16 v[220:223], v[208:211], v[60:63], v[220:223]
 v_add_f32 v240, v240, v243
 s_nop 1
 v_permlane16_swap_b32 v236, v240
 s_waitcnt vmcnt(7)
 v_mfma_f32_16x16x32_bf16 v[224:227], v[200:203], v[64:67], v[224:227]
 ds_read_b128 v[188:191], v2 offset:9216
 buffer_load_dwordx4 v[52:55], v0, s[8:11], s18 offen offset:1024 sc1
 v_add_f32 v236, v236, v240
 v_mov_b32 v237, v236
 v_mfma_f32_16x16x32_bf16 v[228:231], v[204:207], v[64:67], v[228:231]
 s_nop 0
 v_permlane32_swap_b32 v236, v237
 v_mul_f32 v236, 0xbacccccd, v236
 v_mul_f32 v237, 0x3acccccd, v237
 v_mfma_f32_16x16x32_bf16 v[232:235], v[208:211], v[64:67], v[232:235]
 ds_read_b128 v[192:195], v2 offset:10240
 v_fma_f32 v237, -v236, v236, v237
 v_max_f32 v237, 0, v237
 s_waitcnt vmcnt(7) lgkmcnt(2)
 v_mfma_f32_16x16x32_bf16 v[212:215], v[176:179], v[68:71], v[212:215]
 buffer_load_dwordx4 v[56:59], v0, s[8:11], s19 offen offset:1024 sc1
 v_add_f32 v237, 0x3727c5ac, v237
 v_rsq_f32 v238, v237
 v_mfma_f32_16x16x32_bf16 v[216:219], v[180:183], v[68:71], v[216:219]
 ds_read_b128 v[196:199], v2 offset:11264
 v_mul_f32 v237, v237, v238
 v_mov_b32 v240, v236
 v_mov_b32 v241, v237
 v_mfma_f32_16x16x32_bf16 v[220:223], v[184:187], v[68:71], v[220:223]
 v_mov_b32 v242, v238
 v_permlane16_swap_b32 v236, v240
 s_waitcnt vmcnt(7)
 v_mfma_f32_16x16x32_bf16 v[224:227], v[176:179], v[72:75], v[224:227]
 ds_read_b128 v[200:203], v1 offset:16384
 buffer_load_dwordx4 v[60:63], v0, s[8:11], s18 offen offset:2048 sc1
 v_permlane16_swap_b32 v237, v241
 v_mfma_f32_16x16x32_bf16 v[228:231], v[180:183], v[72:75], v[228:231]
 buffer_load_dwordx4 v[244:247], v0, s[4:7], s20 offen offset:2048 sc1
 v_permlane16_swap_b32 v238, v242
 v_cndmask_b32 v14, v236, v237, s[44:45]
 v_mfma_f32_16x16x32_bf16 v[232:235], v[184:187], v[72:75], v[232:235]
 ds_read_b128 v[204:207], v1 offset:17408
 v_cvt_pk_bf16_f32 v236, v14, v14
 v_lshlrev_b32 v239, 16, v236
 s_waitcnt vmcnt(7) lgkmcnt(2)
 v_mfma_f32_16x16x32_bf16 v[212:215], v[188:191], v[76:79], v[212:215]
 buffer_load_dwordx4 v[64:67], v0, s[8:11], s19 offen offset:2048 sc1
 v_sub_f32 v239, v14, v239
 v_cvt_pk_bf16_f32 v237, v239, v239
 v_cndmask_b32 v14, v240, v241, s[44:45]
 v_mfma_f32_16x16x32_bf16 v[216:219], v[192:195], v[76:79], v[216:219]
 ds_read_b128 v[208:211], v1 offset:18432
 v_cvt_pk_bf16_f32 v240, v14, v14
 v_lshlrev_b32 v243, 16, v240
 v_sub_f32 v243, v14, v243
 v_mfma_f32_16x16x32_bf16 v[220:223], v[196:199], v[76:79], v[220:223]
 v_cvt_pk_bf16_f32 v241, v243, v243
 s_waitcnt vmcnt(7)
 v_mfma_f32_16x16x32_bf16 v[224:227], v[188:191], v[80:83], v[224:227]
 ds_read_b128 v[176:179], v1 offset:19456
 buffer_load_dwordx4 v[68:71], v0, s[8:11], s18 offen offset:3072 sc1
 s_add_u32 s18, s18, 4096
 v_mfma_f32_16x16x32_bf16 v[228:231], v[192:195], v[80:83], v[228:231]
 buffer_load_dwordx4 v[248:251], v0, s[4:7], s20 offen offset:3072 sc1
 v_mfma_f32_16x16x32_bf16 v[232:235], v[196:199], v[80:83], v[232:235]
 ds_read_b128 v[180:183], v1 offset:20480
 s_waitcnt vmcnt(8) lgkmcnt(2)
 v_mfma_f32_16x16x32_bf16 v[144:147], v[200:203], v[44:47], 0
 buffer_load_dwordx4 v[72:75], v0, s[8:11], s19 offen offset:3072 sc1
 s_add_u32 s19, s19, 4096
 v_mfma_f32_16x16x32_bf16 v[148:151], v[204:207], v[44:47], 0
 ds_read_b128 v[184:187], v1 offset:21504
 v_mfma_f32_16x16x16_bf16 v[212:215], a[244:245], v[236:237], v[212:215]
 v_mfma_f32_16x16x16_bf16 v[216:219], a[246:247], v[236:237], v[216:219]
 v_mfma_f32_16x16x16_bf16 v[220:223], a[248:249], v[236:237], v[220:223]
 v_mfma_f32_16x16x32_bf16 v[152:155], v[208:211], v[44:47], 0
 v_mfma_f32_16x16x16_bf16 v[224:227], a[244:245], v[240:241], v[224:227]
 v_mfma_f32_16x16x16_bf16 v[228:231], a[246:247], v[240:241], v[228:231]
 v_mfma_f32_16x16x16_bf16 v[232:235], a[248:249], v[240:241], v[232:235]
 s_waitcnt vmcnt(8)
 v_mfma_f32_16x16x32_bf16 v[156:159], v[200:203], v[48:51], 0
 ds_read_b128 v[188:191], v1 offset:22528
 buffer_load_dwordx4 v[76:79], v0, s[8:11], s18 offen sc1
 v_mfma_f32_16x16x32_bf16 v[160:163], v[204:207], v[48:51], 0
 v_mfma_f32_16x16x32_bf16 v[164:167], v[208:211], v[48:51], 0
 ds_read_b128 v[192:195], v1 offset:23552
 v_mul_f32 v212, v212, v238
 v_mul_f32 v212, v212, abs(v212)
 v_mul_f32 v213, v213, v238
 s_waitcnt vmcnt(8) lgkmcnt(2)
 v_mfma_f32_16x16x32_bf16 v[144:147], v[176:179], v[52:55], v[144:147]
 buffer_load_dwordx4 v[80:83], v0, s[8:11], s19 offen sc1
 v_mul_f32 v213, v213, abs(v213)
 v_cvt_pk_bf16_f32 v124, v212, v213
 v_pk_max_i16 v124, v124, 0
 v_mfma_f32_16x16x32_bf16 v[148:151], v[180:183], v[52:55], v[148:151]
 ds_read_b128 v[196:199], v1 offset:24576
 v_mul_f32 v214, v214, v238
 v_mul_f32 v214, v214, abs(v214)
 v_mul_f32 v215, v215, v238
 v_mul_f32 v215, v215, abs(v215)
 v_mfma_f32_16x16x32_bf16 v[152:155], v[184:187], v[52:55], v[152:155]
 v_cvt_pk_bf16_f32 v125, v214, v215
 v_pk_max_i16 v125, v125, 0
 v_mul_f32 v216, v216, v238
 v_mul_f32 v216, v216, abs(v216)
 s_waitcnt vmcnt(8)
 v_mfma_f32_16x16x32_bf16 v[156:159], v[176:179], v[56:59], v[156:159]
 ds_read_b128 v[200:203], v1 offset:25600
 buffer_load_dwordx4 v[44:47], v0, s[8:11], s18 offen offset:1024 sc1
 v_mul_f32 v217, v217, v238
 v_mul_f32 v217, v217, abs(v217)
 v_cvt_pk_bf16_f32 v126, v216, v217
 v_mfma_f32_16x16x32_bf16 v[160:163], v[180:183], v[56:59], v[160:163]
 v_pk_max_i16 v126, v126, 0
 v_mul_f32 v218, v218, v238
 v_mul_f32 v218, v218, abs(v218)
 v_mul_f32 v219, v219, v238
 v_mul_f32 v219, v219, abs(v219)
 v_mfma_f32_16x16x32_bf16 v[164:167], v[184:187], v[56:59], v[164:167]
 ds_read_b128 v[204:207], v1 offset:26624
 v_cvt_pk_bf16_f32 v127, v218, v219
 v_pk_max_i16 v127, v127, 0
 s_waitcnt vmcnt(8) lgkmcnt(2)
 v_mfma_f32_16x16x32_bf16 v[144:147], v[188:191], v[60:63], v[144:147]
 buffer_load_dwordx4 v[48:51], v0, s[8:11], s19 offen offset:1024 sc1
 v_mfma_f32_16x16x32_bf16 v[148:151], v[192:195], v[60:63], v[148:151]
 ds_read_b128 v[208:211], v1 offset:27648
 v_mfma_f32_16x16x32_bf16 v[152:155], v[196:199], v[60:63], v[152:155]
 s_waitcnt vmcnt(7)
 v_mfma_f32_16x16x32_bf16 v[156:159], v[188:191], v[64:67], v[156:159]
 ds_read_b128 v[176:179], v1 offset:28672
 buffer_load_dwordx4 v[52:55], v0, s[8:11], s18 offen offset:2048 sc1
 v_mfma_f32_16x16x32_bf16 v[160:163], v[192:195], v[64:67], v[160:163]
 buffer_store_dwordx4 v[124:127], v0, s[4:7], s34 offen
 v_mfma_f32_16x16x32_bf16 v[164:167], v[196:199], v[64:67], v[164:167]
 ds_read_b128 v[180:183], v1 offset:29696
 s_add_u32 s34, s34, 49152
 v_mul_f32 v220, v220, v238
 v_mul_f32 v220, v220, abs(v220)
 s_waitcnt vmcnt(8) lgkmcnt(2)
 v_mfma_f32_16x16x32_bf16 v[144:147], v[200:203], v[68:71], v[144:147]
 buffer_load_dwordx4 v[56:59], v0, s[8:11], s19 offen offset:2048 sc1
 v_mul_f32 v221, v221, v238
 v_mul_f32 v221, v221, abs(v221)
 v_cvt_pk_bf16_f32 v132, v220, v221
 v_pk_max_i16 v132, v132, 0
 v_mfma_f32_16x16x32_bf16 v[148:151], v[204:207], v[68:71], v[148:151]
 ds_read_b128 v[184:187], v1 offset:30720
 v_mul_f32 v222, v222, v238
 v_mul_f32 v222, v222, abs(v222)
 v_mul_f32 v223, v223, v238
 v_mul_f32 v223, v223, abs(v223)
 v_mfma_f32_16x16x32_bf16 v[152:155], v[208:211], v[68:71], v[152:155]
 v_cvt_pk_bf16_f32 v133, v222, v223
 v_pk_max_i16 v133, v133, 0
 v_mul_f32 v224, v224, v242
 v_mul_f32 v224, v224, abs(v224)
 s_waitcnt vmcnt(7)
 v_mfma_f32_16x16x32_bf16 v[156:159], v[200:203], v[72:75], v[156:159]
 ds_read_b128 v[188:191], v1 offset:31744
 buffer_load_dwordx4 v[60:63], v0, s[8:11], s18 offen offset:3072 sc1
 s_add_u32 s18, s18, 4096
 v_mul_f32 v225, v225, v242
 v_mul_f32 v225, v225, abs(v225)
 v_mfma_f32_16x16x32_bf16 v[160:163], v[204:207], v[72:75], v[160:163]
 v_cvt_pk_bf16_f32 v128, v224, v225
 v_pk_max_i16 v128, v128, 0
 v_mul_f32 v226, v226, v242
 v_mul_f32 v226, v226, abs(v226)
 v_mfma_f32_16x16x32_bf16 v[164:167], v[208:211], v[72:75], v[164:167]
 ds_read_b128 v[192:195], v1 offset:32768
 v_mul_f32 v227, v227, v242
 v_mul_f32 v227, v227, abs(v227)
 v_cvt_pk_bf16_f32 v129, v226, v227
 s_waitcnt vmcnt(7) lgkmcnt(2)
 v_mfma_f32_16x16x32_bf16 v[144:147], v[176:179], v[76:79], v[144:147]
 buffer_load_dwordx4 v[64:67], v0, s[8:11], s19 offen offset:3072 sc1
 s_add_u32 s19, s19, 4096
 v_pk_max_i16 v129, v129, 0
 v_mul_f32 v228, v228, v242
 v_mul_f32 v228, v228, abs(v228)
 v_mfma_f32_16x16x32_bf16 v[148:151], v[180:183], v[76:79], v[148:151]
 ds_read_b128 v[196:199], v1 offset:33792
 v_mul_f32 v229, v229, v242
 v_mul_f32 v229, v229, abs(v229)
 v_cvt_pk_bf16_f32 v130, v228, v229
 v_pk_max_i16 v130, v130, 0
 v_mfma_f32_16x16x32_bf16 v[152:155], v[184:187], v[76:79], v[152:155]
 v_mul_f32 v230, v230, v242
 v_mul_f32 v230, v230, abs(v230)
 v_mul_f32 v231, v231, v242
 v_mul_f32 v231, v231, abs(v231)
 s_waitcnt vmcnt(7)
 v_mfma_f32_16x16x32_bf16 v[156:159], v[176:179], v[80:83], v[156:159]
 ds_read_b128 v[200:203], v1 offset:34816
 buffer_load_dwordx4 v[68:71], v0, s[8:11], s18 offen sc1
 v_cvt_pk_bf16_f32 v131, v230, v231
 v_pk_max_i16 v131, v131, 0
 v_mfma_f32_16x16x32_bf16 v[160:163], v[180:183], v[80:83], v[160:163]
 buffer_store_dwordx4 v[128:131], v0, s[4:7], s34 offen
 v_mfma_f32_16x16x32_bf16 v[164:167], v[184:187], v[80:83], v[164:167]
 ds_read_b128 v[204:207], v1 offset:35840
 s_add_u32 s34, s34, 49152
 v_mul_f32 v232, v232, v242
 v_mul_f32 v232, v232, abs(v232)
 s_waitcnt vmcnt(8) lgkmcnt(2)
 v_mfma_f32_16x16x32_bf16 v[144:147], v[188:191], v[44:47], v[144:147]
 buffer_load_dwordx4 v[72:75], v0, s[8:11], s19 offen sc1
 v_mul_f32 v233, v233, v242
 v_mul_f32 v233, v233, abs(v233)
 v_cvt_pk_bf16_f32 v134, v232, v233
 v_mfma_f32_16x16x32_bf16 v[148:151], v[192:195], v[44:47], v[148:151]
 ds_read_b128 v[208:211], v1 offset:36864
 v_pk_max_i16 v134, v134, 0
 v_mul_f32 v234, v234, v242
 v_mul_f32 v234, v234, abs(v234)
 v_mul_f32 v235, v235, v242
 v_mfma_f32_16x16x32_bf16 v[152:155], v[196:199], v[44:47], v[152:155]
 v_mul_f32 v235, v235, abs(v235)
 v_cvt_pk_bf16_f32 v135, v234, v235
 v_pk_max_i16 v135, v135, 0
 s_waitcnt vmcnt(8)
 v_mfma_f32_16x16x32_bf16 v[156:159], v[188:191], v[48:51], v[156:159]
 ds_read_b128 v[176:179], v1 offset:37888
 buffer_load_dwordx4 v[76:79], v0, s[8:11], s18 offen offset:1024 sc1
 v_permlane16_swap_b32 v132, v134
 v_mfma_f32_16x16x32_bf16 v[160:163], v[192:195], v[48:51], v[160:163]
 v_permlane16_swap_b32 v133, v135
 v_mfma_f32_16x16x32_bf16 v[164:167], v[196:199], v[48:51], v[164:167]
 ds_read_b128 v[180:183], v1 offset:38912
 s_waitcnt vmcnt(8) lgkmcnt(2)
 v_mfma_f32_16x16x32_bf16 v[144:147], v[200:203], v[52:55], v[144:147]
 buffer_load_dwordx4 v[80:83], v0, s[8:11], s19 offen offset:1024 sc1
 v_mfma_f32_16x16x32_bf16 v[148:151], v[204:207], v[52:55], v[148:151]
 ds_read_b128 v[184:187], v1 offset:39936
 v_mfma_f32_16x16x32_bf16 v[152:155], v[208:211], v[52:55], v[152:155]
 s_waitcnt vmcnt(7)
 v_mfma_f32_16x16x32_bf16 v[156:159], v[200:203], v[56:59], v[156:159]
 ds_read_b128 v[188:191], v1 offset:40960
 buffer_load_dwordx4 v[44:47], v0, s[8:11], s18 offen offset:2048 sc1
 v_mfma_f32_16x16x32_bf16 v[160:163], v[204:207], v[56:59], v[160:163]
 buffer_store_dwordx4 v[132:135], v7, s[4:7], s35 offen offset:1024
 v_mfma_f32_16x16x32_bf16 v[164:167], v[208:211], v[56:59], v[164:167]
 ds_read_b128 v[192:195], v1 offset:41984
 s_add_u32 s35, s35, 98304
 s_waitcnt vmcnt(8) lgkmcnt(2)
 v_mfma_f32_16x16x32_bf16 v[144:147], v[176:179], v[60:63], v[144:147]
 buffer_load_dwordx4 v[48:51], v0, s[8:11], s19 offen offset:2048 sc1
 v_mfma_f32_16x16x32_bf16 v[148:151], v[180:183], v[60:63], v[148:151]
 ds_read_b128 v[196:199], v1 offset:43008
 v_mfma_f32_16x16x32_bf16 v[152:155], v[184:187], v[60:63], v[152:155]
 s_waitcnt vmcnt(8)
 v_mfma_f32_16x16x32_bf16 v[156:159], v[176:179], v[64:67], v[156:159]
 ds_read_b128 v[200:203], v1 offset:44032
 buffer_load_dwordx4 v[52:55], v0, s[8:11], s18 offen offset:3072 sc1
 s_add_u32 s18, s18, 4096
 s_lshl_b32 s21, s57, 6
 v_mfma_f32_16x16x32_bf16 v[160:163], v[180:183], v[64:67], v[160:163]
 s_lshl_b32 s22, s58, 1
 s_add_u32 s22, s22, s59
 s_lshl_b32 s22, s22, 5
 v_mfma_f32_16x16x32_bf16 v[164:167], v[184:187], v[64:67], v[164:167]
 ds_read_b128 v[204:207], v1 offset:45056
 v_bfe_u32 v252, v0, 4, 3
 v_mul_u32_u24 v252, 0, v252
 s_waitcnt vmcnt(8) lgkmcnt(2)
 v_mfma_f32_16x16x32_bf16 v[144:147], v[188:191], v[68:71], v[144:147]
 buffer_load_dwordx4 v[56:59], v0, s[8:11], s19 offen offset:3072 sc1
 s_add_u32 s19, s19, 4096
 v_bfe_u32 v14, v0, 7, 1
 v_mfma_f32_16x16x32_bf16 v[148:151], v[192:195], v[68:71], v[148:151]
 ds_read_b128 v[208:211], v1 offset:46080
 v_lshl_add_u32 v252, v14, 6, v252
 v_bfe_u32 v14, v0, 8, 2
 v_lshl_add_u32 v252, v14, 4, v252
 v_mfma_f32_16x16x32_bf16 v[152:155], v[196:199], v[68:71], v[152:155]
 v_bfe_u32 v173, v0, 4, 3
 v_mul_u32_u24 v173, 0, v173
 s_waitcnt vmcnt(7)
 v_mfma_f32_16x16x32_bf16 v[156:159], v[188:191], v[72:75], v[156:159]
 ds_read_b128 v[176:179], v1 offset:47104
 buffer_load_dwordx4 v[60:63], v0, s[8:11], s18 offen sc1
 v_bfe_u32 v14, v0, 7, 1
 v_lshl_add_u32 v173, v14, 2, v173
 v_mfma_f32_16x16x32_bf16 v[160:163], v[192:195], v[72:75], v[160:163]
 v_bfe_u32 v14, v0, 8, 2
 v_lshl_add_u32 v173, v14, 3, v173
 buffer_load_dwordx4 v[252:255], v252, s[12:15], s21 offen
 v_mfma_f32_16x16x32_bf16 v[164:167], v[196:199], v[72:75], v[164:167]
 ds_read_b128 v[180:183], v1 offset:48128
 buffer_load_dword v173, v173, s[12:15], s22 offen
 v_add_f32 v244, v244, v245
 s_waitcnt vmcnt(9) lgkmcnt(2)
 v_mfma_f32_16x16x32_bf16 v[144:147], v[200:203], v[76:79], v[144:147]
 buffer_load_dwordx4 v[64:67], v0, s[8:11], s19 offen sc1
 v_add_f32 v248, v248, v249
 v_add_f32 v244, v244, v246
 v_mfma_f32_16x16x32_bf16 v[148:151], v[204:207], v[76:79], v[148:151]
 ds_read_b128 v[184:187], v1 offset:49152
 v_add_f32 v248, v248, v250
 v_add_f32 v244, v244, v247
 v_add_f32 v248, v248, v251
 v_mfma_f32_16x16x32_bf16 v[152:155], v[208:211], v[76:79], v[152:155]
 s_nop 0
 v_permlane16_swap_b32 v244, v248
 s_waitcnt vmcnt(9)
 v_mfma_f32_16x16x32_bf16 v[156:159], v[200:203], v[80:83], v[156:159]
 ds_read_b128 v[188:191], v1 offset:50176
 buffer_load_dwordx4 v[68:71], v0, s[8:11], s18 offen offset:1024 sc1
 v_add_f32 v244, v244, v248
 v_mov_b32 v245, v244
 v_mfma_f32_16x16x32_bf16 v[160:163], v[204:207], v[80:83], v[160:163]
 s_nop 0
 v_permlane32_swap_b32 v244, v245
 v_mul_f32 v244, 0xbacccccd, v244
 v_mfma_f32_16x16x32_bf16 v[164:167], v[208:211], v[80:83], v[164:167]
 ds_read_b128 v[192:195], v1 offset:51200
 v_mul_f32 v245, 0x3acccccd, v245
 v_fma_f32 v245, -v244, v244, v245
 s_waitcnt vmcnt(9) lgkmcnt(2)
 v_mfma_f32_16x16x32_bf16 v[144:147], v[176:179], v[44:47], v[144:147]
 buffer_load_dwordx4 v[72:75], v0, s[8:11], s19 offen offset:1024 sc1
 v_mov_b32 v15, 3
 v_add_u32 v15, s52, v15
 s_waitcnt vmcnt(9)
 s_mov_b64 exec, 1
 buffer_store_dword v15, v0, s[4:7], s36 offen
 s_mov_b64 exec, -1
 s_add_u32 s36, s36, 4096
 v_mfma_f32_16x16x32_bf16 v[148:151], v[180:183], v[44:47], v[148:151]
 ds_read_b128 v[196:199], v1 offset:52224
 v_max_f32 v245, 0, v245
 v_add_f32 v245, 0x3727c5ac, v245
 v_mfma_f32_16x16x32_bf16 v[152:155], v[184:187], v[44:47], v[152:155]
 v_rsq_f32 v246, v245
 s_waitcnt vmcnt(9)
 v_mfma_f32_16x16x32_bf16 v[156:159], v[176:179], v[48:51], v[156:159]
 ds_read_b128 v[200:203], v1 offset:53248
 buffer_load_dwordx4 v[76:79], v0, s[8:11], s18 offen offset:2048 sc1
 v_mul_f32 v245, v245, v246
 v_mov_b32 v248, v244
 v_mfma_f32_16x16x32_bf16 v[160:163], v[180:183], v[48:51], v[160:163]
 v_mov_b32 v249, v245
 v_mov_b32 v250, v246
 v_mfma_f32_16x16x32_bf16 v[164:167], v[184:187], v[48:51], v[164:167]
 ds_read_b128 v[204:207], v1 offset:54272
 v_permlane16_swap_b32 v244, v248
 s_waitcnt vmcnt(9) lgkmcnt(2)
 v_mfma_f32_16x16x32_bf16 v[144:147], v[188:191], v[52:55], v[144:147]
 buffer_load_dwordx4 v[80:83], v0, s[8:11], s19 offen offset:2048 sc1
 v_permlane16_swap_b32 v245, v249
 v_mfma_f32_16x16x32_bf16 v[148:151], v[192:195], v[52:55], v[148:151]
 ds_read_b128 v[208:211], v1 offset:55296
 v_permlane16_swap_b32 v246, v250
 v_cndmask_b32 v14, v244, v245, s[44:45]
 v_mfma_f32_16x16x32_bf16 v[152:155], v[196:199], v[52:55], v[152:155]
 v_cvt_pk_bf16_f32 v244, v14, v14
 v_lshlrev_b32 v247, 16, v244
 s_waitcnt vmcnt(9)
 v_mfma_f32_16x16x32_bf16 v[156:159], v[188:191], v[56:59], v[156:159]
 ds_read_b128 v[176:179], v1 offset:56320
 buffer_load_dwordx4 v[44:47], v0, s[8:11], s18 offen offset:3072 sc1
 s_add_u32 s18, s18, 4096
 v_sub_f32 v247, v14, v247
 v_mfma_f32_16x16x32_bf16 v[160:163], v[192:195], v[56:59], v[160:163]
 buffer_load_dwordx2 v[104:105], v0, s[4:7], s34 offen sc1
 v_cvt_pk_bf16_f32 v245, v247, v247
 v_cndmask_b32 v14, v248, v249, s[44:45]
 v_mfma_f32_16x16x32_bf16 v[164:167], v[196:199], v[56:59], v[164:167]
 ds_read_b128 v[180:183], v1 offset:57344
 v_cvt_pk_bf16_f32 v248, v14, v14
 v_lshlrev_b32 v251, 16, v248
 s_waitcnt vmcnt(10) lgkmcnt(2)
 v_mfma_f32_16x16x32_bf16 v[144:147], v[200:203], v[60:63], v[144:147]
 buffer_load_dwordx4 v[48:51], v0, s[8:11], s19 offen offset:3072 sc1
 s_add_u32 s19, s19, 4096
 s_add_u32 s23, s34, 49152
 buffer_load_dwordx2 v[104:105], v0, s[4:7], s23 offen sc1
 v_mfma_f32_16x16x32_bf16 v[148:151], v[204:207], v[60:63], v[148:151]
 ds_read_b128 v[184:187], v1 offset:58368
 v_sub_f32 v251, v14, v251
 v_cvt_pk_bf16_f32 v249, v251, v251
 s_mul_i32 s29, s53, 81920
 v_mfma_f32_16x16x32_bf16 v[152:155], v[208:211], v[60:63], v[152:155]
 buffer_load_dwordx2 v[104:105], v7, s[4:7], s35 offen offset:1024 sc1
 s_lshl_b32 s30, s58, 1
 s_waitcnt vmcnt(10)
 v_mfma_f32_16x16x32_bf16 v[156:159], v[200:203], v[64:67], v[156:159]
 ds_read_b128 v[188:191], v1 offset:59392
 buffer_load_dwordx4 v[52:55], v0, s[8:11], s18 offen sc1
 s_add_u32 s30, s30, s59
 s_lshl_b32 s62, s3, 7
 v_mfma_f32_16x16x32_bf16 v[160:163], v[204:207], v[64:67], v[160:163]
 s_add_u32 s62, s62, 0
 v_bfe_u32 v168, v0, 4, 3
 v_mul_u32_u24 v168, 16, v168
 v_mfma_f32_16x16x32_bf16 v[164:167], v[208:211], v[64:67], v[164:167]
 ds_read_b128 v[192:195], v1 offset:60416
 v_bfe_u32 v14, v0, 7, 1
 v_lshl_add_u32 v168, v14, 11, v168
 s_waitcnt vmcnt(10) lgkmcnt(2)
 v_mfma_f32_16x16x32_bf16 v[144:147], v[176:179], v[68:71], v[144:147]
 buffer_load_dwordx4 v[56:59], v0, s[8:11], s19 offen sc1
 v_bfe_u32 v14, v0, 8, 2
 v_lshl_add_u32 v168, v14, 9, v168
 v_mfma_f32_16x16x32_bf16 v[148:151], v[180:183], v[68:71], v[148:151]
 ds_read_b128 v[196:199], v1 offset:61440
 v_bfe_u32 v169, v0, 4, 3
 v_mul_u32_u24 v169, 16, v169
 v_bfe_u32 v14, v0, 7, 1
 v_mfma_f32_16x16x32_bf16 v[152:155], v[184:187], v[68:71], v[152:155]
 s_add_u32 s56, s52, 3
 buffer_load_dword v12, v171, s[4:7], s28 offen sc1
 s_waitcnt vmcnt(11)
 v_mfma_f32_16x16x32_bf16 v[156:159], v[176:179], v[72:75], v[156:159]
 ds_read_b128 v[200:203], v1 offset:62464
 buffer_load_dwordx4 v[60:63], v0, s[8:11], s18 offen offset:1024 sc1
 v_lshl_add_u32 v169, v14, 2, v169
 v_bfe_u32 v14, v0, 8, 1
 v_mfma_f32_16x16x32_bf16 v[160:163], v[180:183], v[72:75], v[160:163]
 v_lshl_add_u32 v169, v14, 3, v169
 v_bfe_u32 v14, v0, 9, 1
 v_lshl_add_u32 v169, v14, 9, v169
 v_mfma_f32_16x16x32_bf16 v[164:167], v[184:187], v[72:75], v[164:167]
 ds_read_b128 v[204:207], v1 offset:63488
 s_add_u32 s29, s29, s62
 s_lshl_b32 s30, s30, 10
 s_waitcnt vmcnt(10) lgkmcnt(2)
 v_mfma_f32_16x16x32_bf16 v[144:147], v[188:191], v[76:79], v[144:147]
 buffer_load_dwordx4 v[64:67], v0, s[8:11], s19 offen offset:1024 sc1
 s_add_u32 s30, s30, s29
 s_lshl_b32 s62, s57, 11
 v_mfma_f32_16x16x32_bf16 v[148:151], v[192:195], v[76:79], v[148:151]
 ds_read_b128 v[208:211], v1 offset:64512
 s_add_u32 s29, s29, s62
 v_bfe_u32 v170, v0, 4, 3
 v_mul_u32_u24 v170, 16, v170
 v_mfma_f32_16x16x32_bf16 v[152:155], v[196:199], v[76:79], v[152:155]
 v_bfe_u32 v14, v0, 7, 1
 v_lshl_add_u32 v170, v14, 30, v170
 s_waitcnt vmcnt(10)
 v_mfma_f32_16x16x32_bf16 v[156:159], v[188:191], v[80:83], v[156:159]
 ds_read_b128 v[176:179], v2
 buffer_load_dwordx4 v[68:71], v0, s[8:11], s18 offen offset:2048 sc1
 v_bfe_u32 v14, v0, 8, 1
 v_lshl_add_u32 v170, v14, 29, v170
 v_mfma_f32_16x16x32_bf16 v[160:163], v[192:195], v[80:83], v[160:163]
 v_bfe_u32 v14, v0, 9, 1
 v_lshl_add_u32 v170, v14, 9, v170
 s_lshl_b32 s31, s53, 2
 v_mfma_f32_16x16x32_bf16 v[164:167], v[196:199], v[80:83], v[164:167]
 ds_read_b128 v[180:183], v2 offset:1024
 s_lshr_b32 s62, s3, 1
 s_add_u32 s31, s31, s62
 s_waitcnt vmcnt(10) lgkmcnt(2)
 v_mfma_f32_16x16x32_bf16 v[144:147], v[200:203], v[44:47], v[144:147]
 buffer_load_dwordx4 v[72:75], v0, s[8:11], s19 offen offset:2048 sc1
 s_lshl_b32 s31, s31, 2
 s_lshr_b32 s62, s51, 2
 v_mfma_f32_16x16x32_bf16 v[148:151], v[204:207], v[44:47], v[148:151]
 ds_read_b128 v[184:187], v2 offset:2048
 s_add_u32 s31, s31, s62
 s_lshl_b32 s31, s31, 1
 s_and_b32 s62, s3, 1
 v_mfma_f32_16x16x32_bf16 v[152:155], v[208:211], v[44:47], v[152:155]
 s_add_u32 s31, s31, s62
 s_lshl_b32 s31, s31, 5
 s_waitcnt vmcnt(9)
 v_mfma_f32_16x16x32_bf16 v[156:159], v[200:203], v[48:51], v[156:159]
 ds_read_b128 v[188:191], v2 offset:3072
 buffer_load_dwordx4 v[76:79], v0, s[8:11], s18 offen offset:3072 sc1
 s_add_u32 s18, s18, 4096
 s_and_b32 s62, s51, 3
 v_mfma_f32_16x16x32_bf16 v[160:163], v[204:207], v[48:51], v[160:163]
 s_add_u32 s31, s31, s62
 s_lshl_b32 s31, s31, 2
 s_add_u32 s31, s31, 24641536
 v_mfma_f32_16x16x32_bf16 v[164:167], v[208:211], v[48:51], v[164:167]
 ds_read_b128 v[192:195], v2 offset:4096
 s_lshl_b32 s32, s53, 3
 s_add_u32 s32, s32, s51
 s_waitcnt vmcnt(7) lgkmcnt(2)
 v_mfma_f32_16x16x32_bf16 v[144:147], v[176:179], v[52:55], v[144:147]
 buffer_load_dwordx4 v[80:83], v0, s[8:11], s19 offen offset:3072 sc1
 s_add_u32 s19, s19, 4096
 s_lshl_b32 s32, s32, 2
 v_mfma_f32_16x16x32_bf16 v[148:151], v[180:183], v[52:55], v[148:151]
 ds_read_b128 v[196:199], v2 offset:5120
 s_add_u32 s32, s32, s3
 s_lshl_b32 s32, s32, 2
 s_add_u32 s32, s32, 7733248
 v_mfma_f32_16x16x32_bf16 v[152:155], v[184:187], v[52:55], v[152:155]
 s_waitcnt vmcnt(6)
 v_cmp_ne_u32 vcc, s56, v12
 s_cbranch_vccnz Lretry_12
Lback_13:
 s_add_u32 s28, s28, 4096
 v_mfma_f32_16x16x32_bf16 v[156:159], v[176:179], v[56:59], v[156:159]
 ds_read_b128 v[200:203], v2 offset:6144
 buffer_load_dwordx4 v[44:47], v0, s[4:7], s24 offen sc1
 v_lshlrev_b32 v14, 16, v252
 v_add_f32 v16, v16, v14
 v_mfma_f32_16x16x32_bf16 v[160:163], v[180:183], v[56:59], v[160:163]
 v_add_f32 v26, v26, v14
 v_and_b32 v14, 0xffff0000, v252
 v_add_f32 v17, v17, v14
 v_mfma_f32_16x16x32_bf16 v[164:167], v[184:187], v[56:59], v[164:167]
 ds_read_b128 v[204:207], v2 offset:7168
 v_add_f32 v27, v27, v14
 v_lshlrev_b32 v14, 16, v253
 s_waitcnt vmcnt(6) lgkmcnt(2)
 v_mfma_f32_16x16x32_bf16 v[144:147], v[188:191], v[60:63], v[144:147]
 buffer_load_dwordx4 v[48:51], v0, s[4:7], s24 offen offset:1024 sc1
 v_add_f32 v18, v18, v14
 v_add_f32 v28, v28, v14
 v_mfma_f32_16x16x32_bf16 v[148:151], v[192:195], v[60:63], v[148:151]
 ds_read_b128 v[208:211], v2 offset:8192
 v_and_b32 v14, 0xffff0000, v253
 v_add_f32 v19, v19, v14
 v_add_f32 v29, v29, v14
 v_mfma_f32_16x16x32_bf16 v[152:155], v[196:199], v[60:63], v[152:155]
 v_lshlrev_b32 v14, 16, v254
 v_add_f32 v20, v20, v14
 s_waitcnt vmcnt(6)
 v_mfma_f32_16x16x32_bf16 v[156:159], v[188:191], v[64:67], v[156:159]
 ds_read_b128 v[176:179], v2 offset:9216
 buffer_load_dwordx4 v[52:55], v0, s[4:7], s24 offen offset:2048 sc1
 v_add_f32 v30, v30, v14
 v_and_b32 v14, 0xffff0000, v254
 v_mfma_f32_16x16x32_bf16 v[160:163], v[192:195], v[64:67], v[160:163]
 v_add_f32 v21, v21, v14
 v_add_f32 v31, v31, v14
 v_lshlrev_b32 v14, 16, v255
 v_mfma_f32_16x16x32_bf16 v[164:167], v[196:199], v[64:67], v[164:167]
 ds_read_b128 v[180:183], v2 offset:10240
 v_add_f32 v22, v22, v14
 v_add_f32 v32, v32, v14
 s_waitcnt vmcnt(6) lgkmcnt(2)
 v_mfma_f32_16x16x32_bf16 v[144:147], v[200:203], v[68:71], v[144:147]
 buffer_load_dwordx4 v[56:59], v0, s[4:7], s24 offen offset:3072 sc1
 s_add_u32 s24, s24, 4096
 v_and_b32 v14, 0xffff0000, v255
 v_mfma_f32_16x16x32_bf16 v[148:151], v[204:207], v[68:71], v[148:151]
 ds_read_b128 v[184:187], v2 offset:11264
 v_add_f32 v23, v23, v14
 v_add_f32 v33, v33, v14
 v_lshlrev_b32 v14, 16, v173
 v_mfma_f32_16x16x32_bf16 v[152:155], v[208:211], v[68:71], v[152:155]
 v_add_f32 v24, v24, v14
 v_add_f32 v34, v34, v14
 s_waitcnt vmcnt(6)
 v_mfma_f32_16x16x32_bf16 v[156:159], v[200:203], v[72:75], v[156:159]
 buffer_load_dwordx4 v[60:63], v0, s[4:7], s24 offen sc1
 v_and_b32 v14, 0xffff0000, v173
 v_add_f32 v25, v25, v14
 v_add_f32 v35, v35, v14
 v_mfma_f32_16x16x32_bf16 v[160:163], v[204:207], v[72:75], v[160:163]
 v_mfma_f32_16x16x32_bf16 v[164:167], v[208:211], v[72:75], v[164:167]
 s_waitcnt vmcnt(6) lgkmcnt(0)
 v_mfma_f32_16x16x32_bf16 v[144:147], v[176:179], v[76:79], v[144:147]
 buffer_load_dwordx4 v[64:67], v0, s[4:7], s24 offen offset:1024 sc1
 v_mfma_f32_16x16x32_bf16 v[148:151], v[180:183], v[76:79], v[148:151]
 v_mfma_f32_16x16x32_bf16 v[152:155], v[184:187], v[76:79], v[152:155]
 s_waitcnt vmcnt(6)
 v_mfma_f32_16x16x32_bf16 v[156:159], v[176:179], v[80:83], v[156:159]
 buffer_load_dwordx4 v[68:71], v0, s[4:7], s24 offen offset:2048 sc1
 v_mfma_f32_16x16x32_bf16 v[160:163], v[180:183], v[80:83], v[160:163]
 v_mfma_f32_16x16x32_bf16 v[164:167], v[184:187], v[80:83], v[164:167]
 s_waitcnt vmcnt(6)
 v_mfma_f32_16x16x32_bf16 v[84:87], a[0:3], v[44:47], 0
 buffer_load_dwordx4 v[72:75], v0, s[4:7], s24 offen offset:3072 sc1
 s_add_u32 s24, s24, 4096
 v_mfma_f32_16x16x16_bf16 v[144:147], a[244:245], v[244:245], v[144:147]
 v_mfma_f32_16x16x16_bf16 v[148:151], a[246:247], v[244:245], v[148:151]
 v_mfma_f32_16x16x16_bf16 v[152:155], a[248:249], v[244:245], v[152:155]
 v_mfma_f32_16x16x32_bf16 v[88:91], a[4:7], v[44:47], 0
 v_mfma_f32_16x16x16_bf16 v[156:159], a[244:245], v[248:249], v[156:159]
 v_mfma_f32_16x16x16_bf16 v[160:163], a[246:247], v[248:249], v[160:163]
 v_mfma_f32_16x16x16_bf16 v[164:167], a[248:249], v[248:249], v[164:167]
 v_mfma_f32_16x16x32_bf16 v[92:95], a[8:11], v[44:47], 0
 v_mfma_f32_16x16x32_bf16 v[96:99], a[12:15], v[44:47], 0
 v_mfma_f32_16x16x32_bf16 v[100:103], a[16:19], v[44:47], 0
 v_mul_f32 v144, v144, v246
 s_waitcnt vmcnt(6)
 v_mfma_f32_16x16x32_bf16 v[84:87], a[20:23], v[48:51], v[84:87]
 buffer_load_dwordx4 v[76:79], v0, s[4:7], s24 offen sc1
 v_mul_f32 v144, v144, abs(v144)
 v_mul_f32 v145, v145, v246
 v_mfma_f32_16x16x32_bf16 v[88:91], a[24:27], v[48:51], v[88:91]
 v_mul_f32 v145, v145, abs(v145)
 v_cvt_pk_bf16_f32 v124, v144, v145
 v_mfma_f32_16x16x32_bf16 v[92:95], a[28:31], v[48:51], v[92:95]
 v_pk_max_i16 v124, v124, 0
 v_mul_f32 v146, v146, v246
 v_mfma_f32_16x16x32_bf16 v[96:99], a[32:35], v[48:51], v[96:99]
 v_mul_f32 v146, v146, abs(v146)
 v_mul_f32 v147, v147, v246
 v_mul_f32 v147, v147, abs(v147)
 v_mfma_f32_16x16x32_bf16 v[100:103], a[36:39], v[48:51], v[100:103]
 v_cvt_pk_bf16_f32 v125, v146, v147
 s_waitcnt vmcnt(6)
 v_mfma_f32_16x16x32_bf16 v[84:87], a[40:43], v[52:55], v[84:87]
 buffer_load_dwordx4 v[80:83], v0, s[4:7], s24 offen offset:1024 sc1
 v_pk_max_i16 v125, v125, 0
 v_mfma_f32_16x16x32_bf16 v[88:91], a[44:47], v[52:55], v[88:91]
 v_mul_f32 v148, v148, v246
 v_mul_f32 v148, v148, abs(v148)
 v_mul_f32 v149, v149, v246
 v_mfma_f32_16x16x32_bf16 v[92:95], a[48:51], v[52:55], v[92:95]
 v_mul_f32 v149, v149, abs(v149)
 v_cvt_pk_bf16_f32 v126, v148, v149
 v_mfma_f32_16x16x32_bf16 v[96:99], a[52:55], v[52:55], v[96:99]
 v_pk_max_i16 v126, v126, 0
 v_mul_f32 v150, v150, v246
 v_mul_f32 v150, v150, abs(v150)
 v_mfma_f32_16x16x32_bf16 v[100:103], a[56:59], v[52:55], v[100:103]
 v_mul_f32 v151, v151, v246
 s_waitcnt vmcnt(6)
 v_mfma_f32_16x16x32_bf16 v[84:87], a[60:63], v[56:59], v[84:87]
 buffer_load_dwordx4 v[44:47], v0, s[4:7], s24 offen offset:2048 sc1
 v_mul_f32 v151, v151, abs(v151)
 v_mfma_f32_16x16x32_bf16 v[88:91], a[64:67], v[56:59], v[88:91]
 v_cvt_pk_bf16_f32 v127, v150, v151
 v_pk_max_i16 v127, v127, 0
 v_mfma_f32_16x16x32_bf16 v[92:95], a[68:71], v[56:59], v[92:95]
 buffer_store_dwordx4 v[124:127], v0, s[4:7], s34 offen
 v_mfma_f32_16x16x32_bf16 v[96:99], a[72:75], v[56:59], v[96:99]
 s_add_u32 s34, s34, 49152
 v_mul_f32 v152, v152, v246
 v_mfma_f32_16x16x32_bf16 v[100:103], a[76:79], v[56:59], v[100:103]
 v_mul_f32 v152, v152, abs(v152)
 v_mul_f32 v153, v153, v246
 s_waitcnt vmcnt(7)
 v_mfma_f32_16x16x32_bf16 v[84:87], a[80:83], v[60:63], v[84:87]
 buffer_load_dwordx4 v[48:51], v0, s[4:7], s24 offen offset:3072 sc1
 v_mul_f32 v153, v153, abs(v153)
 v_mfma_f32_16x16x32_bf16 v[88:91], a[84:87], v[60:63], v[88:91]
 v_cvt_pk_bf16_f32 v132, v152, v153
 v_pk_max_i16 v132, v132, 0
 v_mul_f32 v154, v154, v246
 v_mfma_f32_16x16x32_bf16 v[92:95], a[88:91], v[60:63], v[92:95]
 v_mul_f32 v154, v154, abs(v154)
 v_mul_f32 v155, v155, v246
 v_mfma_f32_16x16x32_bf16 v[96:99], a[92:95], v[60:63], v[96:99]
 v_mul_f32 v155, v155, abs(v155)
 v_cvt_pk_bf16_f32 v133, v154, v155
 v_mfma_f32_16x16x32_bf16 v[100:103], a[96:99], v[60:63], v[100:103]
 v_pk_max_i16 v133, v133, 0
 v_mul_f32 v156, v156, v250
 s_waitcnt vmcnt(7)
 v_mfma_f32_16x16x32_bf16 v[84:87], a[100:103], v[64:67], v[84:87]
 buffer_load_dwordx4 v[52:55], v0, s[4:7], s25 offen sc1
 v_mul_f32 v156, v156, abs(v156)
 v_mfma_f32_16x16x32_bf16 v[88:91], a[104:107], v[64:67], v[88:91]
 v_mul_f32 v157, v157, v250
 v_mul_f32 v157, v157, abs(v157)
 v_mfma_f32_16x16x32_bf16 v[92:95], a[108:111], v[64:67], v[92:95]
 v_cvt_pk_bf16_f32 v128, v156, v157
 v_pk_max_i16 v128, v128, 0
 v_mul_f32 v158, v158, v250
 v_mfma_f32_16x16x32_bf16 v[96:99], a[112:115], v[64:67], v[96:99]
 v_mul_f32 v158, v158, abs(v158)
 v_mul_f32 v159, v159, v250
 v_mfma_f32_16x16x32_bf16 v[100:103], a[116:119], v[64:67], v[100:103]
 v_mul_f32 v159, v159, abs(v159)
 v_cvt_pk_bf16_f32 v129, v158, v159
 s_waitcnt vmcnt(7)
 v_mfma_f32_16x16x32_bf16 v[84:87], a[120:123], v[68:71], v[84:87]
 buffer_load_dwordx4 v[56:59], v0, s[4:7], s25 offen offset:1024 sc1
 v_pk_max_i16 v129, v129, 0
 v_mfma_f32_16x16x32_bf16 v[88:91], a[124:127], v[68:71], v[88:91]
 v_mul_f32 v160, v160, v250
 v_mul_f32 v160, v160, abs(v160)
 v_mfma_f32_16x16x32_bf16 v[92:95], a[128:131], v[68:71], v[92:95]
 v_mul_f32 v161, v161, v250
 v_mul_f32 v161, v161, abs(v161)
 v_cvt_pk_bf16_f32 v130, v160, v161
 v_mfma_f32_16x16x32_bf16 v[96:99], a[132:135], v[68:71], v[96:99]
 v_pk_max_i16 v130, v130, 0
 v_mul_f32 v162, v162, v250
 v_mfma_f32_16x16x32_bf16 v[100:103], a[136:139], v[68:71], v[100:103]
 v_mul_f32 v162, v162, abs(v162)
 s_waitcnt vmcnt(7)
 v_mfma_f32_16x16x32_bf16 v[84:87], a[140:143], v[72:75], v[84:87]
 buffer_load_dwordx4 v[60:63], v0, s[4:7], s25 offen offset:2048 sc1
 v_mul_f32 v163, v163, v250
 v_mul_f32 v163, v163, abs(v163)
 v_mfma_f32_16x16x32_bf16 v[88:91], a[144:147], v[72:75], v[88:91]
 v_cvt_pk_bf16_f32 v131, v162, v163
 v_pk_max_i16 v131, v131, 0
 v_mfma_f32_16x16x32_bf16 v[92:95], a[148:151], v[72:75], v[92:95]
 buffer_store_dwordx4 v[128:131], v0, s[4:7], s34 offen
 v_mfma_f32_16x16x32_bf16 v[96:99], a[152:155], v[72:75], v[96:99]
 s_add_u32 s34, s34, 49152
 v_mul_f32 v164, v164, v250
 v_mfma_f32_16x16x32_bf16 v[100:103], a[156:159], v[72:75], v[100:103]
 v_mul_f32 v164, v164, abs(v164)
 s_waitcnt vmcnt(8)
 v_mfma_f32_16x16x32_bf16 v[84:87], a[160:163], v[76:79], v[84:87]
 buffer_load_dwordx4 v[64:67], v0, s[4:7], s25 offen offset:3072 sc1
 s_add_u32 s25, s25, 4096
 v_mul_f32 v165, v165, v250
 v_mfma_f32_16x16x32_bf16 v[88:91], a[164:167], v[76:79], v[88:91]
 v_mul_f32 v165, v165, abs(v165)
 v_cvt_pk_bf16_f32 v134, v164, v165
 v_mfma_f32_16x16x32_bf16 v[92:95], a[168:171], v[76:79], v[92:95]
 v_pk_max_i16 v134, v134, 0
 v_mul_f32 v166, v166, v250
 v_mfma_f32_16x16x32_bf16 v[96:99], a[172:175], v[76:79], v[96:99]
 v_mul_f32 v166, v166, abs(v166)
 v_mul_f32 v167, v167, v250
 v_mul_f32 v167, v167, abs(v167)
 v_mfma_f32_16x16x32_bf16 v[100:103], a[176:179], v[76:79], v[100:103]
 v_cvt_pk_bf16_f32 v135, v166, v167
 s_waitcnt vmcnt(8)
 v_mfma_f32_16x16x32_bf16 v[84:87], a[180:183], v[80:83], v[84:87]
 buffer_load_dwordx4 v[68:71], v0, s[4:7], s25 offen sc1
 v_pk_max_i16 v135, v135, 0
 v_mfma_f32_16x16x32_bf16 v[88:91], a[184:187], v[80:83], v[88:91]
 v_permlane16_swap_b32 v132, v134
 v_mfma_f32_16x16x32_bf16 v[92:95], a[188:191], v[80:83], v[92:95]
 v_permlane16_swap_b32 v133, v135
 v_mfma_f32_16x16x32_bf16 v[96:99], a[192:195], v[80:83], v[96:99]
 buffer_store_dwordx4 v[132:135], v7, s[4:7], s35 offen offset:1024
 v_mfma_f32_16x16x32_bf16 v[100:103], a[196:199], v[80:83], v[100:103]
 s_add_u32 s35, s35, 98304
 s_waitcnt vmcnt(9)
 v_mfma_f32_16x16x32_bf16 v[84:87], a[200:203], v[44:47], v[84:87]
 buffer_load_dwordx4 v[72:75], v0, s[4:7], s25 offen offset:1024 sc1
 v_mfma_f32_16x16x32_bf16 v[88:91], a[204:207], v[44:47], v[88:91]
 v_mfma_f32_16x16x32_bf16 v[92:95], a[208:211], v[44:47], v[92:95]
 v_mfma_f32_16x16x32_bf16 v[96:99], a[212:215], v[44:47], v[96:99]
 v_mfma_f32_16x16x32_bf16 v[100:103], a[216:219], v[44:47], v[100:103]
 s_waitcnt vmcnt(8)
 v_mfma_f32_16x16x32_bf16 v[84:87], a[220:223], v[48:51], v[84:87]
 buffer_load_dwordx4 v[76:79], v0, s[4:7], s25 offen offset:2048 sc1
 v_mfma_f32_16x16x32_bf16 v[88:91], a[224:227], v[48:51], v[88:91]
 v_mfma_f32_16x16x32_bf16 v[92:95], a[228:231], v[48:51], v[92:95]
 v_mfma_f32_16x16x32_bf16 v[96:99], a[232:235], v[48:51], v[96:99]
 v_mfma_f32_16x16x32_bf16 v[100:103], a[236:239], v[48:51], v[100:103]
 s_waitcnt vmcnt(8)
 v_mfma_f32_16x16x32_bf16 v[104:107], a[0:3], v[52:55], 0
 buffer_load_dwordx4 v[80:83], v0, s[4:7], s25 offen offset:3072 sc1
 s_add_u32 s25, s25, 4096
 s_getpc_b64 s[22:23]
Lpc_18:
 s_lshl_b32 s21, s49, 2
 s_add_u32 s21, s21, s3
 s_lshl_b32 s21, s21, 8
 v_lshl_add_u32 v14, v0, 3, s21
 v_min_u32 v14, Lfast_end-Lpc_18, v14
 s_mov_b64 exec, 3
 global_load_dword v14, v14, s[22:23]
 s_mov_b64 exec, -1
 v_mfma_f32_16x16x32_bf16 v[108:111], a[4:7], v[52:55], 0
 s_waitcnt lgkmcnt(0)
 s_barrier
 v_mfma_f32_16x16x32_bf16 v[112:115], a[8:11], v[52:55], 0
 ds_write_b128 v3, v[84:87] offset:12288
 v_mfma_f32_16x16x32_bf16 v[116:119], a[12:15], v[52:55], 0
 v_mov_b32 v15, 3
 v_add_u32 v15, s52, v15
 s_waitcnt vmcnt(4)
 s_mov_b64 exec, 1
 buffer_store_dword v15, v0, s[4:7], s36 offen
 s_mov_b64 exec, -1
 v_mfma_f32_16x16x32_bf16 v[120:123], a[16:19], v[52:55], 0
 v_mfma_f32_16x16x32_bf16 v[104:107], a[20:23], v[56:59], v[104:107]
 buffer_load_dwordx4 v[44:47], v0, s[4:7], s25 offen sc1
 v_mfma_f32_16x16x32_bf16 v[108:111], a[24:27], v[56:59], v[108:111]
 ds_write_b128 v3, v[88:91] offset:13312
 v_mfma_f32_16x16x32_bf16 v[112:115], a[28:31], v[56:59], v[112:115]
 v_mfma_f32_16x16x32_bf16 v[116:119], a[32:35], v[56:59], v[116:119]
 v_mfma_f32_16x16x32_bf16 v[120:123], a[36:39], v[56:59], v[120:123]
 v_mfma_f32_16x16x32_bf16 v[104:107], a[40:43], v[60:63], v[104:107]
 buffer_load_dwordx4 v[48:51], v0, s[4:7], s25 offen offset:1024 sc1
 v_mfma_f32_16x16x32_bf16 v[108:111], a[44:47], v[60:63], v[108:111]
 ds_write_b128 v3, v[92:95] offset:14336
 v_mfma_f32_16x16x32_bf16 v[112:115], a[48:51], v[60:63], v[112:115]
 v_mfma_f32_16x16x32_bf16 v[116:119], a[52:55], v[60:63], v[116:119]
 ds_write_b128 v3, v[96:99] offset:15360
 v_mfma_f32_16x16x32_bf16 v[120:123], a[56:59], v[60:63], v[120:123]
 v_mfma_f32_16x16x32_bf16 v[104:107], a[60:63], v[64:67], v[104:107]
 buffer_load_dwordx4 v[52:55], v0, s[4:7], s25 offen offset:2048 sc1
 v_mfma_f32_16x16x32_bf16 v[108:111], a[64:67], v[64:67], v[108:111]
 v_mfma_f32_16x16x32_bf16 v[112:115], a[68:71], v[64:67], v[112:115]
 ds_write_b128 v3, v[100:103] offset:16384
 v_mfma_f32_16x16x32_bf16 v[116:119], a[72:75], v[64:67], v[116:119]
 v_mfma_f32_16x16x32_bf16 v[120:123], a[76:79], v[64:67], v[120:123]
 v_mfma_f32_16x16x32_bf16 v[104:107], a[80:83], v[68:71], v[104:107]
 buffer_load_dwordx4 v[56:59], v0, s[4:7], s25 offen offset:3072 sc1
 v_mfma_f32_16x16x32_bf16 v[108:111], a[84:87], v[68:71], v[108:111]
 v_mfma_f32_16x16x32_bf16 v[112:115], a[88:91], v[68:71], v[112:115]
 s_add_u32 s56, s52, 3
 buffer_load_dword v12, v171, s[4:7], s28 offen sc1
 s_waitcnt lgkmcnt(0)
 s_barrier
 v_mfma_f32_16x16x32_bf16 v[116:119], a[92:95], v[68:71], v[116:119]
 ds_read_b128 v[124:127], v5 offset:12288
 v_mfma_f32_16x16x32_bf16 v[120:123], a[96:99], v[68:71], v[120:123]
 ds_read_b128 v[128:131], v5 offset:13312
 s_waitcnt vmcnt(9)
 v_mfma_f32_16x16x32_bf16 v[104:107], a[100:103], v[72:75], v[104:107]
 ds_read_b64 v[132:133], v6 offset:16384
 v_mfma_f32_16x16x32_bf16 v[108:111], a[104:107], v[72:75], v[108:111]
 ds_read_b128 v[134:137], v5 offset:17408
 v_mfma_f32_16x16x32_bf16 v[112:115], a[108:111], v[72:75], v[112:115]
 ds_read_b128 v[138:141], v5 offset:18432
 v_mfma_f32_16x16x32_bf16 v[116:119], a[112:115], v[72:75], v[116:119]
 ds_read_b64 v[142:143], v6 offset:21504
 v_mfma_f32_16x16x32_bf16 v[120:123], a[116:119], v[72:75], v[120:123]
 s_waitcnt vmcnt(8)
 v_mfma_f32_16x16x32_bf16 v[104:107], a[120:123], v[76:79], v[104:107]
 v_mfma_f32_16x16x32_bf16 v[108:111], a[124:127], v[76:79], v[108:111]
 s_waitcnt lgkmcnt(5)
 v_add_f32 v16, v16, v124
 v_add_f32 v17, v17, v125
 v_mfma_f32_16x16x32_bf16 v[112:115], a[128:131], v[76:79], v[112:115]
 v_add_f32 v18, v18, v126
 v_add_f32 v19, v19, v127
 v_mfma_f32_16x16x32_bf16 v[116:119], a[132:135], v[76:79], v[116:119]
 s_waitcnt lgkmcnt(4)
 v_add_f32 v20, v20, v128
 v_add_f32 v21, v21, v129
 v_mfma_f32_16x16x32_bf16 v[120:123], a[136:139], v[76:79], v[120:123]
 v_add_f32 v22, v22, v130
 s_waitcnt vmcnt(7)
 v_mfma_f32_16x16x32_bf16 v[104:107], a[140:143], v[80:83], v[104:107]
 v_add_f32 v23, v23, v131
 s_waitcnt lgkmcnt(3)
 v_add_f32 v24, v24, v132
 v_mfma_f32_16x16x32_bf16 v[108:111], a[144:147], v[80:83], v[108:111]
 v_add_f32 v25, v25, v133
 s_waitcnt lgkmcnt(2)
 v_add_f32 v16, v16, v134
 v_mfma_f32_16x16x32_bf16 v[112:115], a[148:151], v[80:83], v[112:115]
 v_add_f32 v17, v17, v135
 v_add_f32 v18, v18, v136
 v_mfma_f32_16x16x32_bf16 v[116:119], a[152:155], v[80:83], v[116:119]
 s_waitcnt vmcnt(0)
 v_cmp_ne_u32 vcc, s56, v12
 s_cbranch_vccnz Lretry_15
Lback_16:
 buffer_load_dwordx4 v[60:63], v0, s[4:7], s26 offen sc1
 v_mfma_f32_16x16x32_bf16 v[120:123], a[156:159], v[80:83], v[120:123]
 buffer_load_dwordx4 v[64:67], v0, s[4:7], s26 offen offset:1024 sc1
 v_mfma_f32_16x16x32_bf16 v[104:107], a[160:163], v[44:47], v[104:107]
 buffer_load_dwordx4 v[68:71], v0, s[4:7], s26 offen offset:2048 sc1
 v_add_f32 v19, v19, v137
 v_mfma_f32_16x16x32_bf16 v[108:111], a[164:167], v[44:47], v[108:111]
 buffer_load_dwordx4 v[72:75], v0, s[4:7], s26 offen offset:3072 sc1
 s_add_u32 s26, s26, 4096
 v_mfma_f32_16x16x32_bf16 v[112:115], a[168:171], v[44:47], v[112:115]
 s_waitcnt lgkmcnt(1)
 v_add_f32 v20, v20, v138
 v_add_f32 v21, v21, v139
 v_mfma_f32_16x16x32_bf16 v[116:119], a[172:175], v[44:47], v[116:119]
 v_add_f32 v22, v22, v140
 v_add_f32 v23, v23, v141
 v_mfma_f32_16x16x32_bf16 v[120:123], a[176:179], v[44:47], v[120:123]
 s_waitcnt lgkmcnt(0)
 v_add_f32 v24, v24, v142
 v_mfma_f32_16x16x32_bf16 v[104:107], a[180:183], v[48:51], v[104:107]
 buffer_load_dwordx4 v[76:79], v0, s[4:7], s26 offen sc1
 v_add_f32 v25, v25, v143
 v_mfma_f32_16x16x32_bf16 v[108:111], a[184:187], v[48:51], v[108:111]
 v_mfma_f32_16x16x32_bf16 v[112:115], a[188:191], v[48:51], v[112:115]
 v_mfma_f32_16x16x32_bf16 v[116:119], a[192:195], v[48:51], v[116:119]
 v_mfma_f32_16x16x32_bf16 v[120:123], a[196:199], v[48:51], v[120:123]
 v_mfma_f32_16x16x32_bf16 v[104:107], a[200:203], v[52:55], v[104:107]
 buffer_load_dwordx4 v[80:83], v0, s[4:7], s26 offen offset:1024 sc1
 v_mfma_f32_16x16x32_bf16 v[108:111], a[204:207], v[52:55], v[108:111]
 v_mfma_f32_16x16x32_bf16 v[112:115], a[208:211], v[52:55], v[112:115]
 v_mfma_f32_16x16x32_bf16 v[116:119], a[212:215], v[52:55], v[116:119]
 v_mfma_f32_16x16x32_bf16 v[120:123], a[216:219], v[52:55], v[120:123]
 v_mfma_f32_16x16x32_bf16 v[104:107], a[220:223], v[56:59], v[104:107]
 buffer_load_dwordx4 v[44:47], v0, s[4:7], s26 offen offset:2048 sc1
 v_mfma_f32_16x16x32_bf16 v[108:111], a[224:227], v[56:59], v[108:111]
 v_mfma_f32_16x16x32_bf16 v[112:115], a[228:231], v[56:59], v[112:115]
 v_mfma_f32_16x16x32_bf16 v[116:119], a[232:235], v[56:59], v[116:119]
 v_mfma_f32_16x16x32_bf16 v[120:123], a[236:239], v[56:59], v[120:123]
 s_waitcnt vmcnt(6)
 v_mfma_f32_16x16x32_bf16 v[84:87], a[0:3], v[60:63], 0
 buffer_load_dwordx4 v[48:51], v0, s[4:7], s26 offen offset:3072 sc1
 s_add_u32 s26, s26, 4096
 v_mfma_f32_16x16x32_bf16 v[88:91], a[4:7], v[60:63], 0
 s_waitcnt lgkmcnt(0)
 s_barrier
 v_mfma_f32_16x16x32_bf16 v[92:95], a[8:11], v[60:63], 0
 ds_write_b128 v4, v[104:107] offset:12288
 v_mfma_f32_16x16x32_bf16 v[96:99], a[12:15], v[60:63], 0
 v_mfma_f32_16x16x32_bf16 v[100:103], a[16:19], v[60:63], 0
 s_waitcnt vmcnt(6)
 v_mfma_f32_16x16x32_bf16 v[84:87], a[20:23], v[64:67], v[84:87]
 buffer_load_dwordx4 v[52:55], v0, s[4:7], s26 offen sc1
 v_mfma_f32_16x16x32_bf16 v[88:91], a[24:27], v[64:67], v[88:91]
 ds_write_b128 v4, v[108:111] offset:13312
 v_mfma_f32_16x16x32_bf16 v[92:95], a[28:31], v[64:67], v[92:95]
 v_mfma_f32_16x16x32_bf16 v[96:99], a[32:35], v[64:67], v[96:99]
 v_mfma_f32_16x16x32_bf16 v[100:103], a[36:39], v[64:67], v[100:103]
 s_waitcnt vmcnt(6)
 v_mfma_f32_16x16x32_bf16 v[84:87], a[40:43], v[68:71], v[84:87]
 buffer_load_dwordx4 v[56:59], v0, s[4:7], s26 offen offset:1024 sc1
 v_mfma_f32_16x16x32_bf16 v[88:91], a[44:47], v[68:71], v[88:91]
 ds_write_b128 v4, v[112:115] offset:14336
 v_mfma_f32_16x16x32_bf16 v[92:95], a[48:51], v[68:71], v[92:95]
 v_mfma_f32_16x16x32_bf16 v[96:99], a[52:55], v[68:71], v[96:99]
 ds_write_b128 v4, v[116:119] offset:15360
 v_mfma_f32_16x16x32_bf16 v[100:103], a[56:59], v[68:71], v[100:103]
 s_waitcnt vmcnt(6)
 v_mfma_f32_16x16x32_bf16 v[84:87], a[60:63], v[72:75], v[84:87]
 buffer_load_dwordx4 v[60:63], v0, s[4:7], s26 offen offset:2048 sc1
 v_mfma_f32_16x16x32_bf16 v[88:91], a[64:67], v[72:75], v[88:91]
 v_mfma_f32_16x16x32_bf16 v[92:95], a[68:71], v[72:75], v[92:95]
 ds_write_b128 v4, v[120:123] offset:16384
 v_mfma_f32_16x16x32_bf16 v[96:99], a[72:75], v[72:75], v[96:99]
 v_mfma_f32_16x16x32_bf16 v[100:103], a[76:79], v[72:75], v[100:103]
 s_waitcnt vmcnt(6)
 v_mfma_f32_16x16x32_bf16 v[84:87], a[80:83], v[76:79], v[84:87]
 buffer_load_dwordx4 v[64:67], v0, s[4:7], s26 offen offset:3072 sc1
 v_mfma_f32_16x16x32_bf16 v[88:91], a[84:87], v[76:79], v[88:91]
 v_mfma_f32_16x16x32_bf16 v[92:95], a[88:91], v[76:79], v[92:95]
 s_waitcnt lgkmcnt(0)
 s_barrier
 v_mfma_f32_16x16x32_bf16 v[96:99], a[92:95], v[76:79], v[96:99]
 ds_read_b128 v[124:127], v5 offset:12288
 v_mfma_f32_16x16x32_bf16 v[100:103], a[96:99], v[76:79], v[100:103]
 ds_read_b128 v[128:131], v5 offset:13312
 s_waitcnt vmcnt(6)
 v_mfma_f32_16x16x32_bf16 v[84:87], a[100:103], v[80:83], v[84:87]
 buffer_load_dwordx4 v[68:71], v0, s[4:7], s27 offen sc1
 ds_read_b64 v[132:133], v6 offset:16384
 v_mfma_f32_16x16x32_bf16 v[88:91], a[104:107], v[80:83], v[88:91]
 ds_read_b128 v[134:137], v5 offset:17408
 v_mfma_f32_16x16x32_bf16 v[92:95], a[108:111], v[80:83], v[92:95]
 ds_read_b128 v[138:141], v5 offset:18432
 v_mfma_f32_16x16x32_bf16 v[96:99], a[112:115], v[80:83], v[96:99]
 ds_read_b64 v[142:143], v6 offset:21504
 v_mfma_f32_16x16x32_bf16 v[100:103], a[116:119], v[80:83], v[100:103]
 s_waitcnt vmcnt(6)
 v_mfma_f32_16x16x32_bf16 v[84:87], a[120:123], v[44:47], v[84:87]
 buffer_load_dwordx4 v[72:75], v0, s[4:7], s27 offen offset:1024 sc1
 v_mfma_f32_16x16x32_bf16 v[88:91], a[124:127], v[44:47], v[88:91]
 s_waitcnt lgkmcnt(5)
 v_add_f32 v16, v16, v124
 v_add_f32 v17, v17, v125
 v_add_f32 v18, v18, v126
 v_mfma_f32_16x16x32_bf16 v[92:95], a[128:131], v[44:47], v[92:95]
 v_add_f32 v19, v19, v127
 s_waitcnt lgkmcnt(4)
 v_add_f32 v20, v20, v128
 v_mfma_f32_16x16x32_bf16 v[96:99], a[132:135], v[44:47], v[96:99]
 v_add_f32 v21, v21, v129
 v_add_f32 v22, v22, v130
 v_add_f32 v23, v23, v131
 v_mfma_f32_16x16x32_bf16 v[100:103], a[136:139], v[44:47], v[100:103]
 s_waitcnt lgkmcnt(3)
 v_add_f32 v24, v24, v132
 s_waitcnt vmcnt(6)
 v_mfma_f32_16x16x32_bf16 v[84:87], a[140:143], v[48:51], v[84:87]
 buffer_load_dwordx4 v[76:79], v0, s[4:7], s27 offen offset:2048 sc1
 v_add_f32 v25, v25, v133
 s_waitcnt lgkmcnt(2)
 v_add_f32 v16, v16, v134
 v_mfma_f32_16x16x32_bf16 v[88:91], a[144:147], v[48:51], v[88:91]
 v_add_f32 v17, v17, v135
 v_add_f32 v18, v18, v136
 v_mfma_f32_16x16x32_bf16 v[92:95], a[148:151], v[48:51], v[92:95]
 v_add_f32 v19, v19, v137
 s_waitcnt lgkmcnt(1)
 v_add_f32 v20, v20, v138
 v_add_f32 v21, v21, v139
 v_mfma_f32_16x16x32_bf16 v[96:99], a[152:155], v[48:51], v[96:99]
 v_add_f32 v22, v22, v140
 v_add_f32 v23, v23, v141
 v_mfma_f32_16x16x32_bf16 v[100:103], a[156:159], v[48:51], v[100:103]
 s_waitcnt lgkmcnt(0)
 v_add_f32 v24, v24, v142
 v_add_f32 v25, v25, v143
 s_waitcnt vmcnt(6)
 v_mfma_f32_16x16x32_bf16 v[84:87], a[160:163], v[52:55], v[84:87]
 buffer_load_dwordx4 v[80:83], v0, s[4:7], s27 offen offset:3072 sc1
 s_add_u32 s27, s27, 4096
 v_mfma_f32_16x16x32_bf16 v[88:91], a[164:167], v[52:55], v[88:91]
 v_cvt_pk_bf16_f32 v124, v16, v17
 v_cvt_pk_bf16_f32 v125, v18, v19
 v_cvt_pk_bf16_f32 v126, v20, v21
 v_mfma_f32_16x16x32_bf16 v[92:95], a[168:171], v[52:55], v[92:95]
 v_cvt_pk_bf16_f32 v127, v22, v23
 v_cvt_pk_bf16_f32 v128, v24, v25
 v_mfma_f32_16x16x32_bf16 v[96:99], a[172:175], v[52:55], v[96:99]
 buffer_store_dwordx4 v[124:127], v168, s[8:11], s29 offen
 v_mfma_f32_16x16x32_bf16 v[100:103], a[176:179], v[52:55], v[100:103]
 s_waitcnt vmcnt(7)
 v_mfma_f32_16x16x32_bf16 v[84:87], a[180:183], v[56:59], v[84:87]
 buffer_load_dwordx4 v[44:47], v0, s[4:7], s27 offen sc1
 buffer_store_dword v128, v169, s[8:11], s30 offen
 v_mfma_f32_16x16x32_bf16 v[88:91], a[184:187], v[56:59], v[88:91]
 v_add_f32 v130, v16, v17
 v_mul_f32 v132, v16, v16
 v_mfma_f32_16x16x32_bf16 v[92:95], a[188:191], v[56:59], v[92:95]
 v_fmac_f32 v132, v17, v17
 v_add_f32 v130, v130, v18
 v_fmac_f32 v132, v18, v18
 v_mfma_f32_16x16x32_bf16 v[96:99], a[192:195], v[56:59], v[96:99]
 v_add_f32 v130, v130, v19
 v_fmac_f32 v132, v19, v19
 v_mfma_f32_16x16x32_bf16 v[100:103], a[196:199], v[56:59], v[100:103]
 v_add_f32 v130, v130, v20
 v_fmac_f32 v132, v20, v20
 s_waitcnt vmcnt(8)
 v_mfma_f32_16x16x32_bf16 v[84:87], a[200:203], v[60:63], v[84:87]
 buffer_load_dwordx4 v[48:51], v0, s[4:7], s27 offen offset:1024 sc1
 v_add_f32 v130, v130, v21
 v_mfma_f32_16x16x32_bf16 v[88:91], a[204:207], v[60:63], v[88:91]
 v_fmac_f32 v132, v21, v21
 v_add_f32 v130, v130, v22
 v_fmac_f32 v132, v22, v22
 v_mfma_f32_16x16x32_bf16 v[92:95], a[208:211], v[60:63], v[92:95]
 v_add_f32 v130, v130, v23
 v_fmac_f32 v132, v23, v23
 v_mfma_f32_16x16x32_bf16 v[96:99], a[212:215], v[60:63], v[96:99]
 v_add_f32 v130, v130, v24
 v_fmac_f32 v132, v24, v24
 v_add_f32 v130, v130, v25
 v_mfma_f32_16x16x32_bf16 v[100:103], a[216:219], v[60:63], v[100:103]
 v_fmac_f32 v132, v25, v25
 s_waitcnt vmcnt(8)
 v_mfma_f32_16x16x32_bf16 v[84:87], a[220:223], v[64:67], v[84:87]
 buffer_load_dwordx4 v[52:55], v0, s[4:7], s27 offen offset:2048 sc1
 v_permlane32_swap_b32 v130, v132
 v_mfma_f32_16x16x32_bf16 v[88:91], a[224:227], v[64:67], v[88:91]
 v_add_f32 v131, v130, v132
 v_add_f32 v130, v130, v132
 v_mfma_f32_16x16x32_bf16 v[92:95], a[228:231], v[64:67], v[92:95]
 s_nop 0
 v_permlane16_swap_b32 v130, v131
 v_add_f32 v130, v130, v131
 v_mfma_f32_16x16x32_bf16 v[96:99], a[232:235], v[64:67], v[96:99]
 s_nop 0
 v_add_f32_dpp v130, v130, v130 row_ror:8 row_mask:0xf bank_mask:0xf
 v_mfma_f32_16x16x32_bf16 v[100:103], a[236:239], v[64:67], v[100:103]
 buffer_store_dword v130, v170, s[4:7], s31 offen
 s_waitcnt vmcnt(9)
 v_mfma_f32_16x16x32_bf16 v[104:107], a[0:3], v[68:71], 0
 buffer_load_dwordx4 v[56:59], v0, s[4:7], s27 offen offset:3072 sc1
 s_add_u32 s27, s27, 4096
 v_mfma_f32_16x16x32_bf16 v[108:111], a[4:7], v[68:71], 0
 s_waitcnt lgkmcnt(0)
 s_barrier
 s_add_u32 s29, s29, 40960
 v_mfma_f32_16x16x32_bf16 v[112:115], a[8:11], v[68:71], 0
 ds_write_b128 v3, v[84:87] offset:12288
 v_mfma_f32_16x16x32_bf16 v[116:119], a[12:15], v[68:71], 0
 s_add_u32 s30, s30, 40960
 s_add_u32 s31, s31, 2048
 v_mfma_f32_16x16x32_bf16 v[120:123], a[16:19], v[68:71], 0
 s_mul_i32 s16, s54, 81920
 s_waitcnt vmcnt(9)
 v_mfma_f32_16x16x32_bf16 v[104:107], a[20:23], v[72:75], v[104:107]
 buffer_load_dwordx4 v[60:63], v0, s[4:7], s27 offen sc1
 s_add_u32 s16, s16, 0
 v_mfma_f32_16x16x32_bf16 v[108:111], a[24:27], v[72:75], v[108:111]
 ds_write_b128 v3, v[88:91] offset:13312
 v_mfma_f32_16x16x32_bf16 v[112:115], a[28:31], v[72:75], v[112:115]
 s_lshl_b32 s17, s54, 12
 s_add_u32 s17, s17, 24641536
 v_mfma_f32_16x16x32_bf16 v[116:119], a[32:35], v[72:75], v[116:119]
 v_mfma_f32_16x16x32_bf16 v[120:123], a[36:39], v[72:75], v[120:123]
 s_waitcnt vmcnt(9)
 v_mfma_f32_16x16x32_bf16 v[104:107], a[40:43], v[76:79], v[104:107]
 buffer_load_dwordx4 v[64:67], v0, s[4:7], s27 offen offset:1024 sc1
 v_mfma_f32_16x16x32_bf16 v[108:111], a[44:47], v[76:79], v[108:111]
 ds_write_b128 v3, v[92:95] offset:14336
 v_mfma_f32_16x16x32_bf16 v[112:115], a[48:51], v[76:79], v[112:115]
 v_mfma_f32_16x16x32_bf16 v[116:119], a[52:55], v[76:79], v[116:119]
 ds_write_b128 v3, v[96:99] offset:15360
 v_mfma_f32_16x16x32_bf16 v[120:123], a[56:59], v[76:79], v[120:123]
 s_waitcnt vmcnt(9)
 v_mfma_f32_16x16x32_bf16 v[104:107], a[60:63], v[80:83], v[104:107]
 buffer_load_dwordx4 v[68:71], v0, s[4:7], s27 offen offset:2048 sc1
 v_mfma_f32_16x16x32_bf16 v[108:111], a[64:67], v[80:83], v[108:111]
 v_mfma_f32_16x16x32_bf16 v[112:115], a[68:71], v[80:83], v[112:115]
 ds_write_b128 v3, v[100:103] offset:16384
 v_mfma_f32_16x16x32_bf16 v[116:119], a[72:75], v[80:83], v[116:119]
 v_mfma_f32_16x16x32_bf16 v[120:123], a[76:79], v[80:83], v[120:123]
 s_waitcnt vmcnt(8)
 v_mfma_f32_16x16x32_bf16 v[104:107], a[80:83], v[44:47], v[104:107]
 buffer_load_dwordx4 v[72:75], v0, s[4:7], s27 offen offset:3072 sc1
 v_mfma_f32_16x16x32_bf16 v[108:111], a[84:87], v[44:47], v[108:111]
 v_mfma_f32_16x16x32_bf16 v[112:115], a[88:91], v[44:47], v[112:115]
 s_waitcnt lgkmcnt(0)
 s_barrier
 v_mfma_f32_16x16x32_bf16 v[116:119], a[92:95], v[44:47], v[116:119]
 ds_read_b128 v[124:127], v5 offset:12288
 v_mfma_f32_16x16x32_bf16 v[120:123], a[96:99], v[44:47], v[120:123]
 ds_read_b128 v[128:131], v5 offset:13312
 v_mov_b32 v15, 4
 v_add_u32 v15, s52, v15
 s_waitcnt vmcnt(5)
 s_mov_b64 exec, 1
 buffer_store_dword v15, v0, s[4:7], s32 offen
 s_mov_b64 exec, -1
 s_add_u32 s32, s32, 12288
 v_mfma_f32_16x16x32_bf16 v[104:107], a[100:103], v[48:51], v[104:107]
 ds_read_b64 v[132:133], v6 offset:16384
 v_mfma_f32_16x16x32_bf16 v[108:111], a[104:107], v[48:51], v[108:111]
 ds_read_b128 v[134:137], v5 offset:17408
 v_mfma_f32_16x16x32_bf16 v[112:115], a[108:111], v[48:51], v[112:115]
 ds_read_b128 v[138:141], v5 offset:18432
 v_mfma_f32_16x16x32_bf16 v[116:119], a[112:115], v[48:51], v[116:119]
 ds_read_b64 v[142:143], v6 offset:21504
 v_mfma_f32_16x16x32_bf16 v[120:123], a[116:119], v[48:51], v[120:123]
 v_mfma_f32_16x16x32_bf16 v[104:107], a[120:123], v[52:55], v[104:107]
 v_mfma_f32_16x16x32_bf16 v[108:111], a[124:127], v[52:55], v[108:111]
 s_waitcnt lgkmcnt(5)
 v_add_f32 v26, v26, v124
 v_add_f32 v27, v27, v125
 v_mfma_f32_16x16x32_bf16 v[112:115], a[128:131], v[52:55], v[112:115]
 v_add_f32 v28, v28, v126
 v_add_f32 v29, v29, v127
 v_mfma_f32_16x16x32_bf16 v[116:119], a[132:135], v[52:55], v[116:119]
 s_waitcnt lgkmcnt(4)
 v_add_f32 v30, v30, v128
 v_add_f32 v31, v31, v129
 v_mfma_f32_16x16x32_bf16 v[120:123], a[136:139], v[52:55], v[120:123]
 v_add_f32 v32, v32, v130
 s_waitcnt vmcnt(5)
 v_mfma_f32_16x16x32_bf16 v[104:107], a[140:143], v[56:59], v[104:107]
 v_add_f32 v33, v33, v131
 s_waitcnt lgkmcnt(3)
 v_add_f32 v34, v34, v132
 v_mfma_f32_16x16x32_bf16 v[108:111], a[144:147], v[56:59], v[108:111]
 v_add_f32 v35, v35, v133
 s_waitcnt lgkmcnt(2)
 v_add_f32 v26, v26, v134
 v_mfma_f32_16x16x32_bf16 v[112:115], a[148:151], v[56:59], v[112:115]
 v_add_f32 v27, v27, v135
 v_add_f32 v28, v28, v136
 v_mfma_f32_16x16x32_bf16 v[116:119], a[152:155], v[56:59], v[116:119]
 v_add_f32 v29, v29, v137
 s_waitcnt lgkmcnt(1)
 v_add_f32 v30, v30, v138
 v_mfma_f32_16x16x32_bf16 v[120:123], a[156:159], v[56:59], v[120:123]
 v_add_f32 v31, v31, v139
 s_waitcnt vmcnt(4)
 v_mfma_f32_16x16x32_bf16 v[104:107], a[160:163], v[60:63], v[104:107]
 v_add_f32 v32, v32, v140
 v_add_f32 v33, v33, v141
 v_mfma_f32_16x16x32_bf16 v[108:111], a[164:167], v[60:63], v[108:111]
 s_waitcnt lgkmcnt(0)
 v_add_f32 v34, v34, v142
 v_add_f32 v35, v35, v143
 v_mfma_f32_16x16x32_bf16 v[112:115], a[168:171], v[60:63], v[112:115]
 v_mfma_f32_16x16x32_bf16 v[116:119], a[172:175], v[60:63], v[116:119]
 v_mfma_f32_16x16x32_bf16 v[120:123], a[176:179], v[60:63], v[120:123]
 s_waitcnt vmcnt(3)
 v_mfma_f32_16x16x32_bf16 v[104:107], a[180:183], v[64:67], v[104:107]
 v_mfma_f32_16x16x32_bf16 v[108:111], a[184:187], v[64:67], v[108:111]
 v_mfma_f32_16x16x32_bf16 v[112:115], a[188:191], v[64:67], v[112:115]
 v_mfma_f32_16x16x32_bf16 v[116:119], a[192:195], v[64:67], v[116:119]
 s_lshl_b32 s33, s54, 7
 s_add_u32 s33, s33, 7733248
 s_add_u32 s56, s52, 4
 buffer_load_dword v12, v172, s[4:7], s33 offen sc1
 v_mfma_f32_16x16x32_bf16 v[120:123], a[196:199], v[64:67], v[120:123]
 s_waitcnt vmcnt(3)
 v_mfma_f32_16x16x32_bf16 v[104:107], a[200:203], v[68:71], v[104:107]
 v_mfma_f32_16x16x32_bf16 v[108:111], a[204:207], v[68:71], v[108:111]
 v_mfma_f32_16x16x32_bf16 v[112:115], a[208:211], v[68:71], v[112:115]
 v_mfma_f32_16x16x32_bf16 v[116:119], a[212:215], v[68:71], v[116:119]
 v_mfma_f32_16x16x32_bf16 v[120:123], a[216:219], v[68:71], v[120:123]
 s_waitcnt vmcnt(2)
 v_mfma_f32_16x16x32_bf16 v[104:107], a[220:223], v[72:75], v[104:107]
 v_mfma_f32_16x16x32_bf16 v[108:111], a[224:227], v[72:75], v[108:111]
 v_mfma_f32_16x16x32_bf16 v[112:115], a[228:231], v[72:75], v[112:115]
 v_mfma_f32_16x16x32_bf16 v[116:119], a[232:235], v[72:75], v[116:119]
 v_mfma_f32_16x16x32_bf16 v[120:123], a[236:239], v[72:75], v[120:123]
 s_waitcnt vmcnt(0)
 v_cmp_ne_u32 vcc, s56, v12
 s_cbranch_vccz Lgate_19
 s_mov_b32 s55, 0
Lpoll_20:
 buffer_load_dword v12, v172, s[4:7], s33 offen sc1
 s_add_u32 s55, s55, 1
 s_cmp_gt_u32 s55, 0x80000
 s_cbranch_scc1 Lend
 s_waitcnt vmcnt(0)
 v_cmp_ne_u32 vcc, s56, v12
 s_cbranch_vccnz Lpoll_20
Lgate_19:
 s_add_u32 s33, s33, 12288
 buffer_load_dwordx4 v[176:179], v0, s[8:11], s16 offen sc1
 buffer_load_dwordx4 v[180:183], v0, s[8:11], s16 offen offset:1024 sc1
 s_waitcnt lgkmcnt(0)
 s_barrier
 ds_write_b128 v4, v[104:107] offset:12288
 buffer_load_dwordx4 v[184:187], v0, s[8:11], s16 offen offset:2048 sc1
 ds_read_b128 v[224:227], v0
 ds_write_b128 v4, v[108:111] offset:13312
 buffer_load_dwordx4 v[188:191], v0, s[8:11], s16 offen offset:3072 sc1
 s_add_u32 s16, s16, 4096
 ds_read_b128 v[228:231], v0 offset:1024
 ds_write_b128 v4, v[112:115] offset:14336
 buffer_load_dwordx4 v[192:195], v0, s[8:11], s16 offen sc1
 ds_read_b128 v[232:235], v0 offset:2048
 ds_write_b128 v4, v[116:119] offset:15360
 buffer_load_dwordx4 v[196:199], v0, s[8:11], s16 offen offset:1024 sc1
 ds_read_b128 v[236:239], v0 offset:3072
 ds_write_b128 v4, v[120:123] offset:16384
 buffer_load_dwordx4 v[200:203], v0, s[8:11], s16 offen offset:2048 sc1
 ds_read_b128 v[240:243], v0 offset:4096
 s_waitcnt lgkmcnt(0)
 s_barrier
 ds_read_b128 v[124:127], v5 offset:12288
 ds_read_b128 v[128:131], v5 offset:13312
 ds_read_b64 v[132:133], v6 offset:16384
 ds_read_b128 v[134:137], v5 offset:17408
 ds_read_b128 v[138:141], v5 offset:18432
 ds_read_b64 v[142:143], v6 offset:21504
 buffer_load_dwordx4 v[204:207], v0, s[8:11], s16 offen offset:3072 sc1
 s_add_u32 s16, s16, 4096
 buffer_load_dwordx4 v[208:211], v0, s[8:11], s16 offen sc1
 buffer_load_dwordx4 v[212:215], v0, s[8:11], s16 offen offset:1024 sc1
 s_waitcnt vmcnt(9)
 v_mfma_f32_32x32x16_bf16 v[44:59], v[224:227], v[176:179], 0
 ds_read_b128 v[244:247], v0 offset:5120
 v_mfma_f32_32x32x16_bf16 v[76:91], v[228:231], v[176:179], 0
 ds_read_b128 v[248:251], v0 offset:6144
 s_waitcnt vmcnt(8)
 v_mfma_f32_32x32x16_bf16 v[44:59], v[232:235], v[180:183], v[44:59]
 ds_read_b128 v[252:255], v0 offset:7168
 s_waitcnt lgkmcnt(8)
 v_add_f32 v26, v26, v124
 v_add_f32 v27, v27, v125
 v_add_f32 v28, v28, v126
 v_add_f32 v29, v29, v127
 s_waitcnt lgkmcnt(7)
 v_add_f32 v30, v30, v128
 v_mfma_f32_32x32x16_bf16 v[76:91], v[236:239], v[180:183], v[76:91]
 ds_read_b128 v[224:227], v0 offset:8192
 v_add_f32 v31, v31, v129
 v_add_f32 v32, v32, v130
 v_add_f32 v33, v33, v131
 s_waitcnt lgkmcnt(7)
 v_add_f32 v34, v34, v132
 s_waitcnt vmcnt(7) lgkmcnt(3)
 v_mfma_f32_32x32x16_bf16 v[44:59], v[240:243], v[184:187], v[44:59]
 ds_read_b128 v[228:231], v0 offset:9216
 v_add_f32 v35, v35, v133
 v_add_f32 v26, v26, v134
 v_add_f32 v27, v27, v135
 v_add_f32 v28, v28, v136
 v_add_f32 v29, v29, v137
 v_mfma_f32_32x32x16_bf16 v[76:91], v[244:247], v[184:187], v[76:91]
 ds_read_b128 v[232:235], v0 offset:10240
 v_add_f32 v30, v30, v138
 v_add_f32 v31, v31, v139
 v_add_f32 v32, v32, v140
 v_add_f32 v33, v33, v141
 v_add_f32 v34, v34, v142
 s_waitcnt vmcnt(6) lgkmcnt(3)
 v_mfma_f32_32x32x16_bf16 v[44:59], v[248:251], v[188:191], v[44:59]
 buffer_load_dwordx4 v[216:219], v0, s[8:11], s16 offen offset:2048 sc1
 ds_read_b128 v[236:239], v0 offset:11264
 v_add_f32 v35, v35, v143
 v_cvt_pk_bf16_f32 v124, v26, v27
 v_cvt_pk_bf16_f32 v125, v28, v29
 v_cvt_pk_bf16_f32 v126, v30, v31
 v_mfma_f32_32x32x16_bf16 v[76:91], v[252:255], v[188:191], v[76:91]
 ds_read_b128 v[240:243], v0 offset:12288
 v_cvt_pk_bf16_f32 v127, v32, v33
 v_cvt_pk_bf16_f32 v128, v34, v35
 s_waitcnt vmcnt(6) lgkmcnt(3)
 v_mfma_f32_32x32x16_bf16 v[44:59], v[224:227], v[192:195], v[44:59]
 buffer_load_dwordx4 v[220:223], v0, s[8:11], s16 offen offset:3072 sc1
 s_add_u32 s16, s16, 4096
 ds_read_b128 v[244:247], v0 offset:13312
 v_mfma_f32_32x32x16_bf16 v[76:91], v[228:231], v[192:195], v[76:91]
 buffer_load_dwordx4 v[144:147], v0, s[4:7], s17 offen sc1
 ds_read_b128 v[248:251], v0 offset:14336
 s_waitcnt vmcnt(7) lgkmcnt(3)
 v_mfma_f32_32x32x16_bf16 v[44:59], v[232:235], v[196:199], v[44:59]
 buffer_load_dwordx4 v[176:179], v0, s[8:11], s16 offen sc1
 ds_read_b128 v[252:255], v0 offset:15360
 v_mfma_f32_32x32x16_bf16 v[76:91], v[236:239], v[196:199], v[76:91]
 ds_read_b128 v[224:227], v0 offset:16384
 s_waitcnt vmcnt(7) lgkmcnt(3)
 v_mfma_f32_32x32x16_bf16 v[44:59], v[240:243], v[200:203], v[44:59]
 buffer_load_dwordx4 v[180:183], v0, s[8:11], s16 offen offset:1024 sc1
 ds_read_b128 v[228:231], v0 offset:17408
 v_mfma_f32_32x32x16_bf16 v[76:91], v[244:247], v[200:203], v[76:91]
 ds_read_b128 v[232:235], v0 offset:18432
 buffer_store_dwordx4 v[124:127], v168, s[8:11], s29 offen
 s_waitcnt vmcnt(8) lgkmcnt(3)
 v_mfma_f32_32x32x16_bf16 v[44:59], v[248:251], v[204:207], v[44:59]
 buffer_load_dwordx4 v[184:187], v0, s[8:11], s16 offen offset:2048 sc1
 ds_read_b128 v[236:239], v0 offset:19456
 buffer_store_dword v128, v169, s[8:11], s30 offen
 v_add_f32 v130, v26, v27
 v_mul_f32 v132, v26, v26
 v_mfma_f32_32x32x16_bf16 v[76:91], v[252:255], v[204:207], v[76:91]
 buffer_load_dwordx4 v[148:151], v0, s[4:7], s17 offen offset:1024 sc1
 ds_read_b128 v[240:243], v0 offset:20480
 v_fmac_f32 v132, v27, v27
 v_add_f32 v130, v130, v28
 v_fmac_f32 v132, v28, v28
 s_waitcnt vmcnt(10) lgkmcnt(3)
 v_mfma_f32_32x32x16_bf16 v[44:59], v[224:227], v[208:211], v[44:59]
 buffer_load_dwordx4 v[188:191], v0, s[8:11], s16 offen offset:3072 sc1
 s_add_u32 s16, s16, 4096
 ds_read_b128 v[244:247], v0 offset:21504
 v_add_f32 v130, v130, v29
 v_fmac_f32 v132, v29, v29
 v_add_f32 v130, v130, v30
 v_mfma_f32_32x32x16_bf16 v[76:91], v[228:231], v[208:211], v[76:91]
 ds_read_b128 v[248:251], v0 offset:22528
 v_fmac_f32 v132, v30, v30
 v_add_f32 v130, v130, v31
 v_fmac_f32 v132, v31, v31
 v_add_f32 v130, v130, v32
 s_waitcnt vmcnt(10) lgkmcnt(3)
 v_mfma_f32_32x32x16_bf16 v[44:59], v[232:235], v[212:215], v[44:59]
 buffer_load_dwordx4 v[192:195], v0, s[8:11], s16 offen sc1
 ds_read_b128 v[252:255], v0 offset:23552
 v_fmac_f32 v132, v32, v32
 v_add_f32 v130, v130, v33
 v_fmac_f32 v132, v33, v33
 v_add_f32 v130, v130, v34
 v_mfma_f32_32x32x16_bf16 v[76:91], v[236:239], v[212:215], v[76:91]
 ds_read_b128 v[224:227], v0 offset:24576
 v_fmac_f32 v132, v34, v34
 v_add_f32 v130, v130, v35
 v_fmac_f32 v132, v35, v35
 s_waitcnt vmcnt(10) lgkmcnt(3)
 v_mfma_f32_32x32x16_bf16 v[44:59], v[240:243], v[216:219], v[44:59]
 buffer_load_dwordx4 v[196:199], v0, s[8:11], s16 offen offset:1024 sc1
 ds_read_b128 v[228:231], v0 offset:25600
 v_permlane32_swap_b32 v130, v132
 v_add_f32 v131, v130, v132
 v_add_f32 v130, v130, v132
 v_mfma_f32_32x32x16_bf16 v[76:91], v[244:247], v[216:219], v[76:91]
 ds_read_b128 v[232:235], v0 offset:26624
 v_permlane16_swap_b32 v130, v131
 v_add_f32 v130, v130, v131
 s_nop 1
 v_add_f32_dpp v130, v130, v130 row_ror:8 row_mask:0xf bank_mask:0xf
 s_waitcnt vmcnt(10) lgkmcnt(3)
 v_mfma_f32_32x32x16_bf16 v[44:59], v[248:251], v[220:223], v[44:59]
 buffer_load_dwordx4 v[200:203], v0, s[8:11], s16 offen offset:2048 sc1
 ds_read_b128 v[236:239], v0 offset:27648
 buffer_store_dword v130, v170, s[4:7], s31 offen
 v_mfma_f32_32x32x16_bf16 v[76:91], v[252:255], v[220:223], v[76:91]
 ds_read_b128 v[240:243], v0 offset:28672
 s_waitcnt vmcnt(10) lgkmcnt(3)
 v_mfma_f32_32x32x16_bf16 v[44:59], v[224:227], v[176:179], v[44:59]
 buffer_load_dwordx4 v[204:207], v0, s[8:11], s16 offen offset:3072 sc1
 s_add_u32 s16, s16, 4096
 ds_read_b128 v[244:247], v0 offset:29696
 v_mfma_f32_32x32x16_bf16 v[76:91], v[228:231], v[176:179], v[76:91]
 ds_read_b128 v[248:251], v0 offset:30720
 s_waitcnt vmcnt(10) lgkmcnt(3)
 v_mfma_f32_32x32x16_bf16 v[44:59], v[232:235], v[180:183], v[44:59]
 buffer_load_dwordx4 v[208:211], v0, s[8:11], s16 offen sc1
 ds_read_b128 v[252:255], v0 offset:31744
 v_mfma_f32_32x32x16_bf16 v[76:91], v[236:239], v[180:183], v[76:91]
 ds_read_b128 v[224:227], v0 offset:32768
 s_waitcnt vmcnt(9) lgkmcnt(3)
 v_mfma_f32_32x32x16_bf16 v[44:59], v[240:243], v[184:187], v[44:59]
 buffer_load_dwordx4 v[212:215], v0, s[8:11], s16 offen offset:1024 sc1
 ds_read_b128 v[228:231], v0 offset:33792
 v_mfma_f32_32x32x16_bf16 v[76:91], v[244:247], v[184:187], v[76:91]
 ds_read_b128 v[232:235], v0 offset:34816
 s_waitcnt vmcnt(7) lgkmcnt(3)
 v_mfma_f32_32x32x16_bf16 v[44:59], v[248:251], v[188:191], v[44:59]
 buffer_load_dwordx4 v[216:219], v0, s[8:11], s16 offen offset:2048 sc1
 ds_read_b128 v[236:239], v0 offset:35840
 v_mfma_f32_32x32x16_bf16 v[76:91], v[252:255], v[188:191], v[76:91]
 ds_read_b128 v[240:243], v0 offset:36864
 s_waitcnt vmcnt(7) lgkmcnt(3)
 v_mfma_f32_32x32x16_bf16 v[44:59], v[224:227], v[192:195], v[44:59]
 buffer_load_dwordx4 v[220:223], v0, s[8:11], s16 offen offset:3072 sc1
 s_add_u32 s16, s16, 4096
 ds_read_b128 v[244:247], v0 offset:37888
 v_mov_b32 v15, 4
 v_add_u32 v15, s52, v15
 s_waitcnt vmcnt(5)
 s_mov_b64 exec, 1
 buffer_store_dword v15, v0, s[4:7], s32 offen
 s_mov_b64 exec, -1
 v_mfma_f32_32x32x16_bf16 v[76:91], v[228:231], v[192:195], v[76:91]
 ds_read_b128 v[248:251], v0 offset:38912
 s_barrier
 v_add_f32 v144, v144, v145
 v_add_f32 v148, v148, v149
 s_waitcnt lgkmcnt(3)
 v_mfma_f32_32x32x16_bf16 v[44:59], v[232:235], v[196:199], v[44:59]
 buffer_load_dwordx4 v[176:179], v0, s[8:11], s16 offen sc1
 ds_read_b128 v[252:255], v0 offset:39936
 v_add_f32 v144, v144, v146
 v_add_f32 v148, v148, v150
 v_add_f32 v144, v144, v147
 s_mul_i32 s18, s51, 102400
 v_mfma_f32_32x32x16_bf16 v[76:91], v[236:239], v[196:199], v[76:91]
 ds_read_b128 v[224:227], v0 offset:40960
 v_add_f32 v148, v148, v151
 s_nop 1
 v_permlane16_swap_b32 v144, v148
 s_mul_i32 s19, s3, 25600
 s_waitcnt lgkmcnt(3)
 v_mfma_f32_32x32x16_bf16 v[44:59], v[240:243], v[200:203], v[44:59]
 buffer_load_dwordx4 v[180:183], v0, s[8:11], s16 offen offset:1024 sc1
 ds_read_b128 v[228:231], v0 offset:41984
 v_add_f32 v144, v144, v148
 v_mov_b32 v145, v144
 s_add_u32 s18, s18, s19
 s_add_u32 s18, s18, 6553600
 v_mfma_f32_32x32x16_bf16 v[76:91], v[244:247], v[200:203], v[76:91]
 ds_read_b128 v[232:235], v0 offset:43008
 v_permlane32_swap_b32 v144, v145
 v_mul_f32 v144, 0xbacccccd, v144
 s_mul_i32 s20, s54, 196608
 s_waitcnt vmcnt(7) lgkmcnt(3)
 v_mfma_f32_32x32x16_bf16 v[44:59], v[248:251], v[204:207], v[44:59]
 buffer_load_dwordx4 v[184:187], v0, s[8:11], s16 offen offset:2048 sc1
 ds_read_b128 v[236:239], v0 offset:44032
 v_mul_f32 v145, 0x3acccccd, v145
 v_fma_f32 v145, -v144, v144, v145
 v_max_f32 v145, 0, v145
 s_add_u32 s20, s20, 18350080
 v_mfma_f32_32x32x16_bf16 v[76:91], v[252:255], v[204:207], v[76:91]
 ds_read_b128 v[240:243], v0 offset:45056
 v_add_f32 v145, 0x3727c5ac, v145
 v_rsq_f32 v146, v145
 s_mul_i32 s21, s50, 5120
 s_waitcnt vmcnt(7) lgkmcnt(3)
 v_mfma_f32_32x32x16_bf16 v[44:59], v[224:227], v[208:211], v[44:59]
 buffer_load_dwordx4 v[188:191], v0, s[8:11], s16 offen offset:3072 sc1
 s_add_u32 s16, s16, 4096
 ds_read_b128 v[244:247], v0 offset:46080
 v_cvt_pk_bf16_f32 v160, v144, v144
 v_lshlrev_b32 v147, 16, v160
 s_add_u32 s20, s20, s21
 v_mfma_f32_32x32x16_bf16 v[76:91], v[228:231], v[208:211], v[76:91]
 ds_read_b128 v[248:251], v0 offset:47104
 v_sub_f32 v147, v144, v147
 v_cvt_pk_bf16_f32 v161, v147, v147
 v_mov_b32 v170, v146
 s_lshr_b32 s22, s51, 1
 s_waitcnt vmcnt(7) lgkmcnt(3)
 v_mfma_f32_32x32x16_bf16 v[44:59], v[232:235], v[212:215], v[44:59]
 buffer_load_dwordx4 v[192:195], v0, s[8:11], s16 offen sc1
 ds_read_b128 v[252:255], v0 offset:48128
 v_mul_f32 v168, 0x3fb8aa3b, v146
 v_mul_f32 v169, 0xbfb8aa3b, v146
 s_lshl_b32 s22, s22, 5
 s_add_u32 s22, s22, s59
 v_mfma_f32_32x32x16_bf16 v[76:91], v[236:239], v[212:215], v[76:91]
 ds_read_b128 v[224:227], v0 offset:49152
 s_lshl_b32 s22, s22, 3
 s_add_u32 s22, s22, s20
 s_add_u32 s22, s22, 4096
 s_lshl_b32 s21, s51, 9
 s_waitcnt vmcnt(7) lgkmcnt(3)
 v_mfma_f32_32x32x16_bf16 v[44:59], v[240:243], v[216:219], v[44:59]
 buffer_load_dwordx4 v[196:199], v0, s[8:11], s16 offen offset:1024 sc1
 ds_read_b128 v[228:231], v0 offset:50176
 s_add_u32 s20, s20, s21
 s_add_u32 s21, s20, 40960
 s_lshl_b32 s23, s54, 7
 s_add_u32 s23, s23, 7737344
 v_mfma_f32_32x32x16_bf16 v[76:91], v[244:247], v[216:219], v[76:91]
 ds_read_b128 v[232:235], v0 offset:51200
 s_lshl_b32 s24, s49, 2
 s_add_u32 s23, s23, s24
 s_add_u32 s24, s24, s3
 s_mul_i32 s24, s24, 6144
 s_waitcnt vmcnt(7) lgkmcnt(3)
 v_mfma_f32_32x32x16_bf16 v[44:59], v[248:251], v[220:223], v[44:59]
 buffer_load_dwordx4 v[200:203], v0, s[8:11], s16 offen offset:2048 sc1
 ds_read_b128 v[236:239], v0 offset:52224
 s_add_u32 s24, s24, 9437184
 s_xor_b32 s25, s48, 1
 s_mul_i32 s25, s25, 768
 s_add_u32 s25, s25, s24
 v_mfma_f32_32x32x16_bf16 v[76:91], v[252:255], v[220:223], v[76:91]
 ds_read_b128 v[240:243], v0 offset:53248
 s_xor_b32 s26, s48, 2
 s_mul_i32 s26, s26, 768
 s_add_u32 s26, s26, s24
 s_xor_b32 s27, s48, 3
 s_waitcnt vmcnt(6) lgkmcnt(3)
 v_mfma_f32_32x32x16_bf16 v[44:59], v[224:227], v[176:179], v[44:59]
 buffer_load_dwordx4 v[204:207], v0, s[8:11], s16 offen offset:3072 sc1
 s_add_u32 s16, s16, 4096
 ds_read_b128 v[244:247], v0 offset:54272
 s_mul_i32 s27, s27, 768
 s_add_u32 s27, s27, s24
 s_xor_b32 s28, s48, 4
 v_mfma_f32_32x32x16_bf16 v[76:91], v[228:231], v[176:179], v[76:91]
 ds_read_b128 v[248:251], v0 offset:55296
 s_mul_i32 s28, s28, 768
 s_add_u32 s28, s28, s24
 s_xor_b32 s29, s48, 5
 s_mul_i32 s29, s29, 768
 s_waitcnt vmcnt(6) lgkmcnt(3)
 v_mfma_f32_32x32x16_bf16 v[44:59], v[232:235], v[180:183], v[44:59]
 buffer_load_dwordx4 v[208:211], v0, s[8:11], s16 offen sc1
 ds_read_b128 v[252:255], v0 offset:56320
 s_add_u32 s29, s29, s24
 s_xor_b32 s30, s48, 6
 s_mul_i32 s30, s30, 768
 s_add_u32 s30, s30, s24
 v_mfma_f32_32x32x16_bf16 v[76:91], v[236:239], v[180:183], v[76:91]
 ds_read_b128 v[224:227], v0 offset:57344
 s_xor_b32 s31, s48, 7
 s_mul_i32 s31, s31, 768
 s_add_u32 s31, s31, s24
 s_mul_i32 s32, s48, 768
 s_waitcnt vmcnt(6) lgkmcnt(3)
 v_mfma_f32_32x32x16_bf16 v[44:59], v[240:243], v[184:187], v[44:59]
 s_add_u32 s56, s52, 4
 buffer_load_dword v12, v172, s[4:7], s33 offen sc1
 buffer_load_dwordx4 v[212:215], v0, s[8:11], s16 offen offset:1024 sc1
 ds_read_b128 v[228:231], v0 offset:58368
 s_add_u32 s24, s24, s32
 v_mfma_f32_32x32x16_bf16 v[76:91], v[244:247], v[184:187], v[76:91]
 ds_read_b128 v[232:235], v0 offset:59392
 s_waitcnt vmcnt(7) lgkmcnt(3)
 v_mfma_f32_32x32x16_bf16 v[44:59], v[248:251], v[188:191], v[44:59]
 buffer_load_dwordx4 v[216:219], v0, s[8:11], s16 offen offset:2048 sc1
 ds_read_b128 v[236:239], v0 offset:60416
 v_mfma_f32_32x32x16_bf16 v[76:91], v[252:255], v[188:191], v[76:91]
 ds_read_b128 v[240:243], v0 offset:61440
 s_waitcnt vmcnt(7) lgkmcnt(3)
 v_mfma_f32_32x32x16_bf16 v[44:59], v[224:227], v[192:195], v[44:59]
 buffer_load_dwordx4 v[220:223], v0, s[8:11], s16 offen offset:3072 sc1
 s_add_u32 s16, s16, 4096
 ds_read_b128 v[244:247], v0 offset:62464
 v_mfma_f32_32x32x16_bf16 v[76:91], v[228:231], v[192:195], v[76:91]
 ds_read_b128 v[248:251], v0 offset:63488
 s_waitcnt vmcnt(7) lgkmcnt(3)
 v_mfma_f32_32x32x16_bf16 v[44:59], v[232:235], v[196:199], v[44:59]
 buffer_load_dwordx4 v[176:179], v0, s[8:11], s16 offen sc1
 ds_read_b128 v[252:255], v0 offset:64512
 v_mfma_f32_32x32x16_bf16 v[76:91], v[236:239], v[196:199], v[76:91]
 ds_read_b128 v[224:227], v1
 s_waitcnt vmcnt(7) lgkmcnt(3)
 v_mfma_f32_32x32x16_bf16 v[44:59], v[240:243], v[200:203], v[44:59]
 buffer_load_dwordx4 v[180:183], v0, s[8:11], s16 offen offset:1024 sc1
 ds_read_b128 v[228:231], v1 offset:1024
 v_mfma_f32_32x32x16_bf16 v[76:91], v[244:247], v[200:203], v[76:91]
 ds_read_b128 v[232:235], v1 offset:2048
 s_waitcnt vmcnt(7) lgkmcnt(3)
 v_mfma_f32_32x32x16_bf16 v[44:59], v[248:251], v[204:207], v[44:59]
 buffer_load_dwordx4 v[184:187], v0, s[8:11], s16 offen offset:2048 sc1
 ds_read_b128 v[236:239], v1 offset:3072
 v_mfma_f32_32x32x16_bf16 v[76:91], v[252:255], v[204:207], v[76:91]
 ds_read_b128 v[240:243], v1 offset:4096
 s_waitcnt vmcnt(7) lgkmcnt(3)
 v_mfma_f32_32x32x16_bf16 v[44:59], v[224:227], v[208:211], v[44:59]
 s_waitcnt vmcnt(6)
 v_cmp_ne_u32 vcc, s56, v12
 s_cbranch_vccnz Lretry_21
Lback_22:
 buffer_load_dwordx4 v[188:191], v0, s[8:11], s16 offen offset:3072 sc1
 s_add_u32 s16, s16, 4096
 ds_read_b128 v[244:247], v1 offset:5120
 v_mfma_f32_32x32x16_bf16 v[76:91], v[228:231], v[208:211], v[76:91]
 ds_read_b128 v[248:251], v1 offset:6144
 s_waitcnt vmcnt(6) lgkmcnt(3)
 v_mfma_f32_32x32x16_bf16 v[44:59], v[232:235], v[212:215], v[44:59]
 buffer_load_dwordx4 v[192:195], v0, s[8:11], s16 offen sc1
 ds_read_b128 v[252:255], v1 offset:7168
 v_mfma_f32_32x32x16_bf16 v[76:91], v[236:239], v[212:215], v[76:91]
 ds_read_b128 v[224:227], v1 offset:8192
 s_waitcnt vmcnt(6) lgkmcnt(3)
 v_mfma_f32_32x32x16_bf16 v[44:59], v[240:243], v[216:219], v[44:59]
 buffer_load_dwordx4 v[196:199], v0, s[8:11], s16 offen offset:1024 sc1
 ds_read_b128 v[228:231], v1 offset:9216
 v_mfma_f32_32x32x16_bf16 v[76:91], v[244:247], v[216:219], v[76:91]
 ds_read_b128 v[232:235], v1 offset:10240
 s_waitcnt vmcnt(6) lgkmcnt(3)
 v_mfma_f32_32x32x16_bf16 v[44:59], v[248:251], v[220:223], v[44:59]
 buffer_load_dwordx4 v[200:203], v0, s[8:11], s16 offen offset:2048 sc1
 ds_read_b128 v[236:239], v1 offset:11264
 v_mfma_f32_32x32x16_bf16 v[76:91], v[252:255], v[220:223], v[76:91]
 ds_read_b128 v[240:243], v1 offset:12288
 s_waitcnt vmcnt(6) lgkmcnt(3)
 v_mfma_f32_32x32x16_bf16 v[44:59], v[224:227], v[176:179], v[44:59]
 buffer_load_dwordx4 v[204:207], v0, s[8:11], s16 offen offset:3072 sc1
 s_add_u32 s16, s16, 4096
 ds_read_b128 v[244:247], v1 offset:13312
 v_mfma_f32_32x32x16_bf16 v[76:91], v[228:231], v[176:179], v[76:91]
 buffer_load_dwordx4 v[152:155], v0, s[4:7], s17 offen offset:2048 sc1
 ds_read_b128 v[248:251], v1 offset:14336
 s_waitcnt vmcnt(7) lgkmcnt(3)
 v_mfma_f32_32x32x16_bf16 v[44:59], v[232:235], v[180:183], v[44:59]
 buffer_load_dwordx4 v[208:211], v0, s[8:11], s16 offen sc1
 ds_read_b128 v[252:255], v1 offset:15360
 v_mfma_f32_32x32x16_bf16 v[76:91], v[236:239], v[180:183], v[76:91]
 buffer_load_dwordx4 v[156:159], v0, s[4:7], s17 offen offset:3072 sc1
 ds_read_b128 v[224:227], v0
 s_waitcnt vmcnt(8) lgkmcnt(3)
 v_mfma_f32_32x32x16_bf16 v[44:59], v[240:243], v[184:187], v[44:59]
 buffer_load_dwordx4 v[212:215], v0, s[8:11], s16 offen offset:1024 sc1
 ds_read_b128 v[228:231], v0 offset:1024
 v_mfma_f32_32x32x16_bf16 v[76:91], v[244:247], v[184:187], v[76:91]
 ds_read_b128 v[232:235], v0 offset:2048
 s_waitcnt vmcnt(8) lgkmcnt(3)
 v_mfma_f32_32x32x16_bf16 v[44:59], v[248:251], v[188:191], v[44:59]
 buffer_load_dwordx4 v[216:219], v0, s[8:11], s16 offen offset:2048 sc1
 ds_read_b128 v[236:239], v0 offset:3072
 v_mfma_f32_32x32x16_bf16 v[76:91], v[252:255], v[188:191], v[76:91]
 ds_read_b128 v[240:243], v0 offset:4096
 s_waitcnt vmcnt(8) lgkmcnt(3)
 v_mfma_f32_32x32x16_bf16 v[60:75], v[224:227], v[192:195], 0
 buffer_load_dwordx4 v[220:223], v0, s[8:11], s16 offen offset:3072 sc1
 s_add_u32 s16, s16, 4096
 ds_read_b128 v[244:247], v0 offset:5120
 v_mfma_f32_32x32x16_bf16 v[92:107], v[228:231], v[192:195], 0
 ds_read_b128 v[248:251], v0 offset:6144
 s_waitcnt vmcnt(8) lgkmcnt(3)
 v_mfma_f32_32x32x16_bf16 v[60:75], v[232:235], v[196:199], v[60:75]
 buffer_load_dwordx4 v[176:179], v0, s[8:11], s16 offen sc1
 ds_read_b128 v[252:255], v0 offset:7168
 v_mfma_f32_32x32x8_bf16 v[44:59], a[240:241], v[160:161], v[44:59]
 v_mfma_f32_32x32x16_bf16 v[92:107], v[236:239], v[196:199], v[92:107]
 ds_read_b128 v[224:227], v0 offset:8192
 v_mfma_f32_32x32x8_bf16 v[76:91], a[242:243], v[160:161], v[76:91]
 s_waitcnt vmcnt(8) lgkmcnt(3)
 v_mfma_f32_32x32x16_bf16 v[60:75], v[240:243], v[200:203], v[60:75]
 buffer_load_dwordx4 v[180:183], v0, s[8:11], s16 offen offset:1024 sc1
 ds_read_b128 v[228:231], v0 offset:9216
 v_mfma_f32_32x32x16_bf16 v[92:107], v[244:247], v[200:203], v[92:107]
 ds_read_b128 v[232:235], v0 offset:10240
 s_waitcnt vmcnt(8) lgkmcnt(3)
 v_mfma_f32_32x32x16_bf16 v[60:75], v[248:251], v[204:207], v[60:75]
 buffer_load_dwordx4 v[184:187], v0, s[8:11], s16 offen offset:2048 sc1
 ds_read_b128 v[236:239], v0 offset:11264
 s_waitcnt vmcnt(8)
 v_add_f32 v152, v152, v153
 s_waitcnt vmcnt(6)
 v_add_f32 v156, v156, v157
 v_add_f32 v152, v152, v154
 v_add_f32 v156, v156, v158
 v_mfma_f32_32x32x16_bf16 v[92:107], v[252:255], v[204:207], v[92:107]
 ds_read_b128 v[240:243], v0 offset:12288
 v_add_f32 v152, v152, v155
 v_add_f32 v156, v156, v159
 s_nop 1
 v_permlane16_swap_b32 v152, v156
 v_add_f32 v152, v152, v156
 s_waitcnt lgkmcnt(3)
 v_mfma_f32_32x32x16_bf16 v[60:75], v[224:227], v[208:211], v[60:75]
 buffer_load_dwordx4 v[188:191], v0, s[8:11], s16 offen offset:3072 sc1
 s_add_u32 s16, s16, 4096
 ds_read_b128 v[244:247], v0 offset:13312
 v_mov_b32 v153, v152
 s_nop 1
 v_permlane32_swap_b32 v152, v153
 v_mfma_f32_32x32x16_bf16 v[92:107], v[228:231], v[208:211], v[92:107]
 ds_read_b128 v[248:251], v0 offset:14336
 v_mul_f32 v152, 0xbacccccd, v152
 v_mul_f32 v153, 0x3acccccd, v153
 v_fma_f32 v153, -v152, v152, v153
 v_max_f32 v153, 0, v153
 v_add_f32 v153, 0x3727c5ac, v153
 s_waitcnt vmcnt(6) lgkmcnt(3)
 v_mfma_f32_32x32x16_bf16 v[60:75], v[232:235], v[212:215], v[60:75]
 buffer_load_dwordx4 v[192:195], v0, s[8:11], s16 offen sc1
 ds_read_b128 v[252:255], v0 offset:15360
 v_rsq_f32 v154, v153
 v_cvt_pk_bf16_f32 v162, v152, v152
 v_lshlrev_b32 v155, 16, v162
 v_mfma_f32_32x32x16_bf16 v[92:107], v[236:239], v[212:215], v[92:107]
 ds_read_b128 v[224:227], v0 offset:16384
 v_sub_f32 v155, v152, v155
 v_cvt_pk_bf16_f32 v163, v155, v155
 v_mov_b32 v174, v154
 v_mul_f32 v172, 0x3fb8aa3b, v154
 v_mul_f32 v173, 0xbfb8aa3b, v154
 s_waitcnt vmcnt(6) lgkmcnt(3)
 v_mfma_f32_32x32x16_bf16 v[60:75], v[240:243], v[216:219], v[60:75]
 buffer_load_dwordx4 v[196:199], v0, s[8:11], s16 offen offset:1024 sc1
 ds_read_b128 v[228:231], v0 offset:17408
 v_mov_b32 v143, s60
 v_max3_f32 v12, v44, v45, v46
 v_max3_f32 v13, -v44, -v45, -v46
 v_max3_f32 v12, v12, v47, v48
 v_mfma_f32_32x32x16_bf16 v[92:107], v[244:247], v[216:219], v[92:107]
 ds_read_b128 v[232:235], v0 offset:18432
 v_max3_f32 v13, v13, -v47, -v48
 v_max3_f32 v12, v12, v49, v50
 v_max3_f32 v13, v13, -v49, -v50
 v_max3_f32 v12, v12, v51, v52
 v_max3_f32 v13, v13, -v51, -v52
 s_waitcnt vmcnt(6) lgkmcnt(3)
 v_mfma_f32_32x32x16_bf16 v[60:75], v[248:251], v[220:223], v[60:75]
 buffer_load_dwordx4 v[200:203], v0, s[8:11], s16 offen offset:2048 sc1
 ds_read_b128 v[236:239], v0 offset:19456
 v_max_f32 v12, v12, v53
 v_max_f32 v13, v13, -v53
 s_nop 1
 v_permlane32_swap_b32 v12, v13
 v_mfma_f32_32x32x16_bf16 v[92:107], v[252:255], v[220:223], v[92:107]
 ds_read_b128 v[240:243], v0 offset:20480
 v_max_f32 v12, v12, v13
 v_mul_f32 v13, v12, v169
 v_mul_f32 v12, v12, v169
 s_nop 1
 v_permlane32_swap_b32 v12, v13
 s_waitcnt vmcnt(6) lgkmcnt(3)
 v_mfma_f32_32x32x16_bf16 v[60:75], v[224:227], v[176:179], v[60:75]
 buffer_load_dwordx4 v[204:207], v0, s[8:11], s16 offen offset:3072 sc1
 s_add_u32 s16, s16, 4096
 ds_read_b128 v[244:247], v0 offset:21504
 v_fma_f32 v108, v44, v168, v12
 v_fma_f32 v109, v44, v169, v13
 v_fma_f32 v110, v45, v168, v12
 v_mfma_f32_32x32x16_bf16 v[92:107], v[228:231], v[176:179], v[92:107]
 ds_read_b128 v[248:251], v0 offset:22528
 v_fma_f32 v111, v45, v169, v13
 v_fma_f32 v112, v46, v168, v12
 v_fma_f32 v113, v46, v169, v13
 v_fma_f32 v114, v47, v168, v12
 v_fma_f32 v115, v47, v169, v13
 s_waitcnt vmcnt(6) lgkmcnt(3)
 v_mfma_f32_32x32x16_bf16 v[60:75], v[232:235], v[180:183], v[60:75]
 buffer_load_dwordx4 v[208:211], v0, s[8:11], s16 offen sc1
 ds_read_b128 v[252:255], v0 offset:23552
 v_fma_f32 v116, v48, v168, v12
 v_fma_f32 v117, v48, v169, v13
 v_fma_f32 v118, v49, v168, v12
 v_fma_f32 v119, v49, v169, v13
 v_mfma_f32_32x32x16_bf16 v[92:107], v[236:239], v[180:183], v[92:107]
 ds_read_b128 v[224:227], v0 offset:24576
 v_fma_f32 v120, v50, v168, v12
 v_fma_f32 v121, v50, v169, v13
 v_fma_f32 v122, v51, v168, v12
 v_fma_f32 v123, v51, v169, v13
 v_fma_f32 v124, v52, v168, v12
 s_waitcnt vmcnt(6) lgkmcnt(3)
 v_mfma_f32_32x32x16_bf16 v[60:75], v[240:243], v[184:187], v[60:75]
 buffer_load_dwordx4 v[212:215], v0, s[8:11], s16 offen offset:1024 sc1
 ds_read_b128 v[228:231], v0 offset:25600
 v_fma_f32 v125, v52, v169, v13
 v_fma_f32 v126, v53, v168, v12
 v_fma_f32 v127, v53, v169, v13
 v_mfma_f32_32x32x16_bf16 v[92:107], v[244:247], v[184:187], v[92:107]
 ds_read_b128 v[232:235], v0 offset:26624
 v_exp_f32 v108, v108
 v_exp_f32 v109, v109
 s_waitcnt vmcnt(6) lgkmcnt(3)
 v_mfma_f32_32x32x16_bf16 v[60:75], v[248:251], v[188:191], v[60:75]
 buffer_load_dwordx4 v[216:219], v0, s[8:11], s16 offen offset:2048 sc1
 ds_read_b128 v[236:239], v0 offset:27648
 v_exp_f32 v110, v110
 v_exp_f32 v111, v111
 v_mfma_f32_32x32x16_bf16 v[92:107], v[252:255], v[188:191], v[92:107]
 ds_read_b128 v[240:243], v0 offset:28672
 v_exp_f32 v112, v112
 v_exp_f32 v113, v113
 s_waitcnt vmcnt(6) lgkmcnt(3)
 v_mfma_f32_32x32x16_bf16 v[60:75], v[224:227], v[192:195], v[60:75]
 buffer_load_dwordx4 v[220:223], v0, s[8:11], s16 offen offset:3072 sc1
 s_add_u32 s16, s16, 4096
 ds_read_b128 v[244:247], v0 offset:29696
 v_exp_f32 v114, v114
 v_mfma_f32_32x32x16_bf16 v[92:107], v[228:231], v[192:195], v[92:107]
 ds_read_b128 v[248:251], v0 offset:30720
 v_exp_f32 v115, v115
 v_exp_f32 v116, v116
 s_waitcnt vmcnt(6) lgkmcnt(3)
 v_mfma_f32_32x32x16_bf16 v[60:75], v[232:235], v[196:199], v[60:75]
 buffer_load_dwordx4 v[176:179], v0, s[8:11], s16 offen sc1
 ds_read_b128 v[252:255], v0 offset:31744
 v_exp_f32 v117, v117
 v_exp_f32 v118, v118
 v_mfma_f32_32x32x16_bf16 v[92:107], v[236:239], v[196:199], v[92:107]
 ds_read_b128 v[224:227], v0 offset:32768
 v_exp_f32 v119, v119
 v_exp_f32 v120, v120
 s_waitcnt vmcnt(6) lgkmcnt(3)
 v_mfma_f32_32x32x16_bf16 v[60:75], v[240:243], v[200:203], v[60:75]
 buffer_load_dwordx4 v[180:183], v0, s[8:11], s16 offen offset:1024 sc1
 ds_read_b128 v[228:231], v0 offset:33792
 v_exp_f32 v121, v121
 v_exp_f32 v122, v122
 v_mfma_f32_32x32x16_bf16 v[92:107], v[244:247], v[200:203], v[92:107]
 ds_read_b128 v[232:235], v0 offset:34816
 v_exp_f32 v123, v123
 v_exp_f32 v124, v124
 s_waitcnt vmcnt(6) lgkmcnt(3)
 v_mfma_f32_32x32x16_bf16 v[60:75], v[248:251], v[204:207], v[60:75]
 buffer_load_dwordx4 v[184:187], v0, s[8:11], s16 offen offset:2048 sc1
 ds_read_b128 v[236:239], v0 offset:35840
 v_exp_f32 v125, v125
 v_exp_f32 v126, v126
 v_mfma_f32_32x32x16_bf16 v[92:107], v[252:255], v[204:207], v[92:107]
 ds_read_b128 v[240:243], v0 offset:36864
 v_exp_f32 v127, v127
 v_add_f32 v14, v108, v110
 v_add_f32 v15, v109, v111
 v_add_f32 v14, v14, v112
 s_waitcnt vmcnt(6) lgkmcnt(3)
 v_mfma_f32_32x32x16_bf16 v[60:75], v[224:227], v[208:211], v[60:75]
 buffer_load_dwordx4 v[188:191], v0, s[8:11], s16 offen offset:3072 sc1
 s_add_u32 s16, s16, 4096
 ds_read_b128 v[244:247], v0 offset:37888
 v_add_f32 v15, v15, v113
 v_add_f32 v14, v14, v114
 v_add_f32 v15, v15, v115
 v_mfma_f32_32x32x16_bf16 v[92:107], v[228:231], v[208:211], v[92:107]
 ds_read_b128 v[248:251], v0 offset:38912
 v_add_f32 v14, v14, v116
 v_add_f32 v15, v15, v117
 v_add_f32 v14, v14, v118
 v_add_f32 v15, v15, v119
 v_add_f32 v14, v14, v120
 s_waitcnt vmcnt(6) lgkmcnt(3)
 v_mfma_f32_32x32x16_bf16 v[60:75], v[232:235], v[212:215], v[60:75]
 buffer_load_dwordx4 v[192:195], v0, s[8:11], s16 offen sc1
 ds_read_b128 v[252:255], v0 offset:39936
 v_add_f32 v15, v15, v121
 v_add_f32 v14, v14, v122
 v_add_f32 v15, v15, v123
 v_add_f32 v14, v14, v124
 v_mfma_f32_32x32x16_bf16 v[92:107], v[236:239], v[212:215], v[92:107]
 ds_read_b128 v[224:227], v0 offset:40960
 v_add_f32 v15, v15, v125
 v_add_f32 v14, v14, v126
 v_add_f32 v15, v15, v127
 s_nop 1
 v_permlane32_swap_b32 v14, v15
 s_waitcnt vmcnt(6) lgkmcnt(3)
 v_mfma_f32_32x32x16_bf16 v[60:75], v[240:243], v[216:219], v[60:75]
 buffer_load_dwordx4 v[196:199], v0, s[8:11], s16 offen offset:1024 sc1
 ds_read_b128 v[228:231], v0 offset:41984
 v_add_f32 v14, v14, v15
 v_rcp_f32 v14, v14
 s_nop 0
 v_mov_b32 v15, v14
 v_mfma_f32_32x32x16_bf16 v[92:107], v[244:247], v[216:219], v[92:107]
 ds_read_b128 v[232:235], v0 offset:43008
 v_permlane32_swap_b32 v14, v15
 v_mul_f32 v108, v108, v14
 v_mul_f32 v109, v109, v15
 v_cvt_pk_bf16_f32 v128, v108, v109
 s_waitcnt vmcnt(6) lgkmcnt(3)
 v_mfma_f32_32x32x16_bf16 v[60:75], v[248:251], v[220:223], v[60:75]
 buffer_load_dwordx4 v[200:203], v0, s[8:11], s16 offen offset:2048 sc1
 ds_read_b128 v[236:239], v0 offset:44032
 v_mul_f32 v110, v110, v14
 v_mul_f32 v111, v111, v15
 v_cvt_pk_bf16_f32 v129, v110, v111
 v_mul_f32 v112, v112, v14
 v_mfma_f32_32x32x16_bf16 v[92:107], v[252:255], v[220:223], v[92:107]
 ds_read_b128 v[240:243], v0 offset:45056
 v_mul_f32 v113, v113, v15
 v_cvt_pk_bf16_f32 v130, v112, v113
 v_mul_f32 v114, v114, v14
 v_mul_f32 v115, v115, v15
 v_cvt_pk_bf16_f32 v131, v114, v115
 s_waitcnt vmcnt(6) lgkmcnt(3)
 v_mfma_f32_32x32x16_bf16 v[60:75], v[224:227], v[176:179], v[60:75]
 buffer_load_dwordx4 v[204:207], v0, s[8:11], s16 offen offset:3072 sc1
 s_add_u32 s16, s16, 4096
 ds_read_b128 v[244:247], v0 offset:46080
 v_mul_f32 v116, v116, v14
 v_mul_f32 v117, v117, v15
 v_cvt_pk_bf16_f32 v132, v116, v117
 v_mfma_f32_32x32x16_bf16 v[92:107], v[228:231], v[176:179], v[92:107]
 ds_read_b128 v[248:251], v0 offset:47104
 v_mul_f32 v118, v118, v14
 v_mul_f32 v119, v119, v15
 v_cvt_pk_bf16_f32 v133, v118, v119
 v_mul_f32 v120, v120, v14
 v_mul_f32 v121, v121, v15
 s_waitcnt vmcnt(6) lgkmcnt(3)
 v_mfma_f32_32x32x16_bf16 v[60:75], v[232:235], v[180:183], v[60:75]
 buffer_load_dwordx4 v[208:211], v0, s[8:11], s16 offen sc1
 ds_read_b128 v[252:255], v0 offset:48128
 v_cvt_pk_bf16_f32 v134, v120, v121
 v_mul_f32 v122, v122, v14
 v_mul_f32 v123, v123, v15
 v_cvt_pk_bf16_f32 v135, v122, v123
 v_mfma_f32_32x32x16_bf16 v[92:107], v[236:239], v[180:183], v[92:107]
 ds_read_b128 v[224:227], v0 offset:49152
 v_mul_f32 v124, v124, v14
 v_mul_f32 v125, v125, v15
 v_cvt_pk_bf16_f32 v136, v124, v125
 v_mul_f32 v126, v126, v14
 v_mul_f32 v127, v127, v15
 s_waitcnt vmcnt(6) lgkmcnt(3)
 v_mfma_f32_32x32x16_bf16 v[60:75], v[240:243], v[184:187], v[60:75]
 buffer_load_dwordx4 v[212:215], v0, s[8:11], s16 offen offset:1024 sc1
 ds_read_b128 v[228:231], v0 offset:50176
 v_cvt_pk_bf16_f32 v137, v126, v127
 v_mfma_f32_32x32x16_bf16 v[108:123], v[128:131], v[36:39], 0
 v_mfma_f32_32x32x16_bf16 v[92:107], v[244:247], v[184:187], v[92:107]
 ds_read_b128 v[232:235], v0 offset:51200
 v_mfma_f32_32x32x16_bf16 v[108:123], v[132:135], v[40:43], v[108:123]
 v_mul_f32 v54, v54, v170
 v_mul_f32 v55, v55, v170
 v_cvt_pk_bf16_f32 v138, v54, v55
 v_mul_f32 v56, v56, v170
 v_mul_f32 v57, v57, v170
 v_cvt_pk_bf16_f32 v139, v56, v57
 v_mul_f32 v58, v58, v170
 s_waitcnt vmcnt(6) lgkmcnt(3)
 v_mfma_f32_32x32x16_bf16 v[60:75], v[248:251], v[188:191], v[60:75]
 buffer_load_dwordx4 v[216:219], v0, s[8:11], s16 offen offset:2048 sc1
 ds_read_b128 v[236:239], v0 offset:52224
 v_mul_f32 v59, v59, v170
 v_cvt_pk_bf16_f32 v140, v58, v59
 v_mul_f32 v86, v86, v170
 v_mul_f32 v87, v87, v170
 v_mfma_f32_32x32x16_bf16 v[92:107], v[252:255], v[188:191], v[92:107]
 ds_read_b128 v[240:243], v0 offset:53248
 v_cvt_pk_bf16_f32 v141, v86, v87
 v_mul_f32 v88, v88, v170
 v_mul_f32 v89, v89, v170
 v_cvt_pk_bf16_f32 v142, v88, v89
 s_waitcnt vmcnt(6) lgkmcnt(3)
 v_mfma_f32_32x32x16_bf16 v[60:75], v[224:227], v[192:195], v[60:75]
 buffer_load_dwordx4 v[220:223], v0, s[8:11], s16 offen offset:3072 sc1
 s_add_u32 s16, s16, 4096
 ds_read_b128 v[244:247], v0 offset:54272
 v_mfma_f32_32x32x16_bf16 v[44:59], v[136:139], v[36:39], 0
 v_mfma_f32_32x32x16_bf16 v[92:107], v[228:231], v[192:195], v[92:107]
 ds_read_b128 v[248:251], v0 offset:55296
 v_mfma_f32_32x32x16_bf16 v[44:59], v[140:143], v[40:43], v[44:59]
 v_cvt_pk_bf16_f32 v128, v108, v109
 v_cvt_pk_bf16_f32 v129, v110, v111
 v_cvt_pk_bf16_f32 v130, v112, v113
 v_cvt_pk_bf16_f32 v131, v114, v115
 v_cvt_pk_bf16_f32 v132, v116, v117
 v_cvt_pk_bf16_f32 v133, v118, v119
 v_cvt_pk_bf16_f32 v134, v120, v121
 s_waitcnt vmcnt(6) lgkmcnt(3)
 v_mfma_f32_32x32x16_bf16 v[60:75], v[232:235], v[196:199], v[60:75]
 buffer_load_dwordx4 v[176:179], v0, s[8:11], s16 offen sc1
 ds_read_b128 v[252:255], v0 offset:56320
 v_cvt_pk_bf16_f32 v135, v122, v123
 v_mfma_f32_32x32x16_bf16 v[92:107], v[236:239], v[196:199], v[92:107]
 ds_read_b128 v[224:227], v0 offset:57344
 s_waitcnt vmcnt(6) lgkmcnt(3)
 v_mfma_f32_32x32x16_bf16 v[60:75], v[240:243], v[200:203], v[60:75]
 buffer_load_dwordx4 v[180:183], v0, s[8:11], s16 offen offset:1024 sc1
 ds_read_b128 v[228:231], v0 offset:58368
 v_cvt_pk_bf16_f32 v136, v44, v45
 v_cvt_pk_bf16_f32 v137, v46, v47
 v_cvt_pk_bf16_f32 v138, v48, v49
 v_cvt_pk_bf16_f32 v139, v50, v51
 v_mfma_f32_32x32x16_bf16 v[92:107], v[244:247], v[200:203], v[92:107]
 ds_read_b128 v[232:235], v0 offset:59392
 v_cvt_pk_bf16_f32 v140, v52, v53
 v_cvt_pk_bf16_f32 v141, v54, v55
 v_cvt_pk_bf16_f32 v142, v56, v57
 v_cvt_pk_bf16_f32 v143, v58, v59
 s_waitcnt vmcnt(6) lgkmcnt(3)
 v_mfma_f32_32x32x16_bf16 v[60:75], v[248:251], v[204:207], v[60:75]
 buffer_load_dwordx4 v[184:187], v0, s[8:11], s16 offen offset:2048 sc1
 ds_read_b128 v[236:239], v0 offset:60416
 v_mfma_f32_32x32x16_bf16 v[144:159], v[128:131], v[136:139], 0
 v_mfma_f32_32x32x16_bf16 v[92:107], v[252:255], v[204:207], v[92:107]
 ds_read_b128 v[240:243], v0 offset:61440
 v_mfma_f32_32x32x16_bf16 v[144:159], v[132:135], v[140:143], v[144:159]
 s_waitcnt vmcnt(6) lgkmcnt(3)
 v_mfma_f32_32x32x16_bf16 v[60:75], v[224:227], v[208:211], v[60:75]
 buffer_load_dwordx4 v[188:191], v0, s[8:11], s16 offen offset:3072 sc1
 s_add_u32 s16, s16, 4096
 ds_read_b128 v[244:247], v0 offset:62464
 v_mfma_f32_32x32x16_bf16 v[44:59], v[136:139], v[136:139], 0
 v_mfma_f32_32x32x16_bf16 v[92:107], v[228:231], v[208:211], v[92:107]
 ds_read_b128 v[248:251], v0 offset:63488
 v_mfma_f32_32x32x16_bf16 v[44:59], v[140:143], v[140:143], v[44:59]
 s_waitcnt vmcnt(6) lgkmcnt(3)
 v_mfma_f32_32x32x16_bf16 v[60:75], v[232:235], v[212:215], v[60:75]
 buffer_load_dwordx4 v[192:195], v0, s[8:11], s16 offen sc1
 ds_read_b128 v[252:255], v0 offset:64512
 v_mfma_f32_32x32x16_bf16 v[92:107], v[236:239], v[212:215], v[92:107]
 ds_read_b128 v[224:227], v1
 s_waitcnt vmcnt(6) lgkmcnt(3)
 v_mfma_f32_32x32x16_bf16 v[60:75], v[240:243], v[216:219], v[60:75]
 buffer_load_dwordx4 v[196:199], v0, s[8:11], s16 offen offset:1024 sc1
 ds_read_b128 v[228:231], v1 offset:1024
 v_mfma_f32_32x32x16_bf16 v[92:107], v[244:247], v[216:219], v[92:107]
 ds_read_b128 v[232:235], v1 offset:2048
 s_waitcnt vmcnt(6) lgkmcnt(3)
 v_mfma_f32_32x32x16_bf16 v[60:75], v[248:251], v[220:223], v[60:75]
 buffer_load_dwordx4 v[200:203], v0, s[8:11], s16 offen offset:2048 sc1
 ds_read_b128 v[236:239], v1 offset:3072
 v_mfma_f32_32x32x16_bf16 v[92:107], v[252:255], v[220:223], v[92:107]
 ds_read_b128 v[240:243], v1 offset:4096
 s_waitcnt vmcnt(6) lgkmcnt(3)
 v_mfma_f32_32x32x16_bf16 v[60:75], v[224:227], v[176:179], v[60:75]
 buffer_load_dwordx4 v[204:207], v0, s[8:11], s16 offen offset:3072 sc1
 s_add_u32 s16, s16, 4096
 ds_read_b128 v[244:247], v1 offset:5120
 v_mfma_f32_32x32x16_bf16 v[92:107], v[228:231], v[176:179], v[92:107]
 ds_read_b128 v[248:251], v1 offset:6144
 s_waitcnt vmcnt(6) lgkmcnt(3)
 v_mfma_f32_32x32x16_bf16 v[60:75], v[232:235], v[180:183], v[60:75]
 ds_read_b128 v[252:255], v1 offset:7168
 v_mfma_f32_32x32x16_bf16 v[92:107], v[236:239], v[180:183], v[92:107]
 ds_read_b128 v[224:227], v1 offset:8192
 s_waitcnt vmcnt(5) lgkmcnt(3)
 v_mfma_f32_32x32x16_bf16 v[60:75], v[240:243], v[184:187], v[60:75]
 ds_read_b128 v[228:231], v1 offset:9216
 v_mfma_f32_32x32x16_bf16 v[92:107], v[244:247], v[184:187], v[92:107]
 ds_read_b128 v[232:235], v1 offset:10240
 s_waitcnt vmcnt(4) lgkmcnt(3)
 v_mfma_f32_32x32x16_bf16 v[60:75], v[248:251], v[188:191], v[60:75]
 ds_read_b128 v[236:239], v1 offset:11264
 v_mfma_f32_32x32x16_bf16 v[92:107], v[252:255], v[188:191], v[92:107]
 ds_read_b128 v[240:243], v1 offset:12288
 s_waitcnt vmcnt(3) lgkmcnt(3)
 v_mfma_f32_32x32x16_bf16 v[60:75], v[224:227], v[192:195], v[60:75]
 ds_read_b128 v[244:247], v1 offset:13312
 v_mfma_f32_32x32x16_bf16 v[92:107], v[228:231], v[192:195], v[92:107]
 ds_read_b128 v[248:251], v1 offset:14336
 s_waitcnt vmcnt(2) lgkmcnt(3)
 v_mfma_f32_32x32x16_bf16 v[60:75], v[232:235], v[196:199], v[60:75]
 ds_read_b128 v[252:255], v1 offset:15360
 v_mfma_f32_32x32x16_bf16 v[92:107], v[236:239], v[196:199], v[92:107]
 s_waitcnt vmcnt(1) lgkmcnt(2)
 v_mfma_f32_32x32x16_bf16 v[60:75], v[240:243], v[200:203], v[60:75]
 v_mfma_f32_32x32x16_bf16 v[92:107], v[244:247], v[200:203], v[92:107]
 s_waitcnt vmcnt(0) lgkmcnt(0)
 v_mfma_f32_32x32x16_bf16 v[60:75], v[248:251], v[204:207], v[60:75]
 v_mfma_f32_32x32x16_bf16 v[92:107], v[252:255], v[204:207], v[92:107]
 s_nop 8
 v_mfma_f32_32x32x8_bf16 v[60:75], a[240:241], v[162:163], v[60:75]
 v_mfma_f32_32x32x8_bf16 v[92:107], a[242:243], v[162:163], v[92:107]
 v_mov_b32 v143, s60
 s_nop 9
 v_max3_f32 v12, v60, v61, v62
 buffer_load_dwordx4 v[176:179], v0, s[4:7], s18 offen sc1
 v_max3_f32 v13, -v60, -v61, -v62
 v_max3_f32 v12, v12, v63, v64
 v_max3_f32 v13, v13, -v63, -v64
 v_max3_f32 v12, v12, v65, v66
 v_max3_f32 v13, v13, -v65, -v66
 v_max3_f32 v12, v12, v67, v68
 buffer_load_dwordx4 v[180:183], v0, s[4:7], s18 offen offset:1024 sc1
 v_max3_f32 v13, v13, -v67, -v68
 v_max_f32 v12, v12, v69
 v_max_f32 v13, v13, -v69
 s_nop 1
 v_permlane32_swap_b32 v12, v13
 v_max_f32 v12, v12, v13
 v_mul_f32 v13, v12, v173
 v_mul_f32 v12, v12, v173
 buffer_load_dwordx4 v[184:187], v0, s[4:7], s18 offen offset:2048 sc1
 s_nop 0
 v_permlane32_swap_b32 v12, v13
 v_pk_fma_f32 v[108:109], v[60:61], v[172:173], v[12:13] op_sel:[0,0,0] op_sel_hi:[0,1,1]
 v_pk_fma_f32 v[110:111], v[60:61], v[172:173], v[12:13] op_sel:[1,0,0] op_sel_hi:[1,1,1]
 v_pk_fma_f32 v[112:113], v[62:63], v[172:173], v[12:13] op_sel:[0,0,0] op_sel_hi:[0,1,1]
 v_pk_fma_f32 v[114:115], v[62:63], v[172:173], v[12:13] op_sel:[1,0,0] op_sel_hi:[1,1,1]
 v_pk_fma_f32 v[116:117], v[64:65], v[172:173], v[12:13] op_sel:[0,0,0] op_sel_hi:[0,1,1]
 v_pk_fma_f32 v[118:119], v[64:65], v[172:173], v[12:13] op_sel:[1,0,0] op_sel_hi:[1,1,1]
 buffer_load_dwordx4 v[188:191], v0, s[4:7], s18 offen offset:3072 sc1
 s_add_u32 s18, s18, 4096
 v_pk_fma_f32 v[120:121], v[66:67], v[172:173], v[12:13] op_sel:[0,0,0] op_sel_hi:[0,1,1]
 v_pk_fma_f32 v[122:123], v[66:67], v[172:173], v[12:13] op_sel:[1,0,0] op_sel_hi:[1,1,1]
 v_pk_fma_f32 v[124:125], v[68:69], v[172:173], v[12:13] op_sel:[0,0,0] op_sel_hi:[0,1,1]
 v_pk_fma_f32 v[126:127], v[68:69], v[172:173], v[12:13] op_sel:[1,0,0] op_sel_hi:[1,1,1]
 v_exp_f32 v108, v108
 v_exp_f32 v109, v109
 v_exp_f32 v110, v110
 buffer_load_dwordx4 v[192:195], v0, s[4:7], s18 offen sc1
 v_exp_f32 v111, v111
 v_exp_f32 v112, v112
 v_exp_f32 v113, v113
 v_exp_f32 v114, v114
 v_exp_f32 v115, v115
 v_exp_f32 v116, v116
 v_exp_f32 v117, v117
 buffer_load_dwordx4 v[196:199], v0, s[4:7], s18 offen offset:1024 sc1
 v_exp_f32 v118, v118
 v_exp_f32 v119, v119
 v_exp_f32 v120, v120
 v_exp_f32 v121, v121
 v_exp_f32 v122, v122
 v_exp_f32 v123, v123
 v_exp_f32 v124, v124
 buffer_load_dwordx4 v[200:203], v0, s[4:7], s18 offen offset:2048 sc1
 v_exp_f32 v125, v125
 v_exp_f32 v126, v126
 v_exp_f32 v127, v127
 v_pk_add_f32 v[14:15], v[108:109], v[110:111]
 v_pk_add_f32 v[14:15], v[14:15], v[112:113]
 v_pk_add_f32 v[14:15], v[14:15], v[114:115]
 v_pk_add_f32 v[14:15], v[14:15], v[116:117]
 buffer_load_dwordx4 v[204:207], v0, s[4:7], s18 offen offset:3072 sc1
 s_add_u32 s18, s18, 4096
 v_pk_add_f32 v[14:15], v[14:15], v[118:119]
 v_pk_add_f32 v[14:15], v[14:15], v[120:121]
 v_pk_add_f32 v[14:15], v[14:15], v[122:123]
 v_pk_add_f32 v[14:15], v[14:15], v[124:125]
 v_pk_add_f32 v[14:15], v[14:15], v[126:127]
 s_nop 1
 v_permlane32_swap_b32 v14, v15
 v_add_f32 v14, v14, v15
 buffer_load_dwordx4 v[208:211], v0, s[4:7], s18 offen sc1
 v_rcp_f32 v14, v14
 s_nop 0
 v_mov_b32 v15, v14
 s_nop 1
 v_permlane32_swap_b32 v14, v15
 v_pk_mul_f32 v[108:109], v[108:109], v[14:15]
 v_cvt_pk_bf16_f32 v128, v108, v109
 v_pk_mul_f32 v[110:111], v[110:111], v[14:15]
 buffer_load_dwordx4 v[212:215], v0, s[4:7], s18 offen offset:1024 sc1
 v_cvt_pk_bf16_f32 v129, v110, v111
 v_pk_mul_f32 v[112:113], v[112:113], v[14:15]
 v_cvt_pk_bf16_f32 v130, v112, v113
 v_pk_mul_f32 v[114:115], v[114:115], v[14:15]
 v_cvt_pk_bf16_f32 v131, v114, v115
 v_pk_mul_f32 v[116:117], v[116:117], v[14:15]
 v_cvt_pk_bf16_f32 v132, v116, v117
 buffer_load_dwordx4 v[216:219], v0, s[4:7], s18 offen offset:2048 sc1
 v_pk_mul_f32 v[118:119], v[118:119], v[14:15]
 v_cvt_pk_bf16_f32 v133, v118, v119
 v_pk_mul_f32 v[120:121], v[120:121], v[14:15]
 v_cvt_pk_bf16_f32 v134, v120, v121
 v_pk_mul_f32 v[122:123], v[122:123], v[14:15]
 v_cvt_pk_bf16_f32 v135, v122, v123
 v_pk_mul_f32 v[124:125], v[124:125], v[14:15]
 buffer_load_dwordx4 v[220:223], v0, s[4:7], s18 offen offset:3072 sc1
 s_add_u32 s18, s18, 4096
 v_cvt_pk_bf16_f32 v136, v124, v125
 v_pk_mul_f32 v[126:127], v[126:127], v[14:15]
 v_cvt_pk_bf16_f32 v137, v126, v127
 v_mfma_f32_32x32x16_bf16 v[108:123], v[128:131], v[36:39], 0
 v_mfma_f32_32x32x16_bf16 v[108:123], v[132:135], v[40:43], v[108:123]
 v_mul_f32 v70, v70, v174
 v_mul_f32 v71, v71, v174
 buffer_load_dwordx4 v[224:227], v0, s[4:7], s18 offen sc1
 v_cvt_pk_bf16_f32 v138, v70, v71
 v_mul_f32 v72, v72, v174
 v_mul_f32 v73, v73, v174
 v_cvt_pk_bf16_f32 v139, v72, v73
 v_mul_f32 v74, v74, v174
 v_mul_f32 v75, v75, v174
 v_cvt_pk_bf16_f32 v140, v74, v75
 buffer_load_dwordx4 v[228:231], v0, s[4:7], s18 offen offset:1024 sc1
 v_mul_f32 v102, v102, v174
 v_mul_f32 v103, v103, v174
 v_cvt_pk_bf16_f32 v141, v102, v103
 v_mul_f32 v104, v104, v174
 v_mul_f32 v105, v105, v174
 v_cvt_pk_bf16_f32 v142, v104, v105
 v_mfma_f32_32x32x16_bf16 v[60:75], v[136:139], v[36:39], 0
 buffer_load_dwordx4 v[232:235], v0, s[4:7], s18 offen offset:2048 sc1
 v_mfma_f32_32x32x16_bf16 v[60:75], v[140:143], v[40:43], v[60:75]
 v_cvt_pk_bf16_f32 v128, v108, v109
 v_cvt_pk_bf16_f32 v129, v110, v111
 v_cvt_pk_bf16_f32 v130, v112, v113
 v_cvt_pk_bf16_f32 v131, v114, v115
 v_cvt_pk_bf16_f32 v132, v116, v117
 v_cvt_pk_bf16_f32 v133, v118, v119
 buffer_load_dwordx4 v[236:239], v0, s[4:7], s18 offen offset:3072 sc1
 s_add_u32 s18, s18, 4096
 v_cvt_pk_bf16_f32 v134, v120, v121
 v_cvt_pk_bf16_f32 v135, v122, v123
 s_nop 1
 v_cvt_pk_bf16_f32 v136, v60, v61
 v_cvt_pk_bf16_f32 v137, v62, v63
 v_cvt_pk_bf16_f32 v138, v64, v65
 v_cvt_pk_bf16_f32 v139, v66, v67
 v_cvt_pk_bf16_f32 v140, v68, v69
 v_cvt_pk_bf16_f32 v141, v70, v71
 v_cvt_pk_bf16_f32 v142, v72, v73
 v_cvt_pk_bf16_f32 v143, v74, v75
 v_mfma_f32_32x32x16_bf16 v[144:159], v[128:131], v[136:139], v[144:159]
 s_nop 0
 v_mfma_f32_32x32x16_bf16 v[144:159], v[132:135], v[140:143], v[144:159]
 v_mfma_f32_32x32x16_bf16 v[44:59], v[136:139], v[136:139], v[44:59]
 v_mfma_f32_32x32x16_bf16 v[44:59], v[140:143], v[140:143], v[44:59]
 s_lshl_b32 s33, s3, 10
 v_add_u32 v13, s33, v2
 s_lshl_b32 s33, s3, 2
 v_add_u32 v14, s33, v2
 s_add_u32 s56, s52, 10
 v_mov_b32 v131, s56
 s_nop 3
 ds_write_b128 v3, v[144:147] offset:12288
 ds_write_b128 v3, v[148:151] offset:13312
 ds_write_b128 v3, v[152:155] offset:14336
 ds_write_b128 v3, v[156:159] offset:15360
 ds_write_b128 v3, v[44:47] offset:16384
 s_waitcnt lgkmcnt(0)
 s_barrier
 ds_read_b128 v[108:111], v13 offset:12288
 ds_read_b32 v124, v14 offset:16384
 ds_read_b128 v[112:115], v13 offset:17408
 ds_read_b32 v125, v14 offset:21504
 ds_read_b128 v[116:119], v13 offset:22528
 ds_read_b32 v126, v14 offset:26624
 ds_read_b128 v[120:123], v13 offset:27648
 ds_read_b32 v127, v14 offset:31744
 s_waitcnt lgkmcnt(5)
 v_pk_add_f32 v[108:109], v[108:109], v[112:113]
 v_pk_add_f32 v[110:111], v[110:111], v[114:115]
 s_waitcnt lgkmcnt(1)
 v_pk_add_f32 v[116:117], v[116:117], v[120:121]
 v_pk_add_f32 v[118:119], v[118:119], v[122:123]
 s_waitcnt lgkmcnt(0)
 v_pk_add_f32 v[124:125], v[124:125], v[126:127]
 v_pk_add_f32 v[108:109], v[108:109], v[116:117]
 v_pk_add_f32 v[110:111], v[110:111], v[118:119]
 v_add_f32 v124, v124, v125
 v_cvt_pk_bf16_f32 v128, v108, v109
 v_cvt_pk_bf16_f32 v129, v110, v111
 v_cvt_pk_bf16_f32 v130, v124, 0
 buffer_store_dwordx4 v[128:131], v10, s[4:7], s24 offen sc1
 s_barrier
 v_max3_f32 v12, v76, v77, v78
 buffer_load_dwordx4 v[240:243], v0, s[4:7], s18 offen sc1
 v_max3_f32 v13, -v76, -v77, -v78
 v_max3_f32 v12, v12, v79, v80
 v_max3_f32 v13, v13, -v79, -v80
 v_max3_f32 v12, v12, v81, v82
 v_max3_f32 v13, v13, -v81, -v82
 v_max3_f32 v12, v12, v83, v84
 v_max3_f32 v13, v13, -v83, -v84
 v_max_f32 v12, v12, v85
 v_max_f32 v13, v13, -v85
 s_nop 1
 v_permlane32_swap_b32 v12, v13
 v_max_f32 v12, v12, v13
 v_mul_f32 v13, v12, v169
 v_mul_f32 v12, v12, v169
 s_nop 1
 v_permlane32_swap_b32 v12, v13
 v_pk_fma_f32 v[108:109], v[76:77], v[168:169], v[12:13] op_sel:[0,0,0] op_sel_hi:[0,1,1]
 buffer_load_dwordx4 v[244:247], v0, s[4:7], s18 offen offset:1024 sc1
 v_pk_fma_f32 v[110:111], v[76:77], v[168:169], v[12:13] op_sel:[1,0,0] op_sel_hi:[1,1,1]
 v_pk_fma_f32 v[112:113], v[78:79], v[168:169], v[12:13] op_sel:[0,0,0] op_sel_hi:[0,1,1]
 v_pk_fma_f32 v[114:115], v[78:79], v[168:169], v[12:13] op_sel:[1,0,0] op_sel_hi:[1,1,1]
 v_pk_fma_f32 v[116:117], v[80:81], v[168:169], v[12:13] op_sel:[0,0,0] op_sel_hi:[0,1,1]
 v_pk_fma_f32 v[118:119], v[80:81], v[168:169], v[12:13] op_sel:[1,0,0] op_sel_hi:[1,1,1]
 v_pk_fma_f32 v[120:121], v[82:83], v[168:169], v[12:13] op_sel:[0,0,0] op_sel_hi:[0,1,1]
 v_pk_fma_f32 v[122:123], v[82:83], v[168:169], v[12:13] op_sel:[1,0,0] op_sel_hi:[1,1,1]
 v_pk_fma_f32 v[124:125], v[84:85], v[168:169], v[12:13] op_sel:[0,0,0] op_sel_hi:[0,1,1]
 v_pk_fma_f32 v[126:127], v[84:85], v[168:169], v[12:13] op_sel:[1,0,0] op_sel_hi:[1,1,1]
 v_exp_f32 v108, v108
 v_exp_f32 v109, v109
 v_exp_f32 v110, v110
 v_exp_f32 v111, v111
 v_exp_f32 v112, v112
 v_exp_f32 v113, v113
 buffer_load_dwordx4 v[248:251], v0, s[4:7], s18 offen offset:2048 sc1
 v_exp_f32 v114, v114
 v_exp_f32 v115, v115
 v_exp_f32 v116, v116
 v_exp_f32 v117, v117
 v_exp_f32 v118, v118
 v_exp_f32 v119, v119
 v_exp_f32 v120, v120
 v_exp_f32 v121, v121
 v_exp_f32 v122, v122
 v_exp_f32 v123, v123
 v_exp_f32 v124, v124
 v_exp_f32 v125, v125
 v_exp_f32 v126, v126
 v_exp_f32 v127, v127
 v_pk_add_f32 v[14:15], v[108:109], v[110:111]
 v_pk_add_f32 v[14:15], v[14:15], v[112:113]
 buffer_load_dwordx4 v[252:255], v0, s[4:7], s18 offen offset:3072 sc1
 s_add_u32 s18, s18, 4096
 v_pk_add_f32 v[14:15], v[14:15], v[114:115]
 v_pk_add_f32 v[14:15], v[14:15], v[116:117]
 v_pk_add_f32 v[14:15], v[14:15], v[118:119]
 v_pk_add_f32 v[14:15], v[14:15], v[120:121]
 v_pk_add_f32 v[14:15], v[14:15], v[122:123]
 v_pk_add_f32 v[14:15], v[14:15], v[124:125]
 v_pk_add_f32 v[14:15], v[14:15], v[126:127]
 s_nop 1
 v_permlane32_swap_b32 v14, v15
 v_add_f32 v14, v14, v15
 v_rcp_f32 v14, v14
 s_nop 0
 v_mov_b32 v15, v14
 s_nop 1
 v_permlane32_swap_b32 v14, v15
 v_pk_mul_f32 v[108:109], v[108:109], v[14:15]
 v_cvt_pk_bf16_f32 v76, v108, v109
 v_pk_mul_f32 v[110:111], v[110:111], v[14:15]
 buffer_load_dwordx4 v[144:147], v0, s[4:7], s18 offen sc1
 v_cvt_pk_bf16_f32 v77, v110, v111
 v_pk_mul_f32 v[112:113], v[112:113], v[14:15]
 v_cvt_pk_bf16_f32 v78, v112, v113
 v_pk_mul_f32 v[114:115], v[114:115], v[14:15]
 v_cvt_pk_bf16_f32 v79, v114, v115
 v_pk_mul_f32 v[116:117], v[116:117], v[14:15]
 v_cvt_pk_bf16_f32 v80, v116, v117
 v_pk_mul_f32 v[118:119], v[118:119], v[14:15]
 v_cvt_pk_bf16_f32 v81, v118, v119
 v_pk_mul_f32 v[120:121], v[120:121], v[14:15]
 v_cvt_pk_bf16_f32 v82, v120, v121
 v_pk_mul_f32 v[122:123], v[122:123], v[14:15]
 v_cvt_pk_bf16_f32 v83, v122, v123
 v_pk_mul_f32 v[124:125], v[124:125], v[14:15]
 v_cvt_pk_bf16_f32 v84, v124, v125
 buffer_load_dwordx4 v[148:151], v0, s[4:7], s18 offen offset:1024 sc1
 v_pk_mul_f32 v[126:127], v[126:127], v[14:15]
 v_cvt_pk_bf16_f32 v85, v126, v127
 v_max3_f32 v12, v92, v93, v94
 v_max3_f32 v13, -v92, -v93, -v94
 v_max3_f32 v12, v12, v95, v96
 v_max3_f32 v13, v13, -v95, -v96
 v_max3_f32 v12, v12, v97, v98
 v_max3_f32 v13, v13, -v97, -v98
 v_max3_f32 v12, v12, v99, v100
 v_max3_f32 v13, v13, -v99, -v100
 v_max_f32 v12, v12, v101
 v_max_f32 v13, v13, -v101
 s_nop 1
 v_permlane32_swap_b32 v12, v13
 v_max_f32 v12, v12, v13
 v_mul_f32 v13, v12, v173
 v_mul_f32 v12, v12, v173
 buffer_load_dwordx4 v[152:155], v0, s[4:7], s18 offen offset:2048 sc1
 s_nop 0
 v_permlane32_swap_b32 v12, v13
 v_pk_fma_f32 v[108:109], v[92:93], v[172:173], v[12:13] op_sel:[0,0,0] op_sel_hi:[0,1,1]
 v_pk_fma_f32 v[110:111], v[92:93], v[172:173], v[12:13] op_sel:[1,0,0] op_sel_hi:[1,1,1]
 v_pk_fma_f32 v[112:113], v[94:95], v[172:173], v[12:13] op_sel:[0,0,0] op_sel_hi:[0,1,1]
 v_pk_fma_f32 v[114:115], v[94:95], v[172:173], v[12:13] op_sel:[1,0,0] op_sel_hi:[1,1,1]
 v_pk_fma_f32 v[116:117], v[96:97], v[172:173], v[12:13] op_sel:[0,0,0] op_sel_hi:[0,1,1]
 v_pk_fma_f32 v[118:119], v[96:97], v[172:173], v[12:13] op_sel:[1,0,0] op_sel_hi:[1,1,1]
 v_pk_fma_f32 v[120:121], v[98:99], v[172:173], v[12:13] op_sel:[0,0,0] op_sel_hi:[0,1,1]
 v_pk_fma_f32 v[122:123], v[98:99], v[172:173], v[12:13] op_sel:[1,0,0] op_sel_hi:[1,1,1]
 v_pk_fma_f32 v[124:125], v[100:101], v[172:173], v[12:13] op_sel:[0,0,0] op_sel_hi:[0,1,1]
 v_pk_fma_f32 v[126:127], v[100:101], v[172:173], v[12:13] op_sel:[1,0,0] op_sel_hi:[1,1,1]
 v_exp_f32 v108, v108
 v_exp_f32 v109, v109
 v_exp_f32 v110, v110
 v_exp_f32 v111, v111
 buffer_load_dwordx4 v[156:159], v0, s[4:7], s18 offen offset:3072 sc1
 s_add_u32 s18, s18, 4096
 v_exp_f32 v112, v112
 v_exp_f32 v113, v113
 v_exp_f32 v114, v114
 v_exp_f32 v115, v115
 v_exp_f32 v116, v116
 v_exp_f32 v117, v117
 v_exp_f32 v118, v118
 v_exp_f32 v119, v119
 v_exp_f32 v120, v120
 v_exp_f32 v121, v121
 v_exp_f32 v122, v122
 v_exp_f32 v123, v123
 v_exp_f32 v124, v124
 v_exp_f32 v125, v125
 v_exp_f32 v126, v126
 buffer_load_dwordx4 v[160:163], v0, s[4:7], s18 offen sc1
 v_exp_f32 v127, v127
 v_pk_add_f32 v[14:15], v[108:109], v[110:111]
 v_pk_add_f32 v[14:15], v[14:15], v[112:113]
 v_pk_add_f32 v[14:15], v[14:15], v[114:115]
 v_pk_add_f32 v[14:15], v[14:15], v[116:117]
 v_pk_add_f32 v[14:15], v[14:15], v[118:119]
 v_pk_add_f32 v[14:15], v[14:15], v[120:121]
 v_pk_add_f32 v[14:15], v[14:15], v[122:123]
 v_pk_add_f32 v[14:15], v[14:15], v[124:125]
 v_pk_add_f32 v[14:15], v[14:15], v[126:127]
 s_nop 1
 v_permlane32_swap_b32 v14, v15
 v_add_f32 v14, v14, v15
 v_rcp_f32 v14, v14
 s_nop 0
 v_mov_b32 v15, v14
 s_nop 1
 v_permlane32_swap_b32 v14, v15
 v_pk_mul_f32 v[108:109], v[108:109], v[14:15]
 v_cvt_pk_bf16_f32 v92, v108, v109
 v_pk_mul_f32 v[110:111], v[110:111], v[14:15]
 v_cvt_pk_bf16_f32 v93, v110, v111
 v_pk_mul_f32 v[112:113], v[112:113], v[14:15]
 v_cvt_pk_bf16_f32 v94, v112, v113
 v_pk_mul_f32 v[114:115], v[114:115], v[14:15]
 v_cvt_pk_bf16_f32 v95, v114, v115
 v_pk_mul_f32 v[116:117], v[116:117], v[14:15]
 v_cvt_pk_bf16_f32 v96, v116, v117
 v_pk_mul_f32 v[118:119], v[118:119], v[14:15]
 v_cvt_pk_bf16_f32 v97, v118, v119
 v_pk_mul_f32 v[120:121], v[120:121], v[14:15]
 v_cvt_pk_bf16_f32 v98, v120, v121
 v_pk_mul_f32 v[122:123], v[122:123], v[14:15]
 v_cvt_pk_bf16_f32 v99, v122, v123
 v_pk_mul_f32 v[124:125], v[124:125], v[14:15]
 v_cvt_pk_bf16_f32 v100, v124, v125
 v_pk_mul_f32 v[126:127], v[126:127], v[14:15]
 v_cvt_pk_bf16_f32 v101, v126, v127
 s_lshr_b32 s33, s3, 1
 s_lshl_b32 s33, s33, 10
 s_and_b32 s34, s3, 1
 s_lshl_b32 s34, s34, 3
 s_add_u32 s33, s33, s34
 v_add_u32 v118, s33, v2
 v_lshrrev_b32 v119, 1, v0
 v_add_u32 v119, 145408, v119
 s_lshl_b32 s33, s3, 1
 v_add_u32 v120, s33, v119
 s_mov_b32 s55, 0
Lkv_24:
 buffer_load_dwordx4 v[44:47], v11, s[4:7], s25 offen sc1
 buffer_load_dwordx4 v[48:51], v11, s[4:7], s26 offen sc1
 buffer_load_dwordx4 v[52:55], v11, s[4:7], s27 offen sc1
 buffer_load_dwordx4 v[56:59], v11, s[4:7], s28 offen sc1
 buffer_load_dwordx4 v[60:63], v11, s[4:7], s29 offen sc1
 buffer_load_dwordx4 v[64:67], v11, s[4:7], s30 offen sc1
 buffer_load_dwordx4 v[68:71], v11, s[4:7], s31 offen sc1
 s_add_u32 s55, s55, 1
 s_cmp_gt_u32 s55, 0x40000
 s_cbranch_scc1 Lend
 v_lshlrev_b32 v108, 16, v128
 v_and_b32 v109, 0xffff0000, v128
 v_lshlrev_b32 v110, 16, v129
 v_and_b32 v111, 0xffff0000, v129
 v_lshlrev_b32 v112, 16, v130
 v_mov_b32 v12, 0
 s_waitcnt vmcnt(6)
 v_dot2c_f32_bf16 v108, s60, v44
 v_dot2c_f32_bf16 v109, s61, v44
 v_dot2c_f32_bf16 v110, s60, v45
 v_dot2c_f32_bf16 v111, s61, v45
 v_dot2c_f32_bf16 v112, s60, v46
 v_bitop3_b32 v12, v12, v47, s56 bitop3:0xf6
 s_waitcnt vmcnt(5)
 v_dot2c_f32_bf16 v108, s60, v48
 v_dot2c_f32_bf16 v109, s61, v48
 v_dot2c_f32_bf16 v110, s60, v49
 v_dot2c_f32_bf16 v111, s61, v49
 v_dot2c_f32_bf16 v112, s60, v50
 v_bitop3_b32 v12, v12, v51, s56 bitop3:0xf6
 s_waitcnt vmcnt(4)
 v_dot2c_f32_bf16 v108, s60, v52
 v_dot2c_f32_bf16 v109, s61, v52
 v_dot2c_f32_bf16 v110, s60, v53
 v_dot2c_f32_bf16 v111, s61, v53
 v_dot2c_f32_bf16 v112, s60, v54
 v_bitop3_b32 v12, v12, v55, s56 bitop3:0xf6
 s_waitcnt vmcnt(3)
 v_dot2c_f32_bf16 v108, s60, v56
 v_dot2c_f32_bf16 v109, s61, v56
 v_dot2c_f32_bf16 v110, s60, v57
 v_dot2c_f32_bf16 v111, s61, v57
 v_dot2c_f32_bf16 v112, s60, v58
 v_bitop3_b32 v12, v12, v59, s56 bitop3:0xf6
 s_waitcnt vmcnt(2)
 v_dot2c_f32_bf16 v108, s60, v60
 v_dot2c_f32_bf16 v109, s61, v60
 v_dot2c_f32_bf16 v110, s60, v61
 v_dot2c_f32_bf16 v111, s61, v61
 v_dot2c_f32_bf16 v112, s60, v62
 v_bitop3_b32 v12, v12, v63, s56 bitop3:0xf6
 s_waitcnt vmcnt(1)
 v_dot2c_f32_bf16 v108, s60, v64
 v_dot2c_f32_bf16 v109, s61, v64
 v_dot2c_f32_bf16 v110, s60, v65
 v_dot2c_f32_bf16 v111, s61, v65
 v_dot2c_f32_bf16 v112, s60, v66
 v_bitop3_b32 v12, v12, v67, s56 bitop3:0xf6
 s_waitcnt vmcnt(0)
 v_dot2c_f32_bf16 v108, s60, v68
 v_dot2c_f32_bf16 v109, s61, v68
 v_dot2c_f32_bf16 v110, s60, v69
 v_dot2c_f32_bf16 v111, s61, v69
 v_dot2c_f32_bf16 v112, s60, v70
 v_bitop3_b32 v12, v12, v71, s56 bitop3:0xf6
 v_cmp_ne_u32 vcc, 0, v12
 s_cbranch_vccnz Lkv_24
 v_cvt_pk_bf16_f32 v114, v108, v109
 v_cvt_pk_bf16_f32 v115, v110, v111
 v_cvt_pk_bf16_f32 v116, v112, v112
 ds_write_b64 v118, v[114:115] offset:12288
 ds_write_b16 v120, v116
 s_mul_i32 s24, s53, 196608
 s_add_u32 s24, s24, 18350080
 s_mul_i32 s25, s3, 5120
 s_add_u32 s24, s24, s25
 s_lshr_b32 s26, s3, 1
 s_mul_i32 s26, s26, 20480
 s_add_u32 s25, s24, 20480
 s_sub_u32 s25, s25, s26
 s_waitcnt lgkmcnt(0)
 s_barrier
 ds_read_b64 v[136:137], v119
 ds_read_b128 v[128:131], v2 offset:12288
 ds_read_b128 v[132:135], v2 offset:13312
 s_add_u32 s24, s24, s26
 s_add_u32 s26, s24, 40960
 s_add_u32 s27, s25, 40960
 s_lshl_b32 s28, s53, 7
 s_add_u32 s28, s28, 7737344
 s_lshl_b32 s62, s3, 5
 s_add_u32 s28, s28, s62
 v_lshrrev_b32 v172, 2, v0
 v_and_b32 v171, 28, v172
 v_and_b32 v172, 124, v172
 s_waitcnt lgkmcnt(2)
 v_mfma_f32_32x32x8_bf16 v[44:59], v[136:137], v[84:85], 0
 v_mfma_f32_32x32x8_bf16 v[60:75], v[136:137], v[100:101], 0
 s_waitcnt lgkmcnt(1)
 s_nop 7
 v_mfma_f32_32x32x16_bf16 v[44:59], v[128:131], v[76:79], v[44:59]
 s_waitcnt lgkmcnt(0)
 v_mfma_f32_32x32x16_bf16 v[44:59], v[132:135], v[80:83], v[44:59]
 v_mfma_f32_32x32x16_bf16 v[60:75], v[128:131], v[92:95], v[60:75]
 v_mfma_f32_32x32x16_bf16 v[60:75], v[132:135], v[96:99], v[60:75]
 s_nop 9
 v_add_f32 v58, 0x358637bd, v58
 v_rcp_f32 v58, v58
 s_nop 0
 v_mul_f32 v48, v48, v58
 v_mul_f32 v49, v49, v58
 v_mul_f32 v50, v50, v58
 v_mul_f32 v51, v51, v58
 v_mul_f32 v52, v52, v58
 v_mul_f32 v53, v53, v58
 v_mul_f32 v54, v54, v58
 v_mul_f32 v55, v55, v58
 v_mul_f32 v56, v56, v58
 v_mul_f32 v57, v57, v58
 v_cvt_pk_bf16_f32 v108, v48, v49
 v_cvt_pk_bf16_f32 v109, v50, v51
 v_cvt_pk_bf16_f32 v110, v52, v53
 v_cvt_pk_bf16_f32 v111, v54, v55
 v_cvt_pk_bf16_f32 v116, v56, v57
 buffer_store_dwordx4 v[108:111], v8, s[4:7], s20 offen
 v_add_f32 v74, 0x358637bd, v74
 v_rcp_f32 v74, v74
 s_nop 0
 v_pk_mul_f32 v[64:65], v[64:65], v[74:75] op_sel_hi:[1,0]
 v_pk_mul_f32 v[66:67], v[66:67], v[74:75] op_sel_hi:[1,0]
 v_pk_mul_f32 v[68:69], v[68:69], v[74:75] op_sel_hi:[1,0]
 v_pk_mul_f32 v[70:71], v[70:71], v[74:75] op_sel_hi:[1,0]
 v_pk_mul_f32 v[72:73], v[72:73], v[74:75] op_sel_hi:[1,0]
 v_cvt_pk_bf16_f32 v112, v64, v65
 v_cvt_pk_bf16_f32 v113, v66, v67
 v_cvt_pk_bf16_f32 v114, v68, v69
 v_cvt_pk_bf16_f32 v115, v70, v71
 v_cvt_pk_bf16_f32 v117, v72, v73
 buffer_store_dwordx4 v[112:115], v8, s[4:7], s21 offen
 s_nop 0
 v_permlane32_swap_b32 v116, v117
 buffer_store_dwordx2 v[116:117], v9, s[4:7], s22 offen
 s_mul_i32 s29, s53, 81920
 s_lshl_b32 s30, s58, 1
 s_add_u32 s30, s30, s59
 s_lshr_b32 s62, s3, 1
 s_mul_i32 s62, s62, 20224
 s_lshl_b32 s63, s3, 7
 s_add_u32 s62, s62, s63
 s_add_u32 s62, s62, 0
 v_bfe_u32 v168, v0, 4, 3
 v_mul_u32_u24 v168, 16, v168
 v_bfe_u32 v14, v0, 7, 1
 v_lshl_add_u32 v168, v14, 10, v168
 v_bfe_u32 v14, v0, 8, 2
 v_lshl_add_u32 v168, v14, 8, v168
 v_bfe_u32 v169, v0, 4, 3
 v_mul_u32_u24 v169, 16, v169
 v_bfe_u32 v14, v0, 7, 1
 v_lshl_add_u32 v169, v14, 2, v169
 v_bfe_u32 v14, v0, 8, 1
 v_lshl_add_u32 v169, v14, 3, v169
 v_bfe_u32 v14, v0, 9, 1
 v_lshl_add_u32 v169, v14, 8, v169
 s_add_u32 s29, s29, s62
 s_lshl_b32 s30, s30, 9
 s_add_u32 s30, s30, s29
 s_lshl_b32 s62, s57, 10
 s_add_u32 s29, s29, s62
 v_bfe_u32 v170, v0, 4, 3
 v_mul_u32_u24 v170, 16, v170
 v_bfe_u32 v14, v0, 7, 1
 v_lshl_add_u32 v170, v14, 30, v170
 v_bfe_u32 v14, v0, 8, 1
 v_lshl_add_u32 v170, v14, 29, v170
 v_bfe_u32 v14, v0, 9, 1
 v_lshl_add_u32 v170, v14, 9, v170
 s_lshl_b32 s31, s53, 2
 s_lshr_b32 s62, s3, 1
 s_add_u32 s31, s31, s62
 s_lshl_b32 s31, s31, 2
 s_lshr_b32 s62, s51, 2
 s_add_u32 s31, s31, s62
 s_lshl_b32 s31, s31, 1
 s_and_b32 s62, s3, 1
 s_add_u32 s31, s31, s62
 s_lshl_b32 s31, s31, 5
 s_and_b32 s62, s51, 3
 s_add_u32 s31, s31, s62
 s_lshl_b32 s31, s31, 2
 s_add_u32 s31, s31, 24641536
 s_lshl_b32 s32, s53, 3
 s_add_u32 s32, s32, s51
 s_lshl_b32 s32, s32, 2
 s_add_u32 s32, s32, s3
 s_lshl_b32 s32, s32, 2
 s_add_u32 s32, s32, 7733248
 v_mov_b32 v12, 5
 v_add_u32 v12, s52, v12
 s_waitcnt vmcnt(0)
 s_mov_b64 exec, 1
 buffer_store_dword v12, v0, s[4:7], s23 offen
 s_mov_b64 exec, -1
 s_add_u32 s56, s52, 5
 s_mov_b32 s55, 0
Lpoll_25:
 buffer_load_dword v12, v171, s[4:7], s28 offen sc1
 s_add_u32 s55, s55, 1
 s_cmp_gt_u32 s55, 0x80000
 s_cbranch_scc1 Lend
 s_waitcnt vmcnt(0)
 v_cmp_ne_u32 vcc, s56, v12
 s_cbranch_vccnz Lpoll_25
 buffer_load_dwordx4 v[44:47], v0, s[4:7], s24 offen sc1
 buffer_load_dwordx4 v[48:51], v0, s[4:7], s24 offen offset:1024 sc1
 buffer_load_dwordx4 v[52:55], v0, s[4:7], s24 offen offset:2048 sc1
 buffer_load_dwordx4 v[56:59], v0, s[4:7], s24 offen offset:3072 sc1
 s_add_u32 s24, s24, 4096
 buffer_load_dwordx4 v[60:63], v0, s[4:7], s24 offen sc1
 s_mul_i32 s16, s54, 81920
 s_add_u32 s16, s16, 0
 s_add_u32 s17, s16, 20480
 s_add_u32 s18, s16, 40960
 s_add_u32 s19, s16, 61440
 s_lshl_b32 s20, s54, 12
 s_add_u32 s20, s20, 24641536
 s_waitcnt vmcnt(4)
 v_mfma_f32_16x16x32_bf16 v[84:87], v[176:179], v[44:47], 0
 buffer_load_dwordx4 v[64:67], v0, s[4:7], s25 offen sc1
 v_mfma_f32_16x16x32_bf16 v[88:91], v[180:183], v[44:47], 0
 v_mfma_f32_16x16x32_bf16 v[92:95], v[184:187], v[44:47], 0
 v_mfma_f32_16x16x32_bf16 v[96:99], v[188:191], v[44:47], 0
 v_mfma_f32_16x16x32_bf16 v[100:103], v[192:195], v[44:47], 0
 s_waitcnt vmcnt(4)
 v_mfma_f32_16x16x32_bf16 v[84:87], v[196:199], v[48:51], v[84:87]
 buffer_load_dwordx4 v[68:71], v0, s[4:7], s25 offen offset:1024 sc1
 v_mfma_f32_16x16x32_bf16 v[88:91], v[200:203], v[48:51], v[88:91]
 v_mfma_f32_16x16x32_bf16 v[92:95], v[204:207], v[48:51], v[92:95]
 v_mfma_f32_16x16x32_bf16 v[96:99], v[208:211], v[48:51], v[96:99]
 v_mfma_f32_16x16x32_bf16 v[100:103], v[212:215], v[48:51], v[100:103]
 s_waitcnt vmcnt(4)
 v_mfma_f32_16x16x32_bf16 v[84:87], v[216:219], v[52:55], v[84:87]
 buffer_load_dwordx4 v[72:75], v0, s[4:7], s25 offen offset:2048 sc1
 v_mfma_f32_16x16x32_bf16 v[88:91], v[220:223], v[52:55], v[88:91]
 v_mfma_f32_16x16x32_bf16 v[92:95], v[224:227], v[52:55], v[92:95]
 v_mfma_f32_16x16x32_bf16 v[96:99], v[228:231], v[52:55], v[96:99]
 v_mfma_f32_16x16x32_bf16 v[100:103], v[232:235], v[52:55], v[100:103]
 s_waitcnt vmcnt(4)
 v_mfma_f32_16x16x32_bf16 v[84:87], v[236:239], v[56:59], v[84:87]
 buffer_load_dwordx4 v[76:79], v0, s[4:7], s25 offen offset:3072 sc1
 s_add_u32 s25, s25, 4096
 v_mfma_f32_16x16x32_bf16 v[88:91], v[240:243], v[56:59], v[88:91]
 v_mfma_f32_16x16x32_bf16 v[92:95], v[244:247], v[56:59], v[92:95]
 v_mfma_f32_16x16x32_bf16 v[96:99], v[248:251], v[56:59], v[96:99]
 v_mfma_f32_16x16x32_bf16 v[100:103], v[252:255], v[56:59], v[100:103]
 s_waitcnt vmcnt(4)
 v_mfma_f32_16x16x32_bf16 v[84:87], v[144:147], v[60:63], v[84:87]
 buffer_load_dwordx4 v[80:83], v0, s[4:7], s25 offen sc1
 v_mfma_f32_16x16x32_bf16 v[88:91], v[148:151], v[60:63], v[88:91]
 v_mfma_f32_16x16x32_bf16 v[92:95], v[152:155], v[60:63], v[92:95]
 v_mfma_f32_16x16x32_bf16 v[96:99], v[156:159], v[60:63], v[96:99]
 v_mfma_f32_16x16x32_bf16 v[100:103], v[160:163], v[60:63], v[100:103]
 s_waitcnt vmcnt(4)
 v_mfma_f32_16x16x32_bf16 v[104:107], v[176:179], v[64:67], 0
 buffer_load_dwordx4 v[44:47], v0, s[4:7], s26 offen sc1
 v_mfma_f32_16x16x32_bf16 v[108:111], v[180:183], v[64:67], 0
 s_waitcnt lgkmcnt(0)
 s_barrier
 v_mfma_f32_16x16x32_bf16 v[112:115], v[184:187], v[64:67], 0
 ds_write_b128 v3, v[84:87] offset:12288
 v_mfma_f32_16x16x32_bf16 v[116:119], v[188:191], v[64:67], 0
 v_mfma_f32_16x16x32_bf16 v[120:123], v[192:195], v[64:67], 0
 s_waitcnt vmcnt(4)
 v_mfma_f32_16x16x32_bf16 v[104:107], v[196:199], v[68:71], v[104:107]
 buffer_load_dwordx4 v[48:51], v0, s[4:7], s26 offen offset:1024 sc1
 v_mfma_f32_16x16x32_bf16 v[108:111], v[200:203], v[68:71], v[108:111]
 ds_write_b128 v3, v[88:91] offset:13312
 v_mfma_f32_16x16x32_bf16 v[112:115], v[204:207], v[68:71], v[112:115]
 v_mfma_f32_16x16x32_bf16 v[116:119], v[208:211], v[68:71], v[116:119]
 ds_write_b128 v3, v[92:95] offset:14336
 v_mfma_f32_16x16x32_bf16 v[120:123], v[212:215], v[68:71], v[120:123]
 s_waitcnt vmcnt(4)
 v_mfma_f32_16x16x32_bf16 v[104:107], v[216:219], v[72:75], v[104:107]
 buffer_load_dwordx4 v[52:55], v0, s[4:7], s26 offen offset:2048 sc1
 v_mfma_f32_16x16x32_bf16 v[108:111], v[220:223], v[72:75], v[108:111]
 ds_write_b128 v3, v[96:99] offset:15360
 v_mfma_f32_16x16x32_bf16 v[112:115], v[224:227], v[72:75], v[112:115]
 v_mfma_f32_16x16x32_bf16 v[116:119], v[228:231], v[72:75], v[116:119]
 ds_write_b128 v3, v[100:103] offset:16384
 v_mfma_f32_16x16x32_bf16 v[120:123], v[232:235], v[72:75], v[120:123]
 s_waitcnt vmcnt(4)
 v_mfma_f32_16x16x32_bf16 v[104:107], v[236:239], v[76:79], v[104:107]
 buffer_load_dwordx4 v[56:59], v0, s[4:7], s26 offen offset:3072 sc1
 s_add_u32 s26, s26, 4096
 v_mfma_f32_16x16x32_bf16 v[108:111], v[240:243], v[76:79], v[108:111]
 v_mfma_f32_16x16x32_bf16 v[112:115], v[244:247], v[76:79], v[112:115]
 v_mfma_f32_16x16x32_bf16 v[116:119], v[248:251], v[76:79], v[116:119]
 s_waitcnt lgkmcnt(0)
 s_barrier
 v_mfma_f32_16x16x32_bf16 v[120:123], v[252:255], v[76:79], v[120:123]
 ds_read_b128 v[124:127], v5 offset:12288
 s_waitcnt vmcnt(4)
 v_mfma_f32_16x16x32_bf16 v[104:107], v[144:147], v[80:83], v[104:107]
 ds_read_b128 v[128:131], v5 offset:13312
 buffer_load_dwordx4 v[60:63], v0, s[4:7], s26 offen sc1
 v_mfma_f32_16x16x32_bf16 v[108:111], v[148:151], v[80:83], v[108:111]
 ds_read_b64 v[132:133], v6 offset:16384
 v_mfma_f32_16x16x32_bf16 v[112:115], v[152:155], v[80:83], v[112:115]
 ds_read_b128 v[134:137], v5 offset:17408
 v_mfma_f32_16x16x32_bf16 v[116:119], v[156:159], v[80:83], v[116:119]
 ds_read_b128 v[138:141], v5 offset:18432
 v_mfma_f32_16x16x32_bf16 v[120:123], v[160:163], v[80:83], v[120:123]
 ds_read_b64 v[142:143], v6 offset:21504
 s_waitcnt lgkmcnt(0)
 s_barrier
 ds_write_b128 v4, v[104:107] offset:12288
 v_pk_add_f32 v[16:17], v[16:17], v[124:125]
 v_pk_add_f32 v[18:19], v[18:19], v[126:127]
 v_pk_add_f32 v[20:21], v[20:21], v[128:129]
 ds_write_b128 v4, v[108:111] offset:13312
 v_pk_add_f32 v[22:23], v[22:23], v[130:131]
 v_pk_add_f32 v[24:25], v[24:25], v[132:133]
 v_pk_add_f32 v[16:17], v[16:17], v[134:135]
 ds_write_b128 v4, v[112:115] offset:14336
 v_pk_add_f32 v[18:19], v[18:19], v[136:137]
 v_pk_add_f32 v[20:21], v[20:21], v[138:139]
 v_pk_add_f32 v[22:23], v[22:23], v[140:141]
 ds_write_b128 v4, v[116:119] offset:15360
 v_pk_add_f32 v[24:25], v[24:25], v[142:143]
 buffer_load_dwordx4 v[64:67], v0, s[4:7], s27 offen sc1
 buffer_load_dwordx4 v[68:71], v0, s[4:7], s27 offen offset:1024 sc1
 ds_write_b128 v4, v[120:123] offset:16384
 buffer_load_dwordx4 v[72:75], v0, s[4:7], s27 offen offset:2048 sc1
 buffer_load_dwordx4 v[76:79], v0, s[4:7], s27 offen offset:3072 sc1
 s_add_u32 s27, s27, 4096
 buffer_load_dwordx4 v[80:83], v0, s[4:7], s27 offen sc1
 s_waitcnt lgkmcnt(0)
 s_barrier
 ds_read_b128 v[124:127], v5 offset:12288
 ds_read_b128 v[128:131], v5 offset:13312
 ds_read_b64 v[132:133], v6 offset:16384
 ds_read_b128 v[134:137], v5 offset:17408
 ds_read_b128 v[138:141], v5 offset:18432
 ds_read_b64 v[142:143], v6 offset:21504
 s_waitcnt lgkmcnt(5)
 v_pk_add_f32 v[16:17], v[16:17], v[124:125]
 v_pk_add_f32 v[18:19], v[18:19], v[126:127]
 s_waitcnt lgkmcnt(4)
 v_pk_add_f32 v[20:21], v[20:21], v[128:129]
 v_pk_add_f32 v[22:23], v[22:23], v[130:131]
 s_waitcnt lgkmcnt(3)
 v_pk_add_f32 v[24:25], v[24:25], v[132:133]
 s_waitcnt lgkmcnt(2)
 v_pk_add_f32 v[16:17], v[16:17], v[134:135]
 v_pk_add_f32 v[18:19], v[18:19], v[136:137]
 s_waitcnt lgkmcnt(1)
 v_pk_add_f32 v[20:21], v[20:21], v[138:139]
 v_pk_add_f32 v[22:23], v[22:23], v[140:141]
 s_waitcnt lgkmcnt(0)
 v_pk_add_f32 v[24:25], v[24:25], v[142:143]
 v_cvt_pk_bf16_f32 v124, v16, v17
 v_cvt_pk_bf16_f32 v125, v18, v19
 v_cvt_pk_bf16_f32 v126, v20, v21
 v_cvt_pk_bf16_f32 v127, v22, v23
 v_cvt_pk_bf16_f32 v128, v24, v25
 buffer_store_dwordx4 v[124:127], v168, s[8:11], s29 offen
 buffer_store_dword v128, v169, s[8:11], s30 offen
 v_pk_add_f32 v[130:131], v[16:17], v[18:19]
 v_pk_mul_f32 v[132:133], v[16:17], v[16:17]
 v_pk_fma_f32 v[132:133], v[18:19], v[18:19], v[132:133]
 v_pk_add_f32 v[130:131], v[130:131], v[20:21]
 v_pk_fma_f32 v[132:133], v[20:21], v[20:21], v[132:133]
 v_pk_add_f32 v[130:131], v[130:131], v[22:23]
 v_pk_fma_f32 v[132:133], v[22:23], v[22:23], v[132:133]
 v_pk_add_f32 v[130:131], v[130:131], v[24:25]
 v_pk_fma_f32 v[132:133], v[24:25], v[24:25], v[132:133]
 v_add_f32 v130, v130, v131
 v_add_f32 v132, v132, v133
 s_nop 1
 v_permlane32_swap_b32 v130, v132
 v_add_f32 v131, v130, v132
 v_add_f32 v130, v130, v132
 s_nop 1
 v_permlane16_swap_b32 v130, v131
 v_add_f32 v130, v130, v131
 s_nop 1
 v_add_f32_dpp v130, v130, v130 row_ror:8 row_mask:0xf bank_mask:0xf
 buffer_store_dword v130, v170, s[4:7], s31 offen
 s_add_u32 s29, s29, 40960
 s_add_u32 s30, s30, 40960
 s_add_u32 s31, s31, 2048
 s_waitcnt vmcnt(12)
 v_mfma_f32_16x16x32_bf16 v[84:87], v[176:179], v[44:47], 0
 v_mfma_f32_16x16x32_bf16 v[88:91], v[180:183], v[44:47], 0
 v_mfma_f32_16x16x32_bf16 v[92:95], v[184:187], v[44:47], 0
 v_mfma_f32_16x16x32_bf16 v[96:99], v[188:191], v[44:47], 0
 v_mfma_f32_16x16x32_bf16 v[100:103], v[192:195], v[44:47], 0
 s_waitcnt vmcnt(11)
 v_mfma_f32_16x16x32_bf16 v[84:87], v[196:199], v[48:51], v[84:87]
 v_mfma_f32_16x16x32_bf16 v[88:91], v[200:203], v[48:51], v[88:91]
 v_mfma_f32_16x16x32_bf16 v[92:95], v[204:207], v[48:51], v[92:95]
 v_mfma_f32_16x16x32_bf16 v[96:99], v[208:211], v[48:51], v[96:99]
 v_mfma_f32_16x16x32_bf16 v[100:103], v[212:215], v[48:51], v[100:103]
 s_waitcnt vmcnt(10)
 v_mfma_f32_16x16x32_bf16 v[84:87], v[216:219], v[52:55], v[84:87]
 v_mfma_f32_16x16x32_bf16 v[88:91], v[220:223], v[52:55], v[88:91]
 v_mfma_f32_16x16x32_bf16 v[92:95], v[224:227], v[52:55], v[92:95]
 v_mfma_f32_16x16x32_bf16 v[96:99], v[228:231], v[52:55], v[96:99]
 v_mfma_f32_16x16x32_bf16 v[100:103], v[232:235], v[52:55], v[100:103]
 s_waitcnt vmcnt(9)
 v_mfma_f32_16x16x32_bf16 v[84:87], v[236:239], v[56:59], v[84:87]
 v_mfma_f32_16x16x32_bf16 v[88:91], v[240:243], v[56:59], v[88:91]
 v_mfma_f32_16x16x32_bf16 v[92:95], v[244:247], v[56:59], v[92:95]
 v_mfma_f32_16x16x32_bf16 v[96:99], v[248:251], v[56:59], v[96:99]
 v_mfma_f32_16x16x32_bf16 v[100:103], v[252:255], v[56:59], v[100:103]
 s_waitcnt vmcnt(8)
 v_mfma_f32_16x16x32_bf16 v[84:87], v[144:147], v[60:63], v[84:87]
 v_mfma_f32_16x16x32_bf16 v[88:91], v[148:151], v[60:63], v[88:91]
 v_mfma_f32_16x16x32_bf16 v[92:95], v[152:155], v[60:63], v[92:95]
 v_mfma_f32_16x16x32_bf16 v[96:99], v[156:159], v[60:63], v[96:99]
 v_mfma_f32_16x16x32_bf16 v[100:103], v[160:163], v[60:63], v[100:103]
 v_mov_b32 v15, 6
 v_add_u32 v15, s52, v15
 s_waitcnt vmcnt(0)
 s_mov_b64 exec, 1
 buffer_store_dword v15, v0, s[4:7], s32 offen
 s_mov_b64 exec, -1
 s_add_u32 s32, s32, 12288
 v_mfma_f32_16x16x32_bf16 v[104:107], v[176:179], v[64:67], 0
 v_mfma_f32_16x16x32_bf16 v[108:111], v[180:183], v[64:67], 0
 s_waitcnt lgkmcnt(0)
 s_barrier
 v_mfma_f32_16x16x32_bf16 v[112:115], v[184:187], v[64:67], 0
 ds_write_b128 v3, v[84:87] offset:12288
 v_mfma_f32_16x16x32_bf16 v[116:119], v[188:191], v[64:67], 0
 v_mfma_f32_16x16x32_bf16 v[120:123], v[192:195], v[64:67], 0
 v_mfma_f32_16x16x32_bf16 v[104:107], v[196:199], v[68:71], v[104:107]
 v_mfma_f32_16x16x32_bf16 v[108:111], v[200:203], v[68:71], v[108:111]
 ds_write_b128 v3, v[88:91] offset:13312
 v_mfma_f32_16x16x32_bf16 v[112:115], v[204:207], v[68:71], v[112:115]
 v_mfma_f32_16x16x32_bf16 v[116:119], v[208:211], v[68:71], v[116:119]
 ds_write_b128 v3, v[92:95] offset:14336
 v_mfma_f32_16x16x32_bf16 v[120:123], v[212:215], v[68:71], v[120:123]
 v_mfma_f32_16x16x32_bf16 v[104:107], v[216:219], v[72:75], v[104:107]
 v_mfma_f32_16x16x32_bf16 v[108:111], v[220:223], v[72:75], v[108:111]
 ds_write_b128 v3, v[96:99] offset:15360
 v_mfma_f32_16x16x32_bf16 v[112:115], v[224:227], v[72:75], v[112:115]
 v_mfma_f32_16x16x32_bf16 v[116:119], v[228:231], v[72:75], v[116:119]
 ds_write_b128 v3, v[100:103] offset:16384
 v_mfma_f32_16x16x32_bf16 v[120:123], v[232:235], v[72:75], v[120:123]
 v_mfma_f32_16x16x32_bf16 v[104:107], v[236:239], v[76:79], v[104:107]
 v_mfma_f32_16x16x32_bf16 v[108:111], v[240:243], v[76:79], v[108:111]
 v_mfma_f32_16x16x32_bf16 v[112:115], v[244:247], v[76:79], v[112:115]
 v_mfma_f32_16x16x32_bf16 v[116:119], v[248:251], v[76:79], v[116:119]
 s_waitcnt lgkmcnt(0)
 s_barrier
 v_mfma_f32_16x16x32_bf16 v[120:123], v[252:255], v[76:79], v[120:123]
 ds_read_b128 v[124:127], v5 offset:12288
 v_mfma_f32_16x16x32_bf16 v[104:107], v[144:147], v[80:83], v[104:107]
 ds_read_b128 v[128:131], v5 offset:13312
 v_mfma_f32_16x16x32_bf16 v[108:111], v[148:151], v[80:83], v[108:111]
 ds_read_b64 v[132:133], v6 offset:16384
 s_lshl_b32 s33, s54, 7
 s_add_u32 s33, s33, 7733248
 s_add_u32 s56, s52, 6
 buffer_load_dword v12, v172, s[4:7], s33 offen sc1
 v_mfma_f32_16x16x32_bf16 v[112:115], v[152:155], v[80:83], v[112:115]
 ds_read_b128 v[134:137], v5 offset:17408
 v_mfma_f32_16x16x32_bf16 v[116:119], v[156:159], v[80:83], v[116:119]
 ds_read_b128 v[138:141], v5 offset:18432
 v_mfma_f32_16x16x32_bf16 v[120:123], v[160:163], v[80:83], v[120:123]
 ds_read_b64 v[142:143], v6 offset:21504
 s_waitcnt lgkmcnt(0)
 s_barrier
 ds_write_b128 v4, v[104:107] offset:12288
 v_pk_add_f32 v[26:27], v[26:27], v[124:125]
 v_pk_add_f32 v[28:29], v[28:29], v[126:127]
 v_pk_add_f32 v[30:31], v[30:31], v[128:129]
 ds_write_b128 v4, v[108:111] offset:13312
 v_pk_add_f32 v[32:33], v[32:33], v[130:131]
 v_pk_add_f32 v[34:35], v[34:35], v[132:133]
 v_pk_add_f32 v[26:27], v[26:27], v[134:135]
 ds_write_b128 v4, v[112:115] offset:14336
 v_pk_add_f32 v[28:29], v[28:29], v[136:137]
 v_pk_add_f32 v[30:31], v[30:31], v[138:139]
 v_pk_add_f32 v[32:33], v[32:33], v[140:141]
 ds_write_b128 v4, v[116:119] offset:15360
 v_pk_add_f32 v[34:35], v[34:35], v[142:143]
 ds_read_b128 v[176:179], v1 offset:16384
 ds_read_b128 v[180:183], v1 offset:17408
 s_waitcnt vmcnt(0)
 v_cmp_ne_u32 vcc, s56, v12
 s_cbranch_vccz Lgate_26
 s_mov_b32 s55, 0
Lpoll_27:
 buffer_load_dword v12, v172, s[4:7], s33 offen sc1
 s_add_u32 s55, s55, 1
 s_cmp_gt_u32 s55, 0x80000
 s_cbranch_scc1 Lend
 s_waitcnt vmcnt(0)
 v_cmp_ne_u32 vcc, s56, v12
 s_cbranch_vccnz Lpoll_27
Lgate_26:
 s_add_u32 s33, s33, 12288
 buffer_load_dwordx4 v[44:47], v0, s[8:11], s16 offen sc1
 buffer_load_dwordx4 v[48:51], v0, s[8:11], s17 offen sc1
 ds_write_b128 v4, v[120:123] offset:16384
 buffer_load_dwordx4 v[52:55], v0, s[8:11], s16 offen offset:1024 sc1
 buffer_load_dwordx4 v[56:59], v0, s[8:11], s17 offen offset:1024 sc1
 buffer_load_dwordx4 v[60:63], v0, s[8:11], s16 offen offset:2048 sc1
 buffer_load_dwordx4 v[64:67], v0, s[8:11], s17 offen offset:2048 sc1
 buffer_load_dwordx4 v[68:71], v0, s[8:11], s16 offen offset:3072 sc1
 s_add_u32 s16, s16, 4096
 ds_read_b128 v[184:187], v1 offset:18432
 ds_read_b128 v[188:191], v1 offset:19456
 ds_read_b128 v[192:195], v1 offset:20480
 s_waitcnt lgkmcnt(0)
 s_barrier
 ds_read_b128 v[124:127], v5 offset:12288
 ds_read_b128 v[128:131], v5 offset:13312
 ds_read_b64 v[132:133], v6 offset:16384
 ds_read_b128 v[134:137], v5 offset:17408
 ds_read_b128 v[138:141], v5 offset:18432
 ds_read_b64 v[142:143], v6 offset:21504
 buffer_load_dwordx4 v[72:75], v0, s[8:11], s17 offen offset:3072 sc1
 s_add_u32 s17, s17, 4096
 buffer_load_dwordx4 v[76:79], v0, s[8:11], s16 offen sc1
 buffer_load_dwordx4 v[80:83], v0, s[8:11], s17 offen sc1
 s_waitcnt vmcnt(9)
 v_mfma_f32_16x16x32_bf16 v[212:215], v[176:179], v[44:47], 0
 v_mfma_f32_16x16x32_bf16 v[216:219], v[180:183], v[44:47], 0
 ds_read_b128 v[196:199], v1 offset:21504
 v_mfma_f32_16x16x32_bf16 v[220:223], v[184:187], v[44:47], 0
 s_waitcnt lgkmcnt(6)
 v_add_f32 v26, v26, v124
 v_add_f32 v27, v27, v125
 s_waitcnt vmcnt(8)
 v_mfma_f32_16x16x32_bf16 v[224:227], v[176:179], v[48:51], 0
 ds_read_b128 v[200:203], v1 offset:22528
 v_add_f32 v28, v28, v126
 v_add_f32 v29, v29, v127
 s_waitcnt lgkmcnt(6)
 v_add_f32 v30, v30, v128
 v_mfma_f32_16x16x32_bf16 v[228:231], v[180:183], v[48:51], 0
 v_add_f32 v31, v31, v129
 v_add_f32 v32, v32, v130
 v_add_f32 v33, v33, v131
 v_mfma_f32_16x16x32_bf16 v[232:235], v[184:187], v[48:51], 0
 ds_read_b128 v[204:207], v1 offset:23552
 s_waitcnt lgkmcnt(6)
 v_add_f32 v34, v34, v132
 v_add_f32 v35, v35, v133
 s_waitcnt vmcnt(7) lgkmcnt(2)
 v_mfma_f32_16x16x32_bf16 v[212:215], v[188:191], v[52:55], v[212:215]
 v_add_f32 v26, v26, v134
 v_add_f32 v27, v27, v135
 v_add_f32 v28, v28, v136
 v_mfma_f32_16x16x32_bf16 v[216:219], v[192:195], v[52:55], v[216:219]
 ds_read_b128 v[208:211], v1 offset:24576
 v_add_f32 v29, v29, v137
 v_add_f32 v30, v30, v138
 v_add_f32 v31, v31, v139
 v_mfma_f32_16x16x32_bf16 v[220:223], v[196:199], v[52:55], v[220:223]
 v_add_f32 v32, v32, v140
 v_add_f32 v33, v33, v141
 s_waitcnt vmcnt(6)
 v_mfma_f32_16x16x32_bf16 v[224:227], v[188:191], v[56:59], v[224:227]
 ds_read_b128 v[176:179], v1 offset:25600
 buffer_load_dwordx4 v[44:47], v0, s[8:11], s16 offen offset:1024 sc1
 v_add_f32 v34, v34, v142
 v_add_f32 v35, v35, v143
 v_mfma_f32_16x16x32_bf16 v[228:231], v[192:195], v[56:59], v[228:231]
 v_cvt_pk_bf16_f32 v124, v26, v27
 v_cvt_pk_bf16_f32 v125, v28, v29
 v_cvt_pk_bf16_f32 v126, v30, v31
 v_mfma_f32_16x16x32_bf16 v[232:235], v[196:199], v[56:59], v[232:235]
 ds_read_b128 v[180:183], v1 offset:26624
 v_cvt_pk_bf16_f32 v127, v32, v33
 v_cvt_pk_bf16_f32 v128, v34, v35
 s_waitcnt vmcnt(6) lgkmcnt(2)
 v_mfma_f32_16x16x32_bf16 v[212:215], v[200:203], v[60:63], v[212:215]
 buffer_load_dwordx4 v[48:51], v0, s[8:11], s17 offen offset:1024 sc1
 v_mfma_f32_16x16x32_bf16 v[216:219], v[204:207], v[60:63], v[216:219]
 ds_read_b128 v[184:187], v1 offset:27648
 v_mfma_f32_16x16x32_bf16 v[220:223], v[208:211], v[60:63], v[220:223]
 buffer_load_dwordx4 v[236:239], v0, s[4:7], s20 offen sc1
 s_waitcnt vmcnt(7)
 v_mfma_f32_16x16x32_bf16 v[224:227], v[200:203], v[64:67], v[224:227]
 ds_read_b128 v[188:191], v1 offset:28672
 buffer_load_dwordx4 v[52:55], v0, s[8:11], s16 offen offset:2048 sc1
 v_mfma_f32_16x16x32_bf16 v[228:231], v[204:207], v[64:67], v[228:231]
 buffer_store_dwordx4 v[124:127], v168, s[8:11], s29 offen
 v_mfma_f32_16x16x32_bf16 v[232:235], v[208:211], v[64:67], v[232:235]
 ds_read_b128 v[192:195], v1 offset:29696
 buffer_store_dword v128, v169, s[8:11], s30 offen
 s_waitcnt vmcnt(9) lgkmcnt(2)
 v_mfma_f32_16x16x32_bf16 v[212:215], v[176:179], v[68:71], v[212:215]
 buffer_load_dwordx4 v[56:59], v0, s[8:11], s17 offen offset:2048 sc1
 v_add_f32 v130, v26, v27
 v_mul_f32 v132, v26, v26
 v_mfma_f32_16x16x32_bf16 v[216:219], v[180:183], v[68:71], v[216:219]
 ds_read_b128 v[196:199], v1 offset:30720
 v_fmac_f32 v132, v27, v27
 v_add_f32 v130, v130, v28
 v_fmac_f32 v132, v28, v28
 v_mfma_f32_16x16x32_bf16 v[220:223], v[184:187], v[68:71], v[220:223]
 buffer_load_dwordx4 v[240:243], v0, s[4:7], s20 offen offset:1024 sc1
 v_add_f32 v130, v130, v29
 s_waitcnt vmcnt(10)
 v_mfma_f32_16x16x32_bf16 v[224:227], v[176:179], v[72:75], v[224:227]
 ds_read_b128 v[200:203], v1 offset:31744
 buffer_load_dwordx4 v[60:63], v0, s[8:11], s16 offen offset:3072 sc1
 s_add_u32 s16, s16, 4096
 v_fmac_f32 v132, v29, v29
 v_mfma_f32_16x16x32_bf16 v[228:231], v[180:183], v[72:75], v[228:231]
 v_add_f32 v130, v130, v30
 v_fmac_f32 v132, v30, v30
 v_add_f32 v130, v130, v31
 v_mfma_f32_16x16x32_bf16 v[232:235], v[184:187], v[72:75], v[232:235]
 ds_read_b128 v[204:207], v1 offset:32768
 v_fmac_f32 v132, v31, v31
 v_add_f32 v130, v130, v32
 s_waitcnt vmcnt(10) lgkmcnt(2)
 v_mfma_f32_16x16x32_bf16 v[212:215], v[188:191], v[76:79], v[212:215]
 buffer_load_dwordx4 v[64:67], v0, s[8:11], s17 offen offset:3072 sc1
 s_add_u32 s17, s17, 4096
 v_fmac_f32 v132, v32, v32
 v_mfma_f32_16x16x32_bf16 v[216:219], v[192:195], v[76:79], v[216:219]
 ds_read_b128 v[208:211], v1 offset:33792
 v_add_f32 v130, v130, v33
 v_fmac_f32 v132, v33, v33
 v_add_f32 v130, v130, v34
 v_mfma_f32_16x16x32_bf16 v[220:223], v[196:199], v[76:79], v[220:223]
 v_fmac_f32 v132, v34, v34
 v_add_f32 v130, v130, v35
 s_mul_i32 s35, s54, 196608
 s_waitcnt vmcnt(10)
 v_mfma_f32_16x16x32_bf16 v[224:227], v[188:191], v[80:83], v[224:227]
 ds_read_b128 v[176:179], v1 offset:34816
 buffer_load_dwordx4 v[68:71], v0, s[8:11], s16 offen sc1
 v_fmac_f32 v132, v35, v35
 s_add_u32 s35, s35, 18350080
 v_mfma_f32_16x16x32_bf16 v[228:231], v[192:195], v[80:83], v[228:231]
 v_permlane32_swap_b32 v130, v132
 v_add_f32 v131, v130, v132
 s_lshr_b32 s34, s49, 1
 v_mfma_f32_16x16x32_bf16 v[232:235], v[196:199], v[80:83], v[232:235]
 ds_read_b128 v[180:183], v1 offset:35840
 v_add_f32 v130, v130, v132
 s_mul_i32 s34, s34, 3072
 s_waitcnt vmcnt(10) lgkmcnt(2)
 v_mfma_f32_16x16x32_bf16 v[212:215], v[200:203], v[44:47], v[212:215]
 buffer_load_dwordx4 v[72:75], v0, s[8:11], s17 offen sc1
 v_permlane16_swap_b32 v130, v131
 s_add_u32 s35, s35, s34
 v_mfma_f32_16x16x32_bf16 v[216:219], v[204:207], v[44:47], v[216:219]
 ds_read_b128 v[184:187], v1 offset:36864
 v_add_f32 v130, v130, v131
 s_nop 1
 v_add_f32_dpp v130, v130, v130 row_ror:8 row_mask:0xf bank_mask:0xf
 s_lshl_b32 s34, s59, 11
 v_mfma_f32_16x16x32_bf16 v[220:223], v[208:211], v[44:47], v[220:223]
 buffer_store_dword v130, v170, s[4:7], s31 offen
 s_add_u32 s34, s34, s35
 s_waitcnt vmcnt(11)
 v_mfma_f32_16x16x32_bf16 v[224:227], v[200:203], v[48:51], v[224:227]
 ds_read_b128 v[188:191], v1 offset:37888
 buffer_load_dwordx4 v[76:79], v0, s[8:11], s16 offen offset:1024 sc1
 s_lshl_b32 s36, s59, 9
 s_add_u32 s35, s35, s36
 v_mfma_f32_16x16x32_bf16 v[228:231], v[204:207], v[48:51], v[228:231]
 s_lshl_b32 s36, s54, 7
 s_add_u32 s36, s36, 7737344
 s_lshl_b32 s21, s49, 2
 s_add_u32 s36, s36, s21
 v_mfma_f32_16x16x32_bf16 v[232:235], v[208:211], v[48:51], v[232:235]
 ds_read_b128 v[192:195], v1 offset:38912
 s_mul_i32 s24, s53, 196608
 s_add_u32 s24, s24, 18350080
 s_waitcnt vmcnt(10) lgkmcnt(2)
 v_mfma_f32_16x16x32_bf16 v[212:215], v[176:179], v[52:55], v[212:215]
 buffer_load_dwordx4 v[80:83], v0, s[8:11], s17 offen offset:1024 sc1
 s_mul_i32 s25, s3, 12288
 s_add_u32 s24, s24, s25
 s_lshr_b32 s26, s3, 1
 v_mfma_f32_16x16x32_bf16 v[216:219], v[180:183], v[52:55], v[216:219]
 ds_read_b128 v[196:199], v1 offset:39936
 s_mul_i32 s26, s26, 49152
 s_add_u32 s25, s24, 49152
 s_sub_u32 s25, s25, s26
 v_mfma_f32_16x16x32_bf16 v[220:223], v[184:187], v[52:55], v[220:223]
 s_add_u32 s24, s24, s26
 s_add_u32 s26, s24, 98304
 s_add_u32 s27, s25, 98304
 s_waitcnt vmcnt(8)
 v_mfma_f32_16x16x32_bf16 v[224:227], v[176:179], v[56:59], v[224:227]
 ds_read_b128 v[200:203], v1 offset:40960
 buffer_load_dwordx4 v[44:47], v0, s[8:11], s16 offen offset:2048 sc1
 s_mov_b32 s44, 0
 s_mov_b32 s45, 0xffff0000
 v_mfma_f32_16x16x32_bf16 v[228:231], v[180:183], v[56:59], v[228:231]
 v_mfma_f32_16x16x32_bf16 v[232:235], v[184:187], v[56:59], v[232:235]
 ds_read_b128 v[204:207], v1 offset:41984
 s_waitcnt vmcnt(7) lgkmcnt(2)
 v_mfma_f32_16x16x32_bf16 v[212:215], v[188:191], v[60:63], v[212:215]
 buffer_load_dwordx4 v[48:51], v0, s[8:11], s17 offen offset:2048 sc1
 v_mfma_f32_16x16x32_bf16 v[216:219], v[192:195], v[60:63], v[216:219]
 ds_read_b128 v[208:211], v1 offset:43008
 v_mfma_f32_16x16x32_bf16 v[220:223], v[196:199], v[60:63], v[220:223]
 s_waitcnt vmcnt(7)
 v_mfma_f32_16x16x32_bf16 v[224:227], v[188:191], v[64:67], v[224:227]
 ds_read_b128 v[176:179], v1 offset:44032
 buffer_load_dwordx4 v[52:55], v0, s[8:11], s16 offen offset:3072 sc1
 s_add_u32 s16, s16, 4096
 v_mfma_f32_16x16x32_bf16 v[228:231], v[192:195], v[64:67], v[228:231]
 v_mfma_f32_16x16x32_bf16 v[232:235], v[196:199], v[64:67], v[232:235]
 ds_read_b128 v[180:183], v1 offset:45056
 s_waitcnt vmcnt(7) lgkmcnt(2)
 v_mfma_f32_16x16x32_bf16 v[212:215], v[200:203], v[68:71], v[212:215]
 buffer_load_dwordx4 v[56:59], v0, s[8:11], s17 offen offset:3072 sc1
 s_add_u32 s17, s17, 4096
 v_mov_b32 v15, 6
 v_add_u32 v15, s52, v15
 s_waitcnt vmcnt(6)
 s_mov_b64 exec, 1
 buffer_store_dword v15, v0, s[4:7], s32 offen
 s_mov_b64 exec, -1
 v_mfma_f32_16x16x32_bf16 v[216:219], v[204:207], v[68:71], v[216:219]
 ds_read_b128 v[184:187], v1 offset:46080
 v_mfma_f32_16x16x32_bf16 v[220:223], v[208:211], v[68:71], v[220:223]
 v_mfma_f32_16x16x32_bf16 v[224:227], v[200:203], v[72:75], v[224:227]
 ds_read_b128 v[188:191], v1 offset:47104
 buffer_load_dwordx4 v[60:63], v0, s[8:11], s16 offen sc1
 v_mfma_f32_16x16x32_bf16 v[228:231], v[204:207], v[72:75], v[228:231]
 v_mfma_f32_16x16x32_bf16 v[232:235], v[208:211], v[72:75], v[232:235]
 ds_read_b128 v[192:195], v1 offset:48128
 s_waitcnt vmcnt(7) lgkmcnt(2)
 v_mfma_f32_16x16x32_bf16 v[212:215], v[176:179], v[76:79], v[212:215]
 buffer_load_dwordx4 v[64:67], v0, s[8:11], s17 offen sc1
 v_mfma_f32_16x16x32_bf16 v[216:219], v[180:183], v[76:79], v[216:219]
 ds_read_b128 v[196:199], v1 offset:49152
 v_mfma_f32_16x16x32_bf16 v[220:223], v[184:187], v[76:79], v[220:223]
 s_waitcnt vmcnt(7)
 v_mfma_f32_16x16x32_bf16 v[224:227], v[176:179], v[80:83], v[224:227]
 ds_read_b128 v[200:203], v1 offset:50176
 buffer_load_dwordx4 v[68:71], v0, s[8:11], s16 offen offset:1024 sc1
 v_mfma_f32_16x16x32_bf16 v[228:231], v[180:183], v[80:83], v[228:231]
 v_mfma_f32_16x16x32_bf16 v[232:235], v[184:187], v[80:83], v[232:235]
 ds_read_b128 v[204:207], v1 offset:51200
 s_waitcnt vmcnt(7) lgkmcnt(2)
 v_mfma_f32_16x16x32_bf16 v[212:215], v[188:191], v[44:47], v[212:215]
 buffer_load_dwordx4 v[72:75], v0, s[8:11], s17 offen offset:1024 sc1
 v_mfma_f32_16x16x32_bf16 v[216:219], v[192:195], v[44:47], v[216:219]
 ds_read_b128 v[208:211], v1 offset:52224
 v_mfma_f32_16x16x32_bf16 v[220:223], v[196:199], v[44:47], v[220:223]
 s_waitcnt vmcnt(7)
 v_mfma_f32_16x16x32_bf16 v[224:227], v[188:191], v[48:51], v[224:227]
 ds_read_b128 v[176:179], v1 offset:53248
 buffer_load_dwordx4 v[76:79], v0, s[8:11], s16 offen offset:2048 sc1
 v_mfma_f32_16x16x32_bf16 v[228:231], v[192:195], v[48:51], v[228:231]
 v_mfma_f32_16x16x32_bf16 v[232:235], v[196:199], v[48:51], v[232:235]
 ds_read_b128 v[180:183], v1 offset:54272
 s_waitcnt vmcnt(7) lgkmcnt(2)
 v_mfma_f32_16x16x32_bf16 v[212:215], v[200:203], v[52:55], v[212:215]
 buffer_load_dwordx4 v[80:83], v0, s[8:11], s17 offen offset:2048 sc1
 v_mfma_f32_16x16x32_bf16 v[216:219], v[204:207], v[52:55], v[216:219]
 ds_read_b128 v[184:187], v1 offset:55296
 v_mfma_f32_16x16x32_bf16 v[220:223], v[208:211], v[52:55], v[220:223]
 s_waitcnt vmcnt(7)
 v_mfma_f32_16x16x32_bf16 v[224:227], v[200:203], v[56:59], v[224:227]
 ds_read_b128 v[188:191], v1 offset:56320
 buffer_load_dwordx4 v[44:47], v0, s[8:11], s16 offen offset:3072 sc1
 s_add_u32 s16, s16, 4096
 v_mfma_f32_16x16x32_bf16 v[228:231], v[204:207], v[56:59], v[228:231]
 v_mfma_f32_16x16x32_bf16 v[232:235], v[208:211], v[56:59], v[232:235]
 ds_read_b128 v[192:195], v1 offset:57344
 s_waitcnt vmcnt(6) lgkmcnt(2)
 v_mfma_f32_16x16x32_bf16 v[212:215], v[176:179], v[60:63], v[212:215]
 buffer_load_dwordx4 v[48:51], v0, s[8:11], s17 offen offset:3072 sc1
 s_add_u32 s17, s17, 4096
 v_mfma_f32_16x16x32_bf16 v[216:219], v[180:183], v[60:63], v[216:219]
 ds_read_b128 v[196:199], v1 offset:58368
 v_mfma_f32_16x16x32_bf16 v[220:223], v[184:187], v[60:63], v[220:223]
 s_waitcnt vmcnt(6)
 v_mfma_f32_16x16x32_bf16 v[224:227], v[176:179], v[64:67], v[224:227]
 ds_read_b128 v[200:203], v1 offset:59392
 buffer_load_dwordx4 v[52:55], v0, s[8:11], s16 offen sc1
 v_mfma_f32_16x16x32_bf16 v[228:231], v[180:183], v[64:67], v[228:231]
 v_mfma_f32_16x16x32_bf16 v[232:235], v[184:187], v[64:67], v[232:235]
 ds_read_b128 v[204:207], v1 offset:60416
 s_waitcnt vmcnt(6) lgkmcnt(2)
 v_mfma_f32_16x16x32_bf16 v[212:215], v[188:191], v[68:71], v[212:215]
 buffer_load_dwordx4 v[56:59], v0, s[8:11], s17 offen sc1
 v_mfma_f32_16x16x32_bf16 v[216:219], v[192:195], v[68:71], v[216:219]
 ds_read_b128 v[208:211], v1 offset:61440
 v_mfma_f32_16x16x32_bf16 v[220:223], v[196:199], v[68:71], v[220:223]
 v_add_f32 v236, v236, v237
 v_add_f32 v240, v240, v241
 s_waitcnt vmcnt(6)
 v_mfma_f32_16x16x32_bf16 v[224:227], v[188:191], v[72:75], v[224:227]
 ds_read_b128 v[176:179], v1 offset:62464
 buffer_load_dwordx4 v[60:63], v0, s[8:11], s16 offen offset:1024 sc1
 v_add_f32 v236, v236, v238
 v_add_f32 v240, v240, v242
 v_mfma_f32_16x16x32_bf16 v[228:231], v[192:195], v[72:75], v[228:231]
 v_add_f32 v236, v236, v239
 v_add_f32 v240, v240, v243
 v_mfma_f32_16x16x32_bf16 v[232:235], v[196:199], v[72:75], v[232:235]
 ds_read_b128 v[180:183], v1 offset:63488
 v_permlane16_swap_b32 v236, v240
 s_waitcnt vmcnt(6) lgkmcnt(2)
 v_mfma_f32_16x16x32_bf16 v[212:215], v[200:203], v[76:79], v[212:215]
 s_add_u32 s56, s52, 6
 buffer_load_dword v12, v172, s[4:7], s33 offen sc1
 buffer_load_dwordx4 v[64:67], v0, s[8:11], s17 offen offset:1024 sc1
 v_mfma_f32_16x16x32_bf16 v[216:219], v[204:207], v[76:79], v[216:219]
 ds_read_b128 v[184:187], v1 offset:64512
 v_add_f32 v236, v236, v240
 v_mov_b32 v237, v236
 v_mfma_f32_16x16x32_bf16 v[220:223], v[208:211], v[76:79], v[220:223]
 s_nop 0
 v_permlane32_swap_b32 v236, v237
 s_waitcnt vmcnt(7)
 v_mfma_f32_16x16x32_bf16 v[224:227], v[200:203], v[80:83], v[224:227]
 ds_read_b128 v[188:191], v2
 buffer_load_dwordx4 v[68:71], v0, s[8:11], s16 offen offset:2048 sc1
 v_mul_f32 v236, 0xbacccccd, v236
 v_mul_f32 v237, 0x3acccccd, v237
 v_mfma_f32_16x16x32_bf16 v[228:231], v[204:207], v[80:83], v[228:231]
 v_fma_f32 v237, -v236, v236, v237
 v_max_f32 v237, 0, v237
 v_add_f32 v237, 0x3727c5ac, v237
 v_mfma_f32_16x16x32_bf16 v[232:235], v[208:211], v[80:83], v[232:235]
 ds_read_b128 v[192:195], v2 offset:1024
 v_rsq_f32 v238, v237
 s_waitcnt vmcnt(7) lgkmcnt(2)
 v_mfma_f32_16x16x32_bf16 v[212:215], v[176:179], v[44:47], v[212:215]
 buffer_load_dwordx4 v[72:75], v0, s[8:11], s17 offen offset:2048 sc1
 v_mul_f32 v237, v237, v238
 v_mov_b32 v240, v236
 v_mfma_f32_16x16x32_bf16 v[216:219], v[180:183], v[44:47], v[216:219]
 ds_read_b128 v[196:199], v2 offset:2048
 v_mov_b32 v241, v237
 v_mov_b32 v242, v238
 v_mfma_f32_16x16x32_bf16 v[220:223], v[184:187], v[44:47], v[220:223]
 v_permlane16_swap_b32 v236, v240
 s_waitcnt vmcnt(7)
 v_mfma_f32_16x16x32_bf16 v[224:227], v[176:179], v[48:51], v[224:227]
 ds_read_b128 v[200:203], v2 offset:3072
 buffer_load_dwordx4 v[76:79], v0, s[8:11], s16 offen offset:3072 sc1
 s_add_u32 s16, s16, 4096
 v_mfma_f32_16x16x32_bf16 v[228:231], v[180:183], v[48:51], v[228:231]
 v_permlane16_swap_b32 v237, v241
 v_mfma_f32_16x16x32_bf16 v[232:235], v[184:187], v[48:51], v[232:235]
 ds_read_b128 v[204:207], v2 offset:4096
 v_permlane16_swap_b32 v238, v242
 s_waitcnt vmcnt(7) lgkmcnt(2)
 v_mfma_f32_16x16x32_bf16 v[212:215], v[188:191], v[52:55], v[212:215]
 buffer_load_dwordx4 v[80:83], v0, s[8:11], s17 offen offset:3072 sc1
 s_add_u32 s17, s17, 4096
 v_cndmask_b32 v14, v236, v237, s[44:45]
 v_mfma_f32_16x16x32_bf16 v[216:219], v[192:195], v[52:55], v[216:219]
 ds_read_b128 v[208:211], v2 offset:5120
 v_cvt_pk_bf16_f32 v236, v14, v14
 v_lshlrev_b32 v239, 16, v236
 v_sub_f32 v239, v14, v239
 v_mfma_f32_16x16x32_bf16 v[220:223], v[196:199], v[52:55], v[220:223]
 s_waitcnt vmcnt(5)
 v_cmp_ne_u32 vcc, s56, v12
 s_cbranch_vccnz Lretry_28
Lback_29:
 v_mfma_f32_16x16x32_bf16 v[224:227], v[188:191], v[56:59], v[224:227]
 ds_read_b128 v[176:179], v2 offset:6144
 buffer_load_dwordx4 v[44:47], v0, s[8:11], s18 offen sc1
 v_cvt_pk_bf16_f32 v237, v239, v239
 v_cndmask_b32 v14, v240, v241, s[44:45]
 v_mfma_f32_16x16x32_bf16 v[228:231], v[192:195], v[56:59], v[228:231]
 v_cvt_pk_bf16_f32 v240, v14, v14
 v_lshlrev_b32 v243, 16, v240
 v_sub_f32 v243, v14, v243
 v_mfma_f32_16x16x32_bf16 v[232:235], v[196:199], v[56:59], v[232:235]
 ds_read_b128 v[180:183], v2 offset:7168
 v_cvt_pk_bf16_f32 v241, v243, v243
 s_waitcnt lgkmcnt(2)
 v_mfma_f32_16x16x32_bf16 v[212:215], v[200:203], v[60:63], v[212:215]
 buffer_load_dwordx4 v[48:51], v0, s[8:11], s19 offen sc1
 v_mfma_f32_16x16x32_bf16 v[216:219], v[204:207], v[60:63], v[216:219]
 ds_read_b128 v[184:187], v2 offset:8192
 v_mfma_f32_16x16x32_bf16 v[220:223], v[208:211], v[60:63], v[220:223]
 s_waitcnt vmcnt(6)
 v_mfma_f32_16x16x32_bf16 v[224:227], v[200:203], v[64:67], v[224:227]
 ds_read_b128 v[188:191], v2 offset:9216
 buffer_load_dwordx4 v[52:55], v0, s[8:11], s18 offen offset:1024 sc1
 v_mfma_f32_16x16x32_bf16 v[228:231], v[204:207], v[64:67], v[228:231]
 v_mfma_f32_16x16x32_bf16 v[232:235], v[208:211], v[64:67], v[232:235]
 ds_read_b128 v[192:195], v2 offset:10240
 s_waitcnt vmcnt(6) lgkmcnt(2)
 v_mfma_f32_16x16x32_bf16 v[212:215], v[176:179], v[68:71], v[212:215]
 buffer_load_dwordx4 v[56:59], v0, s[8:11], s19 offen offset:1024 sc1
 v_mfma_f32_16x16x32_bf16 v[216:219], v[180:183], v[68:71], v[216:219]
 ds_read_b128 v[196:199], v2 offset:11264
 v_mfma_f32_16x16x32_bf16 v[220:223], v[184:187], v[68:71], v[220:223]
 s_waitcnt vmcnt(6)
 v_mfma_f32_16x16x32_bf16 v[224:227], v[176:179], v[72:75], v[224:227]
 ds_read_b128 v[200:203], v1 offset:16384
 buffer_load_dwordx4 v[60:63], v0, s[8:11], s18 offen offset:2048 sc1
 v_mfma_f32_16x16x32_bf16 v[228:231], v[180:183], v[72:75], v[228:231]
 buffer_load_dwordx4 v[244:247], v0, s[4:7], s20 offen offset:2048 sc1
 v_mfma_f32_16x16x32_bf16 v[232:235], v[184:187], v[72:75], v[232:235]
 ds_read_b128 v[204:207], v1 offset:17408
 s_waitcnt vmcnt(7) lgkmcnt(2)
 v_mfma_f32_16x16x32_bf16 v[212:215], v[188:191], v[76:79], v[212:215]
 buffer_load_dwordx4 v[64:67], v0, s[8:11], s19 offen offset:2048 sc1
 v_mfma_f32_16x16x32_bf16 v[216:219], v[192:195], v[76:79], v[216:219]
 ds_read_b128 v[208:211], v1 offset:18432
 v_mfma_f32_16x16x32_bf16 v[220:223], v[196:199], v[76:79], v[220:223]
 s_waitcnt vmcnt(7)
 v_mfma_f32_16x16x32_bf16 v[224:227], v[188:191], v[80:83], v[224:227]
 ds_read_b128 v[176:179], v1 offset:19456
 buffer_load_dwordx4 v[68:71], v0, s[8:11], s18 offen offset:3072 sc1
 s_add_u32 s18, s18, 4096
 v_mfma_f32_16x16x32_bf16 v[228:231], v[192:195], v[80:83], v[228:231]
 buffer_load_dwordx4 v[248:251], v0, s[4:7], s20 offen offset:3072 sc1
 v_mfma_f32_16x16x32_bf16 v[232:235], v[196:199], v[80:83], v[232:235]
 ds_read_b128 v[180:183], v1 offset:20480
 s_waitcnt vmcnt(8) lgkmcnt(2)
 v_mfma_f32_16x16x32_bf16 v[144:147], v[200:203], v[44:47], 0
 buffer_load_dwordx4 v[72:75], v0, s[8:11], s19 offen offset:3072 sc1
 s_add_u32 s19, s19, 4096
 v_mfma_f32_16x16x32_bf16 v[148:151], v[204:207], v[44:47], 0
 ds_read_b128 v[184:187], v1 offset:21504
 v_mfma_f32_16x16x16_bf16 v[212:215], a[244:245], v[236:237], v[212:215]
 v_mfma_f32_16x16x16_bf16 v[216:219], a[246:247], v[236:237], v[216:219]
 v_mfma_f32_16x16x16_bf16 v[220:223], a[248:249], v[236:237], v[220:223]
 v_mfma_f32_16x16x32_bf16 v[152:155], v[208:211], v[44:47], 0
 v_mfma_f32_16x16x16_bf16 v[224:227], a[244:245], v[240:241], v[224:227]
 v_mfma_f32_16x16x16_bf16 v[228:231], a[246:247], v[240:241], v[228:231]
 v_mfma_f32_16x16x16_bf16 v[232:235], a[248:249], v[240:241], v[232:235]
 s_waitcnt vmcnt(8)
 v_mfma_f32_16x16x32_bf16 v[156:159], v[200:203], v[48:51], 0
 ds_read_b128 v[188:191], v1 offset:22528
 buffer_load_dwordx4 v[76:79], v0, s[8:11], s18 offen sc1
 v_mfma_f32_16x16x32_bf16 v[160:163], v[204:207], v[48:51], 0
 v_mfma_f32_16x16x32_bf16 v[164:167], v[208:211], v[48:51], 0
 ds_read_b128 v[192:195], v1 offset:23552
 v_mul_f32 v212, v212, v238
 v_mul_f32 v212, v212, abs(v212)
 v_mul_f32 v213, v213, v238
 s_waitcnt vmcnt(8) lgkmcnt(2)
 v_mfma_f32_16x16x32_bf16 v[144:147], v[176:179], v[52:55], v[144:147]
 buffer_load_dwordx4 v[80:83], v0, s[8:11], s19 offen sc1
 v_mul_f32 v213, v213, abs(v213)
 v_cvt_pk_bf16_f32 v124, v212, v213
 v_pk_max_i16 v124, v124, 0
 v_mfma_f32_16x16x32_bf16 v[148:151], v[180:183], v[52:55], v[148:151]
 ds_read_b128 v[196:199], v1 offset:24576
 v_mul_f32 v214, v214, v238
 v_mul_f32 v214, v214, abs(v214)
 v_mul_f32 v215, v215, v238
 v_mul_f32 v215, v215, abs(v215)
 v_mfma_f32_16x16x32_bf16 v[152:155], v[184:187], v[52:55], v[152:155]
 v_cvt_pk_bf16_f32 v125, v214, v215
 v_pk_max_i16 v125, v125, 0
 v_mul_f32 v216, v216, v238
 v_mul_f32 v216, v216, abs(v216)
 s_waitcnt vmcnt(8)
 v_mfma_f32_16x16x32_bf16 v[156:159], v[176:179], v[56:59], v[156:159]
 ds_read_b128 v[200:203], v1 offset:25600
 buffer_load_dwordx4 v[44:47], v0, s[8:11], s18 offen offset:1024 sc1
 v_mul_f32 v217, v217, v238
 v_mul_f32 v217, v217, abs(v217)
 v_cvt_pk_bf16_f32 v126, v216, v217
 v_mfma_f32_16x16x32_bf16 v[160:163], v[180:183], v[56:59], v[160:163]
 v_pk_max_i16 v126, v126, 0
 v_mul_f32 v218, v218, v238
 v_mul_f32 v218, v218, abs(v218)
 v_mul_f32 v219, v219, v238
 v_mul_f32 v219, v219, abs(v219)
 v_mfma_f32_16x16x32_bf16 v[164:167], v[184:187], v[56:59], v[164:167]
 ds_read_b128 v[204:207], v1 offset:26624
 v_cvt_pk_bf16_f32 v127, v218, v219
 v_pk_max_i16 v127, v127, 0
 s_waitcnt vmcnt(8) lgkmcnt(2)
 v_mfma_f32_16x16x32_bf16 v[144:147], v[188:191], v[60:63], v[144:147]
 buffer_load_dwordx4 v[48:51], v0, s[8:11], s19 offen offset:1024 sc1
 v_mfma_f32_16x16x32_bf16 v[148:151], v[192:195], v[60:63], v[148:151]
 ds_read_b128 v[208:211], v1 offset:27648
 v_mfma_f32_16x16x32_bf16 v[152:155], v[196:199], v[60:63], v[152:155]
 s_waitcnt vmcnt(7)
 v_mfma_f32_16x16x32_bf16 v[156:159], v[188:191], v[64:67], v[156:159]
 ds_read_b128 v[176:179], v1 offset:28672
 buffer_load_dwordx4 v[52:55], v0, s[8:11], s18 offen offset:2048 sc1
 v_mfma_f32_16x16x32_bf16 v[160:163], v[192:195], v[64:67], v[160:163]
 buffer_store_dwordx4 v[124:127], v0, s[4:7], s34 offen
 v_mfma_f32_16x16x32_bf16 v[164:167], v[196:199], v[64:67], v[164:167]
 ds_read_b128 v[180:183], v1 offset:29696
 s_add_u32 s34, s34, 49152
 v_mul_f32 v220, v220, v238
 v_mul_f32 v220, v220, abs(v220)
 s_waitcnt vmcnt(8) lgkmcnt(2)
 v_mfma_f32_16x16x32_bf16 v[144:147], v[200:203], v[68:71], v[144:147]
 buffer_load_dwordx4 v[56:59], v0, s[8:11], s19 offen offset:2048 sc1
 v_mul_f32 v221, v221, v238
 v_mul_f32 v221, v221, abs(v221)
 v_cvt_pk_bf16_f32 v132, v220, v221
 v_pk_max_i16 v132, v132, 0
 v_mfma_f32_16x16x32_bf16 v[148:151], v[204:207], v[68:71], v[148:151]
 ds_read_b128 v[184:187], v1 offset:30720
 v_mul_f32 v222, v222, v238
 v_mul_f32 v222, v222, abs(v222)
 v_mul_f32 v223, v223, v238
 v_mul_f32 v223, v223, abs(v223)
 v_mfma_f32_16x16x32_bf16 v[152:155], v[208:211], v[68:71], v[152:155]
 v_cvt_pk_bf16_f32 v133, v222, v223
 v_pk_max_i16 v133, v133, 0
 v_mul_f32 v224, v224, v242
 v_mul_f32 v224, v224, abs(v224)
 s_waitcnt vmcnt(7)
 v_mfma_f32_16x16x32_bf16 v[156:159], v[200:203], v[72:75], v[156:159]
 ds_read_b128 v[188:191], v1 offset:31744
 buffer_load_dwordx4 v[60:63], v0, s[8:11], s18 offen offset:3072 sc1
 s_add_u32 s18, s18, 4096
 v_mul_f32 v225, v225, v242
 v_mul_f32 v225, v225, abs(v225)
 v_mfma_f32_16x16x32_bf16 v[160:163], v[204:207], v[72:75], v[160:163]
 v_cvt_pk_bf16_f32 v128, v224, v225
 v_pk_max_i16 v128, v128, 0
 v_mul_f32 v226, v226, v242
 v_mul_f32 v226, v226, abs(v226)
 v_mfma_f32_16x16x32_bf16 v[164:167], v[208:211], v[72:75], v[164:167]
 ds_read_b128 v[192:195], v1 offset:32768
 v_mul_f32 v227, v227, v242
 v_mul_f32 v227, v227, abs(v227)
 v_cvt_pk_bf16_f32 v129, v226, v227
 s_waitcnt vmcnt(7) lgkmcnt(2)
 v_mfma_f32_16x16x32_bf16 v[144:147], v[176:179], v[76:79], v[144:147]
 buffer_load_dwordx4 v[64:67], v0, s[8:11], s19 offen offset:3072 sc1
 s_add_u32 s19, s19, 4096
 v_pk_max_i16 v129, v129, 0
 v_mul_f32 v228, v228, v242
 v_mul_f32 v228, v228, abs(v228)
 v_mfma_f32_16x16x32_bf16 v[148:151], v[180:183], v[76:79], v[148:151]
 ds_read_b128 v[196:199], v1 offset:33792
 v_mul_f32 v229, v229, v242
 v_mul_f32 v229, v229, abs(v229)
 v_cvt_pk_bf16_f32 v130, v228, v229
 v_pk_max_i16 v130, v130, 0
 v_mfma_f32_16x16x32_bf16 v[152:155], v[184:187], v[76:79], v[152:155]
 v_mul_f32 v230, v230, v242
 v_mul_f32 v230, v230, abs(v230)
 v_mul_f32 v231, v231, v242
 v_mul_f32 v231, v231, abs(v231)
 s_waitcnt vmcnt(7)
 v_mfma_f32_16x16x32_bf16 v[156:159], v[176:179], v[80:83], v[156:159]
 ds_read_b128 v[200:203], v1 offset:34816
 buffer_load_dwordx4 v[68:71], v0, s[8:11], s18 offen sc1
 v_cvt_pk_bf16_f32 v131, v230, v231
 v_pk_max_i16 v131, v131, 0
 v_mfma_f32_16x16x32_bf16 v[160:163], v[180:183], v[80:83], v[160:163]
 buffer_store_dwordx4 v[128:131], v0, s[4:7], s34 offen
 v_mfma_f32_16x16x32_bf16 v[164:167], v[184:187], v[80:83], v[164:167]
 ds_read_b128 v[204:207], v1 offset:35840
 s_add_u32 s34, s34, 49152
 v_mul_f32 v232, v232, v242
 v_mul_f32 v232, v232, abs(v232)
 s_waitcnt vmcnt(8) lgkmcnt(2)
 v_mfma_f32_16x16x32_bf16 v[144:147], v[188:191], v[44:47], v[144:147]
 buffer_load_dwordx4 v[72:75], v0, s[8:11], s19 offen sc1
 v_mul_f32 v233, v233, v242
 v_mul_f32 v233, v233, abs(v233)
 v_cvt_pk_bf16_f32 v134, v232, v233
 v_mfma_f32_16x16x32_bf16 v[148:151], v[192:195], v[44:47], v[148:151]
 ds_read_b128 v[208:211], v1 offset:36864
 v_pk_max_i16 v134, v134, 0
 v_mul_f32 v234, v234, v242
 v_mul_f32 v234, v234, abs(v234)
 v_mul_f32 v235, v235, v242
 v_mfma_f32_16x16x32_bf16 v[152:155], v[196:199], v[44:47], v[152:155]
 v_mul_f32 v235, v235, abs(v235)
 v_cvt_pk_bf16_f32 v135, v234, v235
 v_pk_max_i16 v135, v135, 0
 s_waitcnt vmcnt(8)
 v_mfma_f32_16x16x32_bf16 v[156:159], v[188:191], v[48:51], v[156:159]
 ds_read_b128 v[176:179], v1 offset:37888
 buffer_load_dwordx4 v[76:79], v0, s[8:11], s18 offen offset:1024 sc1
 v_permlane16_swap_b32 v132, v134
 v_mfma_f32_16x16x32_bf16 v[160:163], v[192:195], v[48:51], v[160:163]
 v_permlane16_swap_b32 v133, v135
 v_mfma_f32_16x16x32_bf16 v[164:167], v[196:199], v[48:51], v[164:167]
 ds_read_b128 v[180:183], v1 offset:38912
 s_waitcnt vmcnt(8) lgkmcnt(2)
 v_mfma_f32_16x16x32_bf16 v[144:147], v[200:203], v[52:55], v[144:147]
 buffer_load_dwordx4 v[80:83], v0, s[8:11], s19 offen offset:1024 sc1
 v_mfma_f32_16x16x32_bf16 v[148:151], v[204:207], v[52:55], v[148:151]
 ds_read_b128 v[184:187], v1 offset:39936
 v_mfma_f32_16x16x32_bf16 v[152:155], v[208:211], v[52:55], v[152:155]
 s_waitcnt vmcnt(7)
 v_mfma_f32_16x16x32_bf16 v[156:159], v[200:203], v[56:59], v[156:159]
 ds_read_b128 v[188:191], v1 offset:40960
 buffer_load_dwordx4 v[44:47], v0, s[8:11], s18 offen offset:2048 sc1
 v_mfma_f32_16x16x32_bf16 v[160:163], v[204:207], v[56:59], v[160:163]
 buffer_store_dwordx4 v[132:135], v7, s[4:7], s35 offen offset:1024
 v_mfma_f32_16x16x32_bf16 v[164:167], v[208:211], v[56:59], v[164:167]
 ds_read_b128 v[192:195], v1 offset:41984
 s_add_u32 s35, s35, 98304
 s_waitcnt vmcnt(8) lgkmcnt(2)
 v_mfma_f32_16x16x32_bf16 v[144:147], v[176:179], v[60:63], v[144:147]
 buffer_load_dwordx4 v[48:51], v0, s[8:11], s19 offen offset:2048 sc1
 v_mfma_f32_16x16x32_bf16 v[148:151], v[180:183], v[60:63], v[148:151]
 ds_read_b128 v[196:199], v1 offset:43008
 v_mfma_f32_16x16x32_bf16 v[152:155], v[184:187], v[60:63], v[152:155]
 s_waitcnt vmcnt(8)
 v_mfma_f32_16x16x32_bf16 v[156:159], v[176:179], v[64:67], v[156:159]
 ds_read_b128 v[200:203], v1 offset:44032
 buffer_load_dwordx4 v[52:55], v0, s[8:11], s18 offen offset:3072 sc1
 s_add_u32 s18, s18, 4096
 s_lshl_b32 s21, s57, 6
 v_mfma_f32_16x16x32_bf16 v[160:163], v[180:183], v[64:67], v[160:163]
 s_lshl_b32 s22, s58, 1
 s_add_u32 s22, s22, s59
 s_lshl_b32 s22, s22, 5
 v_mfma_f32_16x16x32_bf16 v[164:167], v[184:187], v[64:67], v[164:167]
 ds_read_b128 v[204:207], v1 offset:45056
 v_bfe_u32 v252, v0, 4, 3
 v_mul_u32_u24 v252, 0, v252
 s_waitcnt vmcnt(8) lgkmcnt(2)
 v_mfma_f32_16x16x32_bf16 v[144:147], v[188:191], v[68:71], v[144:147]
 buffer_load_dwordx4 v[56:59], v0, s[8:11], s19 offen offset:3072 sc1
 s_add_u32 s19, s19, 4096
 v_bfe_u32 v14, v0, 7, 1
 v_mfma_f32_16x16x32_bf16 v[148:151], v[192:195], v[68:71], v[148:151]
 ds_read_b128 v[208:211], v1 offset:46080
 v_lshl_add_u32 v252, v14, 6, v252
 v_bfe_u32 v14, v0, 8, 2
 v_lshl_add_u32 v252, v14, 4, v252
 v_mfma_f32_16x16x32_bf16 v[152:155], v[196:199], v[68:71], v[152:155]
 v_bfe_u32 v173, v0, 4, 3
 v_mul_u32_u24 v173, 0, v173
 s_waitcnt vmcnt(7)
 v_mfma_f32_16x16x32_bf16 v[156:159], v[188:191], v[72:75], v[156:159]
 ds_read_b128 v[176:179], v1 offset:47104
 buffer_load_dwordx4 v[60:63], v0, s[8:11], s18 offen sc1
 v_bfe_u32 v14, v0, 7, 1
 v_lshl_add_u32 v173, v14, 2, v173
 v_mfma_f32_16x16x32_bf16 v[160:163], v[192:195], v[72:75], v[160:163]
 v_bfe_u32 v14, v0, 8, 2
 v_lshl_add_u32 v173, v14, 3, v173
 buffer_load_dwordx4 v[252:255], v252, s[12:15], s21 offen
 v_mfma_f32_16x16x32_bf16 v[164:167], v[196:199], v[72:75], v[164:167]
 ds_read_b128 v[180:183], v1 offset:48128
 buffer_load_dword v173, v173, s[12:15], s22 offen
 v_add_f32 v244, v244, v245
 s_waitcnt vmcnt(9) lgkmcnt(2)
 v_mfma_f32_16x16x32_bf16 v[144:147], v[200:203], v[76:79], v[144:147]
 buffer_load_dwordx4 v[64:67], v0, s[8:11], s19 offen sc1
 v_add_f32 v248, v248, v249
 v_add_f32 v244, v244, v246
 v_mfma_f32_16x16x32_bf16 v[148:151], v[204:207], v[76:79], v[148:151]
 ds_read_b128 v[184:187], v1 offset:49152
 v_add_f32 v248, v248, v250
 v_add_f32 v244, v244, v247
 v_add_f32 v248, v248, v251
 v_mfma_f32_16x16x32_bf16 v[152:155], v[208:211], v[76:79], v[152:155]
 s_nop 0
 v_permlane16_swap_b32 v244, v248
 s_waitcnt vmcnt(9)
 v_mfma_f32_16x16x32_bf16 v[156:159], v[200:203], v[80:83], v[156:159]
 ds_read_b128 v[188:191], v1 offset:50176
 buffer_load_dwordx4 v[68:71], v0, s[8:11], s18 offen offset:1024 sc1
 v_add_f32 v244, v244, v248
 v_mov_b32 v245, v244
 v_mfma_f32_16x16x32_bf16 v[160:163], v[204:207], v[80:83], v[160:163]
 s_nop 0
 v_permlane32_swap_b32 v244, v245
 v_mul_f32 v244, 0xbacccccd, v244
 v_mfma_f32_16x16x32_bf16 v[164:167], v[208:211], v[80:83], v[164:167]
 ds_read_b128 v[192:195], v1 offset:51200
 v_mul_f32 v245, 0x3acccccd, v245
 v_fma_f32 v245, -v244, v244, v245
 s_waitcnt vmcnt(9) lgkmcnt(2)
 v_mfma_f32_16x16x32_bf16 v[144:147], v[176:179], v[44:47], v[144:147]
 buffer_load_dwordx4 v[72:75], v0, s[8:11], s19 offen offset:1024 sc1
 v_mov_b32 v15, 7
 v_add_u32 v15, s52, v15
 s_waitcnt vmcnt(9)
 s_mov_b64 exec, 1
 buffer_store_dword v15, v0, s[4:7], s36 offen
 s_mov_b64 exec, -1
 s_add_u32 s36, s36, 4096
 v_mfma_f32_16x16x32_bf16 v[148:151], v[180:183], v[44:47], v[148:151]
 ds_read_b128 v[196:199], v1 offset:52224
 v_max_f32 v245, 0, v245
 v_add_f32 v245, 0x3727c5ac, v245
 v_mfma_f32_16x16x32_bf16 v[152:155], v[184:187], v[44:47], v[152:155]
 v_rsq_f32 v246, v245
 s_waitcnt vmcnt(9)
 v_mfma_f32_16x16x32_bf16 v[156:159], v[176:179], v[48:51], v[156:159]
 ds_read_b128 v[200:203], v1 offset:53248
 buffer_load_dwordx4 v[76:79], v0, s[8:11], s18 offen offset:2048 sc1
 v_mul_f32 v245, v245, v246
 v_mov_b32 v248, v244
 v_mfma_f32_16x16x32_bf16 v[160:163], v[180:183], v[48:51], v[160:163]
 v_mov_b32 v249, v245
 v_mov_b32 v250, v246
 v_mfma_f32_16x16x32_bf16 v[164:167], v[184:187], v[48:51], v[164:167]
 ds_read_b128 v[204:207], v1 offset:54272
 v_permlane16_swap_b32 v244, v248
 s_waitcnt vmcnt(9) lgkmcnt(2)
 v_mfma_f32_16x16x32_bf16 v[144:147], v[188:191], v[52:55], v[144:147]
 buffer_load_dwordx4 v[80:83], v0, s[8:11], s19 offen offset:2048 sc1
 v_permlane16_swap_b32 v245, v249
 v_mfma_f32_16x16x32_bf16 v[148:151], v[192:195], v[52:55], v[148:151]
 ds_read_b128 v[208:211], v1 offset:55296
 v_permlane16_swap_b32 v246, v250
 v_cndmask_b32 v14, v244, v245, s[44:45]
 v_mfma_f32_16x16x32_bf16 v[152:155], v[196:199], v[52:55], v[152:155]
 v_cvt_pk_bf16_f32 v244, v14, v14
 v_lshlrev_b32 v247, 16, v244
 s_waitcnt vmcnt(9)
 v_mfma_f32_16x16x32_bf16 v[156:159], v[188:191], v[56:59], v[156:159]
 ds_read_b128 v[176:179], v1 offset:56320
 buffer_load_dwordx4 v[44:47], v0, s[8:11], s18 offen offset:3072 sc1
 s_add_u32 s18, s18, 4096
 v_sub_f32 v247, v14, v247
 v_mfma_f32_16x16x32_bf16 v[160:163], v[192:195], v[56:59], v[160:163]
 v_cvt_pk_bf16_f32 v245, v247, v247
 v_cndmask_b32 v14, v248, v249, s[44:45]
 v_cvt_pk_bf16_f32 v248, v14, v14
 v_mfma_f32_16x16x32_bf16 v[164:167], v[196:199], v[56:59], v[164:167]
 ds_read_b128 v[180:183], v1 offset:57344
 v_lshlrev_b32 v251, 16, v248
 v_sub_f32 v251, v14, v251
 s_waitcnt vmcnt(9) lgkmcnt(2)
 v_mfma_f32_16x16x32_bf16 v[144:147], v[200:203], v[60:63], v[144:147]
 buffer_load_dwordx4 v[48:51], v0, s[8:11], s19 offen offset:3072 sc1
 s_add_u32 s19, s19, 4096
 v_cvt_pk_bf16_f32 v249, v251, v251
 v_mfma_f32_16x16x32_bf16 v[148:151], v[204:207], v[60:63], v[148:151]
 ds_read_b128 v[184:187], v1 offset:58368
 s_mul_i32 s29, s53, 81920
 s_lshl_b32 s30, s58, 1
 s_add_u32 s30, s30, s59
 v_mfma_f32_16x16x32_bf16 v[152:155], v[208:211], v[60:63], v[152:155]
 s_mul_i32 s62, s3, 10240
 v_bfe_u32 v168, v0, 4, 3
 s_waitcnt vmcnt(7)
 v_mfma_f32_16x16x32_bf16 v[156:159], v[200:203], v[64:67], v[156:159]
 ds_read_b128 v[188:191], v1 offset:59392
 buffer_load_dwordx4 v[52:55], v0, s[8:11], s18 offen sc1
 v_mul_u32_u24 v168, 1280, v168
 v_bfe_u32 v14, v0, 7, 1
 v_mfma_f32_16x16x32_bf16 v[160:163], v[204:207], v[64:67], v[160:163]
 v_lshl_add_u32 v168, v14, 6, v168
 v_bfe_u32 v14, v0, 8, 2
 v_lshl_add_u32 v168, v14, 4, v168
 v_mfma_f32_16x16x32_bf16 v[164:167], v[208:211], v[64:67], v[164:167]
 ds_read_b128 v[192:195], v1 offset:60416
 v_bfe_u32 v169, v0, 4, 3
 v_mul_u32_u24 v169, 1280, v169
 s_waitcnt vmcnt(7) lgkmcnt(2)
 v_mfma_f32_16x16x32_bf16 v[144:147], v[176:179], v[68:71], v[144:147]
 buffer_load_dwordx4 v[56:59], v0, s[8:11], s19 offen sc1
 v_bfe_u32 v14, v0, 7, 1
 v_lshl_add_u32 v169, v14, 2, v169
 v_mfma_f32_16x16x32_bf16 v[148:151], v[180:183], v[68:71], v[148:151]
 ds_read_b128 v[196:199], v1 offset:61440
 v_bfe_u32 v14, v0, 8, 2
 v_lshl_add_u32 v169, v14, 3, v169
 s_add_u32 s29, s29, s62
 v_mfma_f32_16x16x32_bf16 v[152:155], v[184:187], v[68:71], v[152:155]
 s_add_u32 s56, s52, 7
 buffer_load_dword v12, v171, s[4:7], s28 offen sc1
 s_waitcnt vmcnt(8)
 v_mfma_f32_16x16x32_bf16 v[156:159], v[176:179], v[72:75], v[156:159]
 ds_read_b128 v[200:203], v1 offset:62464
 buffer_load_dwordx4 v[60:63], v0, s[8:11], s18 offen offset:1024 sc1
 s_lshl_b32 s30, s30, 5
 s_add_u32 s30, s30, s29
 v_mfma_f32_16x16x32_bf16 v[160:163], v[180:183], v[72:75], v[160:163]
 s_lshl_b32 s62, s57, 6
 s_add_u32 s29, s29, s62
 v_lshlrev_b32 v14, 16, v252
 v_mfma_f32_16x16x32_bf16 v[164:167], v[184:187], v[72:75], v[164:167]
 ds_read_b128 v[204:207], v1 offset:63488
 v_add_f32 v16, v16, v14
 v_add_f32 v26, v26, v14
 s_waitcnt vmcnt(7) lgkmcnt(2)
 v_mfma_f32_16x16x32_bf16 v[144:147], v[188:191], v[76:79], v[144:147]
 buffer_load_dwordx4 v[64:67], v0, s[8:11], s19 offen offset:1024 sc1
 v_and_b32 v14, 0xffff0000, v252
 v_add_f32 v17, v17, v14
 v_mfma_f32_16x16x32_bf16 v[148:151], v[192:195], v[76:79], v[148:151]
 ds_read_b128 v[208:211], v1 offset:64512
 v_add_f32 v27, v27, v14
 v_lshlrev_b32 v14, 16, v253
 v_add_f32 v18, v18, v14
 v_mfma_f32_16x16x32_bf16 v[152:155], v[196:199], v[76:79], v[152:155]
 v_add_f32 v28, v28, v14
 v_and_b32 v14, 0xffff0000, v253
 s_waitcnt vmcnt(7)
 v_mfma_f32_16x16x32_bf16 v[156:159], v[188:191], v[80:83], v[156:159]
 ds_read_b128 v[176:179], v2
 buffer_load_dwordx4 v[68:71], v0, s[8:11], s18 offen offset:2048 sc1
 v_add_f32 v19, v19, v14
 v_add_f32 v29, v29, v14
 v_mfma_f32_16x16x32_bf16 v[160:163], v[192:195], v[80:83], v[160:163]
 v_lshlrev_b32 v14, 16, v254
 v_add_f32 v20, v20, v14
 v_add_f32 v30, v30, v14
 v_mfma_f32_16x16x32_bf16 v[164:167], v[196:199], v[80:83], v[164:167]
 ds_read_b128 v[180:183], v2 offset:1024
 v_and_b32 v14, 0xffff0000, v254
 v_add_f32 v21, v21, v14
 s_waitcnt vmcnt(7) lgkmcnt(2)
 v_mfma_f32_16x16x32_bf16 v[144:147], v[200:203], v[44:47], v[144:147]
 buffer_load_dwordx4 v[72:75], v0, s[8:11], s19 offen offset:2048 sc1
 v_add_f32 v31, v31, v14
 v_lshlrev_b32 v14, 16, v255
 v_mfma_f32_16x16x32_bf16 v[148:151], v[204:207], v[44:47], v[148:151]
 ds_read_b128 v[184:187], v2 offset:2048
 v_add_f32 v22, v22, v14
 v_add_f32 v32, v32, v14
 v_and_b32 v14, 0xffff0000, v255
 v_mfma_f32_16x16x32_bf16 v[152:155], v[208:211], v[44:47], v[152:155]
 v_add_f32 v23, v23, v14
 v_add_f32 v33, v33, v14
 s_waitcnt vmcnt(7)
 v_mfma_f32_16x16x32_bf16 v[156:159], v[200:203], v[48:51], v[156:159]
 ds_read_b128 v[188:191], v2 offset:3072
 buffer_load_dwordx4 v[76:79], v0, s[8:11], s18 offen offset:3072 sc1
 s_add_u32 s18, s18, 4096
 v_lshlrev_b32 v14, 16, v173
 v_mfma_f32_16x16x32_bf16 v[160:163], v[204:207], v[48:51], v[160:163]
 v_add_f32 v24, v24, v14
 v_add_f32 v34, v34, v14
 v_and_b32 v14, 0xffff0000, v173
 v_mfma_f32_16x16x32_bf16 v[164:167], v[208:211], v[48:51], v[164:167]
 ds_read_b128 v[192:195], v2 offset:4096
 v_add_f32 v25, v25, v14
 v_add_f32 v35, v35, v14
 s_waitcnt vmcnt(7) lgkmcnt(2)
 v_mfma_f32_16x16x32_bf16 v[144:147], v[176:179], v[52:55], v[144:147]
 buffer_load_dwordx4 v[80:83], v0, s[8:11], s19 offen offset:3072 sc1
 s_add_u32 s19, s19, 4096
 v_mfma_f32_16x16x32_bf16 v[148:151], v[180:183], v[52:55], v[148:151]
 ds_read_b128 v[196:199], v2 offset:5120
 v_mfma_f32_16x16x32_bf16 v[152:155], v[184:187], v[52:55], v[152:155]
 s_waitcnt vmcnt(6)
 v_cmp_ne_u32 vcc, s56, v12
 s_cbranch_vccnz Lretry_31
Lback_32:
 s_add_u32 s28, s28, 4096
 v_mfma_f32_16x16x32_bf16 v[156:159], v[176:179], v[56:59], v[156:159]
 ds_read_b128 v[200:203], v2 offset:6144
 buffer_load_dwordx4 v[44:47], v0, s[4:7], s24 offen sc1
 v_mfma_f32_16x16x32_bf16 v[160:163], v[180:183], v[56:59], v[160:163]
 v_mfma_f32_16x16x32_bf16 v[164:167], v[184:187], v[56:59], v[164:167]
 ds_read_b128 v[204:207], v2 offset:7168
 s_waitcnt vmcnt(6) lgkmcnt(2)
 v_mfma_f32_16x16x32_bf16 v[144:147], v[188:191], v[60:63], v[144:147]
 buffer_load_dwordx4 v[48:51], v0, s[4:7], s24 offen offset:1024 sc1
 v_mfma_f32_16x16x32_bf16 v[148:151], v[192:195], v[60:63], v[148:151]
 ds_read_b128 v[208:211], v2 offset:8192
 v_mfma_f32_16x16x32_bf16 v[152:155], v[196:199], v[60:63], v[152:155]
 s_waitcnt vmcnt(6)
 v_mfma_f32_16x16x32_bf16 v[156:159], v[188:191], v[64:67], v[156:159]
 ds_read_b128 v[176:179], v2 offset:9216
 buffer_load_dwordx4 v[52:55], v0, s[4:7], s24 offen offset:2048 sc1
 v_mfma_f32_16x16x32_bf16 v[160:163], v[192:195], v[64:67], v[160:163]
 v_mfma_f32_16x16x32_bf16 v[164:167], v[196:199], v[64:67], v[164:167]
 ds_read_b128 v[180:183], v2 offset:10240
 s_waitcnt vmcnt(6) lgkmcnt(2)
 v_mfma_f32_16x16x32_bf16 v[144:147], v[200:203], v[68:71], v[144:147]
 buffer_load_dwordx4 v[56:59], v0, s[4:7], s24 offen offset:3072 sc1
 s_add_u32 s24, s24, 4096
 v_mfma_f32_16x16x32_bf16 v[148:151], v[204:207], v[68:71], v[148:151]
 ds_read_b128 v[184:187], v2 offset:11264
 v_mfma_f32_16x16x32_bf16 v[152:155], v[208:211], v[68:71], v[152:155]
 s_waitcnt vmcnt(6)
 v_mfma_f32_16x16x32_bf16 v[156:159], v[200:203], v[72:75], v[156:159]
 buffer_load_dwordx4 v[60:63], v0, s[4:7], s24 offen sc1
 v_mfma_f32_16x16x32_bf16 v[160:163], v[204:207], v[72:75], v[160:163]
 v_mfma_f32_16x16x32_bf16 v[164:167], v[208:211], v[72:75], v[164:167]
 s_waitcnt vmcnt(6) lgkmcnt(0)
 v_mfma_f32_16x16x32_bf16 v[144:147], v[176:179], v[76:79], v[144:147]
 buffer_load_dwordx4 v[64:67], v0, s[4:7], s24 offen offset:1024 sc1
 v_mfma_f32_16x16x32_bf16 v[148:151], v[180:183], v[76:79], v[148:151]
 v_mfma_f32_16x16x32_bf16 v[152:155], v[184:187], v[76:79], v[152:155]
 s_waitcnt vmcnt(6)
 v_mfma_f32_16x16x32_bf16 v[156:159], v[176:179], v[80:83], v[156:159]
 buffer_load_dwordx4 v[68:71], v0, s[4:7], s24 offen offset:2048 sc1
 v_mfma_f32_16x16x32_bf16 v[160:163], v[180:183], v[80:83], v[160:163]
 v_mfma_f32_16x16x32_bf16 v[164:167], v[184:187], v[80:83], v[164:167]
 s_waitcnt vmcnt(6)
 v_mfma_f32_16x16x32_bf16 v[84:87], a[0:3], v[44:47], 0
 buffer_load_dwordx4 v[72:75], v0, s[4:7], s24 offen offset:3072 sc1
 s_add_u32 s24, s24, 4096
 v_mfma_f32_16x16x16_bf16 v[144:147], a[244:245], v[244:245], v[144:147]
 v_mfma_f32_16x16x16_bf16 v[148:151], a[246:247], v[244:245], v[148:151]
 v_mfma_f32_16x16x16_bf16 v[152:155], a[248:249], v[244:245], v[152:155]
 v_mfma_f32_16x16x32_bf16 v[88:91], a[4:7], v[44:47], 0
 v_mfma_f32_16x16x16_bf16 v[156:159], a[244:245], v[248:249], v[156:159]
 v_mfma_f32_16x16x16_bf16 v[160:163], a[246:247], v[248:249], v[160:163]
 v_mfma_f32_16x16x16_bf16 v[164:167], a[248:249], v[248:249], v[164:167]
 v_mfma_f32_16x16x32_bf16 v[92:95], a[8:11], v[44:47], 0
 v_mfma_f32_16x16x32_bf16 v[96:99], a[12:15], v[44:47], 0
 v_mfma_f32_16x16x32_bf16 v[100:103], a[16:19], v[44:47], 0
 v_mul_f32 v144, v144, v246
 s_waitcnt vmcnt(6)
 v_mfma_f32_16x16x32_bf16 v[84:87], a[20:23], v[48:51], v[84:87]
 buffer_load_dwordx4 v[76:79], v0, s[4:7], s24 offen sc1
 v_mul_f32 v144, v144, abs(v144)
 v_mul_f32 v145, v145, v246
 v_mfma_f32_16x16x32_bf16 v[88:91], a[24:27], v[48:51], v[88:91]
 v_mul_f32 v145, v145, abs(v145)
 v_cvt_pk_bf16_f32 v124, v144, v145
 v_mfma_f32_16x16x32_bf16 v[92:95], a[28:31], v[48:51], v[92:95]
 v_pk_max_i16 v124, v124, 0
 v_mul_f32 v146, v146, v246
 v_mfma_f32_16x16x32_bf16 v[96:99], a[32:35], v[48:51], v[96:99]
 v_mul_f32 v146, v146, abs(v146)
 v_mul_f32 v147, v147, v246
 v_mul_f32 v147, v147, abs(v147)
 v_mfma_f32_16x16x32_bf16 v[100:103], a[36:39], v[48:51], v[100:103]
 v_cvt_pk_bf16_f32 v125, v146, v147
 s_waitcnt vmcnt(6)
 v_mfma_f32_16x16x32_bf16 v[84:87], a[40:43], v[52:55], v[84:87]
 buffer_load_dwordx4 v[80:83], v0, s[4:7], s24 offen offset:1024 sc1
 v_pk_max_i16 v125, v125, 0
 v_mfma_f32_16x16x32_bf16 v[88:91], a[44:47], v[52:55], v[88:91]
 v_mul_f32 v148, v148, v246
 v_mul_f32 v148, v148, abs(v148)
 v_mul_f32 v149, v149, v246
 v_mfma_f32_16x16x32_bf16 v[92:95], a[48:51], v[52:55], v[92:95]
 v_mul_f32 v149, v149, abs(v149)
 v_cvt_pk_bf16_f32 v126, v148, v149
 v_mfma_f32_16x16x32_bf16 v[96:99], a[52:55], v[52:55], v[96:99]
 v_pk_max_i16 v126, v126, 0
 v_mul_f32 v150, v150, v246
 v_mul_f32 v150, v150, abs(v150)
 v_mfma_f32_16x16x32_bf16 v[100:103], a[56:59], v[52:55], v[100:103]
 v_mul_f32 v151, v151, v246
 s_waitcnt vmcnt(6)
 v_mfma_f32_16x16x32_bf16 v[84:87], a[60:63], v[56:59], v[84:87]
 buffer_load_dwordx4 v[44:47], v0, s[4:7], s24 offen offset:2048 sc1
 v_mul_f32 v151, v151, abs(v151)
 v_mfma_f32_16x16x32_bf16 v[88:91], a[64:67], v[56:59], v[88:91]
 v_cvt_pk_bf16_f32 v127, v150, v151
 v_pk_max_i16 v127, v127, 0
 v_mfma_f32_16x16x32_bf16 v[92:95], a[68:71], v[56:59], v[92:95]
 buffer_store_dwordx4 v[124:127], v0, s[4:7], s34 offen
 v_mfma_f32_16x16x32_bf16 v[96:99], a[72:75], v[56:59], v[96:99]
 s_add_u32 s34, s34, 49152
 v_mul_f32 v152, v152, v246
 v_mfma_f32_16x16x32_bf16 v[100:103], a[76:79], v[56:59], v[100:103]
 v_mul_f32 v152, v152, abs(v152)
 v_mul_f32 v153, v153, v246
 s_waitcnt vmcnt(7)
 v_mfma_f32_16x16x32_bf16 v[84:87], a[80:83], v[60:63], v[84:87]
 buffer_load_dwordx4 v[48:51], v0, s[4:7], s24 offen offset:3072 sc1
 v_mul_f32 v153, v153, abs(v153)
 v_mfma_f32_16x16x32_bf16 v[88:91], a[84:87], v[60:63], v[88:91]
 v_cvt_pk_bf16_f32 v132, v152, v153
 v_pk_max_i16 v132, v132, 0
 v_mul_f32 v154, v154, v246
 v_mfma_f32_16x16x32_bf16 v[92:95], a[88:91], v[60:63], v[92:95]
 v_mul_f32 v154, v154, abs(v154)
 v_mul_f32 v155, v155, v246
 v_mfma_f32_16x16x32_bf16 v[96:99], a[92:95], v[60:63], v[96:99]
 v_mul_f32 v155, v155, abs(v155)
 v_cvt_pk_bf16_f32 v133, v154, v155
 v_mfma_f32_16x16x32_bf16 v[100:103], a[96:99], v[60:63], v[100:103]
 v_pk_max_i16 v133, v133, 0
 v_mul_f32 v156, v156, v250
 s_waitcnt vmcnt(7)
 v_mfma_f32_16x16x32_bf16 v[84:87], a[100:103], v[64:67], v[84:87]
 buffer_load_dwordx4 v[52:55], v0, s[4:7], s25 offen sc1
 v_mul_f32 v156, v156, abs(v156)
 v_mfma_f32_16x16x32_bf16 v[88:91], a[104:107], v[64:67], v[88:91]
 v_mul_f32 v157, v157, v250
 v_mul_f32 v157, v157, abs(v157)
 v_mfma_f32_16x16x32_bf16 v[92:95], a[108:111], v[64:67], v[92:95]
 v_cvt_pk_bf16_f32 v128, v156, v157
 v_pk_max_i16 v128, v128, 0
 v_mul_f32 v158, v158, v250
 v_mfma_f32_16x16x32_bf16 v[96:99], a[112:115], v[64:67], v[96:99]
 v_mul_f32 v158, v158, abs(v158)
 v_mul_f32 v159, v159, v250
 v_mfma_f32_16x16x32_bf16 v[100:103], a[116:119], v[64:67], v[100:103]
 v_mul_f32 v159, v159, abs(v159)
 v_cvt_pk_bf16_f32 v129, v158, v159
 s_waitcnt vmcnt(7)
 v_mfma_f32_16x16x32_bf16 v[84:87], a[120:123], v[68:71], v[84:87]
 buffer_load_dwordx4 v[56:59], v0, s[4:7], s25 offen offset:1024 sc1
 v_pk_max_i16 v129, v129, 0
 v_mfma_f32_16x16x32_bf16 v[88:91], a[124:127], v[68:71], v[88:91]
 v_mul_f32 v160, v160, v250
 v_mul_f32 v160, v160, abs(v160)
 v_mfma_f32_16x16x32_bf16 v[92:95], a[128:131], v[68:71], v[92:95]
 v_mul_f32 v161, v161, v250
 v_mul_f32 v161, v161, abs(v161)
 v_cvt_pk_bf16_f32 v130, v160, v161
 v_mfma_f32_16x16x32_bf16 v[96:99], a[132:135], v[68:71], v[96:99]
 v_pk_max_i16 v130, v130, 0
 v_mul_f32 v162, v162, v250
 v_mfma_f32_16x16x32_bf16 v[100:103], a[136:139], v[68:71], v[100:103]
 v_mul_f32 v162, v162, abs(v162)
 s_waitcnt vmcnt(7)
 v_mfma_f32_16x16x32_bf16 v[84:87], a[140:143], v[72:75], v[84:87]
 buffer_load_dwordx4 v[60:63], v0, s[4:7], s25 offen offset:2048 sc1
 v_mul_f32 v163, v163, v250
 v_mul_f32 v163, v163, abs(v163)
 v_mfma_f32_16x16x32_bf16 v[88:91], a[144:147], v[72:75], v[88:91]
 v_cvt_pk_bf16_f32 v131, v162, v163
 v_pk_max_i16 v131, v131, 0
 v_mfma_f32_16x16x32_bf16 v[92:95], a[148:151], v[72:75], v[92:95]
 buffer_store_dwordx4 v[128:131], v0, s[4:7], s34 offen
 v_mfma_f32_16x16x32_bf16 v[96:99], a[152:155], v[72:75], v[96:99]
 s_add_u32 s34, s34, 49152
 v_mul_f32 v164, v164, v250
 v_mfma_f32_16x16x32_bf16 v[100:103], a[156:159], v[72:75], v[100:103]
 v_mul_f32 v164, v164, abs(v164)
 s_waitcnt vmcnt(8)
 v_mfma_f32_16x16x32_bf16 v[84:87], a[160:163], v[76:79], v[84:87]
 buffer_load_dwordx4 v[64:67], v0, s[4:7], s25 offen offset:3072 sc1
 s_add_u32 s25, s25, 4096
 v_mul_f32 v165, v165, v250
 v_mfma_f32_16x16x32_bf16 v[88:91], a[164:167], v[76:79], v[88:91]
 v_mul_f32 v165, v165, abs(v165)
 v_cvt_pk_bf16_f32 v134, v164, v165
 v_mfma_f32_16x16x32_bf16 v[92:95], a[168:171], v[76:79], v[92:95]
 v_pk_max_i16 v134, v134, 0
 v_mul_f32 v166, v166, v250
 v_mfma_f32_16x16x32_bf16 v[96:99], a[172:175], v[76:79], v[96:99]
 v_mul_f32 v166, v166, abs(v166)
 v_mul_f32 v167, v167, v250
 v_mul_f32 v167, v167, abs(v167)
 v_mfma_f32_16x16x32_bf16 v[100:103], a[176:179], v[76:79], v[100:103]
 v_cvt_pk_bf16_f32 v135, v166, v167
 s_waitcnt vmcnt(8)
 v_mfma_f32_16x16x32_bf16 v[84:87], a[180:183], v[80:83], v[84:87]
 buffer_load_dwordx4 v[68:71], v0, s[4:7], s25 offen sc1
 v_pk_max_i16 v135, v135, 0
 v_mfma_f32_16x16x32_bf16 v[88:91], a[184:187], v[80:83], v[88:91]
 v_permlane16_swap_b32 v132, v134
 v_mfma_f32_16x16x32_bf16 v[92:95], a[188:191], v[80:83], v[92:95]
 v_permlane16_swap_b32 v133, v135
 v_mfma_f32_16x16x32_bf16 v[96:99], a[192:195], v[80:83], v[96:99]
 buffer_store_dwordx4 v[132:135], v7, s[4:7], s35 offen offset:1024
 v_mfma_f32_16x16x32_bf16 v[100:103], a[196:199], v[80:83], v[100:103]
 s_add_u32 s35, s35, 98304
 s_waitcnt vmcnt(9)
 v_mfma_f32_16x16x32_bf16 v[84:87], a[200:203], v[44:47], v[84:87]
 buffer_load_dwordx4 v[72:75], v0, s[4:7], s25 offen offset:1024 sc1
 v_mfma_f32_16x16x32_bf16 v[88:91], a[204:207], v[44:47], v[88:91]
 v_mfma_f32_16x16x32_bf16 v[92:95], a[208:211], v[44:47], v[92:95]
 v_mfma_f32_16x16x32_bf16 v[96:99], a[212:215], v[44:47], v[96:99]
 v_mfma_f32_16x16x32_bf16 v[100:103], a[216:219], v[44:47], v[100:103]
 s_waitcnt vmcnt(8)
 v_mfma_f32_16x16x32_bf16 v[84:87], a[220:223], v[48:51], v[84:87]
 buffer_load_dwordx4 v[76:79], v0, s[4:7], s25 offen offset:2048 sc1
 v_mfma_f32_16x16x32_bf16 v[88:91], a[224:227], v[48:51], v[88:91]
 v_mfma_f32_16x16x32_bf16 v[92:95], a[228:231], v[48:51], v[92:95]
 v_mfma_f32_16x16x32_bf16 v[96:99], a[232:235], v[48:51], v[96:99]
 v_mfma_f32_16x16x32_bf16 v[100:103], a[236:239], v[48:51], v[100:103]
 s_waitcnt vmcnt(8)
 v_mfma_f32_16x16x32_bf16 v[104:107], a[0:3], v[52:55], 0
 buffer_load_dwordx4 v[80:83], v0, s[4:7], s25 offen offset:3072 sc1
 s_add_u32 s25, s25, 4096
 v_mfma_f32_16x16x32_bf16 v[108:111], a[4:7], v[52:55], 0
 s_waitcnt lgkmcnt(0)
 s_barrier
 v_mfma_f32_16x16x32_bf16 v[112:115], a[8:11], v[52:55], 0
 ds_write_b128 v3, v[84:87] offset:12288
 v_mfma_f32_16x16x32_bf16 v[116:119], a[12:15], v[52:55], 0
 v_mov_b32 v15, 7
 v_add_u32 v15, s52, v15
 s_waitcnt vmcnt(3)
 s_mov_b64 exec, 1
 buffer_store_dword v15, v0, s[4:7], s36 offen
 s_mov_b64 exec, -1
 v_mfma_f32_16x16x32_bf16 v[120:123], a[16:19], v[52:55], 0
 v_mfma_f32_16x16x32_bf16 v[104:107], a[20:23], v[56:59], v[104:107]
 buffer_load_dwordx4 v[44:47], v0, s[4:7], s25 offen sc1
 v_mfma_f32_16x16x32_bf16 v[108:111], a[24:27], v[56:59], v[108:111]
 ds_write_b128 v3, v[88:91] offset:13312
 v_mfma_f32_16x16x32_bf16 v[112:115], a[28:31], v[56:59], v[112:115]
 v_mfma_f32_16x16x32_bf16 v[116:119], a[32:35], v[56:59], v[116:119]
 v_mfma_f32_16x16x32_bf16 v[120:123], a[36:39], v[56:59], v[120:123]
 v_mfma_f32_16x16x32_bf16 v[104:107], a[40:43], v[60:63], v[104:107]
 buffer_load_dwordx4 v[48:51], v0, s[4:7], s25 offen offset:1024 sc1
 v_mfma_f32_16x16x32_bf16 v[108:111], a[44:47], v[60:63], v[108:111]
 ds_write_b128 v3, v[92:95] offset:14336
 v_mfma_f32_16x16x32_bf16 v[112:115], a[48:51], v[60:63], v[112:115]
 v_mfma_f32_16x16x32_bf16 v[116:119], a[52:55], v[60:63], v[116:119]
 ds_write_b128 v3, v[96:99] offset:15360
 v_mfma_f32_16x16x32_bf16 v[120:123], a[56:59], v[60:63], v[120:123]
 v_mfma_f32_16x16x32_bf16 v[104:107], a[60:63], v[64:67], v[104:107]
 buffer_load_dwordx4 v[52:55], v0, s[4:7], s25 offen offset:2048 sc1
 v_mfma_f32_16x16x32_bf16 v[108:111], a[64:67], v[64:67], v[108:111]
 v_mfma_f32_16x16x32_bf16 v[112:115], a[68:71], v[64:67], v[112:115]
 ds_write_b128 v3, v[100:103] offset:16384
 v_mfma_f32_16x16x32_bf16 v[116:119], a[72:75], v[64:67], v[116:119]
 v_mfma_f32_16x16x32_bf16 v[120:123], a[76:79], v[64:67], v[120:123]
 v_mfma_f32_16x16x32_bf16 v[104:107], a[80:83], v[68:71], v[104:107]
 buffer_load_dwordx4 v[56:59], v0, s[4:7], s25 offen offset:3072 sc1
 v_mfma_f32_16x16x32_bf16 v[108:111], a[84:87], v[68:71], v[108:111]
 v_mfma_f32_16x16x32_bf16 v[112:115], a[88:91], v[68:71], v[112:115]
 s_add_u32 s56, s52, 7
 buffer_load_dword v12, v171, s[4:7], s28 offen sc1
 s_waitcnt lgkmcnt(0)
 s_barrier
 v_mfma_f32_16x16x32_bf16 v[116:119], a[92:95], v[68:71], v[116:119]
 ds_read_b128 v[124:127], v5 offset:12288
 v_mfma_f32_16x16x32_bf16 v[120:123], a[96:99], v[68:71], v[120:123]
 ds_read_b128 v[128:131], v5 offset:13312
 s_waitcnt vmcnt(8)
 v_mfma_f32_16x16x32_bf16 v[104:107], a[100:103], v[72:75], v[104:107]
 ds_read_b64 v[132:133], v6 offset:16384
 v_mfma_f32_16x16x32_bf16 v[108:111], a[104:107], v[72:75], v[108:111]
 ds_read_b128 v[134:137], v5 offset:17408
 v_mfma_f32_16x16x32_bf16 v[112:115], a[108:111], v[72:75], v[112:115]
 ds_read_b128 v[138:141], v5 offset:18432
 v_mfma_f32_16x16x32_bf16 v[116:119], a[112:115], v[72:75], v[116:119]
 ds_read_b64 v[142:143], v6 offset:21504
 v_mfma_f32_16x16x32_bf16 v[120:123], a[116:119], v[72:75], v[120:123]
 s_waitcnt vmcnt(7)
 v_mfma_f32_16x16x32_bf16 v[104:107], a[120:123], v[76:79], v[104:107]
 v_mfma_f32_16x16x32_bf16 v[108:111], a[124:127], v[76:79], v[108:111]
 s_waitcnt lgkmcnt(5)
 v_add_f32 v16, v16, v124
 v_add_f32 v17, v17, v125
 v_mfma_f32_16x16x32_bf16 v[112:115], a[128:131], v[76:79], v[112:115]
 v_add_f32 v18, v18, v126
 v_add_f32 v19, v19, v127
 v_mfma_f32_16x16x32_bf16 v[116:119], a[132:135], v[76:79], v[116:119]
 s_waitcnt lgkmcnt(4)
 v_add_f32 v20, v20, v128
 v_add_f32 v21, v21, v129
 v_mfma_f32_16x16x32_bf16 v[120:123], a[136:139], v[76:79], v[120:123]
 v_add_f32 v22, v22, v130
 s_waitcnt vmcnt(6)
 v_mfma_f32_16x16x32_bf16 v[104:107], a[140:143], v[80:83], v[104:107]
 v_add_f32 v23, v23, v131
 s_waitcnt lgkmcnt(3)
 v_add_f32 v24, v24, v132
 v_mfma_f32_16x16x32_bf16 v[108:111], a[144:147], v[80:83], v[108:111]
 v_add_f32 v25, v25, v133
 s_waitcnt lgkmcnt(2)
 v_add_f32 v16, v16, v134
 v_mfma_f32_16x16x32_bf16 v[112:115], a[148:151], v[80:83], v[112:115]
 v_add_f32 v17, v17, v135
 v_add_f32 v18, v18, v136
 v_mfma_f32_16x16x32_bf16 v[116:119], a[152:155], v[80:83], v[116:119]
 s_waitcnt vmcnt(0)
 v_cmp_ne_u32 vcc, s56, v12
 s_cbranch_vccnz Lretry_34
Lback_35:
 buffer_load_dwordx4 v[60:63], v0, s[4:7], s26 offen sc1
 v_mfma_f32_16x16x32_bf16 v[120:123], a[156:159], v[80:83], v[120:123]
 buffer_load_dwordx4 v[64:67], v0, s[4:7], s26 offen offset:1024 sc1
 v_mfma_f32_16x16x32_bf16 v[104:107], a[160:163], v[44:47], v[104:107]
 buffer_load_dwordx4 v[68:71], v0, s[4:7], s26 offen offset:2048 sc1
 v_add_f32 v19, v19, v137
 v_mfma_f32_16x16x32_bf16 v[108:111], a[164:167], v[44:47], v[108:111]
 buffer_load_dwordx4 v[72:75], v0, s[4:7], s26 offen offset:3072 sc1
 s_add_u32 s26, s26, 4096
 v_mfma_f32_16x16x32_bf16 v[112:115], a[168:171], v[44:47], v[112:115]
 s_waitcnt lgkmcnt(1)
 v_add_f32 v20, v20, v138
 v_add_f32 v21, v21, v139
 v_mfma_f32_16x16x32_bf16 v[116:119], a[172:175], v[44:47], v[116:119]
 v_add_f32 v22, v22, v140
 v_add_f32 v23, v23, v141
 v_mfma_f32_16x16x32_bf16 v[120:123], a[176:179], v[44:47], v[120:123]
 s_waitcnt lgkmcnt(0)
 v_add_f32 v24, v24, v142
 v_mfma_f32_16x16x32_bf16 v[104:107], a[180:183], v[48:51], v[104:107]
 buffer_load_dwordx4 v[76:79], v0, s[4:7], s26 offen sc1
 v_add_f32 v25, v25, v143
 v_mfma_f32_16x16x32_bf16 v[108:111], a[184:187], v[48:51], v[108:111]
 v_mfma_f32_16x16x32_bf16 v[112:115], a[188:191], v[48:51], v[112:115]
 v_mfma_f32_16x16x32_bf16 v[116:119], a[192:195], v[48:51], v[116:119]
 v_mfma_f32_16x16x32_bf16 v[120:123], a[196:199], v[48:51], v[120:123]
 v_mfma_f32_16x16x32_bf16 v[104:107], a[200:203], v[52:55], v[104:107]
 buffer_load_dwordx4 v[80:83], v0, s[4:7], s26 offen offset:1024 sc1
 v_mfma_f32_16x16x32_bf16 v[108:111], a[204:207], v[52:55], v[108:111]
 v_mfma_f32_16x16x32_bf16 v[112:115], a[208:211], v[52:55], v[112:115]
 v_mfma_f32_16x16x32_bf16 v[116:119], a[212:215], v[52:55], v[116:119]
 v_mfma_f32_16x16x32_bf16 v[120:123], a[216:219], v[52:55], v[120:123]
 v_mfma_f32_16x16x32_bf16 v[104:107], a[220:223], v[56:59], v[104:107]
 buffer_load_dwordx4 v[44:47], v0, s[4:7], s26 offen offset:2048 sc1
 v_mfma_f32_16x16x32_bf16 v[108:111], a[224:227], v[56:59], v[108:111]
 v_mfma_f32_16x16x32_bf16 v[112:115], a[228:231], v[56:59], v[112:115]
 v_mfma_f32_16x16x32_bf16 v[116:119], a[232:235], v[56:59], v[116:119]
 v_mfma_f32_16x16x32_bf16 v[120:123], a[236:239], v[56:59], v[120:123]
 s_waitcnt vmcnt(6)
 v_mfma_f32_16x16x32_bf16 v[84:87], a[0:3], v[60:63], 0
 buffer_load_dwordx4 v[48:51], v0, s[4:7], s26 offen offset:3072 sc1
 s_add_u32 s26, s26, 4096
 v_mfma_f32_16x16x32_bf16 v[88:91], a[4:7], v[60:63], 0
 s_waitcnt lgkmcnt(0)
 s_barrier
 v_mfma_f32_16x16x32_bf16 v[92:95], a[8:11], v[60:63], 0
 ds_write_b128 v4, v[104:107] offset:12288
 v_mfma_f32_16x16x32_bf16 v[96:99], a[12:15], v[60:63], 0
 v_mfma_f32_16x16x32_bf16 v[100:103], a[16:19], v[60:63], 0
 s_waitcnt vmcnt(6)
 v_mfma_f32_16x16x32_bf16 v[84:87], a[20:23], v[64:67], v[84:87]
 buffer_load_dwordx4 v[52:55], v0, s[4:7], s26 offen sc1
 v_mfma_f32_16x16x32_bf16 v[88:91], a[24:27], v[64:67], v[88:91]
 ds_write_b128 v4, v[108:111] offset:13312
 v_mfma_f32_16x16x32_bf16 v[92:95], a[28:31], v[64:67], v[92:95]
 v_mfma_f32_16x16x32_bf16 v[96:99], a[32:35], v[64:67], v[96:99]
 v_mfma_f32_16x16x32_bf16 v[100:103], a[36:39], v[64:67], v[100:103]
 s_waitcnt vmcnt(6)
 v_mfma_f32_16x16x32_bf16 v[84:87], a[40:43], v[68:71], v[84:87]
 buffer_load_dwordx4 v[56:59], v0, s[4:7], s26 offen offset:1024 sc1
 v_mfma_f32_16x16x32_bf16 v[88:91], a[44:47], v[68:71], v[88:91]
 ds_write_b128 v4, v[112:115] offset:14336
 v_mfma_f32_16x16x32_bf16 v[92:95], a[48:51], v[68:71], v[92:95]
 v_mfma_f32_16x16x32_bf16 v[96:99], a[52:55], v[68:71], v[96:99]
 ds_write_b128 v4, v[116:119] offset:15360
 v_mfma_f32_16x16x32_bf16 v[100:103], a[56:59], v[68:71], v[100:103]
 s_waitcnt vmcnt(6)
 v_mfma_f32_16x16x32_bf16 v[84:87], a[60:63], v[72:75], v[84:87]
 buffer_load_dwordx4 v[60:63], v0, s[4:7], s26 offen offset:2048 sc1
 v_mfma_f32_16x16x32_bf16 v[88:91], a[64:67], v[72:75], v[88:91]
 v_mfma_f32_16x16x32_bf16 v[92:95], a[68:71], v[72:75], v[92:95]
 ds_write_b128 v4, v[120:123] offset:16384
 v_mfma_f32_16x16x32_bf16 v[96:99], a[72:75], v[72:75], v[96:99]
 v_mfma_f32_16x16x32_bf16 v[100:103], a[76:79], v[72:75], v[100:103]
 s_waitcnt vmcnt(6)
 v_mfma_f32_16x16x32_bf16 v[84:87], a[80:83], v[76:79], v[84:87]
 buffer_load_dwordx4 v[64:67], v0, s[4:7], s26 offen offset:3072 sc1
 v_mfma_f32_16x16x32_bf16 v[88:91], a[84:87], v[76:79], v[88:91]
 v_mfma_f32_16x16x32_bf16 v[92:95], a[88:91], v[76:79], v[92:95]
 s_waitcnt lgkmcnt(0)
 s_barrier
 v_mfma_f32_16x16x32_bf16 v[96:99], a[92:95], v[76:79], v[96:99]
 ds_read_b128 v[124:127], v5 offset:12288
 v_mfma_f32_16x16x32_bf16 v[100:103], a[96:99], v[76:79], v[100:103]
 ds_read_b128 v[128:131], v5 offset:13312
 s_waitcnt vmcnt(6)
 v_mfma_f32_16x16x32_bf16 v[84:87], a[100:103], v[80:83], v[84:87]
 buffer_load_dwordx4 v[68:71], v0, s[4:7], s27 offen sc1
 ds_read_b64 v[132:133], v6 offset:16384
 v_mfma_f32_16x16x32_bf16 v[88:91], a[104:107], v[80:83], v[88:91]
 ds_read_b128 v[134:137], v5 offset:17408
 v_mfma_f32_16x16x32_bf16 v[92:95], a[108:111], v[80:83], v[92:95]
 ds_read_b128 v[138:141], v5 offset:18432
 v_mfma_f32_16x16x32_bf16 v[96:99], a[112:115], v[80:83], v[96:99]
 ds_read_b64 v[142:143], v6 offset:21504
 v_mfma_f32_16x16x32_bf16 v[100:103], a[116:119], v[80:83], v[100:103]
 s_waitcnt vmcnt(6)
 v_mfma_f32_16x16x32_bf16 v[84:87], a[120:123], v[44:47], v[84:87]
 buffer_load_dwordx4 v[72:75], v0, s[4:7], s27 offen offset:1024 sc1
 v_mfma_f32_16x16x32_bf16 v[88:91], a[124:127], v[44:47], v[88:91]
 s_waitcnt lgkmcnt(5)
 v_add_f32 v16, v16, v124
 v_add_f32 v17, v17, v125
 v_mfma_f32_16x16x32_bf16 v[92:95], a[128:131], v[44:47], v[92:95]
 v_add_f32 v18, v18, v126
 v_add_f32 v19, v19, v127
 v_mfma_f32_16x16x32_bf16 v[96:99], a[132:135], v[44:47], v[96:99]
 s_waitcnt lgkmcnt(4)
 v_add_f32 v20, v20, v128
 v_add_f32 v21, v21, v129
 v_mfma_f32_16x16x32_bf16 v[100:103], a[136:139], v[44:47], v[100:103]
 v_add_f32 v22, v22, v130
 s_waitcnt vmcnt(6)
 v_mfma_f32_16x16x32_bf16 v[84:87], a[140:143], v[48:51], v[84:87]
 buffer_load_dwordx4 v[76:79], v0, s[4:7], s27 offen offset:2048 sc1
 v_add_f32 v23, v23, v131
 v_mfma_f32_16x16x32_bf16 v[88:91], a[144:147], v[48:51], v[88:91]
 s_waitcnt lgkmcnt(3)
 v_add_f32 v24, v24, v132
 v_add_f32 v25, v25, v133
 v_mfma_f32_16x16x32_bf16 v[92:95], a[148:151], v[48:51], v[92:95]
 s_waitcnt lgkmcnt(2)
 v_add_f32 v16, v16, v134
 v_add_f32 v17, v17, v135
 v_mfma_f32_16x16x32_bf16 v[96:99], a[152:155], v[48:51], v[96:99]
 v_add_f32 v18, v18, v136
 v_add_f32 v19, v19, v137
 v_mfma_f32_16x16x32_bf16 v[100:103], a[156:159], v[48:51], v[100:103]
 s_waitcnt lgkmcnt(1)
 v_add_f32 v20, v20, v138
 s_waitcnt vmcnt(6)
 v_mfma_f32_16x16x32_bf16 v[84:87], a[160:163], v[52:55], v[84:87]
 buffer_load_dwordx4 v[80:83], v0, s[4:7], s27 offen offset:3072 sc1
 s_add_u32 s27, s27, 4096
 v_mfma_f32_16x16x32_bf16 v[88:91], a[164:167], v[52:55], v[88:91]
 v_add_f32 v21, v21, v139
 v_add_f32 v22, v22, v140
 v_mfma_f32_16x16x32_bf16 v[92:95], a[168:171], v[52:55], v[92:95]
 v_add_f32 v23, v23, v141
 s_waitcnt lgkmcnt(0)
 v_add_f32 v24, v24, v142
 v_mfma_f32_16x16x32_bf16 v[96:99], a[172:175], v[52:55], v[96:99]
 v_add_f32 v25, v25, v143
 v_cvt_pk_bf16_f32 v124, v16, v17
 v_mfma_f32_16x16x32_bf16 v[100:103], a[176:179], v[52:55], v[100:103]
 v_cvt_pk_bf16_f32 v125, v18, v19
 s_waitcnt vmcnt(6)
 v_mfma_f32_16x16x32_bf16 v[84:87], a[180:183], v[56:59], v[84:87]
 buffer_load_dwordx4 v[44:47], v0, s[4:7], s27 offen sc1
 v_cvt_pk_bf16_f32 v126, v20, v21
 v_mfma_f32_16x16x32_bf16 v[88:91], a[184:187], v[56:59], v[88:91]
 v_cvt_pk_bf16_f32 v127, v22, v23
 v_cvt_pk_bf16_f32 v128, v24, v25
 v_mfma_f32_16x16x32_bf16 v[92:95], a[188:191], v[56:59], v[92:95]
 buffer_store_dwordx4 v[124:127], v168, s[8:11], s29 offen
 v_mfma_f32_16x16x32_bf16 v[96:99], a[192:195], v[56:59], v[96:99]
 buffer_store_dword v128, v169, s[8:11], s30 offen
 v_mfma_f32_16x16x32_bf16 v[100:103], a[196:199], v[56:59], v[100:103]
 s_add_u32 s29, s29, 40960
 s_waitcnt vmcnt(8)
 v_mfma_f32_16x16x32_bf16 v[84:87], a[200:203], v[60:63], v[84:87]
 buffer_load_dwordx4 v[48:51], v0, s[4:7], s27 offen offset:1024 sc1
 s_add_u32 s30, s30, 40960
 v_mfma_f32_16x16x32_bf16 v[88:91], a[204:207], v[60:63], v[88:91]
 v_mfma_f32_16x16x32_bf16 v[92:95], a[208:211], v[60:63], v[92:95]
 v_mfma_f32_16x16x32_bf16 v[96:99], a[212:215], v[60:63], v[96:99]
 v_mfma_f32_16x16x32_bf16 v[100:103], a[216:219], v[60:63], v[100:103]
 s_waitcnt vmcnt(8)
 v_mfma_f32_16x16x32_bf16 v[84:87], a[220:223], v[64:67], v[84:87]
 buffer_load_dwordx4 v[52:55], v0, s[4:7], s27 offen offset:2048 sc1
 v_mfma_f32_16x16x32_bf16 v[88:91], a[224:227], v[64:67], v[88:91]
 v_mfma_f32_16x16x32_bf16 v[92:95], a[228:231], v[64:67], v[92:95]
 v_mfma_f32_16x16x32_bf16 v[96:99], a[232:235], v[64:67], v[96:99]
 v_mfma_f32_16x16x32_bf16 v[100:103], a[236:239], v[64:67], v[100:103]
 s_waitcnt vmcnt(8)
 v_mfma_f32_16x16x32_bf16 v[104:107], a[0:3], v[68:71], 0
 buffer_load_dwordx4 v[56:59], v0, s[4:7], s27 offen offset:3072 sc1
 s_add_u32 s27, s27, 4096
 v_mfma_f32_16x16x32_bf16 v[108:111], a[4:7], v[68:71], 0
 s_waitcnt lgkmcnt(0)
 s_barrier
 v_mfma_f32_16x16x32_bf16 v[112:115], a[8:11], v[68:71], 0
 ds_write_b128 v3, v[84:87] offset:12288
 v_mfma_f32_16x16x32_bf16 v[116:119], a[12:15], v[68:71], 0
 v_mfma_f32_16x16x32_bf16 v[120:123], a[16:19], v[68:71], 0
 s_waitcnt vmcnt(8)
 v_mfma_f32_16x16x32_bf16 v[104:107], a[20:23], v[72:75], v[104:107]
 buffer_load_dwordx4 v[60:63], v0, s[4:7], s27 offen sc1
 v_mfma_f32_16x16x32_bf16 v[108:111], a[24:27], v[72:75], v[108:111]
 ds_write_b128 v3, v[88:91] offset:13312
 v_mfma_f32_16x16x32_bf16 v[112:115], a[28:31], v[72:75], v[112:115]
 v_mfma_f32_16x16x32_bf16 v[116:119], a[32:35], v[72:75], v[116:119]
 v_mfma_f32_16x16x32_bf16 v[120:123], a[36:39], v[72:75], v[120:123]
 s_waitcnt vmcnt(8)
 v_mfma_f32_16x16x32_bf16 v[104:107], a[40:43], v[76:79], v[104:107]
 buffer_load_dwordx4 v[64:67], v0, s[4:7], s27 offen offset:1024 sc1
 v_mfma_f32_16x16x32_bf16 v[108:111], a[44:47], v[76:79], v[108:111]
 ds_write_b128 v3, v[92:95] offset:14336
 v_mfma_f32_16x16x32_bf16 v[112:115], a[48:51], v[76:79], v[112:115]
 v_mfma_f32_16x16x32_bf16 v[116:119], a[52:55], v[76:79], v[116:119]
 ds_write_b128 v3, v[96:99] offset:15360
 v_mfma_f32_16x16x32_bf16 v[120:123], a[56:59], v[76:79], v[120:123]
 s_waitcnt vmcnt(8)
 v_mfma_f32_16x16x32_bf16 v[104:107], a[60:63], v[80:83], v[104:107]
 buffer_load_dwordx4 v[68:71], v0, s[4:7], s27 offen offset:2048 sc1
 v_mfma_f32_16x16x32_bf16 v[108:111], a[64:67], v[80:83], v[108:111]
 v_mfma_f32_16x16x32_bf16 v[112:115], a[68:71], v[80:83], v[112:115]
 ds_write_b128 v3, v[100:103] offset:16384
 v_mfma_f32_16x16x32_bf16 v[116:119], a[72:75], v[80:83], v[116:119]
 v_mfma_f32_16x16x32_bf16 v[120:123], a[76:79], v[80:83], v[120:123]
 s_waitcnt vmcnt(8)
 v_mfma_f32_16x16x32_bf16 v[104:107], a[80:83], v[44:47], v[104:107]
 buffer_load_dwordx4 v[72:75], v0, s[4:7], s27 offen offset:3072 sc1
 v_mfma_f32_16x16x32_bf16 v[108:111], a[84:87], v[44:47], v[108:111]
 v_mfma_f32_16x16x32_bf16 v[112:115], a[88:91], v[44:47], v[112:115]
 s_waitcnt lgkmcnt(0)
 s_barrier
 v_mfma_f32_16x16x32_bf16 v[116:119], a[92:95], v[44:47], v[116:119]
 ds_read_b128 v[124:127], v5 offset:12288
 v_mfma_f32_16x16x32_bf16 v[120:123], a[96:99], v[44:47], v[120:123]
 ds_read_b128 v[128:131], v5 offset:13312
 s_waitcnt vmcnt(6)
 v_mfma_f32_16x16x32_bf16 v[104:107], a[100:103], v[48:51], v[104:107]
 ds_read_b64 v[132:133], v6 offset:16384
 v_mfma_f32_16x16x32_bf16 v[108:111], a[104:107], v[48:51], v[108:111]
 ds_read_b128 v[134:137], v5 offset:17408
 v_mfma_f32_16x16x32_bf16 v[112:115], a[108:111], v[48:51], v[112:115]
 ds_read_b128 v[138:141], v5 offset:18432
 v_mfma_f32_16x16x32_bf16 v[116:119], a[112:115], v[48:51], v[116:119]
 ds_read_b64 v[142:143], v6 offset:21504
 v_mfma_f32_16x16x32_bf16 v[120:123], a[116:119], v[48:51], v[120:123]
 s_waitcnt vmcnt(5)
 v_mfma_f32_16x16x32_bf16 v[104:107], a[120:123], v[52:55], v[104:107]
 v_mfma_f32_16x16x32_bf16 v[108:111], a[124:127], v[52:55], v[108:111]
 s_waitcnt lgkmcnt(5)
 v_add_f32 v26, v26, v124
 v_add_f32 v27, v27, v125
 v_mfma_f32_16x16x32_bf16 v[112:115], a[128:131], v[52:55], v[112:115]
 v_add_f32 v28, v28, v126
 v_add_f32 v29, v29, v127
 v_mfma_f32_16x16x32_bf16 v[116:119], a[132:135], v[52:55], v[116:119]
 s_waitcnt lgkmcnt(4)
 v_add_f32 v30, v30, v128
 v_add_f32 v31, v31, v129
 v_mfma_f32_16x16x32_bf16 v[120:123], a[136:139], v[52:55], v[120:123]
 v_add_f32 v32, v32, v130
 s_waitcnt vmcnt(4)
 v_mfma_f32_16x16x32_bf16 v[104:107], a[140:143], v[56:59], v[104:107]
 v_add_f32 v33, v33, v131
 s_waitcnt lgkmcnt(3)
 v_add_f32 v34, v34, v132
 v_mfma_f32_16x16x32_bf16 v[108:111], a[144:147], v[56:59], v[108:111]
 v_add_f32 v35, v35, v133
 s_waitcnt lgkmcnt(2)
 v_add_f32 v26, v26, v134
 v_mfma_f32_16x16x32_bf16 v[112:115], a[148:151], v[56:59], v[112:115]
 v_add_f32 v27, v27, v135
 v_add_f32 v28, v28, v136
 v_mfma_f32_16x16x32_bf16 v[116:119], a[152:155], v[56:59], v[116:119]
 v_add_f32 v29, v29, v137
 s_waitcnt lgkmcnt(1)
 v_add_f32 v30, v30, v138
 v_mfma_f32_16x16x32_bf16 v[120:123], a[156:159], v[56:59], v[120:123]
 v_add_f32 v31, v31, v139
 s_waitcnt vmcnt(3)
 v_mfma_f32_16x16x32_bf16 v[104:107], a[160:163], v[60:63], v[104:107]
 v_add_f32 v32, v32, v140
 v_add_f32 v33, v33, v141
 v_mfma_f32_16x16x32_bf16 v[108:111], a[164:167], v[60:63], v[108:111]
 s_waitcnt lgkmcnt(0)
 v_add_f32 v34, v34, v142
 v_add_f32 v35, v35, v143
 v_mfma_f32_16x16x32_bf16 v[112:115], a[168:171], v[60:63], v[112:115]
 v_mfma_f32_16x16x32_bf16 v[116:119], a[172:175], v[60:63], v[116:119]
 v_mfma_f32_16x16x32_bf16 v[120:123], a[176:179], v[60:63], v[120:123]
 s_waitcnt vmcnt(2)
 v_mfma_f32_16x16x32_bf16 v[104:107], a[180:183], v[64:67], v[104:107]
 v_mfma_f32_16x16x32_bf16 v[108:111], a[184:187], v[64:67], v[108:111]
 v_mfma_f32_16x16x32_bf16 v[112:115], a[188:191], v[64:67], v[112:115]
 v_mfma_f32_16x16x32_bf16 v[116:119], a[192:195], v[64:67], v[116:119]
 v_mfma_f32_16x16x32_bf16 v[120:123], a[196:199], v[64:67], v[120:123]
 s_waitcnt vmcnt(1)
 v_mfma_f32_16x16x32_bf16 v[104:107], a[200:203], v[68:71], v[104:107]
 v_mfma_f32_16x16x32_bf16 v[108:111], a[204:207], v[68:71], v[108:111]
 v_mfma_f32_16x16x32_bf16 v[112:115], a[208:211], v[68:71], v[112:115]
 v_mfma_f32_16x16x32_bf16 v[116:119], a[212:215], v[68:71], v[116:119]
 v_mfma_f32_16x16x32_bf16 v[120:123], a[216:219], v[68:71], v[120:123]
 s_waitcnt vmcnt(0)
 v_mfma_f32_16x16x32_bf16 v[104:107], a[220:223], v[72:75], v[104:107]
 v_mfma_f32_16x16x32_bf16 v[108:111], a[224:227], v[72:75], v[108:111]
 v_mfma_f32_16x16x32_bf16 v[112:115], a[228:231], v[72:75], v[112:115]
 v_mfma_f32_16x16x32_bf16 v[116:119], a[232:235], v[72:75], v[116:119]
 v_mfma_f32_16x16x32_bf16 v[120:123], a[236:239], v[72:75], v[120:123]
 s_waitcnt lgkmcnt(0)
 s_barrier
 s_nop 1
 ds_write_b128 v4, v[104:107] offset:12288
 ds_write_b128 v4, v[108:111] offset:13312
 ds_write_b128 v4, v[112:115] offset:14336
 ds_write_b128 v4, v[116:119] offset:15360
 ds_write_b128 v4, v[120:123] offset:16384
 s_waitcnt lgkmcnt(0)
 s_barrier
 ds_read_b128 v[124:127], v5 offset:12288
 ds_read_b128 v[128:131], v5 offset:13312
 ds_read_b64 v[132:133], v6 offset:16384
 ds_read_b128 v[134:137], v5 offset:17408
 ds_read_b128 v[138:141], v5 offset:18432
 ds_read_b64 v[142:143], v6 offset:21504
 s_waitcnt lgkmcnt(5)
 v_pk_add_f32 v[26:27], v[26:27], v[124:125]
 v_pk_add_f32 v[28:29], v[28:29], v[126:127]
 s_waitcnt lgkmcnt(4)
 v_pk_add_f32 v[30:31], v[30:31], v[128:129]
 v_pk_add_f32 v[32:33], v[32:33], v[130:131]
 s_waitcnt lgkmcnt(3)
 v_pk_add_f32 v[34:35], v[34:35], v[132:133]
 s_waitcnt lgkmcnt(2)
 v_pk_add_f32 v[26:27], v[26:27], v[134:135]
 v_pk_add_f32 v[28:29], v[28:29], v[136:137]
 s_waitcnt lgkmcnt(1)
 v_pk_add_f32 v[30:31], v[30:31], v[138:139]
 v_pk_add_f32 v[32:33], v[32:33], v[140:141]
 s_waitcnt lgkmcnt(0)
 v_pk_add_f32 v[34:35], v[34:35], v[142:143]
 v_cvt_pk_bf16_f32 v124, v26, v27
 v_cvt_pk_bf16_f32 v125, v28, v29
 v_cvt_pk_bf16_f32 v126, v30, v31
 v_cvt_pk_bf16_f32 v127, v32, v33
 v_cvt_pk_bf16_f32 v128, v34, v35
 buffer_store_dwordx4 v[124:127], v168, s[8:11], s29 offen
 buffer_store_dword v128, v169, s[8:11], s30 offen
 s_add_u32 s56, s52, 16
 v_mov_b32 v12, s56
 s_mov_b32 s16, 7782400
 s_or_b32 s17, s2, s3
 s_cmp_eq_u32 s17, 0
 s_cselect_b32 s17, 0, 1073741824
 v_mov_b32 v13, s17
 s_mov_b64 exec, 1
 buffer_store_dword v12, v13, s[4:7], s16 offen sc1
 s_mov_b64 exec, -1
 s_endpgm
Lretry_2:
 s_nop 7
 s_nop 3
 s_mov_b32 s55, 0
Lpoll_4:
 buffer_load_dword v12, v205, s[4:7], s39 offen sc1
 s_add_u32 s55, s55, 1
 s_cmp_gt_u32 s55, 0x80000
 s_cbranch_scc1 Lend
 s_waitcnt vmcnt(0)
 v_cmp_ne_u32 vcc, s56, v12
 s_cbranch_vccnz Lpoll_4
 s_branch Lback_3
Lretry_9:
 s_nop 7
 s_nop 3
 s_mov_b32 s55, 0
Lpoll_11:
 buffer_load_dword v12, v172, s[4:7], s33 offen sc1
 s_add_u32 s55, s55, 1
 s_cmp_gt_u32 s55, 0x80000
 s_cbranch_scc1 Lend
 s_waitcnt vmcnt(0)
 v_cmp_ne_u32 vcc, s56, v12
 s_cbranch_vccnz Lpoll_11
 s_branch Lback_10
Lretry_12:
 s_nop 7
 s_nop 3
 s_mov_b32 s55, 0
Lpoll_14:
 buffer_load_dword v12, v171, s[4:7], s28 offen sc1
 s_add_u32 s55, s55, 1
 s_cmp_gt_u32 s55, 0x80000
 s_cbranch_scc1 Lend
 s_waitcnt vmcnt(0)
 v_cmp_ne_u32 vcc, s56, v12
 s_cbranch_vccnz Lpoll_14
 s_branch Lback_13
Lretry_15:
 s_nop 7
 s_nop 3
 s_mov_b32 s55, 0
Lpoll_17:
 buffer_load_dword v12, v171, s[4:7], s28 offen sc1
 s_add_u32 s55, s55, 1
 s_cmp_gt_u32 s55, 0x80000
 s_cbranch_scc1 Lend
 s_waitcnt vmcnt(0)
 v_cmp_ne_u32 vcc, s56, v12
 s_cbranch_vccnz Lpoll_17
 s_branch Lback_16
Lretry_21:
 s_nop 7
 s_nop 3
 s_mov_b32 s55, 0
Lpoll_23:
 buffer_load_dword v12, v172, s[4:7], s33 offen sc1
 s_add_u32 s55, s55, 1
 s_cmp_gt_u32 s55, 0x80000
 s_cbranch_scc1 Lend
 s_waitcnt vmcnt(0)
 v_cmp_ne_u32 vcc, s56, v12
 s_cbranch_vccnz Lpoll_23
 s_branch Lback_22
Lretry_28:
 s_nop 7
 s_nop 3
 s_mov_b32 s55, 0
Lpoll_30:
 buffer_load_dword v12, v172, s[4:7], s33 offen sc1
 s_add_u32 s55, s55, 1
 s_cmp_gt_u32 s55, 0x80000
 s_cbranch_scc1 Lend
 s_waitcnt vmcnt(0)
 v_cmp_ne_u32 vcc, s56, v12
 s_cbranch_vccnz Lpoll_30
 s_branch Lback_29
Lretry_31:
 s_nop 7
 s_nop 3
 s_mov_b32 s55, 0
Lpoll_33:
 buffer_load_dword v12, v171, s[4:7], s28 offen sc1
 s_add_u32 s55, s55, 1
 s_cmp_gt_u32 s55, 0x80000
 s_cbranch_scc1 Lend
 s_waitcnt vmcnt(0)
 v_cmp_ne_u32 vcc, s56, v12
 s_cbranch_vccnz Lpoll_33
 s_branch Lback_32
Lretry_34:
 s_nop 7
 s_nop 3
 s_mov_b32 s55, 0
Lpoll_36:
 buffer_load_dword v12, v171, s[4:7], s28 offen sc1
 s_add_u32 s55, s55, 1
 s_cmp_gt_u32 s55, 0x80000
 s_cbranch_scc1 Lend
 s_waitcnt vmcnt(0)
 v_cmp_ne_u32 vcc, s56, v12
 s_cbranch_vccnz Lpoll_36
 s_branch Lback_35
Lfast_end:
Lend:
 s_endpgm
Lslow:
 s_mul_i32 s16, s54, 81920
 s_add_u32 s16, s16, 0
 s_lshl_b32 s17, s54, 12
 s_add_u32 s17, s17, 24641536
 s_mul_i32 s33, s49, 221184
 s_add_u32 s33, s33, 40108032
 s_lshl_b32 s34, s3, 12
 s_add_u32 s33, s33, s34
 s_mov_b32 m0, s34
 s_nop 0
 buffer_load_dwordx4 v0, s[4:7], s33 offen sc1  lds
 s_mov_b32 m0, s34
 s_nop 0
 buffer_load_dwordx4 v0, s[4:7], s33 offen offset:1024 sc1  lds
 s_mov_b32 m0, s34
 s_nop 0
 buffer_load_dwordx4 v0, s[4:7], s33 offen offset:2048 sc1  lds
 s_mov_b32 m0, s34
 s_nop 0
 buffer_load_dwordx4 v0, s[4:7], s33 offen offset:3072 sc1  lds
 s_add_u32 s33, s33, 16384
 s_add_u32 s34, s34, 16384
 s_mov_b32 m0, s34
 s_nop 0
 buffer_load_dwordx4 v0, s[4:7], s33 offen sc1  lds
 s_mov_b32 m0, s34
 s_nop 0
 buffer_load_dwordx4 v0, s[4:7], s33 offen offset:1024 sc1  lds
 s_mov_b32 m0, s34
 s_nop 0
 buffer_load_dwordx4 v0, s[4:7], s33 offen offset:2048 sc1  lds
 s_mov_b32 m0, s34
 s_nop 0
 buffer_load_dwordx4 v0, s[4:7], s33 offen offset:3072 sc1  lds
 s_add_u32 s33, s33, 16384
 s_add_u32 s34, s34, 16384
 ds_read_b128 a[36:39], v20
 ds_read_b128 a[44:47], v21
 ds_read_b128 a[52:55], v22
 ds_read_b128 a[60:63], v23
 ds_read_b128 a[64:67], v20 offset:16384
 ds_read_b128 a[72:75], v21 offset:16384
 ds_read_b128 a[80:83], v22 offset:16384
 ds_read_b128 a[88:91], v23 offset:16384
 ds_read_b128 a[68:71], v20 offset:32768
 ds_read_b128 a[76:79], v21 offset:32768
 ds_read_b128 a[84:87], v22 offset:32768
 ds_read_b128 a[92:95], v23 offset:32768
 ds_read_b128 a[96:99], v20 offset:49152
 ds_read_b128 a[104:107], v21 offset:49152
 ds_read_b128 a[112:115], v22 offset:49152
 ds_read_b128 a[120:123], v23 offset:49152
 ds_read_b128 a[100:103], v24
 ds_read_b128 a[108:111], v25
 ds_read_b128 a[116:119], v26
 ds_read_b128 a[124:127], v27
 ds_read_b128 a[128:131], v24 offset:16384
 ds_read_b128 a[136:139], v25 offset:16384
 ds_read_b128 a[144:147], v26 offset:16384
 ds_read_b128 a[152:155], v27 offset:16384
 ds_read_b128 a[132:135], v24 offset:32768
 ds_read_b128 a[140:143], v25 offset:32768
 ds_read_b128 a[148:151], v26 offset:32768
 ds_read_b128 a[156:159], v27 offset:32768
 s_mul_i32 s18, s51, 102400
 s_mul_i32 s19, s3, 25600
 s_add_u32 s18, s18, s19
 s_add_u32 s18, s18, 6553600
 s_mul_i32 s20, s54, 196608
 s_add_u32 s20, s20, 18350080
 s_mul_i32 s21, s50, 5120
 s_add_u32 s20, s20, s21
 s_lshr_b32 s22, s51, 1
 s_lshl_b32 s22, s22, 5
 s_add_u32 s22, s22, s59
 s_lshl_b32 s22, s22, 3
 s_add_u32 s22, s22, s20
 s_add_u32 s22, s22, 4096
 s_lshl_b32 s21, s51, 9
 s_add_u32 s20, s20, s21
 s_add_u32 s21, s20, 40960
 s_lshl_b32 s23, s54, 7
 s_add_u32 s23, s23, 7737344
 s_lshl_b32 s24, s49, 2
 s_add_u32 s23, s23, s24
 s_add_u32 s24, s24, s3
 s_mul_i32 s24, s24, 6144
 s_add_u32 s24, s24, 8388608
 s_xor_b32 s25, s48, 1
 s_mul_i32 s25, s25, 768
 s_add_u32 s25, s25, s24
 s_xor_b32 s26, s48, 2
 s_mul_i32 s26, s26, 768
 s_add_u32 s26, s26, s24
 s_xor_b32 s27, s48, 3
 s_mul_i32 s27, s27, 768
 s_add_u32 s27, s27, s24
 s_xor_b32 s28, s48, 4
 s_mul_i32 s28, s28, 768
 s_add_u32 s28, s28, s24
 s_xor_b32 s29, s48, 5
 s_mul_i32 s29, s29, 768
 s_add_u32 s29, s29, s24
 s_xor_b32 s30, s48, 6
 s_mul_i32 s30, s30, 768
 s_add_u32 s30, s30, s24
 s_xor_b32 s31, s48, 7
 s_mul_i32 s31, s31, 768
 s_add_u32 s31, s31, s24
 s_mul_i32 s32, s48, 768
 s_add_u32 s24, s24, s32
 s_waitcnt lgkmcnt(0)
 s_add_u32 s46, s44, 640
 s_add_u32 m0, s45, 32768
 s_nop 0
 buffer_load_dwordx4 v16, s[40:43], s46 offen lds
 s_add_u32 m0, s45, 32768
 s_nop 0
 buffer_load_dwordx4 v17, s[40:43], s46 offen offset:1024 lds
 s_add_u32 m0, s45, 32768
 s_nop 0
 buffer_load_dwordx4 v18, s[40:43], s46 offen offset:2048 lds
 s_add_u32 m0, s45, 32768
 s_nop 0
 buffer_load_dwordx4 v19, s[40:43], s46 offen offset:3072 lds
 s_waitcnt vmcnt(8)
 s_barrier
 ds_read_b128 v[224:227], v0
 ds_read_b128 v[228:231], v0 offset:1024
 ds_read_b128 v[232:235], v0 offset:2048
 ds_read_b128 v[236:239], v0 offset:3072
 ds_read_b128 v[240:243], v0 offset:4096
 s_waitcnt lgkmcnt(4)
 v_mfma_f32_32x32x16_bf16 v[44:59], v[224:227], a[0:3], 0
 s_mov_b32 m0, s34
 s_nop 0
 buffer_load_dwordx4 v0, s[4:7], s33 offen sc1  lds
 ds_read_b128 v[244:247], v0 offset:5120
 s_add_u32 s56, s52, 12
 v_mov_b32 v12, s56
 v_mov_b32 v13, s56
 v_mov_b32 v14, s56
 v_mfma_f32_32x32x16_bf16 v[60:75], v[224:227], a[4:7], 0
 s_add_u32 s46, s44, 41600
 s_add_u32 m0, s45, 49152
 s_nop 0
 buffer_load_dwordx4 v16, s[40:43], s46 offen lds
 v_mov_b32 v15, s56
 s_lshl_b32 s39, s2, 7
 s_add_u32 s39, s39, 7798784
 s_cmp_eq_u32 s3, 0
 s_cselect_b32 s36, 0, 1073741824
 s_waitcnt lgkmcnt(4)
 v_mfma_f32_32x32x16_bf16 v[76:91], v[228:231], a[0:3], 0
 ds_read_b128 v[248:251], v0 offset:6144
 v_add_u32 v166, s36, v0
 s_mov_b64 exec, 0xff
 buffer_store_dwordx4 v[12:15], v166, s[4:7], s39 offen sc1
 s_mov_b64 exec, -1
 s_mov_b32 s39, 7798784
 s_mul_i32 s47, s51, 884736
 v_mfma_f32_32x32x16_bf16 v[92:107], v[228:231], a[4:7], 0
 s_add_u32 m0, s45, 49152
 s_nop 0
 buffer_load_dwordx4 v17, s[40:43], s46 offen offset:1024 lds
 s_mul_i32 s36, s3, 221184
 s_add_u32 s47, s47, s36
 s_add_u32 s47, s47, 40288256
 s_waitcnt lgkmcnt(4)
 v_mfma_f32_32x32x16_bf16 v[44:59], v[232:235], a[8:11], v[44:59]
 ds_read_b128 v[252:255], v0 offset:7168
 v_mfma_f32_32x32x16_bf16 v[60:75], v[232:235], a[12:15], v[60:75]
 s_add_u32 m0, s45, 49152
 s_nop 0
 buffer_load_dwordx4 v18, s[40:43], s46 offen offset:2048 lds
 s_waitcnt lgkmcnt(4)
 v_mfma_f32_32x32x16_bf16 v[76:91], v[236:239], a[8:11], v[76:91]
 ds_read_b128 v[224:227], v0 offset:8192
 v_mfma_f32_32x32x16_bf16 v[92:107], v[236:239], a[12:15], v[92:107]
 s_add_u32 m0, s45, 49152
 s_nop 0
 buffer_load_dwordx4 v19, s[40:43], s46 offen offset:3072 lds
 s_waitcnt lgkmcnt(4)
 v_mfma_f32_32x32x16_bf16 v[44:59], v[240:243], a[16:19], v[44:59]
 s_mov_b32 m0, s34
 s_nop 0
 buffer_load_dwordx4 v0, s[4:7], s33 offen offset:1024 sc1  lds
 ds_read_b128 v[228:231], v0 offset:9216
 v_mfma_f32_32x32x16_bf16 v[60:75], v[240:243], a[20:23], v[60:75]
 s_waitcnt lgkmcnt(4)
 v_mfma_f32_32x32x16_bf16 v[76:91], v[244:247], a[16:19], v[76:91]
 ds_read_b128 v[232:235], v0 offset:10240
 v_mfma_f32_32x32x16_bf16 v[92:107], v[244:247], a[20:23], v[92:107]
 s_waitcnt lgkmcnt(4)
 v_mfma_f32_32x32x16_bf16 v[44:59], v[248:251], a[24:27], v[44:59]
 ds_read_b128 v[236:239], v0 offset:11264
 v_mfma_f32_32x32x16_bf16 v[60:75], v[248:251], a[28:31], v[60:75]
 s_waitcnt vmcnt(7)
 ds_read_b128 a[160:163], v20 offset:32768
 s_add_u32 s46, s44, 768
 s_add_u32 m0, s45, 65536
 s_nop 0
 buffer_load_dwordx4 v16, s[40:43], s46 offen lds
 s_waitcnt lgkmcnt(5)
 v_mfma_f32_32x32x16_bf16 v[76:91], v[252:255], a[24:27], v[76:91]
 ds_read_b128 a[168:171], v21 offset:32768
 ds_read_b128 v[240:243], v0 offset:12288
 v_mfma_f32_32x32x16_bf16 v[92:107], v[252:255], a[28:31], v[92:107]
 ds_read_b128 a[176:179], v22 offset:32768
 s_add_u32 m0, s45, 65536
 s_nop 0
 buffer_load_dwordx4 v17, s[40:43], s46 offen offset:1024 lds
 s_waitcnt lgkmcnt(7)
 v_mfma_f32_32x32x16_bf16 v[44:59], v[224:227], a[32:35], v[44:59]
 s_mov_b32 m0, s34
 s_nop 0
 buffer_load_dwordx4 v0, s[4:7], s33 offen offset:2048 sc1  lds
 ds_read_b128 a[184:187], v23 offset:32768
 ds_read_b128 v[244:247], v0 offset:13312
 v_mfma_f32_32x32x16_bf16 v[60:75], v[224:227], a[36:39], v[60:75]
 s_add_u32 m0, s45, 65536
 s_nop 0
 buffer_load_dwordx4 v18, s[40:43], s46 offen offset:2048 lds
 s_waitcnt lgkmcnt(8)
 v_mfma_f32_32x32x16_bf16 v[76:91], v[228:231], a[32:35], v[76:91]
 ds_read_b128 v[248:251], v0 offset:14336
 v_mfma_f32_32x32x16_bf16 v[92:107], v[228:231], a[36:39], v[92:107]
 s_add_u32 m0, s45, 65536
 s_nop 0
 buffer_load_dwordx4 v19, s[40:43], s46 offen offset:3072 lds
 s_waitcnt lgkmcnt(8)
 v_mfma_f32_32x32x16_bf16 v[44:59], v[232:235], a[40:43], v[44:59]
 ds_read_b128 v[252:255], v0 offset:15360
 v_mfma_f32_32x32x16_bf16 v[60:75], v[232:235], a[44:47], v[60:75]
 s_waitcnt lgkmcnt(8)
 v_mfma_f32_32x32x16_bf16 v[76:91], v[236:239], a[40:43], v[76:91]
 s_barrier
 ds_read_b128 v[224:227], v0 offset:16384
 v_mfma_f32_32x32x16_bf16 v[92:107], v[236:239], a[44:47], v[92:107]
 s_waitcnt lgkmcnt(6)
 v_mfma_f32_32x32x16_bf16 v[44:59], v[240:243], a[48:51], v[44:59]
 s_mov_b32 m0, s34
 s_nop 0
 buffer_load_dwordx4 v0, s[4:7], s33 offen offset:3072 sc1  lds
 s_add_u32 s33, s33, 16384
 s_add_u32 s34, s34, 16384
 ds_read_b128 v[228:231], v0 offset:17408
 v_mfma_f32_32x32x16_bf16 v[60:75], v[240:243], a[52:55], v[60:75]
 s_waitcnt vmcnt(7)
 ds_read_b128 a[164:167], v20 offset:49152
 s_waitcnt lgkmcnt(6)
 s_add_u32 s46, s44, 41728
 s_add_u32 m0, s45, 32768
 s_nop 0
 buffer_load_dwordx4 v16, s[40:43], s46 offen lds
 s_waitcnt lgkmcnt(5)
 v_mfma_f32_32x32x16_bf16 v[76:91], v[244:247], a[48:51], v[76:91]
 ds_read_b128 a[172:175], v21 offset:49152
 ds_read_b128 v[232:235], v0 offset:18432
 v_mfma_f32_32x32x16_bf16 v[92:107], v[244:247], a[52:55], v[92:107]
 ds_read_b128 a[180:183], v22 offset:49152
 s_add_u32 m0, s45, 32768
 s_nop 0
 buffer_load_dwordx4 v17, s[40:43], s46 offen offset:1024 lds
 s_waitcnt lgkmcnt(7)
 v_mfma_f32_32x32x16_bf16 v[44:59], v[248:251], a[56:59], v[44:59]
 ds_read_b128 a[188:191], v23 offset:49152
 ds_read_b128 v[236:239], v0 offset:19456
 v_mfma_f32_32x32x16_bf16 v[60:75], v[248:251], a[60:63], v[60:75]
 s_add_u32 m0, s45, 32768
 s_nop 0
 buffer_load_dwordx4 v18, s[40:43], s46 offen offset:2048 lds
 s_waitcnt lgkmcnt(8)
 v_mfma_f32_32x32x16_bf16 v[76:91], v[252:255], a[56:59], v[76:91]
 ds_read_b128 v[240:243], v0 offset:20480
 s_mul_i32 s35, s49, 5120
 s_mul_i32 s36, s3, 1280
 s_add_u32 s35, s35, s36
 s_add_u32 s35, s35, 7405568
 s_add_u32 m0, s36, 143360
 v_lshrrev_b32 v164, 2, v0
 buffer_load_dwordx4 v0, s[4:7], s35 offen sc1 lds
 buffer_load_dword v164, s[4:7], s35 offen offset:1024 sc1 lds
 v_mfma_f32_32x32x16_bf16 v[92:107], v[252:255], a[60:63], v[92:107]
 s_add_u32 m0, s45, 32768
 s_nop 0
 buffer_load_dwordx4 v19, s[40:43], s46 offen offset:3072 lds
 s_waitcnt lgkmcnt(8)
 v_mfma_f32_32x32x16_bf16 v[44:59], v[224:227], a[64:67], v[44:59]
 s_mov_b32 m0, s34
 s_nop 0
 buffer_load_dwordx4 v0, s[4:7], s33 offen sc1  lds
 ds_read_b128 v[244:247], v0 offset:21504
 v_mfma_f32_32x32x16_bf16 v[60:75], v[224:227], a[68:71], v[60:75]
 s_waitcnt lgkmcnt(8)
 v_mfma_f32_32x32x16_bf16 v[76:91], v[228:231], a[64:67], v[76:91]
 ds_read_b128 v[248:251], v0 offset:22528
 v_mfma_f32_32x32x16_bf16 v[92:107], v[228:231], a[68:71], v[92:107]
 s_waitcnt lgkmcnt(6)
 v_mfma_f32_32x32x16_bf16 v[44:59], v[232:235], a[72:75], v[44:59]
 ds_read_b128 v[252:255], v0 offset:23552
 v_mfma_f32_32x32x16_bf16 v[60:75], v[232:235], a[76:79], v[60:75]
 s_waitcnt vmcnt(8)
 ds_read_b128 a[192:195], v24
 s_waitcnt lgkmcnt(6)
 s_add_u32 s46, s44, 896
 s_add_u32 m0, s45, 49152
 s_nop 0
 buffer_load_dwordx4 v16, s[40:43], s46 offen lds
 s_waitcnt lgkmcnt(5)
 v_mfma_f32_32x32x16_bf16 v[76:91], v[236:239], a[72:75], v[76:91]
 ds_read_b128 a[200:203], v25
 ds_read_b128 v[224:227], v0 offset:24576
 v_mfma_f32_32x32x16_bf16 v[92:107], v[236:239], a[76:79], v[92:107]
 ds_read_b128 a[208:211], v26
 s_add_u32 m0, s45, 49152
 s_nop 0
 buffer_load_dwordx4 v17, s[40:43], s46 offen offset:1024 lds
 s_waitcnt lgkmcnt(7)
 v_mfma_f32_32x32x16_bf16 v[44:59], v[240:243], a[80:83], v[44:59]
 s_mov_b32 m0, s34
 s_nop 0
 buffer_load_dwordx4 v0, s[4:7], s33 offen offset:1024 sc1  lds
 ds_read_b128 a[216:219], v27
 ds_read_b128 v[228:231], v0 offset:25600
 v_mfma_f32_32x32x16_bf16 v[60:75], v[240:243], a[84:87], v[60:75]
 s_add_u32 m0, s45, 49152
 s_nop 0
 buffer_load_dwordx4 v18, s[40:43], s46 offen offset:2048 lds
 s_waitcnt lgkmcnt(8)
 v_mfma_f32_32x32x16_bf16 v[76:91], v[244:247], a[80:83], v[76:91]
 ds_read_b128 v[232:235], v0 offset:26624
 v_mfma_f32_32x32x16_bf16 v[92:107], v[244:247], a[84:87], v[92:107]
 s_add_u32 m0, s45, 49152
 s_nop 0
 buffer_load_dwordx4 v19, s[40:43], s46 offen offset:3072 lds
 s_waitcnt lgkmcnt(8)
 v_mfma_f32_32x32x16_bf16 v[44:59], v[248:251], a[88:91], v[44:59]
 ds_read_b128 v[236:239], v0 offset:27648
 v_mfma_f32_32x32x16_bf16 v[60:75], v[248:251], a[92:95], v[60:75]
 s_waitcnt lgkmcnt(8)
 v_mfma_f32_32x32x16_bf16 v[76:91], v[252:255], a[88:91], v[76:91]
 ds_read_b128 v[240:243], v0 offset:28672
 v_mfma_f32_32x32x16_bf16 v[92:107], v[252:255], a[92:95], v[92:107]
 s_waitcnt lgkmcnt(6)
 v_mfma_f32_32x32x16_bf16 v[44:59], v[224:227], a[96:99], v[44:59]
 s_mov_b32 m0, s34
 s_nop 0
 buffer_load_dwordx4 v0, s[4:7], s33 offen offset:2048 sc1  lds
 ds_read_b128 v[244:247], v0 offset:29696
 v_mfma_f32_32x32x16_bf16 v[60:75], v[224:227], a[100:103], v[60:75]
 s_waitcnt vmcnt(7)
 ds_read_b128 a[196:199], v20 offset:32768
 s_waitcnt lgkmcnt(6)
 s_add_u32 s46, s44, 41856
 s_add_u32 m0, s45, 65536
 s_nop 0
 buffer_load_dwordx4 v16, s[40:43], s46 offen lds
 s_waitcnt lgkmcnt(5)
 v_mfma_f32_32x32x16_bf16 v[76:91], v[228:231], a[96:99], v[76:91]
 ds_read_b128 a[204:207], v21 offset:32768
 ds_read_b128 v[248:251], v0 offset:30720
 v_mfma_f32_32x32x16_bf16 v[92:107], v[228:231], a[100:103], v[92:107]
 ds_read_b128 a[212:215], v22 offset:32768
 s_add_u32 m0, s45, 65536
 s_nop 0
 buffer_load_dwordx4 v17, s[40:43], s46 offen offset:1024 lds
 s_waitcnt lgkmcnt(7)
 v_mfma_f32_32x32x16_bf16 v[44:59], v[232:235], a[104:107], v[44:59]
 ds_read_b128 a[220:223], v23 offset:32768
 ds_read_b128 v[252:255], v0 offset:31744
 v_mfma_f32_32x32x16_bf16 v[60:75], v[232:235], a[108:111], v[60:75]
 s_add_u32 m0, s45, 65536
 s_nop 0
 buffer_load_dwordx4 v18, s[40:43], s46 offen offset:2048 lds
 s_waitcnt lgkmcnt(8)
 v_mfma_f32_32x32x16_bf16 v[76:91], v[236:239], a[104:107], v[76:91]
 s_barrier
 ds_read_b128 v[224:227], v0 offset:32768
 v_mfma_f32_32x32x16_bf16 v[92:107], v[236:239], a[108:111], v[92:107]
 s_add_u32 m0, s45, 65536
 s_nop 0
 buffer_load_dwordx4 v19, s[40:43], s46 offen offset:3072 lds
 s_waitcnt lgkmcnt(8)
 v_mfma_f32_32x32x16_bf16 v[44:59], v[240:243], a[112:115], v[44:59]
 s_mov_b32 m0, s34
 s_nop 0
 buffer_load_dwordx4 v0, s[4:7], s33 offen offset:3072 sc1  lds
 s_add_u32 s33, s33, 16384
 s_add_u32 s34, s34, 16384
 ds_read_b128 v[228:231], v0 offset:33792
 v_mfma_f32_32x32x16_bf16 v[60:75], v[240:243], a[116:119], v[60:75]
 s_waitcnt lgkmcnt(8)
 v_mfma_f32_32x32x16_bf16 v[76:91], v[244:247], a[112:115], v[76:91]
 ds_read_b128 v[232:235], v0 offset:34816
 v_mfma_f32_32x32x16_bf16 v[92:107], v[244:247], a[116:119], v[92:107]
 s_waitcnt lgkmcnt(6)
 v_mfma_f32_32x32x16_bf16 v[44:59], v[248:251], a[120:123], v[44:59]
 ds_read_b128 v[236:239], v0 offset:35840
 buffer_load_dwordx4 v[144:147], v0, s[4:7], s17 offen sc1
 v_mfma_f32_32x32x16_bf16 v[60:75], v[248:251], a[124:127], v[60:75]
 s_waitcnt vmcnt(7)
 ds_read_b128 a[224:227], v20 offset:49152
 s_waitcnt lgkmcnt(6)
 s_add_u32 s46, s44, 1024
 s_add_u32 m0, s45, 32768
 s_nop 0
 buffer_load_dwordx4 v16, s[40:43], s46 offen lds
 s_waitcnt lgkmcnt(5)
 v_mfma_f32_32x32x16_bf16 v[76:91], v[252:255], a[120:123], v[76:91]
 ds_read_b128 a[232:235], v21 offset:49152
 ds_read_b128 v[240:243], v0 offset:36864
 v_mfma_f32_32x32x16_bf16 v[92:107], v[252:255], a[124:127], v[92:107]
 ds_read_b128 a[0:3], v22 offset:49152
 s_add_u32 m0, s45, 32768
 s_nop 0
 buffer_load_dwordx4 v17, s[40:43], s46 offen offset:1024 lds
 s_waitcnt lgkmcnt(7)
 v_mfma_f32_32x32x16_bf16 v[44:59], v[224:227], a[128:131], v[44:59]
 s_mov_b32 m0, s34
 s_nop 0
 buffer_load_dwordx4 v0, s[4:7], s33 offen sc1  lds
 ds_read_b128 a[8:11], v23 offset:49152
 ds_read_b128 v[244:247], v0 offset:37888
 buffer_load_dwordx4 v[148:151], v0, s[4:7], s17 offen offset:1024 sc1
 v_mfma_f32_32x32x16_bf16 v[60:75], v[224:227], a[132:135], v[60:75]
 s_add_u32 m0, s45, 32768
 s_nop 0
 buffer_load_dwordx4 v18, s[40:43], s46 offen offset:2048 lds
 s_waitcnt lgkmcnt(8)
 v_mfma_f32_32x32x16_bf16 v[76:91], v[228:231], a[128:131], v[76:91]
 ds_read_b128 v[248:251], v0 offset:38912
 v_mfma_f32_32x32x16_bf16 v[92:107], v[228:231], a[132:135], v[92:107]
 s_add_u32 m0, s45, 32768
 s_nop 0
 buffer_load_dwordx4 v19, s[40:43], s46 offen offset:3072 lds
 s_waitcnt lgkmcnt(8)
 v_mfma_f32_32x32x16_bf16 v[44:59], v[232:235], a[136:139], v[44:59]
 ds_read_b128 v[252:255], v0 offset:39936
 buffer_load_dwordx4 v[152:155], v0, s[4:7], s17 offen offset:2048 sc1
 v_mfma_f32_32x32x16_bf16 v[60:75], v[232:235], a[140:143], v[60:75]
 s_waitcnt lgkmcnt(8)
 v_mfma_f32_32x32x16_bf16 v[76:91], v[236:239], a[136:139], v[76:91]
 ds_read_b128 v[224:227], v0 offset:40960
 v_mfma_f32_32x32x16_bf16 v[92:107], v[236:239], a[140:143], v[92:107]
 s_waitcnt lgkmcnt(6)
 v_mfma_f32_32x32x16_bf16 v[44:59], v[240:243], a[144:147], v[44:59]
 s_mov_b32 m0, s34
 s_nop 0
 buffer_load_dwordx4 v0, s[4:7], s33 offen offset:1024 sc1  lds
 ds_read_b128 v[228:231], v0 offset:41984
 buffer_load_dwordx4 v[156:159], v0, s[4:7], s17 offen offset:3072 sc1
 v_mfma_f32_32x32x16_bf16 v[60:75], v[240:243], a[148:151], v[60:75]
 s_waitcnt vmcnt(11)
 ds_read_b128 a[228:231], v24
 s_waitcnt lgkmcnt(6)
 s_add_u32 s46, s44, 41984
 s_add_u32 m0, s45, 49152
 s_nop 0
 buffer_load_dwordx4 v16, s[40:43], s46 offen lds
 s_waitcnt lgkmcnt(5)
 v_mfma_f32_32x32x16_bf16 v[76:91], v[244:247], a[144:147], v[76:91]
 ds_read_b128 a[236:239], v25
 ds_read_b128 v[232:235], v0 offset:43008
 v_mfma_f32_32x32x16_bf16 v[92:107], v[244:247], a[148:151], v[92:107]
 ds_read_b128 a[4:7], v26
 s_add_u32 m0, s45, 49152
 s_nop 0
 buffer_load_dwordx4 v17, s[40:43], s46 offen offset:1024 lds
 s_waitcnt lgkmcnt(7)
 v_mfma_f32_32x32x16_bf16 v[44:59], v[248:251], a[152:155], v[44:59]
 ds_read_b128 a[12:15], v27
 ds_read_b128 v[236:239], v0 offset:44032
 v_mfma_f32_32x32x16_bf16 v[60:75], v[248:251], a[156:159], v[60:75]
 s_add_u32 m0, s45, 49152
 s_nop 0
 buffer_load_dwordx4 v18, s[40:43], s46 offen offset:2048 lds
 s_waitcnt lgkmcnt(8)
 v_mfma_f32_32x32x16_bf16 v[76:91], v[252:255], a[152:155], v[76:91]
 ds_read_b128 v[240:243], v0 offset:45056
 v_mfma_f32_32x32x16_bf16 v[92:107], v[252:255], a[156:159], v[92:107]
 s_add_u32 m0, s45, 49152
 s_nop 0
 buffer_load_dwordx4 v19, s[40:43], s46 offen offset:3072 lds
 s_waitcnt lgkmcnt(8)
 v_mfma_f32_32x32x16_bf16 v[44:59], v[224:227], a[160:163], v[44:59]
 s_mov_b32 m0, s34
 s_nop 0
 buffer_load_dwordx4 v0, s[4:7], s33 offen offset:2048 sc1  lds
 ds_read_b128 v[244:247], v0 offset:46080
 v_mfma_f32_32x32x16_bf16 v[60:75], v[224:227], a[164:167], v[60:75]
 s_waitcnt lgkmcnt(8)
 v_mfma_f32_32x32x16_bf16 v[76:91], v[228:231], a[160:163], v[76:91]
 ds_read_b128 v[248:251], v0 offset:47104
 v_mfma_f32_32x32x16_bf16 v[92:107], v[228:231], a[164:167], v[92:107]
 s_waitcnt lgkmcnt(6)
 v_mfma_f32_32x32x16_bf16 v[44:59], v[232:235], a[168:171], v[44:59]
 ds_read_b128 v[252:255], v0 offset:48128
 v_mfma_f32_32x32x16_bf16 v[60:75], v[232:235], a[172:175], v[60:75]
 s_waitcnt vmcnt(8)
 ds_read_b128 a[16:19], v20 offset:32768
 s_waitcnt lgkmcnt(6)
 s_add_u32 s46, s44, 1152
 s_add_u32 m0, s45, 65536
 s_nop 0
 buffer_load_dwordx4 v16, s[40:43], s46 offen lds
 s_waitcnt lgkmcnt(5)
 v_mfma_f32_32x32x16_bf16 v[76:91], v[236:239], a[168:171], v[76:91]
 s_barrier
 ds_read_b128 a[24:27], v21 offset:32768
 ds_read_b128 v[224:227], v0 offset:49152
 v_mfma_f32_32x32x16_bf16 v[92:107], v[236:239], a[172:175], v[92:107]
 ds_read_b128 a[32:35], v22 offset:32768
 s_add_u32 m0, s45, 65536
 s_nop 0
 buffer_load_dwordx4 v17, s[40:43], s46 offen offset:1024 lds
 s_waitcnt lgkmcnt(7)
 v_mfma_f32_32x32x16_bf16 v[44:59], v[240:243], a[176:179], v[44:59]
 s_mov_b32 m0, s34
 s_nop 0
 buffer_load_dwordx4 v0, s[4:7], s33 offen offset:3072 sc1  lds
 s_add_u32 s33, s33, 16384
 s_add_u32 s34, s34, 16384
 ds_read_b128 a[40:43], v23 offset:32768
 ds_read_b128 v[228:231], v0 offset:50176
 v_lshrrev_b32 v165, 2, v0
 v_add_u32 v165, 143360, v165
 v_mfma_f32_32x32x16_bf16 v[60:75], v[240:243], a[180:183], v[60:75]
 s_add_u32 m0, s45, 65536
 s_nop 0
 buffer_load_dwordx4 v18, s[40:43], s46 offen offset:2048 lds
 ds_read2st64_b32 v[108:109], v165 offset0:0 offset1:1
 s_waitcnt lgkmcnt(9)
 v_mfma_f32_32x32x16_bf16 v[76:91], v[244:247], a[176:179], v[76:91]
 ds_read_b128 v[232:235], v0 offset:51200
 ds_read2st64_b32 v[110:111], v165 offset0:2 offset1:3
 ds_read2st64_b32 v[112:113], v165 offset0:4 offset1:5
 v_mfma_f32_32x32x16_bf16 v[92:107], v[244:247], a[180:183], v[92:107]
 s_add_u32 m0, s45, 65536
 s_nop 0
 buffer_load_dwordx4 v19, s[40:43], s46 offen offset:3072 lds
 ds_read2st64_b32 v[114:115], v165 offset0:6 offset1:7
 s_waitcnt lgkmcnt(12)
 v_mfma_f32_32x32x16_bf16 v[44:59], v[248:251], a[184:187], v[44:59]
 ds_read_b128 v[236:239], v0 offset:52224
 ds_read2st64_b32 v[116:117], v165 offset0:8 offset1:9
 s_waitcnt lgkmcnt(6)
 v_add_f32 v108, v108, v109
 v_mfma_f32_32x32x16_bf16 v[60:75], v[248:251], a[188:191], v[60:75]
 s_waitcnt lgkmcnt(4)
 v_add_f32 v108, v108, v110
 v_mfma_f32_32x32x16_bf16 v[76:91], v[252:255], a[184:187], v[76:91]
 ds_read_b128 v[240:243], v0 offset:53248
 v_add_f32 v108, v108, v111
 s_waitcnt lgkmcnt(4)
 v_add_f32 v108, v108, v112
 v_mfma_f32_32x32x16_bf16 v[92:107], v[252:255], a[188:191], v[92:107]
 v_add_f32 v108, v108, v113
 v_mfma_f32_32x32x16_bf16 v[44:59], v[224:227], a[192:195], v[44:59]
 ds_read_b128 v[244:247], v0 offset:54272
 s_waitcnt lgkmcnt(4)
 v_add_f32 v108, v108, v114
 v_add_f32 v108, v108, v115
 v_mfma_f32_32x32x16_bf16 v[60:75], v[224:227], a[196:199], v[60:75]
 s_waitcnt vmcnt(6)
 ds_read_b128 a[20:23], v20 offset:49152
 s_add_u32 s46, s44, 42112
 s_add_u32 m0, s45, 32768
 s_nop 0
 buffer_load_dwordx4 v16, s[40:43], s46 offen lds
 s_waitcnt lgkmcnt(3)
 v_add_f32 v108, v108, v116
 v_mfma_f32_32x32x16_bf16 v[76:91], v[228:231], a[192:195], v[76:91]
 ds_read_b128 a[28:31], v21 offset:49152
 ds_read_b128 v[248:251], v0 offset:55296
 v_add_f32 v108, v108, v117
 ds_read2st64_b32 v[110:111], v165 offset0:10 offset1:11
 v_mfma_f32_32x32x16_bf16 v[92:107], v[228:231], a[196:199], v[92:107]
 ds_read_b128 a[36:39], v22 offset:49152
 s_add_u32 m0, s45, 32768
 s_nop 0
 buffer_load_dwordx4 v17, s[40:43], s46 offen offset:1024 lds
 ds_read2st64_b32 v[112:113], v165 offset0:12 offset1:13
 v_mfma_f32_32x32x16_bf16 v[44:59], v[232:235], a[200:203], v[44:59]
 ds_read_b128 a[44:47], v23 offset:49152
 ds_read_b128 v[252:255], v0 offset:56320
 ds_read2st64_b32 v[114:115], v165 offset0:14 offset1:15
 ds_read2st64_b32 v[116:117], v165 offset0:16 offset1:17
 v_mfma_f32_32x32x16_bf16 v[60:75], v[232:235], a[204:207], v[60:75]
 s_add_u32 m0, s45, 32768
 s_nop 0
 buffer_load_dwordx4 v18, s[40:43], s46 offen offset:2048 lds
 s_waitcnt lgkmcnt(6)
 v_add_f32 v108, v108, v110
 v_mfma_f32_32x32x16_bf16 v[76:91], v[236:239], a[200:203], v[76:91]
 ds_read_b128 v[224:227], v0 offset:57344
 v_add_f32 v108, v108, v111
 s_waitcnt lgkmcnt(5)
 v_add_f32 v108, v108, v112
 v_mfma_f32_32x32x16_bf16 v[92:107], v[236:239], a[204:207], v[92:107]
 s_add_u32 m0, s45, 32768
 s_nop 0
 buffer_load_dwordx4 v19, s[40:43], s46 offen offset:3072 lds
 v_add_f32 v108, v108, v113
 v_mfma_f32_32x32x16_bf16 v[44:59], v[240:243], a[208:211], v[44:59]
 ds_read_b128 v[228:231], v0 offset:58368
 s_waitcnt lgkmcnt(3)
 v_add_f32 v108, v108, v114
 v_add_f32 v108, v108, v115
 buffer_load_dword v12, v205, s[4:7], s39 offen sc1
 v_mfma_f32_32x32x16_bf16 v[60:75], v[240:243], a[212:215], v[60:75]
 s_waitcnt lgkmcnt(2)
 v_add_f32 v108, v108, v116
 v_mfma_f32_32x32x16_bf16 v[76:91], v[244:247], a[208:211], v[76:91]
 ds_read_b128 v[232:235], v0 offset:59392
 v_add_f32 v108, v108, v117
 ds_read2st64_b32 v[110:111], v165 offset0:18 offset1:19
 v_mfma_f32_32x32x16_bf16 v[92:107], v[244:247], a[212:215], v[92:107]
 s_waitcnt lgkmcnt(0)
 v_add_f32 v108, v108, v110
 v_mfma_f32_32x32x16_bf16 v[44:59], v[248:251], a[216:219], v[44:59]
 ds_read_b128 v[236:239], v0 offset:60416
 v_add_f32 v108, v108, v111
 v_cvt_pk_bf16_f32 v109, v108, v108
 v_mfma_f32_32x32x16_bf16 v[60:75], v[248:251], a[220:223], v[60:75]
 s_waitcnt vmcnt(5)
 ds_read_b128 a[48:51], v24
 v_lshlrev_b32 v109, 16, v109
 v_mfma_f32_32x32x16_bf16 v[76:91], v[252:255], a[216:219], v[76:91]
 ds_read_b128 a[56:59], v25
 ds_read_b128 v[240:243], v0 offset:61440
 v_sub_f32 v110, v108, v109
 v_cvt_pk_bf16_f32 v108, v109, v110
 v_mfma_f32_32x32x16_bf16 v[92:107], v[252:255], a[220:223], v[92:107]
 ds_read_b128 a[64:67], v26
 v_cmp_gt_u32 vcc, 512, v0
 v_mfma_f32_32x32x16_bf16 v[44:59], v[224:227], a[224:227], v[44:59]
 ds_read_b128 a[72:75], v27
 ds_read_b128 v[244:247], v0 offset:62464
 v_cndmask_b32 v109, 0, v108, vcc
 v_cndmask_b32 v110, v108, 0, vcc
 v_mfma_f32_32x32x16_bf16 v[60:75], v[224:227], a[228:231], v[60:75]
 v_accvgpr_write_b32 a240, v109
 v_mfma_f32_32x32x16_bf16 v[76:91], v[228:231], a[224:227], v[76:91]
 ds_read_b128 v[248:251], v0 offset:63488
 v_accvgpr_write_b32 a241, v109
 v_accvgpr_write_b32 a242, v110
 v_mfma_f32_32x32x16_bf16 v[92:107], v[228:231], a[228:231], v[92:107]
 v_accvgpr_write_b32 a243, v110
 v_mfma_f32_32x32x16_bf16 v[44:59], v[232:235], a[232:235], v[44:59]
 ds_read_b128 v[252:255], v0 offset:64512
 v_mfma_f32_32x32x16_bf16 v[60:75], v[232:235], a[236:239], v[60:75]
 s_waitcnt lgkmcnt(8)
 v_mfma_f32_32x32x16_bf16 v[76:91], v[236:239], a[232:235], v[76:91]
 s_barrier
 ds_read_b128 v[224:227], v1
 v_mfma_f32_32x32x16_bf16 v[92:107], v[236:239], a[236:239], v[92:107]
 v_add_f32 v144, v144, v145
 v_add_f32 v148, v148, v149
 s_waitcnt lgkmcnt(6)
 v_mfma_f32_32x32x16_bf16 v[44:59], v[240:243], a[0:3], v[44:59]
 ds_read_b128 v[228:231], v1 offset:1024
 v_add_f32 v144, v144, v146
 s_lshl_b32 s62, s48, 5
 s_add_u32 s62, s62, s49
 s_lshl_b32 s62, s62, 2
 s_add_u32 s62, s62, s3
 v_lshlrev_b32 v165, 3, v0
 s_mul_i32 s63, s62, 2560
 s_add_u32 s63, s63, 0
 s_mov_b32 exec_lo, 0xfffff
 s_mov_b32 exec_hi, 0x0
 buffer_load_dword v164, v165, s[8:11], s63 offen sc1
 s_mov_b64 exec, -1
 v_mfma_f32_32x32x16_bf16 v[60:75], v[240:243], a[4:7], v[60:75]
 s_waitcnt vmcnt(2)
 ds_read_b128 a[52:55], v20 offset:32768
 v_add_f32 v148, v148, v150
 v_add_f32 v144, v144, v147
 s_waitcnt lgkmcnt(5)
 v_mfma_f32_32x32x16_bf16 v[76:91], v[244:247], a[0:3], v[76:91]
 ds_read_b128 a[60:63], v21 offset:32768
 ds_read_b128 v[232:235], v1 offset:2048
 v_add_f32 v148, v148, v151
 s_waitcnt vmcnt(1)
 v_cmp_ne_u32 vcc, s56, v12
 s_cbranch_vccnz Lretry_37
Lback_38:
 v_mfma_f32_32x32x16_bf16 v[92:107], v[244:247], a[4:7], v[92:107]
 ds_read_b128 a[68:71], v22 offset:32768
 v_permlane16_swap_b32 v144, v148
 v_add_f32 v144, v144, v148
 buffer_load_dwordx4 v[176:179], v0, s[4:7], s18 offen sc1
 s_waitcnt lgkmcnt(7)
 v_mfma_f32_32x32x16_bf16 v[44:59], v[248:251], a[8:11], v[44:59]
 ds_read_b128 a[76:79], v23 offset:32768
 ds_read_b128 v[236:239], v1 offset:3072
 v_mov_b32 v145, v144
 v_mfma_f32_32x32x16_bf16 v[60:75], v[248:251], a[12:15], v[60:75]
 s_nop 0
 v_permlane32_swap_b32 v144, v145
 v_mul_f32 v144, 0xbacccccd, v144
 s_waitcnt lgkmcnt(8)
 v_mfma_f32_32x32x16_bf16 v[76:91], v[252:255], a[8:11], v[76:91]
 ds_read_b128 v[240:243], v1 offset:4096
 v_mul_f32 v145, 0x3acccccd, v145
 buffer_load_dwordx4 v[180:183], v0, s[4:7], s18 offen offset:1024 sc1
 v_mfma_f32_32x32x16_bf16 v[92:107], v[252:255], a[12:15], v[92:107]
 v_fma_f32 v145, -v144, v144, v145
 v_max_f32 v145, 0, v145
 s_waitcnt lgkmcnt(8)
 v_mfma_f32_32x32x16_bf16 v[44:59], v[224:227], a[16:19], v[44:59]
 ds_read_b128 v[244:247], v1 offset:5120
 v_add_f32 v145, 0x3727c5ac, v145
 v_mfma_f32_32x32x16_bf16 v[60:75], v[224:227], a[20:23], v[60:75]
 v_rsq_f32 v146, v145
 v_cvt_pk_bf16_f32 v160, v144, v144
 buffer_load_dwordx4 v[184:187], v0, s[4:7], s18 offen offset:2048 sc1
 s_waitcnt lgkmcnt(8)
 v_mfma_f32_32x32x16_bf16 v[76:91], v[228:231], a[16:19], v[76:91]
 ds_read_b128 v[248:251], v1 offset:6144
 v_lshlrev_b32 v147, 16, v160
 v_mfma_f32_32x32x16_bf16 v[92:107], v[228:231], a[20:23], v[92:107]
 v_sub_f32 v147, v144, v147
 v_cvt_pk_bf16_f32 v161, v147, v147
 s_waitcnt lgkmcnt(6)
 v_mfma_f32_32x32x16_bf16 v[44:59], v[232:235], a[24:27], v[44:59]
 ds_read_b128 v[252:255], v1 offset:7168
 v_mov_b32 v170, v146
 buffer_load_dwordx4 v[188:191], v0, s[4:7], s18 offen offset:3072 sc1
 s_add_u32 s18, s18, 4096
 v_mfma_f32_32x32x16_bf16 v[60:75], v[232:235], a[28:31], v[60:75]
 v_mul_f32 v168, 0x3fb8aa3b, v146
 v_mul_f32 v169, 0xbfb8aa3b, v146
 s_waitcnt lgkmcnt(4)
 v_mfma_f32_32x32x16_bf16 v[76:91], v[236:239], a[24:27], v[76:91]
 ds_read_b128 v[224:227], v1 offset:8192
 v_add_f32 v152, v152, v153
 v_mfma_f32_32x32x16_bf16 v[92:107], v[236:239], a[28:31], v[92:107]
 v_add_f32 v156, v156, v157
 v_add_f32 v152, v152, v154
 buffer_load_dwordx4 v[192:195], v0, s[4:7], s18 offen sc1
 s_waitcnt lgkmcnt(4)
 v_mfma_f32_32x32x16_bf16 v[44:59], v[240:243], a[32:35], v[44:59]
 ds_read_b128 v[228:231], v1 offset:9216
 v_add_f32 v156, v156, v158
 v_mfma_f32_32x32x16_bf16 v[60:75], v[240:243], a[36:39], v[60:75]
 v_add_f32 v152, v152, v155
 v_add_f32 v156, v156, v159
 s_waitcnt lgkmcnt(4)
 v_mfma_f32_32x32x16_bf16 v[76:91], v[244:247], a[32:35], v[76:91]
 ds_read_b128 v[232:235], v1 offset:10240
 v_permlane16_swap_b32 v152, v156
 buffer_load_dwordx4 v[196:199], v0, s[4:7], s18 offen offset:1024 sc1
 v_mfma_f32_32x32x16_bf16 v[92:107], v[244:247], a[36:39], v[92:107]
 v_add_f32 v152, v152, v156
 v_mov_b32 v153, v152
 s_waitcnt lgkmcnt(4)
 v_mfma_f32_32x32x16_bf16 v[44:59], v[248:251], a[40:43], v[44:59]
 ds_read_b128 v[236:239], v1 offset:11264
 v_permlane32_swap_b32 v152, v153
 v_mfma_f32_32x32x16_bf16 v[60:75], v[248:251], a[44:47], v[60:75]
 v_mul_f32 v152, 0xbacccccd, v152
 v_mul_f32 v153, 0x3acccccd, v153
 buffer_load_dwordx4 v[200:203], v0, s[4:7], s18 offen offset:2048 sc1
 s_waitcnt lgkmcnt(4)
 v_mfma_f32_32x32x16_bf16 v[76:91], v[252:255], a[40:43], v[76:91]
 ds_read_b128 v[240:243], v1 offset:12288
 v_fma_f32 v153, -v152, v152, v153
 v_mfma_f32_32x32x16_bf16 v[92:107], v[252:255], a[44:47], v[92:107]
 v_max_f32 v153, 0, v153
 v_add_f32 v153, 0x3727c5ac, v153
 s_waitcnt lgkmcnt(4)
 v_mfma_f32_32x32x16_bf16 v[44:59], v[224:227], a[48:51], v[44:59]
 ds_read_b128 v[244:247], v1 offset:13312
 v_rsq_f32 v154, v153
 buffer_load_dwordx4 v[204:207], v0, s[4:7], s18 offen offset:3072 sc1
 s_add_u32 s18, s18, 4096
 v_mfma_f32_32x32x16_bf16 v[60:75], v[224:227], a[52:55], v[60:75]
 v_cvt_pk_bf16_f32 v162, v152, v152
 v_lshlrev_b32 v155, 16, v162
 s_waitcnt lgkmcnt(4)
 v_mfma_f32_32x32x16_bf16 v[76:91], v[228:231], a[48:51], v[76:91]
 ds_read_b128 v[248:251], v1 offset:14336
 v_sub_f32 v155, v152, v155
 v_mfma_f32_32x32x16_bf16 v[92:107], v[228:231], a[52:55], v[92:107]
 v_cvt_pk_bf16_f32 v163, v155, v155
 v_mov_b32 v174, v154
 buffer_load_dwordx4 v[208:211], v0, s[4:7], s18 offen sc1
 s_waitcnt lgkmcnt(4)
 v_mfma_f32_32x32x16_bf16 v[44:59], v[232:235], a[56:59], v[44:59]
 ds_read_b128 v[252:255], v1 offset:15360
 v_mul_f32 v172, 0x3fb8aa3b, v154
 v_mfma_f32_32x32x16_bf16 v[60:75], v[232:235], a[60:63], v[60:75]
 v_mul_f32 v173, 0xbfb8aa3b, v154
 s_waitcnt lgkmcnt(4)
 v_mfma_f32_32x32x16_bf16 v[76:91], v[236:239], a[56:59], v[76:91]
 buffer_load_dwordx4 v[212:215], v0, s[4:7], s18 offen offset:1024 sc1
 v_mfma_f32_32x32x16_bf16 v[92:107], v[236:239], a[60:63], v[92:107]
 s_waitcnt lgkmcnt(3)
 v_mfma_f32_32x32x16_bf16 v[44:59], v[240:243], a[64:67], v[44:59]
 v_mfma_f32_32x32x16_bf16 v[60:75], v[240:243], a[68:71], v[60:75]
 buffer_load_dwordx4 v[216:219], v0, s[4:7], s18 offen offset:2048 sc1
 s_waitcnt lgkmcnt(2)
 v_mfma_f32_32x32x16_bf16 v[76:91], v[244:247], a[64:67], v[76:91]
 v_mfma_f32_32x32x16_bf16 v[92:107], v[244:247], a[68:71], v[92:107]
 s_waitcnt lgkmcnt(1)
 v_mfma_f32_32x32x16_bf16 v[44:59], v[248:251], a[72:75], v[44:59]
 buffer_load_dwordx4 v[220:223], v0, s[4:7], s18 offen offset:3072 sc1
 s_add_u32 s18, s18, 4096
 v_mfma_f32_32x32x16_bf16 v[60:75], v[248:251], a[76:79], v[60:75]
 s_waitcnt lgkmcnt(0)
 v_mfma_f32_32x32x16_bf16 v[76:91], v[252:255], a[72:75], v[76:91]
 v_mfma_f32_32x32x16_bf16 v[92:107], v[252:255], a[76:79], v[92:107]
 s_barrier
 s_mul_i32 s37, s49, 221184
 s_mul_i32 s38, s3, 15360
 s_add_u32 s37, s37, s38
 s_add_u32 s37, s37, 40206336
 s_add_u32 s38, s38, 81920
 v_mfma_f32_32x32x8_bf16 v[44:59], a[240:241], v[160:161], v[44:59]
 v_lshlrev_b32 v16, 16, v28
 v_and_b32 v17, 0xffff0000, v28
 v_lshlrev_b32 v18, 16, v29
 v_and_b32 v19, 0xffff0000, v29
 v_lshlrev_b32 v20, 16, v30
 v_and_b32 v21, 0xffff0000, v30
 v_lshlrev_b32 v22, 16, v31
 v_and_b32 v23, 0xffff0000, v31
 v_lshlrev_b32 v24, 16, v128
 v_and_b32 v25, 0xffff0000, v128
 v_mfma_f32_32x32x8_bf16 v[76:91], a[242:243], v[160:161], v[76:91]
 v_lshlrev_b32 v26, 16, v32
 v_and_b32 v27, 0xffff0000, v32
 v_lshlrev_b32 v28, 16, v33
 v_and_b32 v29, 0xffff0000, v33
 v_lshlrev_b32 v30, 16, v34
 v_and_b32 v31, 0xffff0000, v34
 v_lshlrev_b32 v32, 16, v35
 v_and_b32 v33, 0xffff0000, v35
 v_lshlrev_b32 v34, 16, v129
 v_and_b32 v35, 0xffff0000, v129
 v_mfma_f32_32x32x8_bf16 v[60:75], a[240:241], v[162:163], v[60:75]
 v_mfma_f32_32x32x8_bf16 v[92:107], a[242:243], v[162:163], v[92:107]
 v_mov_b32 v143, s60
 v_max3_f32 v12, v44, v45, v46
 buffer_load_dwordx2 v[164:165], v8, s[4:7], s20 offen sc1
 v_max3_f32 v13, -v44, -v45, -v46
 v_max3_f32 v12, v12, v47, v48
 v_max3_f32 v13, v13, -v47, -v48
 v_max3_f32 v12, v12, v49, v50
 v_max3_f32 v13, v13, -v49, -v50
 v_max3_f32 v12, v12, v51, v52
 v_max3_f32 v13, v13, -v51, -v52
 v_max_f32 v12, v12, v53
 v_max_f32 v13, v13, -v53
 s_nop 1
 v_permlane32_swap_b32 v12, v13
 buffer_load_dwordx2 v[164:165], v8, s[4:7], s21 offen sc1
 v_max_f32 v12, v12, v13
 v_mul_f32 v13, v12, v169
 v_mul_f32 v12, v12, v169
 s_nop 1
 v_permlane32_swap_b32 v12, v13
 v_pk_fma_f32 v[108:109], v[44:45], v[168:169], v[12:13] op_sel:[0,0,0] op_sel_hi:[0,1,1]
 v_pk_fma_f32 v[110:111], v[44:45], v[168:169], v[12:13] op_sel:[1,0,0] op_sel_hi:[1,1,1]
 v_pk_fma_f32 v[112:113], v[46:47], v[168:169], v[12:13] op_sel:[0,0,0] op_sel_hi:[0,1,1]
 v_pk_fma_f32 v[114:115], v[46:47], v[168:169], v[12:13] op_sel:[1,0,0] op_sel_hi:[1,1,1]
 v_pk_fma_f32 v[116:117], v[48:49], v[168:169], v[12:13] op_sel:[0,0,0] op_sel_hi:[0,1,1]
 v_pk_fma_f32 v[118:119], v[48:49], v[168:169], v[12:13] op_sel:[1,0,0] op_sel_hi:[1,1,1]
 buffer_load_dwordx2 v[164:165], v9, s[4:7], s22 offen sc1
 v_pk_fma_f32 v[120:121], v[50:51], v[168:169], v[12:13] op_sel:[0,0,0] op_sel_hi:[0,1,1]
 v_pk_fma_f32 v[122:123], v[50:51], v[168:169], v[12:13] op_sel:[1,0,0] op_sel_hi:[1,1,1]
 v_pk_fma_f32 v[124:125], v[52:53], v[168:169], v[12:13] op_sel:[0,0,0] op_sel_hi:[0,1,1]
 v_pk_fma_f32 v[126:127], v[52:53], v[168:169], v[12:13] op_sel:[1,0,0] op_sel_hi:[1,1,1]
 v_exp_f32 v108, v108
 v_exp_f32 v109, v109
 v_exp_f32 v110, v110
 v_exp_f32 v111, v111
 v_exp_f32 v112, v112
 v_exp_f32 v113, v113
 v_exp_f32 v114, v114
 buffer_load_dwordx4 v[224:227], v0, s[4:7], s18 offen sc1
 v_exp_f32 v115, v115
 v_exp_f32 v116, v116
 v_exp_f32 v117, v117
 v_exp_f32 v118, v118
 v_exp_f32 v119, v119
 v_exp_f32 v120, v120
 v_exp_f32 v121, v121
 v_exp_f32 v122, v122
 v_exp_f32 v123, v123
 v_exp_f32 v124, v124
 buffer_load_dwordx4 v[228:231], v0, s[4:7], s18 offen offset:1024 sc1
 v_exp_f32 v125, v125
 v_exp_f32 v126, v126
 v_exp_f32 v127, v127
 v_pk_add_f32 v[14:15], v[108:109], v[110:111]
 v_pk_add_f32 v[14:15], v[14:15], v[112:113]
 v_pk_add_f32 v[14:15], v[14:15], v[114:115]
 v_pk_add_f32 v[14:15], v[14:15], v[116:117]
 v_pk_add_f32 v[14:15], v[14:15], v[118:119]
 v_pk_add_f32 v[14:15], v[14:15], v[120:121]
 v_pk_add_f32 v[14:15], v[14:15], v[122:123]
 v_pk_add_f32 v[14:15], v[14:15], v[124:125]
 buffer_load_dwordx4 v[232:235], v0, s[4:7], s18 offen offset:2048 sc1
 v_pk_add_f32 v[14:15], v[14:15], v[126:127]
 s_nop 1
 v_permlane32_swap_b32 v14, v15
 v_add_f32 v14, v14, v15
 v_rcp_f32 v14, v14
 s_nop 0
 v_mov_b32 v15, v14
 s_nop 1
 v_permlane32_swap_b32 v14, v15
 v_pk_mul_f32 v[108:109], v[108:109], v[14:15]
 v_cvt_pk_bf16_f32 v128, v108, v109
 v_pk_mul_f32 v[110:111], v[110:111], v[14:15]
 v_cvt_pk_bf16_f32 v129, v110, v111
 buffer_load_dwordx4 v[236:239], v0, s[4:7], s18 offen offset:3072 sc1
 s_add_u32 s18, s18, 4096
 v_pk_mul_f32 v[112:113], v[112:113], v[14:15]
 v_cvt_pk_bf16_f32 v130, v112, v113
 v_pk_mul_f32 v[114:115], v[114:115], v[14:15]
 v_cvt_pk_bf16_f32 v131, v114, v115
 v_pk_mul_f32 v[116:117], v[116:117], v[14:15]
 v_cvt_pk_bf16_f32 v132, v116, v117
 v_pk_mul_f32 v[118:119], v[118:119], v[14:15]
 v_cvt_pk_bf16_f32 v133, v118, v119
 v_pk_mul_f32 v[120:121], v[120:121], v[14:15]
 v_cvt_pk_bf16_f32 v134, v120, v121
 buffer_load_dwordx4 v[240:243], v0, s[4:7], s18 offen sc1
 v_pk_mul_f32 v[122:123], v[122:123], v[14:15]
 v_cvt_pk_bf16_f32 v135, v122, v123
 v_pk_mul_f32 v[124:125], v[124:125], v[14:15]
 v_cvt_pk_bf16_f32 v136, v124, v125
 v_pk_mul_f32 v[126:127], v[126:127], v[14:15]
 v_cvt_pk_bf16_f32 v137, v126, v127
 v_mfma_f32_32x32x16_bf16 v[108:123], v[128:131], v[36:39], 0
 v_mfma_f32_32x32x16_bf16 v[108:123], v[132:135], v[40:43], v[108:123]
 v_mul_f32 v54, v54, v170
 v_mul_f32 v55, v55, v170
 v_cvt_pk_bf16_f32 v138, v54, v55
 buffer_load_dwordx4 v[244:247], v0, s[4:7], s18 offen offset:1024 sc1
 v_mul_f32 v56, v56, v170
 v_mul_f32 v57, v57, v170
 v_cvt_pk_bf16_f32 v139, v56, v57
 v_mul_f32 v58, v58, v170
 v_mul_f32 v59, v59, v170
 v_cvt_pk_bf16_f32 v140, v58, v59
 v_mul_f32 v86, v86, v170
 v_mul_f32 v87, v87, v170
 v_cvt_pk_bf16_f32 v141, v86, v87
 v_mul_f32 v88, v88, v170
 buffer_load_dwordx4 v[248:251], v0, s[4:7], s18 offen offset:2048 sc1
 v_mul_f32 v89, v89, v170
 v_cvt_pk_bf16_f32 v142, v88, v89
 v_mfma_f32_32x32x16_bf16 v[44:59], v[136:139], v[36:39], 0
 s_nop 0
 v_mfma_f32_32x32x16_bf16 v[44:59], v[140:143], v[40:43], v[44:59]
 v_cvt_pk_bf16_f32 v128, v108, v109
 v_cvt_pk_bf16_f32 v129, v110, v111
 v_cvt_pk_bf16_f32 v130, v112, v113
 v_cvt_pk_bf16_f32 v131, v114, v115
 v_cvt_pk_bf16_f32 v132, v116, v117
 v_cvt_pk_bf16_f32 v133, v118, v119
 v_cvt_pk_bf16_f32 v134, v120, v121
 buffer_load_dwordx4 v[252:255], v0, s[4:7], s18 offen offset:3072 sc1
 s_add_u32 s18, s18, 4096
 v_cvt_pk_bf16_f32 v135, v122, v123
 s_nop 1
 v_cvt_pk_bf16_f32 v136, v44, v45
 v_cvt_pk_bf16_f32 v137, v46, v47
 v_cvt_pk_bf16_f32 v138, v48, v49
 v_cvt_pk_bf16_f32 v139, v50, v51
 v_cvt_pk_bf16_f32 v140, v52, v53
 v_cvt_pk_bf16_f32 v141, v54, v55
 v_cvt_pk_bf16_f32 v142, v56, v57
 v_cvt_pk_bf16_f32 v143, v58, v59
 v_mfma_f32_32x32x16_bf16 v[144:159], v[128:131], v[136:139], 0
 buffer_load_dwordx4 a[80:83], v0, s[4:7], s47 offen sc1
 v_mfma_f32_32x32x16_bf16 v[144:159], v[132:135], v[140:143], v[144:159]
 v_mfma_f32_32x32x16_bf16 v[44:59], v[136:139], v[136:139], 0
 v_mfma_f32_32x32x16_bf16 v[44:59], v[140:143], v[140:143], v[44:59]
 v_mov_b32 v143, s60
 v_max3_f32 v12, v60, v61, v62
 v_max3_f32 v13, -v60, -v61, -v62
 v_max3_f32 v12, v12, v63, v64
 v_max3_f32 v13, v13, -v63, -v64
 v_max3_f32 v12, v12, v65, v66
 v_max3_f32 v13, v13, -v65, -v66
 s_mov_b32 m0, s38
 s_nop 0
 buffer_load_dwordx4 v0, s[4:7], s37 offen sc1  lds
 v_max3_f32 v12, v12, v67, v68
 v_max3_f32 v13, v13, -v67, -v68
 v_max_f32 v12, v12, v69
 v_max_f32 v13, v13, -v69
 s_nop 1
 v_permlane32_swap_b32 v12, v13
 v_max_f32 v12, v12, v13
 v_mul_f32 v13, v12, v173
 v_mul_f32 v12, v12, v173
 s_nop 1
 v_permlane32_swap_b32 v12, v13
 v_pk_fma_f32 v[108:109], v[60:61], v[172:173], v[12:13] op_sel:[0,0,0] op_sel_hi:[0,1,1]
 v_pk_fma_f32 v[110:111], v[60:61], v[172:173], v[12:13] op_sel:[1,0,0] op_sel_hi:[1,1,1]
 buffer_load_dwordx4 a[84:87], v0, s[4:7], s47 offen offset:1024 sc1
 v_pk_fma_f32 v[112:113], v[62:63], v[172:173], v[12:13] op_sel:[0,0,0] op_sel_hi:[0,1,1]
 v_pk_fma_f32 v[114:115], v[62:63], v[172:173], v[12:13] op_sel:[1,0,0] op_sel_hi:[1,1,1]
 v_pk_fma_f32 v[116:117], v[64:65], v[172:173], v[12:13] op_sel:[0,0,0] op_sel_hi:[0,1,1]
 v_pk_fma_f32 v[118:119], v[64:65], v[172:173], v[12:13] op_sel:[1,0,0] op_sel_hi:[1,1,1]
 v_pk_fma_f32 v[120:121], v[66:67], v[172:173], v[12:13] op_sel:[0,0,0] op_sel_hi:[0,1,1]
 v_pk_fma_f32 v[122:123], v[66:67], v[172:173], v[12:13] op_sel:[1,0,0] op_sel_hi:[1,1,1]
 v_pk_fma_f32 v[124:125], v[68:69], v[172:173], v[12:13] op_sel:[0,0,0] op_sel_hi:[0,1,1]
 v_pk_fma_f32 v[126:127], v[68:69], v[172:173], v[12:13] op_sel:[1,0,0] op_sel_hi:[1,1,1]
 v_exp_f32 v108, v108
 v_exp_f32 v109, v109
 buffer_load_dwordx4 a[88:91], v0, s[4:7], s47 offen offset:2048 sc1
 v_exp_f32 v110, v110
 v_exp_f32 v111, v111
 v_exp_f32 v112, v112
 v_exp_f32 v113, v113
 v_exp_f32 v114, v114
 v_exp_f32 v115, v115
 v_exp_f32 v116, v116
 v_exp_f32 v117, v117
 v_exp_f32 v118, v118
 v_exp_f32 v119, v119
 v_exp_f32 v120, v120
 buffer_load_dwordx4 a[92:95], v0, s[4:7], s47 offen offset:3072 sc1
 s_add_u32 s47, s47, 4096
 v_exp_f32 v121, v121
 v_exp_f32 v122, v122
 v_exp_f32 v123, v123
 v_exp_f32 v124, v124
 v_exp_f32 v125, v125
 v_exp_f32 v126, v126
 v_exp_f32 v127, v127
 v_pk_add_f32 v[14:15], v[108:109], v[110:111]
 v_pk_add_f32 v[14:15], v[14:15], v[112:113]
 v_pk_add_f32 v[14:15], v[14:15], v[114:115]
 s_mov_b32 m0, s38
 s_nop 0
 buffer_load_dwordx4 v0, s[4:7], s37 offen offset:1024 sc1  lds
 v_pk_add_f32 v[14:15], v[14:15], v[116:117]
 v_pk_add_f32 v[14:15], v[14:15], v[118:119]
 v_pk_add_f32 v[14:15], v[14:15], v[120:121]
 v_pk_add_f32 v[14:15], v[14:15], v[122:123]
 v_pk_add_f32 v[14:15], v[14:15], v[124:125]
 v_pk_add_f32 v[14:15], v[14:15], v[126:127]
 s_nop 1
 v_permlane32_swap_b32 v14, v15
 v_add_f32 v14, v14, v15
 v_rcp_f32 v14, v14
 s_nop 0
 v_mov_b32 v15, v14
 buffer_load_dwordx4 a[96:99], v0, s[4:7], s47 offen sc1
 s_nop 0
 v_permlane32_swap_b32 v14, v15
 v_pk_mul_f32 v[108:109], v[108:109], v[14:15]
 v_cvt_pk_bf16_f32 v128, v108, v109
 v_pk_mul_f32 v[110:111], v[110:111], v[14:15]
 v_cvt_pk_bf16_f32 v129, v110, v111
 v_pk_mul_f32 v[112:113], v[112:113], v[14:15]
 v_cvt_pk_bf16_f32 v130, v112, v113
 v_pk_mul_f32 v[114:115], v[114:115], v[14:15]
 v_cvt_pk_bf16_f32 v131, v114, v115
 v_pk_mul_f32 v[116:117], v[116:117], v[14:15]
 v_cvt_pk_bf16_f32 v132, v116, v117
 buffer_load_dwordx4 a[100:103], v0, s[4:7], s47 offen offset:1024 sc1
 v_pk_mul_f32 v[118:119], v[118:119], v[14:15]
 v_cvt_pk_bf16_f32 v133, v118, v119
 v_pk_mul_f32 v[120:121], v[120:121], v[14:15]
 v_cvt_pk_bf16_f32 v134, v120, v121
 v_pk_mul_f32 v[122:123], v[122:123], v[14:15]
 v_cvt_pk_bf16_f32 v135, v122, v123
 v_pk_mul_f32 v[124:125], v[124:125], v[14:15]
 v_cvt_pk_bf16_f32 v136, v124, v125
 v_pk_mul_f32 v[126:127], v[126:127], v[14:15]
 v_cvt_pk_bf16_f32 v137, v126, v127
 buffer_load_dwordx4 a[104:107], v0, s[4:7], s47 offen offset:2048 sc1
 v_mfma_f32_32x32x16_bf16 v[108:123], v[128:131], v[36:39], 0
 v_mfma_f32_32x32x16_bf16 v[108:123], v[132:135], v[40:43], v[108:123]
 v_mul_f32 v70, v70, v174
 v_mul_f32 v71, v71, v174
 v_cvt_pk_bf16_f32 v138, v70, v71
 v_mul_f32 v72, v72, v174
 v_mul_f32 v73, v73, v174
 v_cvt_pk_bf16_f32 v139, v72, v73
 v_mul_f32 v74, v74, v174
 v_mul_f32 v75, v75, v174
 v_cvt_pk_bf16_f32 v140, v74, v75
 s_mov_b32 m0, s38
 s_nop 0
 buffer_load_dwordx4 v0, s[4:7], s37 offen offset:2048 sc1  lds
 v_mul_f32 v102, v102, v174
 v_mul_f32 v103, v103, v174
 v_cvt_pk_bf16_f32 v141, v102, v103
 v_mul_f32 v104, v104, v174
 v_mul_f32 v105, v105, v174
 v_cvt_pk_bf16_f32 v142, v104, v105
 v_mfma_f32_32x32x16_bf16 v[60:75], v[136:139], v[36:39], 0
 s_nop 0
 v_mfma_f32_32x32x16_bf16 v[60:75], v[140:143], v[40:43], v[60:75]
 v_cvt_pk_bf16_f32 v128, v108, v109
 v_cvt_pk_bf16_f32 v129, v110, v111
 buffer_load_dwordx4 a[108:111], v0, s[4:7], s47 offen offset:3072 sc1
 s_add_u32 s47, s47, 4096
 v_cvt_pk_bf16_f32 v130, v112, v113
 v_cvt_pk_bf16_f32 v131, v114, v115
 v_cvt_pk_bf16_f32 v132, v116, v117
 v_cvt_pk_bf16_f32 v133, v118, v119
 v_cvt_pk_bf16_f32 v134, v120, v121
 v_cvt_pk_bf16_f32 v135, v122, v123
 s_nop 1
 v_cvt_pk_bf16_f32 v136, v60, v61
 v_cvt_pk_bf16_f32 v137, v62, v63
 v_cvt_pk_bf16_f32 v138, v64, v65
 v_cvt_pk_bf16_f32 v139, v66, v67
 v_cvt_pk_bf16_f32 v140, v68, v69
 v_cvt_pk_bf16_f32 v141, v70, v71
 v_cvt_pk_bf16_f32 v142, v72, v73
 v_cvt_pk_bf16_f32 v143, v74, v75
 v_mfma_f32_32x32x16_bf16 v[144:159], v[128:131], v[136:139], v[144:159]
 s_nop 0
 v_mfma_f32_32x32x16_bf16 v[144:159], v[132:135], v[140:143], v[144:159]
 v_mfma_f32_32x32x16_bf16 v[44:59], v[136:139], v[136:139], v[44:59]
 v_mfma_f32_32x32x16_bf16 v[44:59], v[140:143], v[140:143], v[44:59]
 s_lshl_b32 s33, s3, 10
 v_add_u32 v13, s33, v2
 s_lshl_b32 s33, s3, 2
 v_add_u32 v14, s33, v2
 s_add_u32 s56, s52, 9
 v_mov_b32 v131, s56
 s_nop 3
 ds_write_b128 v3, v[144:147] offset:12288
 ds_write_b128 v3, v[148:151] offset:13312
 ds_write_b128 v3, v[152:155] offset:14336
 ds_write_b128 v3, v[156:159] offset:15360
 ds_write_b128 v3, v[44:47] offset:16384
 s_waitcnt lgkmcnt(0)
 s_barrier
 ds_read_b128 v[108:111], v13 offset:12288
 ds_read_b32 v124, v14 offset:16384
 ds_read_b128 v[112:115], v13 offset:17408
 ds_read_b32 v125, v14 offset:21504
 ds_read_b128 v[116:119], v13 offset:22528
 ds_read_b32 v126, v14 offset:26624
 ds_read_b128 v[120:123], v13 offset:27648
 ds_read_b32 v127, v14 offset:31744
 s_waitcnt lgkmcnt(5)
 v_pk_add_f32 v[108:109], v[108:109], v[112:113]
 v_pk_add_f32 v[110:111], v[110:111], v[114:115]
 s_waitcnt lgkmcnt(1)
 v_pk_add_f32 v[116:117], v[116:117], v[120:121]
 v_pk_add_f32 v[118:119], v[118:119], v[122:123]
 s_waitcnt lgkmcnt(0)
 v_pk_add_f32 v[124:125], v[124:125], v[126:127]
 v_pk_add_f32 v[108:109], v[108:109], v[116:117]
 v_pk_add_f32 v[110:111], v[110:111], v[118:119]
 v_add_f32 v124, v124, v125
 v_cvt_pk_bf16_f32 v128, v108, v109
 v_cvt_pk_bf16_f32 v129, v110, v111
 v_cvt_pk_bf16_f32 v130, v124, 0
 buffer_store_dwordx4 v[128:131], v10, s[4:7], s24 offen sc1
 s_barrier
 v_max3_f32 v12, v76, v77, v78
 buffer_load_dwordx4 v[144:147], v0, s[4:7], s18 offen sc1
 v_max3_f32 v13, -v76, -v77, -v78
 v_max3_f32 v12, v12, v79, v80
 v_max3_f32 v13, v13, -v79, -v80
 v_max3_f32 v12, v12, v81, v82
 v_max3_f32 v13, v13, -v81, -v82
 v_max3_f32 v12, v12, v83, v84
 v_max3_f32 v13, v13, -v83, -v84
 v_max_f32 v12, v12, v85
 v_max_f32 v13, v13, -v85
 buffer_load_dwordx4 v[148:151], v0, s[4:7], s18 offen offset:1024 sc1
 s_nop 0
 v_permlane32_swap_b32 v12, v13
 v_max_f32 v12, v12, v13
 v_mul_f32 v13, v12, v169
 v_mul_f32 v12, v12, v169
 s_nop 1
 v_permlane32_swap_b32 v12, v13
 v_pk_fma_f32 v[108:109], v[76:77], v[168:169], v[12:13] op_sel:[0,0,0] op_sel_hi:[0,1,1]
 v_pk_fma_f32 v[110:111], v[76:77], v[168:169], v[12:13] op_sel:[1,0,0] op_sel_hi:[1,1,1]
 v_pk_fma_f32 v[112:113], v[78:79], v[168:169], v[12:13] op_sel:[0,0,0] op_sel_hi:[0,1,1]
 v_pk_fma_f32 v[114:115], v[78:79], v[168:169], v[12:13] op_sel:[1,0,0] op_sel_hi:[1,1,1]
 buffer_load_dwordx4 v[152:155], v0, s[4:7], s18 offen offset:2048 sc1
 v_pk_fma_f32 v[116:117], v[80:81], v[168:169], v[12:13] op_sel:[0,0,0] op_sel_hi:[0,1,1]
 v_pk_fma_f32 v[118:119], v[80:81], v[168:169], v[12:13] op_sel:[1,0,0] op_sel_hi:[1,1,1]
 v_pk_fma_f32 v[120:121], v[82:83], v[168:169], v[12:13] op_sel:[0,0,0] op_sel_hi:[0,1,1]
 v_pk_fma_f32 v[122:123], v[82:83], v[168:169], v[12:13] op_sel:[1,0,0] op_sel_hi:[1,1,1]
 v_pk_fma_f32 v[124:125], v[84:85], v[168:169], v[12:13] op_sel:[0,0,0] op_sel_hi:[0,1,1]
 v_pk_fma_f32 v[126:127], v[84:85], v[168:169], v[12:13] op_sel:[1,0,0] op_sel_hi:[1,1,1]
 v_exp_f32 v108, v108
 v_exp_f32 v109, v109
 v_exp_f32 v110, v110
 buffer_load_dwordx4 v[156:159], v0, s[4:7], s18 offen offset:3072 sc1
 s_add_u32 s18, s18, 4096
 v_exp_f32 v111, v111
 v_exp_f32 v112, v112
 v_exp_f32 v113, v113
 v_exp_f32 v114, v114
 v_exp_f32 v115, v115
 v_exp_f32 v116, v116
 v_exp_f32 v117, v117
 v_exp_f32 v118, v118
 v_exp_f32 v119, v119
 buffer_load_dwordx4 v[160:163], v0, s[4:7], s18 offen sc1
 v_exp_f32 v120, v120
 v_exp_f32 v121, v121
 v_exp_f32 v122, v122
 v_exp_f32 v123, v123
 v_exp_f32 v124, v124
 v_exp_f32 v125, v125
 v_exp_f32 v126, v126
 v_exp_f32 v127, v127
 v_pk_add_f32 v[14:15], v[108:109], v[110:111]
 v_pk_add_f32 v[14:15], v[14:15], v[112:113]
 buffer_load_dwordx4 a[112:115], v0, s[4:7], s47 offen sc1
 v_pk_add_f32 v[14:15], v[14:15], v[114:115]
 v_pk_add_f32 v[14:15], v[14:15], v[116:117]
 v_pk_add_f32 v[14:15], v[14:15], v[118:119]
 v_pk_add_f32 v[14:15], v[14:15], v[120:121]
 v_pk_add_f32 v[14:15], v[14:15], v[122:123]
 v_pk_add_f32 v[14:15], v[14:15], v[124:125]
 v_pk_add_f32 v[14:15], v[14:15], v[126:127]
 s_nop 1
 v_permlane32_swap_b32 v14, v15
 v_add_f32 v14, v14, v15
 buffer_load_dwordx4 a[116:119], v0, s[4:7], s47 offen offset:1024 sc1
 v_rcp_f32 v14, v14
 s_nop 0
 v_mov_b32 v15, v14
 s_nop 1
 v_permlane32_swap_b32 v14, v15
 v_pk_mul_f32 v[108:109], v[108:109], v[14:15]
 v_cvt_pk_bf16_f32 v76, v108, v109
 v_pk_mul_f32 v[110:111], v[110:111], v[14:15]
 v_cvt_pk_bf16_f32 v77, v110, v111
 v_pk_mul_f32 v[112:113], v[112:113], v[14:15]
 v_cvt_pk_bf16_f32 v78, v112, v113
 s_mov_b32 m0, s38
 s_nop 0
 buffer_load_dwordx4 v0, s[4:7], s37 offen offset:3072 sc1  lds
 s_add_u32 s37, s37, 4096
 s_add_u32 s38, s38, 4096
 v_pk_mul_f32 v[114:115], v[114:115], v[14:15]
 v_cvt_pk_bf16_f32 v79, v114, v115
 v_pk_mul_f32 v[116:117], v[116:117], v[14:15]
 v_cvt_pk_bf16_f32 v80, v116, v117
 v_pk_mul_f32 v[118:119], v[118:119], v[14:15]
 v_cvt_pk_bf16_f32 v81, v118, v119
 v_pk_mul_f32 v[120:121], v[120:121], v[14:15]
 v_cvt_pk_bf16_f32 v82, v120, v121
 v_pk_mul_f32 v[122:123], v[122:123], v[14:15]
 buffer_load_dwordx4 a[120:123], v0, s[4:7], s47 offen offset:2048 sc1
 v_cvt_pk_bf16_f32 v83, v122, v123
 v_pk_mul_f32 v[124:125], v[124:125], v[14:15]
 v_cvt_pk_bf16_f32 v84, v124, v125
 v_pk_mul_f32 v[126:127], v[126:127], v[14:15]
 v_cvt_pk_bf16_f32 v85, v126, v127
 v_max3_f32 v12, v92, v93, v94
 v_max3_f32 v13, -v92, -v93, -v94
 v_max3_f32 v12, v12, v95, v96
 v_max3_f32 v13, v13, -v95, -v96
 buffer_load_dwordx4 a[124:127], v0, s[4:7], s47 offen offset:3072 sc1
 s_add_u32 s47, s47, 4096
 v_max3_f32 v12, v12, v97, v98
 v_max3_f32 v13, v13, -v97, -v98
 v_max3_f32 v12, v12, v99, v100
 v_max3_f32 v13, v13, -v99, -v100
 v_max_f32 v12, v12, v101
 v_max_f32 v13, v13, -v101
 s_nop 1
 v_permlane32_swap_b32 v12, v13
 v_max_f32 v12, v12, v13
 v_mul_f32 v13, v12, v173
 v_mul_f32 v12, v12, v173
 buffer_load_dwordx4 a[128:131], v0, s[4:7], s47 offen sc1
 s_nop 0
 v_permlane32_swap_b32 v12, v13
 v_pk_fma_f32 v[108:109], v[92:93], v[172:173], v[12:13] op_sel:[0,0,0] op_sel_hi:[0,1,1]
 v_pk_fma_f32 v[110:111], v[92:93], v[172:173], v[12:13] op_sel:[1,0,0] op_sel_hi:[1,1,1]
 v_pk_fma_f32 v[112:113], v[94:95], v[172:173], v[12:13] op_sel:[0,0,0] op_sel_hi:[0,1,1]
 v_pk_fma_f32 v[114:115], v[94:95], v[172:173], v[12:13] op_sel:[1,0,0] op_sel_hi:[1,1,1]
 v_pk_fma_f32 v[116:117], v[96:97], v[172:173], v[12:13] op_sel:[0,0,0] op_sel_hi:[0,1,1]
 v_pk_fma_f32 v[118:119], v[96:97], v[172:173], v[12:13] op_sel:[1,0,0] op_sel_hi:[1,1,1]
 v_pk_fma_f32 v[120:121], v[98:99], v[172:173], v[12:13] op_sel:[0,0,0] op_sel_hi:[0,1,1]
 v_pk_fma_f32 v[122:123], v[98:99], v[172:173], v[12:13] op_sel:[1,0,0] op_sel_hi:[1,1,1]
 buffer_load_dwordx4 a[132:135], v0, s[4:7], s47 offen offset:1024 sc1
 v_pk_fma_f32 v[124:125], v[100:101], v[172:173], v[12:13] op_sel:[0,0,0] op_sel_hi:[0,1,1]
 v_pk_fma_f32 v[126:127], v[100:101], v[172:173], v[12:13] op_sel:[1,0,0] op_sel_hi:[1,1,1]
 v_exp_f32 v108, v108
 v_exp_f32 v109, v109
 v_exp_f32 v110, v110
 v_exp_f32 v111, v111
 v_exp_f32 v112, v112
 v_exp_f32 v113, v113
 v_exp_f32 v114, v114
 s_mov_b32 m0, s38
 s_nop 0
 buffer_load_dwordx4 v0, s[4:7], s37 offen sc1  lds
 v_exp_f32 v115, v115
 v_exp_f32 v116, v116
 v_exp_f32 v117, v117
 v_exp_f32 v118, v118
 v_exp_f32 v119, v119
 v_exp_f32 v120, v120
 v_exp_f32 v121, v121
 v_exp_f32 v122, v122
 v_exp_f32 v123, v123
 buffer_load_dwordx4 a[136:139], v0, s[4:7], s47 offen offset:2048 sc1
 v_exp_f32 v124, v124
 v_exp_f32 v125, v125
 v_exp_f32 v126, v126
 v_exp_f32 v127, v127
 v_pk_add_f32 v[14:15], v[108:109], v[110:111]
 v_pk_add_f32 v[14:15], v[14:15], v[112:113]
 v_pk_add_f32 v[14:15], v[14:15], v[114:115]
 v_pk_add_f32 v[14:15], v[14:15], v[116:117]
 v_pk_add_f32 v[14:15], v[14:15], v[118:119]
 buffer_load_dwordx4 a[140:143], v0, s[4:7], s47 offen offset:3072 sc1
 s_add_u32 s47, s47, 4096
 v_pk_add_f32 v[14:15], v[14:15], v[120:121]
 v_pk_add_f32 v[14:15], v[14:15], v[122:123]
 v_pk_add_f32 v[14:15], v[14:15], v[124:125]
 v_pk_add_f32 v[14:15], v[14:15], v[126:127]
 s_nop 1
 v_permlane32_swap_b32 v14, v15
 v_add_f32 v14, v14, v15
 v_rcp_f32 v14, v14
 s_nop 0
 v_mov_b32 v15, v14
 s_nop 1
 v_permlane32_swap_b32 v14, v15
 v_pk_mul_f32 v[108:109], v[108:109], v[14:15]
 v_cvt_pk_bf16_f32 v92, v108, v109
 v_pk_mul_f32 v[110:111], v[110:111], v[14:15]
 v_cvt_pk_bf16_f32 v93, v110, v111
 v_pk_mul_f32 v[112:113], v[112:113], v[14:15]
 v_cvt_pk_bf16_f32 v94, v112, v113
 v_pk_mul_f32 v[114:115], v[114:115], v[14:15]
 v_cvt_pk_bf16_f32 v95, v114, v115
 v_pk_mul_f32 v[116:117], v[116:117], v[14:15]
 v_cvt_pk_bf16_f32 v96, v116, v117
 v_pk_mul_f32 v[118:119], v[118:119], v[14:15]
 v_cvt_pk_bf16_f32 v97, v118, v119
 v_pk_mul_f32 v[120:121], v[120:121], v[14:15]
 v_cvt_pk_bf16_f32 v98, v120, v121
 v_pk_mul_f32 v[122:123], v[122:123], v[14:15]
 v_cvt_pk_bf16_f32 v99, v122, v123
 v_pk_mul_f32 v[124:125], v[124:125], v[14:15]
 v_cvt_pk_bf16_f32 v100, v124, v125
 v_pk_mul_f32 v[126:127], v[126:127], v[14:15]
 v_cvt_pk_bf16_f32 v101, v126, v127
 s_lshr_b32 s33, s3, 1
 s_lshl_b32 s33, s33, 10
 s_and_b32 s34, s3, 1
 s_lshl_b32 s34, s34, 3
 s_add_u32 s33, s33, s34
 v_add_u32 v118, s33, v2
 v_lshrrev_b32 v119, 1, v0
 v_add_u32 v119, 145408, v119
 s_lshl_b32 s33, s3, 1
 v_add_u32 v120, s33, v119
 s_mov_b32 s55, 0
Lkv_40:
 buffer_load_dwordx4 v[44:47], v11, s[4:7], s25 offen sc1
 buffer_load_dwordx4 v[48:51], v11, s[4:7], s26 offen sc1
 buffer_load_dwordx4 v[52:55], v11, s[4:7], s27 offen sc1
 buffer_load_dwordx4 v[56:59], v11, s[4:7], s28 offen sc1
 buffer_load_dwordx4 v[60:63], v11, s[4:7], s29 offen sc1
 buffer_load_dwordx4 v[64:67], v11, s[4:7], s30 offen sc1
 buffer_load_dwordx4 v[68:71], v11, s[4:7], s31 offen sc1
 s_add_u32 s55, s55, 1
 s_cmp_gt_u32 s55, 0x40000
 s_cbranch_scc1 Lend
 v_lshlrev_b32 v108, 16, v128
 v_and_b32 v109, 0xffff0000, v128
 v_lshlrev_b32 v110, 16, v129
 v_and_b32 v111, 0xffff0000, v129
 v_lshlrev_b32 v112, 16, v130
 v_mov_b32 v12, 0
 s_waitcnt vmcnt(6)
 v_dot2c_f32_bf16 v108, s60, v44
 v_dot2c_f32_bf16 v109, s61, v44
 v_dot2c_f32_bf16 v110, s60, v45
 v_dot2c_f32_bf16 v111, s61, v45
 v_dot2c_f32_bf16 v112, s60, v46
 v_bitop3_b32 v12, v12, v47, s56 bitop3:0xf6
 s_waitcnt vmcnt(5)
 v_dot2c_f32_bf16 v108, s60, v48
 v_dot2c_f32_bf16 v109, s61, v48
 v_dot2c_f32_bf16 v110, s60, v49
 v_dot2c_f32_bf16 v111, s61, v49
 v_dot2c_f32_bf16 v112, s60, v50
 v_bitop3_b32 v12, v12, v51, s56 bitop3:0xf6
 s_waitcnt vmcnt(4)
 v_dot2c_f32_bf16 v108, s60, v52
 v_dot2c_f32_bf16 v109, s61, v52
 v_dot2c_f32_bf16 v110, s60, v53
 v_dot2c_f32_bf16 v111, s61, v53
 v_dot2c_f32_bf16 v112, s60, v54
 v_bitop3_b32 v12, v12, v55, s56 bitop3:0xf6
 s_waitcnt vmcnt(3)
 v_dot2c_f32_bf16 v108, s60, v56
 v_dot2c_f32_bf16 v109, s61, v56
 v_dot2c_f32_bf16 v110, s60, v57
 v_dot2c_f32_bf16 v111, s61, v57
 v_dot2c_f32_bf16 v112, s60, v58
 v_bitop3_b32 v12, v12, v59, s56 bitop3:0xf6
 s_waitcnt vmcnt(2)
 v_dot2c_f32_bf16 v108, s60, v60
 v_dot2c_f32_bf16 v109, s61, v60
 v_dot2c_f32_bf16 v110, s60, v61
 v_dot2c_f32_bf16 v111, s61, v61
 v_dot2c_f32_bf16 v112, s60, v62
 v_bitop3_b32 v12, v12, v63, s56 bitop3:0xf6
 s_waitcnt vmcnt(1)
 v_dot2c_f32_bf16 v108, s60, v64
 v_dot2c_f32_bf16 v109, s61, v64
 v_dot2c_f32_bf16 v110, s60, v65
 v_dot2c_f32_bf16 v111, s61, v65
 v_dot2c_f32_bf16 v112, s60, v66
 v_bitop3_b32 v12, v12, v67, s56 bitop3:0xf6
 s_waitcnt vmcnt(0)
 v_dot2c_f32_bf16 v108, s60, v68
 v_dot2c_f32_bf16 v109, s61, v68
 v_dot2c_f32_bf16 v110, s60, v69
 v_dot2c_f32_bf16 v111, s61, v69
 v_dot2c_f32_bf16 v112, s60, v70
 v_bitop3_b32 v12, v12, v71, s56 bitop3:0xf6
 v_cmp_ne_u32 vcc, 0, v12
 s_cbranch_vccnz Lkv_40
 buffer_load_dwordx4 a[144:147], v0, s[4:7], s47 offen sc1
 buffer_load_dwordx4 a[148:151], v0, s[4:7], s47 offen offset:1024 sc1
 s_mov_b32 m0, s38
 s_nop 0
 buffer_load_dwordx4 v0, s[4:7], s37 offen offset:1024 sc1  lds
 buffer_load_dwordx4 a[152:155], v0, s[4:7], s47 offen offset:2048 sc1
 buffer_load_dwordx4 a[156:159], v0, s[4:7], s47 offen offset:3072 sc1
 s_add_u32 s47, s47, 4096
 buffer_load_dwordx4 a[160:163], v0, s[4:7], s47 offen sc1
 buffer_load_dwordx4 a[164:167], v0, s[4:7], s47 offen offset:1024 sc1
 s_mov_b32 m0, s38
 s_nop 0
 buffer_load_dwordx4 v0, s[4:7], s37 offen offset:2048 sc1  lds
 buffer_load_dwordx4 a[168:171], v0, s[4:7], s47 offen offset:2048 sc1
 buffer_load_dwordx4 a[172:175], v0, s[4:7], s47 offen offset:3072 sc1
 s_add_u32 s47, s47, 4096
 v_cvt_pk_bf16_f32 v114, v108, v109
 v_cvt_pk_bf16_f32 v115, v110, v111
 v_cvt_pk_bf16_f32 v116, v112, v112
 ds_write_b64 v118, v[114:115] offset:12288
 ds_write_b16 v120, v116
 s_mul_i32 s24, s53, 196608
 s_add_u32 s24, s24, 18350080
 s_mul_i32 s25, s3, 5120
 s_add_u32 s24, s24, s25
 s_lshr_b32 s26, s3, 1
 s_mul_i32 s26, s26, 20480
 s_add_u32 s25, s24, 20480
 s_sub_u32 s25, s25, s26
 s_waitcnt lgkmcnt(0)
 s_barrier
 ds_read_b64 v[136:137], v119
 ds_read_b128 v[128:131], v2 offset:12288
 ds_read_b128 v[132:135], v2 offset:13312
 s_add_u32 s24, s24, s26
 s_add_u32 s26, s24, 40960
 s_add_u32 s27, s25, 40960
 s_lshl_b32 s28, s53, 7
 s_add_u32 s28, s28, 7737344
 s_lshl_b32 s62, s3, 5
 s_add_u32 s28, s28, s62
 v_lshrrev_b32 v172, 2, v0
 v_and_b32 v171, 28, v172
 v_and_b32 v172, 124, v172
 s_waitcnt lgkmcnt(2)
 v_mfma_f32_32x32x8_bf16 v[44:59], v[136:137], v[84:85], 0
 v_mfma_f32_32x32x8_bf16 v[60:75], v[136:137], v[100:101], 0
 s_waitcnt lgkmcnt(1)
 s_nop 7
 v_mfma_f32_32x32x16_bf16 v[44:59], v[128:131], v[76:79], v[44:59]
 s_waitcnt lgkmcnt(0)
 v_mfma_f32_32x32x16_bf16 v[44:59], v[132:135], v[80:83], v[44:59]
 v_mfma_f32_32x32x16_bf16 v[60:75], v[128:131], v[92:95], v[60:75]
 v_mfma_f32_32x32x16_bf16 v[60:75], v[132:135], v[96:99], v[60:75]
 s_nop 9
 v_add_f32 v58, 0x358637bd, v58
 v_rcp_f32 v58, v58
 s_nop 0
 v_mul_f32 v48, v48, v58
 v_mul_f32 v49, v49, v58
 v_mul_f32 v50, v50, v58
 v_mul_f32 v51, v51, v58
 v_mul_f32 v52, v52, v58
 v_mul_f32 v53, v53, v58
 v_mul_f32 v54, v54, v58
 v_mul_f32 v55, v55, v58
 v_mul_f32 v56, v56, v58
 v_mul_f32 v57, v57, v58
 v_cvt_pk_bf16_f32 v108, v48, v49
 v_cvt_pk_bf16_f32 v109, v50, v51
 v_cvt_pk_bf16_f32 v110, v52, v53
 v_cvt_pk_bf16_f32 v111, v54, v55
 v_cvt_pk_bf16_f32 v116, v56, v57
 buffer_store_dwordx4 v[108:111], v8, s[4:7], s20 offen sc1
 v_add_f32 v74, 0x358637bd, v74
 v_rcp_f32 v74, v74
 s_nop 0
 v_pk_mul_f32 v[64:65], v[64:65], v[74:75] op_sel_hi:[1,0]
 v_pk_mul_f32 v[66:67], v[66:67], v[74:75] op_sel_hi:[1,0]
 v_pk_mul_f32 v[68:69], v[68:69], v[74:75] op_sel_hi:[1,0]
 v_pk_mul_f32 v[70:71], v[70:71], v[74:75] op_sel_hi:[1,0]
 v_pk_mul_f32 v[72:73], v[72:73], v[74:75] op_sel_hi:[1,0]
 v_cvt_pk_bf16_f32 v112, v64, v65
 v_cvt_pk_bf16_f32 v113, v66, v67
 v_cvt_pk_bf16_f32 v114, v68, v69
 v_cvt_pk_bf16_f32 v115, v70, v71
 v_cvt_pk_bf16_f32 v117, v72, v73
 buffer_store_dwordx4 v[112:115], v8, s[4:7], s21 offen sc1
 s_nop 0
 v_permlane32_swap_b32 v116, v117
 buffer_store_dwordx2 v[116:117], v9, s[4:7], s22 offen sc1
 s_mul_i32 s29, s53, 81920
 s_lshl_b32 s30, s58, 1
 s_add_u32 s30, s30, s59
 s_lshr_b32 s62, s3, 1
 s_mul_i32 s62, s62, 20224
 s_lshl_b32 s63, s3, 7
 s_add_u32 s62, s62, s63
 s_add_u32 s62, s62, 0
 v_bfe_u32 v168, v0, 4, 3
 v_mul_u32_u24 v168, 16, v168
 v_bfe_u32 v14, v0, 7, 1
 v_lshl_add_u32 v168, v14, 10, v168
 v_bfe_u32 v14, v0, 8, 2
 v_lshl_add_u32 v168, v14, 8, v168
 v_bfe_u32 v169, v0, 4, 3
 v_mul_u32_u24 v169, 16, v169
 v_bfe_u32 v14, v0, 7, 1
 v_lshl_add_u32 v169, v14, 2, v169
 v_bfe_u32 v14, v0, 8, 1
 v_lshl_add_u32 v169, v14, 3, v169
 v_bfe_u32 v14, v0, 9, 1
 v_lshl_add_u32 v169, v14, 8, v169
 s_add_u32 s29, s29, s62
 s_lshl_b32 s30, s30, 9
 s_add_u32 s30, s30, s29
 s_lshl_b32 s62, s57, 10
 s_add_u32 s29, s29, s62
 v_bfe_u32 v170, v0, 4, 3
 v_mul_u32_u24 v170, 16, v170
 v_bfe_u32 v14, v0, 7, 1
 v_lshl_add_u32 v170, v14, 30, v170
 v_bfe_u32 v14, v0, 8, 1
 v_lshl_add_u32 v170, v14, 29, v170
 v_bfe_u32 v14, v0, 9, 1
 v_lshl_add_u32 v170, v14, 9, v170
 s_lshl_b32 s31, s53, 2
 s_lshr_b32 s62, s3, 1
 s_add_u32 s31, s31, s62
 s_lshl_b32 s31, s31, 2
 s_lshr_b32 s62, s51, 2
 s_add_u32 s31, s31, s62
 s_lshl_b32 s31, s31, 1
 s_and_b32 s62, s3, 1
 s_add_u32 s31, s31, s62
 s_lshl_b32 s31, s31, 5
 s_and_b32 s62, s51, 3
 s_add_u32 s31, s31, s62
 s_lshl_b32 s31, s31, 2
 s_add_u32 s31, s31, 24641536
 s_lshl_b32 s32, s53, 3
 s_add_u32 s32, s32, s51
 s_lshl_b32 s32, s32, 2
 s_add_u32 s32, s32, s3
 s_lshl_b32 s32, s32, 2
 s_add_u32 s32, s32, 7733248
 v_mov_b32 v12, 1
 v_add_u32 v12, s52, v12
 s_waitcnt vmcnt(0)
 s_mov_b64 exec, 1
 buffer_store_dword v12, v0, s[4:7], s23 offen sc1
 s_mov_b64 exec, -1
 s_add_u32 s62, s29, 40960
 s_add_u32 s63, s30, 40960
 buffer_load_dwordx4 a[176:179], v0, s[4:7], s47 offen sc1
 buffer_load_dwordx4 a[180:183], v0, s[4:7], s47 offen offset:1024 sc1
 s_mov_b32 m0, s38
 s_nop 0
 buffer_load_dwordx4 v0, s[4:7], s37 offen offset:3072 sc1  lds
 s_add_u32 s37, s37, 4096
 s_add_u32 s38, s38, 4096
 buffer_load_dwordx4 a[184:187], v0, s[4:7], s47 offen offset:2048 sc1
 buffer_load_dwordx4 a[188:191], v0, s[4:7], s47 offen offset:3072 sc1
 s_add_u32 s47, s47, 4096
 buffer_load_dwordx4 a[192:195], v0, s[4:7], s47 offen sc1
 buffer_load_dwordx4 a[196:199], v0, s[4:7], s47 offen offset:1024 sc1
 s_mov_b32 m0, s38
 s_nop 0
 buffer_load_dwordx4 v0, s[4:7], s37 offen sc1  lds
 buffer_load_dwordx4 a[200:203], v0, s[4:7], s47 offen offset:2048 sc1
 buffer_load_dwordx4 a[204:207], v0, s[4:7], s47 offen offset:3072 sc1
 s_add_u32 s47, s47, 4096
 s_add_u32 s56, s52, 1
 s_mov_b32 s55, 0
Lpoll_41:
 buffer_load_dword v12, v171, s[4:7], s28 offen sc1
 s_add_u32 s55, s55, 1
 s_cmp_gt_u32 s55, 0x80000
 s_cbranch_scc1 Lend
 s_waitcnt vmcnt(0)
 v_cmp_ne_u32 vcc, s56, v12
 s_cbranch_vccnz Lpoll_41
 buffer_load_dwordx4 v[44:47], v0, s[4:7], s24 offen sc1
 buffer_load_dwordx4 v[48:51], v0, s[4:7], s24 offen offset:1024 sc1
 buffer_load_dwordx4 v[52:55], v0, s[4:7], s24 offen offset:2048 sc1
 buffer_load_dwordx4 v[56:59], v0, s[4:7], s24 offen offset:3072 sc1
 s_add_u32 s24, s24, 4096
 buffer_load_dwordx4 v[60:63], v0, s[4:7], s24 offen sc1
 s_mul_i32 s16, s54, 81920
 s_add_u32 s16, s16, 0
 s_add_u32 s17, s16, 20480
 s_add_u32 s18, s16, 40960
 s_add_u32 s19, s16, 61440
 s_lshl_b32 s20, s54, 12
 s_add_u32 s20, s20, 24641536
 s_waitcnt vmcnt(4)
 v_mfma_f32_16x16x32_bf16 v[84:87], v[176:179], v[44:47], 0
 buffer_load_dwordx4 v[64:67], v0, s[4:7], s25 offen sc1
 v_mfma_f32_16x16x32_bf16 v[88:91], v[180:183], v[44:47], 0
 v_mfma_f32_16x16x32_bf16 v[92:95], v[184:187], v[44:47], 0
 buffer_load_dwordx4 a[208:211], v0, s[4:7], s47 offen sc1
 v_mfma_f32_16x16x32_bf16 v[96:99], v[188:191], v[44:47], 0
 v_mfma_f32_16x16x32_bf16 v[100:103], v[192:195], v[44:47], 0
 s_waitcnt vmcnt(5)
 v_mfma_f32_16x16x32_bf16 v[84:87], v[196:199], v[48:51], v[84:87]
 buffer_load_dwordx4 v[68:71], v0, s[4:7], s25 offen offset:1024 sc1
 s_mov_b32 m0, s38
 s_nop 0
 buffer_load_dwordx4 v0, s[4:7], s37 offen offset:1024 sc1  lds
 v_mfma_f32_16x16x32_bf16 v[88:91], v[200:203], v[48:51], v[88:91]
 v_mfma_f32_16x16x32_bf16 v[92:95], v[204:207], v[48:51], v[92:95]
 v_mfma_f32_16x16x32_bf16 v[96:99], v[208:211], v[48:51], v[96:99]
 buffer_load_dwordx4 a[212:215], v0, s[4:7], s47 offen offset:1024 sc1
 v_mfma_f32_16x16x32_bf16 v[100:103], v[212:215], v[48:51], v[100:103]
 s_waitcnt vmcnt(7)
 v_mfma_f32_16x16x32_bf16 v[84:87], v[216:219], v[52:55], v[84:87]
 buffer_load_dwordx4 v[72:75], v0, s[4:7], s25 offen offset:2048 sc1
 v_mfma_f32_16x16x32_bf16 v[88:91], v[220:223], v[52:55], v[88:91]
 s_mov_b32 m0, s38
 s_nop 0
 buffer_load_dwordx4 v0, s[4:7], s37 offen offset:2048 sc1  lds
 v_mfma_f32_16x16x32_bf16 v[92:95], v[224:227], v[52:55], v[92:95]
 v_mfma_f32_16x16x32_bf16 v[96:99], v[228:231], v[52:55], v[96:99]
 v_mfma_f32_16x16x32_bf16 v[100:103], v[232:235], v[52:55], v[100:103]
 s_waitcnt vmcnt(8)
 v_mfma_f32_16x16x32_bf16 v[84:87], v[236:239], v[56:59], v[84:87]
 buffer_load_dwordx4 v[76:79], v0, s[4:7], s25 offen offset:3072 sc1
 s_add_u32 s25, s25, 4096
 buffer_load_dwordx4 a[216:219], v0, s[4:7], s47 offen offset:2048 sc1
 v_mfma_f32_16x16x32_bf16 v[88:91], v[240:243], v[56:59], v[88:91]
 v_mfma_f32_16x16x32_bf16 v[92:95], v[244:247], v[56:59], v[92:95]
 v_mfma_f32_16x16x32_bf16 v[96:99], v[248:251], v[56:59], v[96:99]
 s_mov_b32 m0, s38
 s_nop 0
 buffer_load_dwordx4 v0, s[4:7], s37 offen offset:3072 sc1  lds
 s_add_u32 s37, s37, 4096
 s_add_u32 s38, s38, 4096
 v_mfma_f32_16x16x32_bf16 v[100:103], v[252:255], v[56:59], v[100:103]
 s_waitcnt vmcnt(10)
 v_mfma_f32_16x16x32_bf16 v[84:87], v[144:147], v[60:63], v[84:87]
 buffer_load_dwordx4 v[80:83], v0, s[4:7], s25 offen sc1
 v_mfma_f32_16x16x32_bf16 v[88:91], v[148:151], v[60:63], v[88:91]
 buffer_load_dwordx4 a[220:223], v0, s[4:7], s47 offen offset:3072 sc1
 s_add_u32 s47, s47, 4096
 v_mfma_f32_16x16x32_bf16 v[92:95], v[152:155], v[60:63], v[92:95]
 v_mfma_f32_16x16x32_bf16 v[96:99], v[156:159], v[60:63], v[96:99]
 v_mfma_f32_16x16x32_bf16 v[100:103], v[160:163], v[60:63], v[100:103]
 s_waitcnt vmcnt(11)
 v_mfma_f32_16x16x32_bf16 v[104:107], v[176:179], v[64:67], 0
 buffer_load_dwordx4 v[44:47], v0, s[4:7], s26 offen sc1
 buffer_load_dwordx4 a[224:227], v0, s[4:7], s47 offen sc1
 v_mfma_f32_16x16x32_bf16 v[108:111], v[180:183], v[64:67], 0
 s_waitcnt lgkmcnt(0)
 s_barrier
 v_mfma_f32_16x16x32_bf16 v[112:115], v[184:187], v[64:67], 0
 ds_write_b128 v3, v[84:87] offset:12288
 v_mfma_f32_16x16x32_bf16 v[116:119], v[188:191], v[64:67], 0
 s_mov_b32 m0, s38
 s_nop 0
 buffer_load_dwordx4 v0, s[4:7], s37 offen sc1  lds
 v_mfma_f32_16x16x32_bf16 v[120:123], v[192:195], v[64:67], 0
 s_waitcnt vmcnt(12)
 v_mfma_f32_16x16x32_bf16 v[104:107], v[196:199], v[68:71], v[104:107]
 buffer_load_dwordx4 v[48:51], v0, s[4:7], s26 offen offset:1024 sc1
 v_mfma_f32_16x16x32_bf16 v[108:111], v[200:203], v[68:71], v[108:111]
 ds_write_b128 v3, v[88:91] offset:13312
 buffer_load_dwordx4 a[228:231], v0, s[4:7], s47 offen offset:1024 sc1
 v_mfma_f32_16x16x32_bf16 v[112:115], v[204:207], v[68:71], v[112:115]
 v_mfma_f32_16x16x32_bf16 v[116:119], v[208:211], v[68:71], v[116:119]
 ds_write_b128 v3, v[92:95] offset:14336
 v_mfma_f32_16x16x32_bf16 v[120:123], v[212:215], v[68:71], v[120:123]
 s_mov_b32 m0, s38
 s_nop 0
 buffer_load_dwordx4 v0, s[4:7], s37 offen offset:1024 sc1  lds
 s_waitcnt vmcnt(12)
 v_mfma_f32_16x16x32_bf16 v[104:107], v[216:219], v[72:75], v[104:107]
 buffer_load_dwordx4 v[52:55], v0, s[4:7], s26 offen offset:2048 sc1
 v_mfma_f32_16x16x32_bf16 v[108:111], v[220:223], v[72:75], v[108:111]
 ds_write_b128 v3, v[96:99] offset:15360
 v_mfma_f32_16x16x32_bf16 v[112:115], v[224:227], v[72:75], v[112:115]
 v_mfma_f32_16x16x32_bf16 v[116:119], v[228:231], v[72:75], v[116:119]
 ds_write_b128 v3, v[100:103] offset:16384
 buffer_load_dwordx4 a[232:235], v0, s[4:7], s47 offen offset:2048 sc1
 v_mfma_f32_16x16x32_bf16 v[120:123], v[232:235], v[72:75], v[120:123]
 s_waitcnt vmcnt(12)
 v_mfma_f32_16x16x32_bf16 v[104:107], v[236:239], v[76:79], v[104:107]
 buffer_load_dwordx4 v[56:59], v0, s[4:7], s26 offen offset:3072 sc1
 s_add_u32 s26, s26, 4096
 v_mfma_f32_16x16x32_bf16 v[108:111], v[240:243], v[76:79], v[108:111]
 s_mov_b32 m0, s38
 s_nop 0
 buffer_load_dwordx4 v0, s[4:7], s37 offen offset:2048 sc1  lds
 v_mfma_f32_16x16x32_bf16 v[112:115], v[244:247], v[76:79], v[112:115]
 v_mfma_f32_16x16x32_bf16 v[116:119], v[248:251], v[76:79], v[116:119]
 s_waitcnt lgkmcnt(0)
 s_barrier
 v_mfma_f32_16x16x32_bf16 v[120:123], v[252:255], v[76:79], v[120:123]
 ds_read_b128 v[124:127], v5 offset:12288
 buffer_load_dwordx4 a[236:239], v0, s[4:7], s47 offen offset:3072 sc1
 s_sub_u32 s47, s47, 57344
 s_waitcnt vmcnt(12)
 v_mfma_f32_16x16x32_bf16 v[104:107], v[144:147], v[80:83], v[104:107]
 ds_read_b128 v[128:131], v5 offset:13312
 buffer_load_dwordx4 v[60:63], v0, s[4:7], s26 offen sc1
 v_mfma_f32_16x16x32_bf16 v[108:111], v[148:151], v[80:83], v[108:111]
 ds_read_b64 v[132:133], v6 offset:16384
 v_mfma_f32_16x16x32_bf16 v[112:115], v[152:155], v[80:83], v[112:115]
 ds_read_b128 v[134:137], v5 offset:17408
 v_mfma_f32_16x16x32_bf16 v[116:119], v[156:159], v[80:83], v[116:119]
 ds_read_b128 v[138:141], v5 offset:18432
 v_mfma_f32_16x16x32_bf16 v[120:123], v[160:163], v[80:83], v[120:123]
 ds_read_b64 v[142:143], v6 offset:21504
 s_waitcnt lgkmcnt(0)
 s_barrier
 ds_write_b128 v4, v[104:107] offset:12288
 v_pk_add_f32 v[16:17], v[16:17], v[124:125]
 v_pk_add_f32 v[18:19], v[18:19], v[126:127]
 v_pk_add_f32 v[20:21], v[20:21], v[128:129]
 ds_write_b128 v4, v[108:111] offset:13312
 v_pk_add_f32 v[22:23], v[22:23], v[130:131]
 v_pk_add_f32 v[24:25], v[24:25], v[132:133]
 v_pk_add_f32 v[16:17], v[16:17], v[134:135]
 ds_write_b128 v4, v[112:115] offset:14336
 v_pk_add_f32 v[18:19], v[18:19], v[136:137]
 v_pk_add_f32 v[20:21], v[20:21], v[138:139]
 v_pk_add_f32 v[22:23], v[22:23], v[140:141]
 ds_write_b128 v4, v[116:119] offset:15360
 v_pk_add_f32 v[24:25], v[24:25], v[142:143]
 buffer_load_dwordx4 v[64:67], v0, s[4:7], s27 offen sc1
 buffer_load_dwordx4 v[68:71], v0, s[4:7], s27 offen offset:1024 sc1
 ds_write_b128 v4, v[120:123] offset:16384
 buffer_load_dwordx4 v[72:75], v0, s[4:7], s27 offen offset:2048 sc1
 buffer_load_dwordx4 v[76:79], v0, s[4:7], s27 offen offset:3072 sc1
 s_add_u32 s27, s27, 4096
 buffer_load_dwordx4 v[80:83], v0, s[4:7], s27 offen sc1
 s_waitcnt lgkmcnt(0)
 s_barrier
 ds_read_b128 v[124:127], v5 offset:12288
 ds_read_b128 v[128:131], v5 offset:13312
 ds_read_b64 v[132:133], v6 offset:16384
 ds_read_b128 v[134:137], v5 offset:17408
 ds_read_b128 v[138:141], v5 offset:18432
 ds_read_b64 v[142:143], v6 offset:21504
 s_waitcnt lgkmcnt(5)
 v_pk_add_f32 v[16:17], v[16:17], v[124:125]
 v_pk_add_f32 v[18:19], v[18:19], v[126:127]
 s_waitcnt lgkmcnt(4)
 v_pk_add_f32 v[20:21], v[20:21], v[128:129]
 v_pk_add_f32 v[22:23], v[22:23], v[130:131]
 s_waitcnt lgkmcnt(3)
 v_pk_add_f32 v[24:25], v[24:25], v[132:133]
 s_waitcnt lgkmcnt(2)
 v_pk_add_f32 v[16:17], v[16:17], v[134:135]
 v_pk_add_f32 v[18:19], v[18:19], v[136:137]
 s_waitcnt lgkmcnt(1)
 v_pk_add_f32 v[20:21], v[20:21], v[138:139]
 v_pk_add_f32 v[22:23], v[22:23], v[140:141]
 s_waitcnt lgkmcnt(0)
 v_pk_add_f32 v[24:25], v[24:25], v[142:143]
 v_cvt_pk_bf16_f32 v124, v16, v17
 v_cvt_pk_bf16_f32 v125, v18, v19
 v_cvt_pk_bf16_f32 v126, v20, v21
 v_cvt_pk_bf16_f32 v127, v22, v23
 v_cvt_pk_bf16_f32 v128, v24, v25
 buffer_store_dwordx4 v[124:127], v168, s[8:11], s29 offen sc1
 buffer_store_dword v128, v169, s[8:11], s30 offen sc1
 v_pk_add_f32 v[130:131], v[16:17], v[18:19]
 v_pk_mul_f32 v[132:133], v[16:17], v[16:17]
 v_pk_fma_f32 v[132:133], v[18:19], v[18:19], v[132:133]
 v_pk_add_f32 v[130:131], v[130:131], v[20:21]
 v_pk_fma_f32 v[132:133], v[20:21], v[20:21], v[132:133]
 v_pk_add_f32 v[130:131], v[130:131], v[22:23]
 v_pk_fma_f32 v[132:133], v[22:23], v[22:23], v[132:133]
 v_pk_add_f32 v[130:131], v[130:131], v[24:25]
 v_pk_fma_f32 v[132:133], v[24:25], v[24:25], v[132:133]
 v_add_f32 v130, v130, v131
 v_add_f32 v132, v132, v133
 s_nop 1
 v_permlane32_swap_b32 v130, v132
 v_add_f32 v131, v130, v132
 v_add_f32 v130, v130, v132
 s_nop 1
 v_permlane16_swap_b32 v130, v131
 v_add_f32 v130, v130, v131
 s_nop 1
 v_add_f32_dpp v130, v130, v130 row_ror:8 row_mask:0xf bank_mask:0xf
 buffer_store_dword v130, v170, s[4:7], s31 offen sc1
 s_add_u32 s29, s29, 40960
 s_add_u32 s30, s30, 40960
 s_add_u32 s31, s31, 2048
 s_waitcnt vmcnt(19)
 v_mfma_f32_16x16x32_bf16 v[84:87], v[176:179], v[44:47], 0
 buffer_load_dwordx4 a[0:3], v0, s[4:7], s47 offen sc1
 v_mfma_f32_16x16x32_bf16 v[88:91], v[180:183], v[44:47], 0
 v_mfma_f32_16x16x32_bf16 v[92:95], v[184:187], v[44:47], 0
 v_mfma_f32_16x16x32_bf16 v[96:99], v[188:191], v[44:47], 0
 buffer_load_dwordx4 a[4:7], v0, s[4:7], s47 offen offset:1024 sc1
 v_mfma_f32_16x16x32_bf16 v[100:103], v[192:195], v[44:47], 0
 s_waitcnt vmcnt(18)
 v_mfma_f32_16x16x32_bf16 v[84:87], v[196:199], v[48:51], v[84:87]
 v_mfma_f32_16x16x32_bf16 v[88:91], v[200:203], v[48:51], v[88:91]
 buffer_load_dwordx4 a[8:11], v0, s[4:7], s47 offen offset:2048 sc1
 v_mfma_f32_16x16x32_bf16 v[92:95], v[204:207], v[48:51], v[92:95]
 v_mfma_f32_16x16x32_bf16 v[96:99], v[208:211], v[48:51], v[96:99]
 v_mfma_f32_16x16x32_bf16 v[100:103], v[212:215], v[48:51], v[100:103]
 s_waitcnt vmcnt(16)
 v_mfma_f32_16x16x32_bf16 v[84:87], v[216:219], v[52:55], v[84:87]
 buffer_load_dwordx4 a[12:15], v0, s[4:7], s47 offen offset:3072 sc1
 s_add_u32 s47, s47, 4096
 v_mfma_f32_16x16x32_bf16 v[88:91], v[220:223], v[52:55], v[88:91]
 v_mfma_f32_16x16x32_bf16 v[92:95], v[224:227], v[52:55], v[92:95]
 v_mfma_f32_16x16x32_bf16 v[96:99], v[228:231], v[52:55], v[96:99]
 buffer_load_dwordx4 a[16:19], v0, s[4:7], s47 offen sc1
 v_mfma_f32_16x16x32_bf16 v[100:103], v[232:235], v[52:55], v[100:103]
 s_waitcnt vmcnt(16)
 v_mfma_f32_16x16x32_bf16 v[84:87], v[236:239], v[56:59], v[84:87]
 v_mfma_f32_16x16x32_bf16 v[88:91], v[240:243], v[56:59], v[88:91]
 buffer_load_dwordx4 a[20:23], v0, s[4:7], s47 offen offset:1024 sc1
 v_mfma_f32_16x16x32_bf16 v[92:95], v[244:247], v[56:59], v[92:95]
 v_mfma_f32_16x16x32_bf16 v[96:99], v[248:251], v[56:59], v[96:99]
 v_mfma_f32_16x16x32_bf16 v[100:103], v[252:255], v[56:59], v[100:103]
 s_waitcnt vmcnt(14)
 v_mfma_f32_16x16x32_bf16 v[84:87], v[144:147], v[60:63], v[84:87]
 buffer_load_dwordx4 a[24:27], v0, s[4:7], s47 offen offset:2048 sc1
 v_mfma_f32_16x16x32_bf16 v[88:91], v[148:151], v[60:63], v[88:91]
 v_mfma_f32_16x16x32_bf16 v[92:95], v[152:155], v[60:63], v[92:95]
 v_mfma_f32_16x16x32_bf16 v[96:99], v[156:159], v[60:63], v[96:99]
 buffer_load_dwordx4 a[28:31], v0, s[4:7], s47 offen offset:3072 sc1
 s_add_u32 s47, s47, 4096
 v_mfma_f32_16x16x32_bf16 v[100:103], v[160:163], v[60:63], v[100:103]
 v_mov_b32 v15, 2
 v_add_u32 v15, s52, v15
 s_waitcnt vmcnt(8)
 s_mov_b64 exec, 1
 buffer_store_dword v15, v0, s[4:7], s32 offen sc1
 s_mov_b64 exec, -1
 s_add_u32 s32, s32, 12288
 v_mfma_f32_16x16x32_bf16 v[104:107], v[176:179], v[64:67], 0
 v_mfma_f32_16x16x32_bf16 v[108:111], v[180:183], v[64:67], 0
 s_waitcnt lgkmcnt(0)
 s_barrier
 buffer_load_dwordx4 a[32:35], v0, s[4:7], s47 offen sc1
 v_mfma_f32_16x16x32_bf16 v[112:115], v[184:187], v[64:67], 0
 ds_write_b128 v3, v[84:87] offset:12288
 v_mfma_f32_16x16x32_bf16 v[116:119], v[188:191], v[64:67], 0
 v_mfma_f32_16x16x32_bf16 v[120:123], v[192:195], v[64:67], 0
 v_mfma_f32_16x16x32_bf16 v[104:107], v[196:199], v[68:71], v[104:107]
 buffer_load_dwordx4 a[36:39], v0, s[4:7], s47 offen offset:1024 sc1
 v_mfma_f32_16x16x32_bf16 v[108:111], v[200:203], v[68:71], v[108:111]
 ds_write_b128 v3, v[88:91] offset:13312
 v_mfma_f32_16x16x32_bf16 v[112:115], v[204:207], v[68:71], v[112:115]
 v_mfma_f32_16x16x32_bf16 v[116:119], v[208:211], v[68:71], v[116:119]
 ds_write_b128 v3, v[92:95] offset:14336
 buffer_load_dwordx4 a[40:43], v0, s[4:7], s47 offen offset:2048 sc1
 v_mfma_f32_16x16x32_bf16 v[120:123], v[212:215], v[68:71], v[120:123]
 v_mfma_f32_16x16x32_bf16 v[104:107], v[216:219], v[72:75], v[104:107]
 v_mfma_f32_16x16x32_bf16 v[108:111], v[220:223], v[72:75], v[108:111]
 ds_write_b128 v3, v[96:99] offset:15360
 buffer_load_dwordx4 a[44:47], v0, s[4:7], s47 offen offset:3072 sc1
 s_add_u32 s47, s47, 4096
 v_mfma_f32_16x16x32_bf16 v[112:115], v[224:227], v[72:75], v[112:115]
 v_mfma_f32_16x16x32_bf16 v[116:119], v[228:231], v[72:75], v[116:119]
 ds_write_b128 v3, v[100:103] offset:16384
 v_mfma_f32_16x16x32_bf16 v[120:123], v[232:235], v[72:75], v[120:123]
 v_mfma_f32_16x16x32_bf16 v[104:107], v[236:239], v[76:79], v[104:107]
 v_mfma_f32_16x16x32_bf16 v[108:111], v[240:243], v[76:79], v[108:111]
 v_mfma_f32_16x16x32_bf16 v[112:115], v[244:247], v[76:79], v[112:115]
 v_mfma_f32_16x16x32_bf16 v[116:119], v[248:251], v[76:79], v[116:119]
 s_waitcnt lgkmcnt(0)
 s_barrier
 v_mfma_f32_16x16x32_bf16 v[120:123], v[252:255], v[76:79], v[120:123]
 ds_read_b128 v[124:127], v5 offset:12288
 v_mfma_f32_16x16x32_bf16 v[104:107], v[144:147], v[80:83], v[104:107]
 ds_read_b128 v[128:131], v5 offset:13312
 v_mfma_f32_16x16x32_bf16 v[108:111], v[148:151], v[80:83], v[108:111]
 ds_read_b64 v[132:133], v6 offset:16384
 s_lshl_b32 s33, s54, 7
 s_add_u32 s33, s33, 7733248
 s_add_u32 s56, s52, 2
 buffer_load_dword v12, v172, s[4:7], s33 offen sc1
 v_mfma_f32_16x16x32_bf16 v[112:115], v[152:155], v[80:83], v[112:115]
 ds_read_b128 v[134:137], v5 offset:17408
 v_mfma_f32_16x16x32_bf16 v[116:119], v[156:159], v[80:83], v[116:119]
 ds_read_b128 v[138:141], v5 offset:18432
 v_mfma_f32_16x16x32_bf16 v[120:123], v[160:163], v[80:83], v[120:123]
 ds_read_b64 v[142:143], v6 offset:21504
 s_waitcnt lgkmcnt(0)
 s_barrier
 ds_write_b128 v4, v[104:107] offset:12288
 v_pk_add_f32 v[26:27], v[26:27], v[124:125]
 v_pk_add_f32 v[28:29], v[28:29], v[126:127]
 v_pk_add_f32 v[30:31], v[30:31], v[128:129]
 ds_write_b128 v4, v[108:111] offset:13312
 v_pk_add_f32 v[32:33], v[32:33], v[130:131]
 v_pk_add_f32 v[34:35], v[34:35], v[132:133]
 v_pk_add_f32 v[26:27], v[26:27], v[134:135]
 ds_write_b128 v4, v[112:115] offset:14336
 v_pk_add_f32 v[28:29], v[28:29], v[136:137]
 v_pk_add_f32 v[30:31], v[30:31], v[138:139]
 v_pk_add_f32 v[32:33], v[32:33], v[140:141]
 ds_write_b128 v4, v[116:119] offset:15360
 v_pk_add_f32 v[34:35], v[34:35], v[142:143]
 ds_read_b128 v[176:179], v1 offset:16384
 ds_read_b128 v[180:183], v1 offset:17408
 s_waitcnt vmcnt(0)
 v_cmp_ne_u32 vcc, s56, v12
 s_cbranch_vccz Lgate_42
 s_mov_b32 s55, 0
Lpoll_43:
 buffer_load_dword v12, v172, s[4:7], s33 offen sc1
 s_add_u32 s55, s55, 1
 s_cmp_gt_u32 s55, 0x80000
 s_cbranch_scc1 Lend
 s_waitcnt vmcnt(0)
 v_cmp_ne_u32 vcc, s56, v12
 s_cbranch_vccnz Lpoll_43
Lgate_42:
 s_add_u32 s33, s33, 12288
 buffer_load_dwordx4 v[44:47], v0, s[8:11], s16 offen sc1
 buffer_load_dwordx4 v[48:51], v0, s[8:11], s17 offen sc1
 ds_write_b128 v4, v[120:123] offset:16384
 buffer_load_dwordx4 v[52:55], v0, s[8:11], s16 offen offset:1024 sc1
 buffer_load_dwordx4 v[56:59], v0, s[8:11], s17 offen offset:1024 sc1
 buffer_load_dwordx4 v[60:63], v0, s[8:11], s16 offen offset:2048 sc1
 buffer_load_dwordx4 v[64:67], v0, s[8:11], s17 offen offset:2048 sc1
 buffer_load_dwordx4 v[68:71], v0, s[8:11], s16 offen offset:3072 sc1
 s_add_u32 s16, s16, 4096
 ds_read_b128 v[184:187], v1 offset:18432
 ds_read_b128 v[188:191], v1 offset:19456
 ds_read_b128 v[192:195], v1 offset:20480
 s_waitcnt lgkmcnt(0)
 s_barrier
 ds_read_b128 v[124:127], v5 offset:12288
 ds_read_b128 v[128:131], v5 offset:13312
 ds_read_b64 v[132:133], v6 offset:16384
 ds_read_b128 v[134:137], v5 offset:17408
 ds_read_b128 v[138:141], v5 offset:18432
 ds_read_b64 v[142:143], v6 offset:21504
 buffer_load_dwordx4 v[72:75], v0, s[8:11], s17 offen offset:3072 sc1
 s_add_u32 s17, s17, 4096
 buffer_load_dwordx4 v[76:79], v0, s[8:11], s16 offen sc1
 buffer_load_dwordx4 v[80:83], v0, s[8:11], s17 offen sc1
 s_waitcnt vmcnt(9)
 v_mfma_f32_16x16x32_bf16 v[212:215], v[176:179], v[44:47], 0
 v_mfma_f32_16x16x32_bf16 v[216:219], v[180:183], v[44:47], 0
 ds_read_b128 v[196:199], v1 offset:21504
 v_mfma_f32_16x16x32_bf16 v[220:223], v[184:187], v[44:47], 0
 s_waitcnt lgkmcnt(6)
 v_add_f32 v26, v26, v124
 v_add_f32 v27, v27, v125
 s_waitcnt vmcnt(8)
 v_mfma_f32_16x16x32_bf16 v[224:227], v[176:179], v[48:51], 0
 ds_read_b128 v[200:203], v1 offset:22528
 v_add_f32 v28, v28, v126
 v_add_f32 v29, v29, v127
 s_waitcnt lgkmcnt(6)
 v_add_f32 v30, v30, v128
 v_mfma_f32_16x16x32_bf16 v[228:231], v[180:183], v[48:51], 0
 v_add_f32 v31, v31, v129
 v_add_f32 v32, v32, v130
 v_add_f32 v33, v33, v131
 v_mfma_f32_16x16x32_bf16 v[232:235], v[184:187], v[48:51], 0
 ds_read_b128 v[204:207], v1 offset:23552
 s_waitcnt lgkmcnt(6)
 v_add_f32 v34, v34, v132
 v_add_f32 v35, v35, v133
 s_waitcnt vmcnt(7) lgkmcnt(2)
 v_mfma_f32_16x16x32_bf16 v[212:215], v[188:191], v[52:55], v[212:215]
 v_add_f32 v26, v26, v134
 v_add_f32 v27, v27, v135
 v_add_f32 v28, v28, v136
 v_mfma_f32_16x16x32_bf16 v[216:219], v[192:195], v[52:55], v[216:219]
 ds_read_b128 v[208:211], v1 offset:24576
 v_add_f32 v29, v29, v137
 v_add_f32 v30, v30, v138
 v_add_f32 v31, v31, v139
 v_mfma_f32_16x16x32_bf16 v[220:223], v[196:199], v[52:55], v[220:223]
 v_add_f32 v32, v32, v140
 v_add_f32 v33, v33, v141
 s_waitcnt vmcnt(6)
 v_mfma_f32_16x16x32_bf16 v[224:227], v[188:191], v[56:59], v[224:227]
 ds_read_b128 v[176:179], v1 offset:25600
 buffer_load_dwordx4 v[44:47], v0, s[8:11], s16 offen offset:1024 sc1
 v_add_f32 v34, v34, v142
 v_add_f32 v35, v35, v143
 v_mfma_f32_16x16x32_bf16 v[228:231], v[192:195], v[56:59], v[228:231]
 v_cvt_pk_bf16_f32 v124, v26, v27
 v_cvt_pk_bf16_f32 v125, v28, v29
 v_cvt_pk_bf16_f32 v126, v30, v31
 v_mfma_f32_16x16x32_bf16 v[232:235], v[196:199], v[56:59], v[232:235]
 ds_read_b128 v[180:183], v1 offset:26624
 v_cvt_pk_bf16_f32 v127, v32, v33
 v_cvt_pk_bf16_f32 v128, v34, v35
 s_waitcnt vmcnt(6) lgkmcnt(2)
 v_mfma_f32_16x16x32_bf16 v[212:215], v[200:203], v[60:63], v[212:215]
 buffer_load_dwordx4 v[48:51], v0, s[8:11], s17 offen offset:1024 sc1
 v_mfma_f32_16x16x32_bf16 v[216:219], v[204:207], v[60:63], v[216:219]
 ds_read_b128 v[184:187], v1 offset:27648
 v_mfma_f32_16x16x32_bf16 v[220:223], v[208:211], v[60:63], v[220:223]
 buffer_load_dwordx4 v[236:239], v0, s[4:7], s20 offen sc1
 s_waitcnt vmcnt(7)
 v_mfma_f32_16x16x32_bf16 v[224:227], v[200:203], v[64:67], v[224:227]
 ds_read_b128 v[188:191], v1 offset:28672
 buffer_load_dwordx4 v[52:55], v0, s[8:11], s16 offen offset:2048 sc1
 v_mfma_f32_16x16x32_bf16 v[228:231], v[204:207], v[64:67], v[228:231]
 buffer_store_dwordx4 v[124:127], v168, s[8:11], s29 offen sc1
 v_mfma_f32_16x16x32_bf16 v[232:235], v[208:211], v[64:67], v[232:235]
 ds_read_b128 v[192:195], v1 offset:29696
 buffer_store_dword v128, v169, s[8:11], s30 offen sc1
 s_waitcnt vmcnt(9) lgkmcnt(2)
 v_mfma_f32_16x16x32_bf16 v[212:215], v[176:179], v[68:71], v[212:215]
 buffer_load_dwordx4 v[56:59], v0, s[8:11], s17 offen offset:2048 sc1
 v_add_f32 v130, v26, v27
 v_mul_f32 v132, v26, v26
 v_mfma_f32_16x16x32_bf16 v[216:219], v[180:183], v[68:71], v[216:219]
 ds_read_b128 v[196:199], v1 offset:30720
 v_fmac_f32 v132, v27, v27
 v_add_f32 v130, v130, v28
 v_fmac_f32 v132, v28, v28
 v_mfma_f32_16x16x32_bf16 v[220:223], v[184:187], v[68:71], v[220:223]
 buffer_load_dwordx4 v[240:243], v0, s[4:7], s20 offen offset:1024 sc1
 v_add_f32 v130, v130, v29
 s_waitcnt vmcnt(10)
 v_mfma_f32_16x16x32_bf16 v[224:227], v[176:179], v[72:75], v[224:227]
 ds_read_b128 v[200:203], v1 offset:31744
 buffer_load_dwordx4 v[60:63], v0, s[8:11], s16 offen offset:3072 sc1
 s_add_u32 s16, s16, 4096
 v_fmac_f32 v132, v29, v29
 v_mfma_f32_16x16x32_bf16 v[228:231], v[180:183], v[72:75], v[228:231]
 v_add_f32 v130, v130, v30
 v_fmac_f32 v132, v30, v30
 v_add_f32 v130, v130, v31
 v_mfma_f32_16x16x32_bf16 v[232:235], v[184:187], v[72:75], v[232:235]
 ds_read_b128 v[204:207], v1 offset:32768
 v_fmac_f32 v132, v31, v31
 v_add_f32 v130, v130, v32
 s_waitcnt vmcnt(10) lgkmcnt(2)
 v_mfma_f32_16x16x32_bf16 v[212:215], v[188:191], v[76:79], v[212:215]
 buffer_load_dwordx4 v[64:67], v0, s[8:11], s17 offen offset:3072 sc1
 s_add_u32 s17, s17, 4096
 v_fmac_f32 v132, v32, v32
 s_barrier
 s_mul_i32 s22, s49, 5120
 s_mul_i32 s23, s3, 1280
 s_add_u32 s22, s22, s23
 s_add_u32 s22, s22, 7569408
 s_add_u32 m0, s23, 143360
 v_lshrrev_b32 v13, 2, v0
 buffer_load_dwordx4 v0, s[4:7], s22 offen sc1 lds
 buffer_load_dword v13, s[4:7], s22 offen offset:1024 sc1 lds
 v_mfma_f32_16x16x32_bf16 v[216:219], v[192:195], v[76:79], v[216:219]
 ds_read_b128 v[208:211], v1 offset:33792
 v_add_f32 v130, v130, v33
 v_fmac_f32 v132, v33, v33
 v_add_f32 v130, v130, v34
 v_mfma_f32_16x16x32_bf16 v[220:223], v[196:199], v[76:79], v[220:223]
 v_fmac_f32 v132, v34, v34
 v_add_f32 v130, v130, v35
 s_mul_i32 s35, s54, 196608
 s_waitcnt vmcnt(12)
 v_mfma_f32_16x16x32_bf16 v[224:227], v[188:191], v[80:83], v[224:227]
 ds_read_b128 v[176:179], v1 offset:34816
 buffer_load_dwordx4 v[68:71], v0, s[8:11], s16 offen sc1
 v_fmac_f32 v132, v35, v35
 s_add_u32 s35, s35, 18350080
 v_mfma_f32_16x16x32_bf16 v[228:231], v[192:195], v[80:83], v[228:231]
 v_permlane32_swap_b32 v130, v132
 v_add_f32 v131, v130, v132
 s_lshr_b32 s34, s49, 1
 v_mfma_f32_16x16x32_bf16 v[232:235], v[196:199], v[80:83], v[232:235]
 ds_read_b128 v[180:183], v1 offset:35840
 v_add_f32 v130, v130, v132
 s_mul_i32 s34, s34, 3072
 s_waitcnt vmcnt(12) lgkmcnt(2)
 v_mfma_f32_16x16x32_bf16 v[212:215], v[200:203], v[44:47], v[212:215]
 buffer_load_dwordx4 v[72:75], v0, s[8:11], s17 offen sc1
 v_permlane16_swap_b32 v130, v131
 buffer_load_dwordx4 a[48:51], v0, s[4:7], s47 offen sc1
 v_mfma_f32_16x16x32_bf16 v[216:219], v[204:207], v[44:47], v[216:219]
 ds_read_b128 v[184:187], v1 offset:36864
 v_add_f32 v130, v130, v131
 s_nop 1
 v_add_f32_dpp v130, v130, v130 row_ror:8 row_mask:0xf bank_mask:0xf
 s_add_u32 s35, s35, s34
 v_mfma_f32_16x16x32_bf16 v[220:223], v[208:211], v[44:47], v[220:223]
 buffer_store_dword v130, v170, s[4:7], s31 offen sc1
 s_lshl_b32 s34, s59, 11
 s_waitcnt vmcnt(14)
 v_mfma_f32_16x16x32_bf16 v[224:227], v[200:203], v[48:51], v[224:227]
 ds_read_b128 v[188:191], v1 offset:37888
 buffer_load_dwordx4 v[76:79], v0, s[8:11], s16 offen offset:1024 sc1
 s_add_u32 s34, s34, s35
 s_lshl_b32 s36, s59, 9
 v_mfma_f32_16x16x32_bf16 v[228:231], v[204:207], v[48:51], v[228:231]
 s_add_u32 s35, s35, s36
 s_lshl_b32 s36, s54, 7
 s_add_u32 s36, s36, 7737344
 s_lshl_b32 s21, s49, 2
 v_mfma_f32_16x16x32_bf16 v[232:235], v[208:211], v[48:51], v[232:235]
 ds_read_b128 v[192:195], v1 offset:38912
 s_add_u32 s36, s36, s21
 s_mul_i32 s24, s53, 196608
 s_waitcnt vmcnt(13) lgkmcnt(2)
 v_mfma_f32_16x16x32_bf16 v[212:215], v[176:179], v[52:55], v[212:215]
 buffer_load_dwordx4 v[80:83], v0, s[8:11], s17 offen offset:1024 sc1
 s_add_u32 s24, s24, 18350080
 s_mul_i32 s25, s3, 12288
 s_add_u32 s24, s24, s25
 v_mfma_f32_16x16x32_bf16 v[216:219], v[180:183], v[52:55], v[216:219]
 ds_read_b128 v[196:199], v1 offset:39936
 s_lshr_b32 s26, s3, 1
 s_mul_i32 s26, s26, 49152
 s_add_u32 s25, s24, 49152
 v_mfma_f32_16x16x32_bf16 v[220:223], v[184:187], v[52:55], v[220:223]
 buffer_load_dwordx4 a[52:55], v0, s[4:7], s47 offen offset:1024 sc1
 s_sub_u32 s25, s25, s26
 s_add_u32 s24, s24, s26
 s_waitcnt vmcnt(12)
 v_mfma_f32_16x16x32_bf16 v[224:227], v[176:179], v[56:59], v[224:227]
 ds_read_b128 v[200:203], v1 offset:40960
 buffer_load_dwordx4 v[44:47], v0, s[8:11], s16 offen offset:2048 sc1
 s_add_u32 s26, s24, 98304
 s_add_u32 s27, s25, 98304
 v_mfma_f32_16x16x32_bf16 v[228:231], v[180:183], v[56:59], v[228:231]
 s_mov_b32 s44, 0
 s_mov_b32 s45, 0xffff0000
 v_mfma_f32_16x16x32_bf16 v[232:235], v[184:187], v[56:59], v[232:235]
 ds_read_b128 v[204:207], v1 offset:41984
 s_waitcnt vmcnt(11) lgkmcnt(2)
 v_mfma_f32_16x16x32_bf16 v[212:215], v[188:191], v[60:63], v[212:215]
 buffer_load_dwordx4 v[48:51], v0, s[8:11], s17 offen offset:2048 sc1
 v_mfma_f32_16x16x32_bf16 v[216:219], v[192:195], v[60:63], v[216:219]
 ds_read_b128 v[208:211], v1 offset:43008
 v_mfma_f32_16x16x32_bf16 v[220:223], v[196:199], v[60:63], v[220:223]
 s_waitcnt vmcnt(11)
 v_mfma_f32_16x16x32_bf16 v[224:227], v[188:191], v[64:67], v[224:227]
 ds_read_b128 v[176:179], v1 offset:44032
 buffer_load_dwordx4 v[52:55], v0, s[8:11], s16 offen offset:3072 sc1
 s_add_u32 s16, s16, 4096
 v_mfma_f32_16x16x32_bf16 v[228:231], v[192:195], v[64:67], v[228:231]
 v_mfma_f32_16x16x32_bf16 v[232:235], v[196:199], v[64:67], v[232:235]
 ds_read_b128 v[180:183], v1 offset:45056
 buffer_load_dwordx4 a[56:59], v0, s[4:7], s47 offen offset:2048 sc1
 s_waitcnt vmcnt(10) lgkmcnt(2)
 v_mfma_f32_16x16x32_bf16 v[212:215], v[200:203], v[68:71], v[212:215]
 buffer_load_dwordx4 v[56:59], v0, s[8:11], s17 offen offset:3072 sc1
 s_add_u32 s17, s17, 4096
 v_mov_b32 v15, 2
 v_add_u32 v15, s52, v15
 s_waitcnt vmcnt(8)
 s_mov_b64 exec, 1
 buffer_store_dword v15, v0, s[4:7], s32 offen sc1
 s_mov_b64 exec, -1
 v_mfma_f32_16x16x32_bf16 v[216:219], v[204:207], v[68:71], v[216:219]
 ds_read_b128 v[184:187], v1 offset:46080
 v_mfma_f32_16x16x32_bf16 v[220:223], v[208:211], v[68:71], v[220:223]
 v_mfma_f32_16x16x32_bf16 v[224:227], v[200:203], v[72:75], v[224:227]
 ds_read_b128 v[188:191], v1 offset:47104
 buffer_load_dwordx4 v[60:63], v0, s[8:11], s16 offen sc1
 v_mfma_f32_16x16x32_bf16 v[228:231], v[204:207], v[72:75], v[228:231]
 v_mfma_f32_16x16x32_bf16 v[232:235], v[208:211], v[72:75], v[232:235]
 ds_read_b128 v[192:195], v1 offset:48128
 s_waitcnt vmcnt(9) lgkmcnt(2)
 v_mfma_f32_16x16x32_bf16 v[212:215], v[176:179], v[76:79], v[212:215]
 buffer_load_dwordx4 v[64:67], v0, s[8:11], s17 offen sc1
 v_mfma_f32_16x16x32_bf16 v[216:219], v[180:183], v[76:79], v[216:219]
 ds_read_b128 v[196:199], v1 offset:49152
 v_mfma_f32_16x16x32_bf16 v[220:223], v[184:187], v[76:79], v[220:223]
 buffer_load_dwordx4 a[60:63], v0, s[4:7], s47 offen offset:3072 sc1
 s_add_u32 s47, s47, 4096
 s_waitcnt vmcnt(10)
 v_mfma_f32_16x16x32_bf16 v[224:227], v[176:179], v[80:83], v[224:227]
 ds_read_b128 v[200:203], v1 offset:50176
 buffer_load_dwordx4 v[68:71], v0, s[8:11], s16 offen offset:1024 sc1
 v_mfma_f32_16x16x32_bf16 v[228:231], v[180:183], v[80:83], v[228:231]
 v_mfma_f32_16x16x32_bf16 v[232:235], v[184:187], v[80:83], v[232:235]
 ds_read_b128 v[204:207], v1 offset:51200
 s_waitcnt vmcnt(9) lgkmcnt(2)
 v_mfma_f32_16x16x32_bf16 v[212:215], v[188:191], v[44:47], v[212:215]
 buffer_load_dwordx4 v[72:75], v0, s[8:11], s17 offen offset:1024 sc1
 v_mfma_f32_16x16x32_bf16 v[216:219], v[192:195], v[44:47], v[216:219]
 ds_read_b128 v[208:211], v1 offset:52224
 v_mfma_f32_16x16x32_bf16 v[220:223], v[196:199], v[44:47], v[220:223]
 s_waitcnt vmcnt(9)
 v_mfma_f32_16x16x32_bf16 v[224:227], v[188:191], v[48:51], v[224:227]
 ds_read_b128 v[176:179], v1 offset:53248
 buffer_load_dwordx4 v[76:79], v0, s[8:11], s16 offen offset:2048 sc1
 v_mfma_f32_16x16x32_bf16 v[228:231], v[192:195], v[48:51], v[228:231]
 v_mfma_f32_16x16x32_bf16 v[232:235], v[196:199], v[48:51], v[232:235]
 ds_read_b128 v[180:183], v1 offset:54272
 buffer_load_dwordx4 a[64:67], v0, s[4:7], s47 offen sc1
 s_waitcnt vmcnt(10) lgkmcnt(2)
 v_mfma_f32_16x16x32_bf16 v[212:215], v[200:203], v[52:55], v[212:215]
 buffer_load_dwordx4 v[80:83], v0, s[8:11], s17 offen offset:2048 sc1
 v_mfma_f32_16x16x32_bf16 v[216:219], v[204:207], v[52:55], v[216:219]
 ds_read_b128 v[184:187], v1 offset:55296
 v_mfma_f32_16x16x32_bf16 v[220:223], v[208:211], v[52:55], v[220:223]
 s_waitcnt vmcnt(9)
 v_mfma_f32_16x16x32_bf16 v[224:227], v[200:203], v[56:59], v[224:227]
 ds_read_b128 v[188:191], v1 offset:56320
 buffer_load_dwordx4 v[44:47], v0, s[8:11], s16 offen offset:3072 sc1
 s_add_u32 s16, s16, 4096
 v_mfma_f32_16x16x32_bf16 v[228:231], v[204:207], v[56:59], v[228:231]
 s_barrier
 v_mfma_f32_16x16x32_bf16 v[232:235], v[208:211], v[56:59], v[232:235]
 ds_read_b128 v[192:195], v1 offset:57344
 buffer_load_dwordx2 v[104:105], v0, s[4:7], s34 offen sc1
 s_waitcnt vmcnt(9) lgkmcnt(2)
 v_mfma_f32_16x16x32_bf16 v[212:215], v[176:179], v[60:63], v[212:215]
 buffer_load_dwordx4 v[48:51], v0, s[8:11], s17 offen offset:3072 sc1
 s_add_u32 s17, s17, 4096
 v_mfma_f32_16x16x32_bf16 v[216:219], v[180:183], v[60:63], v[216:219]
 ds_read_b128 v[196:199], v1 offset:58368
 buffer_load_dwordx4 a[68:71], v0, s[4:7], s47 offen offset:1024 sc1
 s_add_u32 s23, s34, 49152
 buffer_load_dwordx2 v[104:105], v0, s[4:7], s23 offen sc1
 v_mfma_f32_16x16x32_bf16 v[220:223], v[184:187], v[60:63], v[220:223]
 s_waitcnt vmcnt(11)
 v_mfma_f32_16x16x32_bf16 v[224:227], v[176:179], v[64:67], v[224:227]
 ds_read_b128 v[200:203], v1 offset:59392
 buffer_load_dwordx4 v[52:55], v0, s[8:11], s16 offen sc1
 buffer_load_dwordx2 v[104:105], v7, s[4:7], s35 offen offset:1024 sc1
 v_mfma_f32_16x16x32_bf16 v[228:231], v[180:183], v[64:67], v[228:231]
 v_mfma_f32_16x16x32_bf16 v[232:235], v[184:187], v[64:67], v[232:235]
 ds_read_b128 v[204:207], v1 offset:60416
 s_waitcnt vmcnt(11) lgkmcnt(2)
 v_mfma_f32_16x16x32_bf16 v[212:215], v[188:191], v[68:71], v[212:215]
 buffer_load_dwordx4 v[56:59], v0, s[8:11], s17 offen sc1
 v_mfma_f32_16x16x32_bf16 v[216:219], v[192:195], v[68:71], v[216:219]
 ds_read_b128 v[208:211], v1 offset:61440
 v_mfma_f32_16x16x32_bf16 v[220:223], v[196:199], v[68:71], v[220:223]
 v_lshrrev_b32 v13, 2, v0
 v_add_u32 v13, 143360, v13
 ds_read2st64_b32 v[84:85], v13 offset0:0 offset1:1
 s_waitcnt vmcnt(11)
 v_mfma_f32_16x16x32_bf16 v[224:227], v[188:191], v[72:75], v[224:227]
 ds_read_b128 v[176:179], v1 offset:62464
 buffer_load_dwordx4 v[60:63], v0, s[8:11], s16 offen offset:1024 sc1
 ds_read2st64_b32 v[86:87], v13 offset0:2 offset1:3
 ds_read2st64_b32 v[88:89], v13 offset0:4 offset1:5
 v_mfma_f32_16x16x32_bf16 v[228:231], v[192:195], v[72:75], v[228:231]
 buffer_load_dwordx4 a[72:75], v0, s[4:7], s47 offen offset:2048 sc1
 ds_read2st64_b32 v[90:91], v13 offset0:6 offset1:7
 ds_read2st64_b32 v[92:93], v13 offset0:8 offset1:9
 s_waitcnt lgkmcnt(5)
 v_add_f32 v84, v84, v85
 v_mfma_f32_16x16x32_bf16 v[232:235], v[196:199], v[72:75], v[232:235]
 ds_read_b128 v[180:183], v1 offset:63488
 s_waitcnt lgkmcnt(4)
 v_add_f32 v84, v84, v86
 v_add_f32 v84, v84, v87
 s_waitcnt vmcnt(12)
 v_mfma_f32_16x16x32_bf16 v[212:215], v[200:203], v[76:79], v[212:215]
 s_add_u32 s56, s52, 2
 buffer_load_dword v12, v172, s[4:7], s33 offen sc1
 buffer_load_dwordx4 v[64:67], v0, s[8:11], s17 offen offset:1024 sc1
 s_waitcnt lgkmcnt(3)
 v_add_f32 v84, v84, v88
 v_mfma_f32_16x16x32_bf16 v[216:219], v[204:207], v[76:79], v[216:219]
 ds_read_b128 v[184:187], v1 offset:64512
 v_add_f32 v84, v84, v89
 s_waitcnt lgkmcnt(3)
 v_add_f32 v84, v84, v90
 v_add_f32 v84, v84, v91
 v_mfma_f32_16x16x32_bf16 v[220:223], v[208:211], v[76:79], v[220:223]
 s_waitcnt lgkmcnt(2)
 v_add_f32 v84, v84, v92
 v_add_f32 v84, v84, v93
 ds_read2st64_b32 v[86:87], v13 offset0:10 offset1:11
 s_waitcnt vmcnt(12)
 v_mfma_f32_16x16x32_bf16 v[224:227], v[200:203], v[80:83], v[224:227]
 ds_read_b128 v[188:191], v2
 buffer_load_dwordx4 v[68:71], v0, s[8:11], s16 offen offset:2048 sc1
 ds_read2st64_b32 v[88:89], v13 offset0:12 offset1:13
 ds_read2st64_b32 v[90:91], v13 offset0:14 offset1:15
 v_mfma_f32_16x16x32_bf16 v[228:231], v[204:207], v[80:83], v[228:231]
 ds_read2st64_b32 v[92:93], v13 offset0:16 offset1:17
 s_waitcnt lgkmcnt(4)
 v_add_f32 v84, v84, v86
 v_add_f32 v84, v84, v87
 s_waitcnt lgkmcnt(2)
 v_add_f32 v84, v84, v88
 v_mfma_f32_16x16x32_bf16 v[232:235], v[208:211], v[80:83], v[232:235]
 ds_read_b128 v[192:195], v2 offset:1024
 v_add_f32 v84, v84, v89
 s_waitcnt lgkmcnt(2)
 v_add_f32 v84, v84, v90
 s_waitcnt vmcnt(12)
 v_mfma_f32_16x16x32_bf16 v[212:215], v[176:179], v[44:47], v[212:215]
 buffer_load_dwordx4 v[72:75], v0, s[8:11], s17 offen offset:2048 sc1
 v_add_f32 v84, v84, v91
 s_waitcnt lgkmcnt(1)
 v_add_f32 v84, v84, v92
 v_add_f32 v84, v84, v93
 v_mfma_f32_16x16x32_bf16 v[216:219], v[180:183], v[44:47], v[216:219]
 ds_read_b128 v[196:199], v2 offset:2048
 buffer_load_dwordx4 a[76:79], v0, s[4:7], s47 offen offset:3072 sc1
 s_add_u32 s47, s47, 4096
 ds_read2st64_b32 v[86:87], v13 offset0:18 offset1:19
 v_mfma_f32_16x16x32_bf16 v[220:223], v[184:187], v[44:47], v[220:223]
 s_waitcnt lgkmcnt(0)
 v_add_f32 v84, v84, v86
 v_add_f32 v84, v84, v87
 v_cvt_pk_bf16_f32 v85, v84, v84
 s_waitcnt vmcnt(12)
 v_mfma_f32_16x16x32_bf16 v[224:227], v[176:179], v[48:51], v[224:227]
 ds_read_b128 v[200:203], v2 offset:3072
 buffer_load_dwordx4 v[76:79], v0, s[8:11], s16 offen offset:3072 sc1
 s_add_u32 s16, s16, 4096
 v_lshlrev_b32 v85, 16, v85
 v_mfma_f32_16x16x32_bf16 v[228:231], v[180:183], v[48:51], v[228:231]
 v_sub_f32 v86, v84, v85
 v_cvt_pk_bf16_f32 v84, v85, v86
 v_lshrrev_b32 v85, 8, v0
 v_cmp_eq_u32 s[22:23], 0, v85
 v_mfma_f32_16x16x32_bf16 v[232:235], v[184:187], v[48:51], v[232:235]
 ds_read_b128 v[204:207], v2 offset:4096
 v_accvgpr_read_b32 v87, a250
 v_cndmask_b32 v86, 0, v84, s[22:23]
 s_waitcnt vmcnt(10)
 v_mfma_f32_16x16x32_bf16 v[212:215], v[188:191], v[52:55], v[212:215]
 buffer_load_dwordx4 v[80:83], v0, s[8:11], s17 offen offset:3072 sc1
 s_add_u32 s17, s17, 4096
 v_cndmask_b32 v86, v86, v87, s[44:45]
 v_accvgpr_write_b32 a244, v86
 v_mfma_f32_16x16x32_bf16 v[216:219], v[192:195], v[52:55], v[216:219]
 ds_read_b128 v[208:211], v2 offset:5120
 v_accvgpr_write_b32 a245, v86
 v_cmp_eq_u32 s[22:23], 1, v85
 v_accvgpr_read_b32 v87, a251
 v_mfma_f32_16x16x32_bf16 v[220:223], v[196:199], v[52:55], v[220:223]
 s_waitcnt vmcnt(6)
 v_cmp_ne_u32 vcc, s56, v12
 s_cbranch_vccnz Lretry_44
Lback_45:
 v_cndmask_b32 v86, 0, v84, s[22:23]
 v_mfma_f32_16x16x32_bf16 v[224:227], v[188:191], v[56:59], v[224:227]
 ds_read_b128 v[176:179], v2 offset:6144
 buffer_load_dwordx4 v[44:47], v0, s[8:11], s18 offen sc1
 v_cndmask_b32 v86, v86, v87, s[44:45]
 v_accvgpr_write_b32 a246, v86
 v_mfma_f32_16x16x32_bf16 v[228:231], v[192:195], v[56:59], v[228:231]
 v_accvgpr_write_b32 a247, v86
 v_cmp_eq_u32 s[22:23], 2, v85
 v_accvgpr_read_b32 v87, a252
 s_nop 0
 v_cndmask_b32 v86, 0, v84, s[22:23]
 v_mfma_f32_16x16x32_bf16 v[232:235], v[196:199], v[56:59], v[232:235]
 ds_read_b128 v[180:183], v2 offset:7168
 v_cndmask_b32 v86, v86, v87, s[44:45]
 v_accvgpr_write_b32 a248, v86
 s_waitcnt lgkmcnt(2)
 v_mfma_f32_16x16x32_bf16 v[212:215], v[200:203], v[60:63], v[212:215]
 buffer_load_dwordx4 v[48:51], v0, s[8:11], s19 offen sc1
 v_accvgpr_write_b32 a249, v86
 v_add_f32 v236, v236, v237
 v_add_f32 v240, v240, v241
 v_mfma_f32_16x16x32_bf16 v[216:219], v[204:207], v[60:63], v[216:219]
 ds_read_b128 v[184:187], v2 offset:8192
 v_add_f32 v236, v236, v238
 v_add_f32 v240, v240, v242
 v_add_f32 v236, v236, v239
 v_mfma_f32_16x16x32_bf16 v[220:223], v[208:211], v[60:63], v[220:223]
 v_add_f32 v240, v240, v243
 s_nop 1
 v_permlane16_swap_b32 v236, v240
 s_waitcnt vmcnt(7)
 v_mfma_f32_16x16x32_bf16 v[224:227], v[200:203], v[64:67], v[224:227]
 ds_read_b128 v[188:191], v2 offset:9216
 buffer_load_dwordx4 v[52:55], v0, s[8:11], s18 offen offset:1024 sc1
 v_add_f32 v236, v236, v240
 v_mov_b32 v237, v236
 v_mfma_f32_16x16x32_bf16 v[228:231], v[204:207], v[64:67], v[228:231]
 s_nop 0
 v_permlane32_swap_b32 v236, v237
 v_mul_f32 v236, 0xbacccccd, v236
 v_mul_f32 v237, 0x3acccccd, v237
 v_mfma_f32_16x16x32_bf16 v[232:235], v[208:211], v[64:67], v[232:235]
 ds_read_b128 v[192:195], v2 offset:10240
 v_fma_f32 v237, -v236, v236, v237
 v_max_f32 v237, 0, v237
 s_waitcnt vmcnt(7) lgkmcnt(2)
 v_mfma_f32_16x16x32_bf16 v[212:215], v[176:179], v[68:71], v[212:215]
 buffer_load_dwordx4 v[56:59], v0, s[8:11], s19 offen offset:1024 sc1
 v_add_f32 v237, 0x3727c5ac, v237
 v_rsq_f32 v238, v237
 v_mfma_f32_16x16x32_bf16 v[216:219], v[180:183], v[68:71], v[216:219]
 ds_read_b128 v[196:199], v2 offset:11264
 v_mul_f32 v237, v237, v238
 v_mov_b32 v240, v236
 v_mov_b32 v241, v237
 v_mfma_f32_16x16x32_bf16 v[220:223], v[184:187], v[68:71], v[220:223]
 v_mov_b32 v242, v238
 v_permlane16_swap_b32 v236, v240
 s_waitcnt vmcnt(7)
 v_mfma_f32_16x16x32_bf16 v[224:227], v[176:179], v[72:75], v[224:227]
 ds_read_b128 v[200:203], v1 offset:16384
 buffer_load_dwordx4 v[60:63], v0, s[8:11], s18 offen offset:2048 sc1
 v_permlane16_swap_b32 v237, v241
 v_mfma_f32_16x16x32_bf16 v[228:231], v[180:183], v[72:75], v[228:231]
 buffer_load_dwordx4 v[244:247], v0, s[4:7], s20 offen offset:2048 sc1
 v_permlane16_swap_b32 v238, v242
 v_cndmask_b32 v14, v236, v237, s[44:45]
 v_mfma_f32_16x16x32_bf16 v[232:235], v[184:187], v[72:75], v[232:235]
 ds_read_b128 v[204:207], v1 offset:17408
 v_cvt_pk_bf16_f32 v236, v14, v14
 v_lshlrev_b32 v239, 16, v236
 s_waitcnt vmcnt(7) lgkmcnt(2)
 v_mfma_f32_16x16x32_bf16 v[212:215], v[188:191], v[76:79], v[212:215]
 buffer_load_dwordx4 v[64:67], v0, s[8:11], s19 offen offset:2048 sc1
 v_sub_f32 v239, v14, v239
 v_cvt_pk_bf16_f32 v237, v239, v239
 v_cndmask_b32 v14, v240, v241, s[44:45]
 v_mfma_f32_16x16x32_bf16 v[216:219], v[192:195], v[76:79], v[216:219]
 ds_read_b128 v[208:211], v1 offset:18432
 v_cvt_pk_bf16_f32 v240, v14, v14
 v_lshlrev_b32 v243, 16, v240
 v_sub_f32 v243, v14, v243
 v_mfma_f32_16x16x32_bf16 v[220:223], v[196:199], v[76:79], v[220:223]
 v_cvt_pk_bf16_f32 v241, v243, v243
 s_waitcnt vmcnt(7)
 v_mfma_f32_16x16x32_bf16 v[224:227], v[188:191], v[80:83], v[224:227]
 ds_read_b128 v[176:179], v1 offset:19456
 buffer_load_dwordx4 v[68:71], v0, s[8:11], s18 offen offset:3072 sc1
 s_add_u32 s18, s18, 4096
 v_mfma_f32_16x16x32_bf16 v[228:231], v[192:195], v[80:83], v[228:231]
 buffer_load_dwordx4 v[248:251], v0, s[4:7], s20 offen offset:3072 sc1
 v_mfma_f32_16x16x32_bf16 v[232:235], v[196:199], v[80:83], v[232:235]
 ds_read_b128 v[180:183], v1 offset:20480
 s_waitcnt vmcnt(8) lgkmcnt(2)
 v_mfma_f32_16x16x32_bf16 v[144:147], v[200:203], v[44:47], 0
 buffer_load_dwordx4 v[72:75], v0, s[8:11], s19 offen offset:3072 sc1
 s_add_u32 s19, s19, 4096
 v_mfma_f32_16x16x32_bf16 v[148:151], v[204:207], v[44:47], 0
 ds_read_b128 v[184:187], v1 offset:21504
 v_mfma_f32_16x16x16_bf16 v[212:215], a[244:245], v[236:237], v[212:215]
 v_mfma_f32_16x16x16_bf16 v[216:219], a[246:247], v[236:237], v[216:219]
 v_mfma_f32_16x16x16_bf16 v[220:223], a[248:249], v[236:237], v[220:223]
 v_mfma_f32_16x16x32_bf16 v[152:155], v[208:211], v[44:47], 0
 v_mfma_f32_16x16x16_bf16 v[224:227], a[244:245], v[240:241], v[224:227]
 v_mfma_f32_16x16x16_bf16 v[228:231], a[246:247], v[240:241], v[228:231]
 v_mfma_f32_16x16x16_bf16 v[232:235], a[248:249], v[240:241], v[232:235]
 s_waitcnt vmcnt(8)
 v_mfma_f32_16x16x32_bf16 v[156:159], v[200:203], v[48:51], 0
 ds_read_b128 v[188:191], v1 offset:22528
 buffer_load_dwordx4 v[76:79], v0, s[8:11], s18 offen sc1
 v_mfma_f32_16x16x32_bf16 v[160:163], v[204:207], v[48:51], 0
 v_mfma_f32_16x16x32_bf16 v[164:167], v[208:211], v[48:51], 0
 ds_read_b128 v[192:195], v1 offset:23552
 v_mul_f32 v212, v212, v238
 v_mul_f32 v212, v212, abs(v212)
 v_mul_f32 v213, v213, v238
 s_waitcnt vmcnt(8) lgkmcnt(2)
 v_mfma_f32_16x16x32_bf16 v[144:147], v[176:179], v[52:55], v[144:147]
 buffer_load_dwordx4 v[80:83], v0, s[8:11], s19 offen sc1
 v_mul_f32 v213, v213, abs(v213)
 v_cvt_pk_bf16_f32 v124, v212, v213
 v_pk_max_i16 v124, v124, 0
 v_mfma_f32_16x16x32_bf16 v[148:151], v[180:183], v[52:55], v[148:151]
 ds_read_b128 v[196:199], v1 offset:24576
 v_mul_f32 v214, v214, v238
 v_mul_f32 v214, v214, abs(v214)
 v_mul_f32 v215, v215, v238
 v_mul_f32 v215, v215, abs(v215)
 v_mfma_f32_16x16x32_bf16 v[152:155], v[184:187], v[52:55], v[152:155]
 v_cvt_pk_bf16_f32 v125, v214, v215
 v_pk_max_i16 v125, v125, 0
 v_mul_f32 v216, v216, v238
 v_mul_f32 v216, v216, abs(v216)
 s_waitcnt vmcnt(8)
 v_mfma_f32_16x16x32_bf16 v[156:159], v[176:179], v[56:59], v[156:159]
 ds_read_b128 v[200:203], v1 offset:25600
 buffer_load_dwordx4 v[44:47], v0, s[8:11], s18 offen offset:1024 sc1
 v_mul_f32 v217, v217, v238
 v_mul_f32 v217, v217, abs(v217)
 v_cvt_pk_bf16_f32 v126, v216, v217
 v_mfma_f32_16x16x32_bf16 v[160:163], v[180:183], v[56:59], v[160:163]
 v_pk_max_i16 v126, v126, 0
 v_mul_f32 v218, v218, v238
 v_mul_f32 v218, v218, abs(v218)
 v_mul_f32 v219, v219, v238
 v_mul_f32 v219, v219, abs(v219)
 v_mfma_f32_16x16x32_bf16 v[164:167], v[184:187], v[56:59], v[164:167]
 ds_read_b128 v[204:207], v1 offset:26624
 v_cvt_pk_bf16_f32 v127, v218, v219
 v_pk_max_i16 v127, v127, 0
 s_waitcnt vmcnt(8) lgkmcnt(2)
 v_mfma_f32_16x16x32_bf16 v[144:147], v[188:191], v[60:63], v[144:147]
 buffer_load_dwordx4 v[48:51], v0, s[8:11], s19 offen offset:1024 sc1
 v_mfma_f32_16x16x32_bf16 v[148:151], v[192:195], v[60:63], v[148:151]
 ds_read_b128 v[208:211], v1 offset:27648
 v_mfma_f32_16x16x32_bf16 v[152:155], v[196:199], v[60:63], v[152:155]
 s_waitcnt vmcnt(7)
 v_mfma_f32_16x16x32_bf16 v[156:159], v[188:191], v[64:67], v[156:159]
 ds_read_b128 v[176:179], v1 offset:28672
 buffer_load_dwordx4 v[52:55], v0, s[8:11], s18 offen offset:2048 sc1
 v_mfma_f32_16x16x32_bf16 v[160:163], v[192:195], v[64:67], v[160:163]
 buffer_store_dwordx4 v[124:127], v0, s[4:7], s34 offen sc1
 v_mfma_f32_16x16x32_bf16 v[164:167], v[196:199], v[64:67], v[164:167]
 ds_read_b128 v[180:183], v1 offset:29696
 s_add_u32 s34, s34, 49152
 v_mul_f32 v220, v220, v238
 v_mul_f32 v220, v220, abs(v220)
 s_waitcnt vmcnt(8) lgkmcnt(2)
 v_mfma_f32_16x16x32_bf16 v[144:147], v[200:203], v[68:71], v[144:147]
 buffer_load_dwordx4 v[56:59], v0, s[8:11], s19 offen offset:2048 sc1
 v_mul_f32 v221, v221, v238
 v_mul_f32 v221, v221, abs(v221)
 v_cvt_pk_bf16_f32 v132, v220, v221
 v_pk_max_i16 v132, v132, 0
 v_mfma_f32_16x16x32_bf16 v[148:151], v[204:207], v[68:71], v[148:151]
 ds_read_b128 v[184:187], v1 offset:30720
 v_mul_f32 v222, v222, v238
 v_mul_f32 v222, v222, abs(v222)
 v_mul_f32 v223, v223, v238
 v_mul_f32 v223, v223, abs(v223)
 v_mfma_f32_16x16x32_bf16 v[152:155], v[208:211], v[68:71], v[152:155]
 v_cvt_pk_bf16_f32 v133, v222, v223
 v_pk_max_i16 v133, v133, 0
 v_mul_f32 v224, v224, v242
 v_mul_f32 v224, v224, abs(v224)
 s_waitcnt vmcnt(7)
 v_mfma_f32_16x16x32_bf16 v[156:159], v[200:203], v[72:75], v[156:159]
 ds_read_b128 v[188:191], v1 offset:31744
 buffer_load_dwordx4 v[60:63], v0, s[8:11], s18 offen offset:3072 sc1
 s_add_u32 s18, s18, 4096
 v_mul_f32 v225, v225, v242
 v_mul_f32 v225, v225, abs(v225)
 v_mfma_f32_16x16x32_bf16 v[160:163], v[204:207], v[72:75], v[160:163]
 v_cvt_pk_bf16_f32 v128, v224, v225
 v_pk_max_i16 v128, v128, 0
 v_mul_f32 v226, v226, v242
 v_mul_f32 v226, v226, abs(v226)
 v_mfma_f32_16x16x32_bf16 v[164:167], v[208:211], v[72:75], v[164:167]
 ds_read_b128 v[192:195], v1 offset:32768
 v_mul_f32 v227, v227, v242
 v_mul_f32 v227, v227, abs(v227)
 v_cvt_pk_bf16_f32 v129, v226, v227
 s_waitcnt vmcnt(7) lgkmcnt(2)
 v_mfma_f32_16x16x32_bf16 v[144:147], v[176:179], v[76:79], v[144:147]
 buffer_load_dwordx4 v[64:67], v0, s[8:11], s19 offen offset:3072 sc1
 s_add_u32 s19, s19, 4096
 v_pk_max_i16 v129, v129, 0
 v_mul_f32 v228, v228, v242
 v_mul_f32 v228, v228, abs(v228)
 v_mfma_f32_16x16x32_bf16 v[148:151], v[180:183], v[76:79], v[148:151]
 ds_read_b128 v[196:199], v1 offset:33792
 v_mul_f32 v229, v229, v242
 v_mul_f32 v229, v229, abs(v229)
 v_cvt_pk_bf16_f32 v130, v228, v229
 v_pk_max_i16 v130, v130, 0
 v_mfma_f32_16x16x32_bf16 v[152:155], v[184:187], v[76:79], v[152:155]
 v_mul_f32 v230, v230, v242
 v_mul_f32 v230, v230, abs(v230)
 v_mul_f32 v231, v231, v242
 v_mul_f32 v231, v231, abs(v231)
 s_waitcnt vmcnt(7)
 v_mfma_f32_16x16x32_bf16 v[156:159], v[176:179], v[80:83], v[156:159]
 ds_read_b128 v[200:203], v1 offset:34816
 buffer_load_dwordx4 v[68:71], v0, s[8:11], s18 offen sc1
 v_cvt_pk_bf16_f32 v131, v230, v231
 v_pk_max_i16 v131, v131, 0
 v_mfma_f32_16x16x32_bf16 v[160:163], v[180:183], v[80:83], v[160:163]
 buffer_store_dwordx4 v[128:131], v0, s[4:7], s34 offen sc1
 v_mfma_f32_16x16x32_bf16 v[164:167], v[184:187], v[80:83], v[164:167]
 ds_read_b128 v[204:207], v1 offset:35840
 s_add_u32 s34, s34, 49152
 v_mul_f32 v232, v232, v242
 v_mul_f32 v232, v232, abs(v232)
 s_waitcnt vmcnt(8) lgkmcnt(2)
 v_mfma_f32_16x16x32_bf16 v[144:147], v[188:191], v[44:47], v[144:147]
 buffer_load_dwordx4 v[72:75], v0, s[8:11], s19 offen sc1
 v_mul_f32 v233, v233, v242
 v_mul_f32 v233, v233, abs(v233)
 v_cvt_pk_bf16_f32 v134, v232, v233
 v_mfma_f32_16x16x32_bf16 v[148:151], v[192:195], v[44:47], v[148:151]
 ds_read_b128 v[208:211], v1 offset:36864
 v_pk_max_i16 v134, v134, 0
 v_mul_f32 v234, v234, v242
 v_mul_f32 v234, v234, abs(v234)
 v_mul_f32 v235, v235, v242
 v_mfma_f32_16x16x32_bf16 v[152:155], v[196:199], v[44:47], v[152:155]
 v_mul_f32 v235, v235, abs(v235)
 v_cvt_pk_bf16_f32 v135, v234, v235
 v_pk_max_i16 v135, v135, 0
 s_waitcnt vmcnt(8)
 v_mfma_f32_16x16x32_bf16 v[156:159], v[188:191], v[48:51], v[156:159]
 ds_read_b128 v[176:179], v1 offset:37888
 buffer_load_dwordx4 v[76:79], v0, s[8:11], s18 offen offset:1024 sc1
 v_permlane16_swap_b32 v132, v134
 v_mfma_f32_16x16x32_bf16 v[160:163], v[192:195], v[48:51], v[160:163]
 v_permlane16_swap_b32 v133, v135
 v_mfma_f32_16x16x32_bf16 v[164:167], v[196:199], v[48:51], v[164:167]
 ds_read_b128 v[180:183], v1 offset:38912
 s_waitcnt vmcnt(8) lgkmcnt(2)
 v_mfma_f32_16x16x32_bf16 v[144:147], v[200:203], v[52:55], v[144:147]
 buffer_load_dwordx4 v[80:83], v0, s[8:11], s19 offen offset:1024 sc1
 v_mfma_f32_16x16x32_bf16 v[148:151], v[204:207], v[52:55], v[148:151]
 ds_read_b128 v[184:187], v1 offset:39936
 v_mfma_f32_16x16x32_bf16 v[152:155], v[208:211], v[52:55], v[152:155]
 s_waitcnt vmcnt(7)
 v_mfma_f32_16x16x32_bf16 v[156:159], v[200:203], v[56:59], v[156:159]
 ds_read_b128 v[188:191], v1 offset:40960
 buffer_load_dwordx4 v[44:47], v0, s[8:11], s18 offen offset:2048 sc1
 v_mfma_f32_16x16x32_bf16 v[160:163], v[204:207], v[56:59], v[160:163]
 buffer_store_dwordx4 v[132:135], v7, s[4:7], s35 offen offset:1024 sc1
 v_mfma_f32_16x16x32_bf16 v[164:167], v[208:211], v[56:59], v[164:167]
 ds_read_b128 v[192:195], v1 offset:41984
 s_add_u32 s35, s35, 98304
 s_waitcnt vmcnt(8) lgkmcnt(2)
 v_mfma_f32_16x16x32_bf16 v[144:147], v[176:179], v[60:63], v[144:147]
 buffer_load_dwordx4 v[48:51], v0, s[8:11], s19 offen offset:2048 sc1
 v_mfma_f32_16x16x32_bf16 v[148:151], v[180:183], v[60:63], v[148:151]
 ds_read_b128 v[196:199], v1 offset:43008
 v_mfma_f32_16x16x32_bf16 v[152:155], v[184:187], v[60:63], v[152:155]
 s_waitcnt vmcnt(8)
 v_mfma_f32_16x16x32_bf16 v[156:159], v[176:179], v[64:67], v[156:159]
 ds_read_b128 v[200:203], v1 offset:44032
 buffer_load_dwordx4 v[52:55], v0, s[8:11], s18 offen offset:3072 sc1
 s_add_u32 s18, s18, 4096
 s_lshl_b32 s21, s57, 6
 v_mfma_f32_16x16x32_bf16 v[160:163], v[180:183], v[64:67], v[160:163]
 s_lshl_b32 s22, s58, 1
 s_add_u32 s22, s22, s59
 s_lshl_b32 s22, s22, 5
 v_mfma_f32_16x16x32_bf16 v[164:167], v[184:187], v[64:67], v[164:167]
 ds_read_b128 v[204:207], v1 offset:45056
 v_bfe_u32 v252, v0, 4, 3
 v_mul_u32_u24 v252, 0, v252
 s_waitcnt vmcnt(8) lgkmcnt(2)
 v_mfma_f32_16x16x32_bf16 v[144:147], v[188:191], v[68:71], v[144:147]
 buffer_load_dwordx4 v[56:59], v0, s[8:11], s19 offen offset:3072 sc1
 s_add_u32 s19, s19, 4096
 v_bfe_u32 v14, v0, 7, 1
 v_mfma_f32_16x16x32_bf16 v[148:151], v[192:195], v[68:71], v[148:151]
 ds_read_b128 v[208:211], v1 offset:46080
 v_lshl_add_u32 v252, v14, 6, v252
 v_bfe_u32 v14, v0, 8, 2
 v_lshl_add_u32 v252, v14, 4, v252
 v_mfma_f32_16x16x32_bf16 v[152:155], v[196:199], v[68:71], v[152:155]
 v_bfe_u32 v173, v0, 4, 3
 v_mul_u32_u24 v173, 0, v173
 s_waitcnt vmcnt(7)
 v_mfma_f32_16x16x32_bf16 v[156:159], v[188:191], v[72:75], v[156:159]
 ds_read_b128 v[176:179], v1 offset:47104
 buffer_load_dwordx4 v[60:63], v0, s[8:11], s18 offen sc1
 v_bfe_u32 v14, v0, 7, 1
 v_lshl_add_u32 v173, v14, 2, v173
 v_mfma_f32_16x16x32_bf16 v[160:163], v[192:195], v[72:75], v[160:163]
 v_bfe_u32 v14, v0, 8, 2
 v_lshl_add_u32 v173, v14, 3, v173
 buffer_load_dwordx4 v[252:255], v252, s[12:15], s21 offen
 v_mfma_f32_16x16x32_bf16 v[164:167], v[196:199], v[72:75], v[164:167]
 ds_read_b128 v[180:183], v1 offset:48128
 buffer_load_dword v173, v173, s[12:15], s22 offen
 v_add_f32 v244, v244, v245
 s_waitcnt vmcnt(9) lgkmcnt(2)
 v_mfma_f32_16x16x32_bf16 v[144:147], v[200:203], v[76:79], v[144:147]
 buffer_load_dwordx4 v[64:67], v0, s[8:11], s19 offen sc1
 v_add_f32 v248, v248, v249
 v_add_f32 v244, v244, v246
 v_mfma_f32_16x16x32_bf16 v[148:151], v[204:207], v[76:79], v[148:151]
 ds_read_b128 v[184:187], v1 offset:49152
 v_add_f32 v248, v248, v250
 v_add_f32 v244, v244, v247
 v_add_f32 v248, v248, v251
 v_mfma_f32_16x16x32_bf16 v[152:155], v[208:211], v[76:79], v[152:155]
 s_nop 0
 v_permlane16_swap_b32 v244, v248
 s_waitcnt vmcnt(9)
 v_mfma_f32_16x16x32_bf16 v[156:159], v[200:203], v[80:83], v[156:159]
 ds_read_b128 v[188:191], v1 offset:50176
 buffer_load_dwordx4 v[68:71], v0, s[8:11], s18 offen offset:1024 sc1
 v_add_f32 v244, v244, v248
 v_mov_b32 v245, v244
 v_mfma_f32_16x16x32_bf16 v[160:163], v[204:207], v[80:83], v[160:163]
 s_nop 0
 v_permlane32_swap_b32 v244, v245
 v_mul_f32 v244, 0xbacccccd, v244
 v_mfma_f32_16x16x32_bf16 v[164:167], v[208:211], v[80:83], v[164:167]
 ds_read_b128 v[192:195], v1 offset:51200
 v_mul_f32 v245, 0x3acccccd, v245
 v_fma_f32 v245, -v244, v244, v245
 s_waitcnt vmcnt(9) lgkmcnt(2)
 v_mfma_f32_16x16x32_bf16 v[144:147], v[176:179], v[44:47], v[144:147]
 buffer_load_dwordx4 v[72:75], v0, s[8:11], s19 offen offset:1024 sc1
 v_mov_b32 v15, 3
 v_add_u32 v15, s52, v15
 s_waitcnt vmcnt(9)
 s_mov_b64 exec, 1
 buffer_store_dword v15, v0, s[4:7], s36 offen sc1
 s_mov_b64 exec, -1
 s_add_u32 s36, s36, 4096
 v_mfma_f32_16x16x32_bf16 v[148:151], v[180:183], v[44:47], v[148:151]
 ds_read_b128 v[196:199], v1 offset:52224
 v_max_f32 v245, 0, v245
 v_add_f32 v245, 0x3727c5ac, v245
 v_mfma_f32_16x16x32_bf16 v[152:155], v[184:187], v[44:47], v[152:155]
 v_rsq_f32 v246, v245
 s_waitcnt vmcnt(9)
 v_mfma_f32_16x16x32_bf16 v[156:159], v[176:179], v[48:51], v[156:159]
 ds_read_b128 v[200:203], v1 offset:53248
 buffer_load_dwordx4 v[76:79], v0, s[8:11], s18 offen offset:2048 sc1
 v_mul_f32 v245, v245, v246
 v_mov_b32 v248, v244
 v_mfma_f32_16x16x32_bf16 v[160:163], v[180:183], v[48:51], v[160:163]
 v_mov_b32 v249, v245
 v_mov_b32 v250, v246
 v_mfma_f32_16x16x32_bf16 v[164:167], v[184:187], v[48:51], v[164:167]
 ds_read_b128 v[204:207], v1 offset:54272
 v_permlane16_swap_b32 v244, v248
 s_waitcnt vmcnt(9) lgkmcnt(2)
 v_mfma_f32_16x16x32_bf16 v[144:147], v[188:191], v[52:55], v[144:147]
 buffer_load_dwordx4 v[80:83], v0, s[8:11], s19 offen offset:2048 sc1
 v_permlane16_swap_b32 v245, v249
 v_mfma_f32_16x16x32_bf16 v[148:151], v[192:195], v[52:55], v[148:151]
 ds_read_b128 v[208:211], v1 offset:55296
 v_permlane16_swap_b32 v246, v250
 v_cndmask_b32 v14, v244, v245, s[44:45]
 v_mfma_f32_16x16x32_bf16 v[152:155], v[196:199], v[52:55], v[152:155]
 v_cvt_pk_bf16_f32 v244, v14, v14
 v_lshlrev_b32 v247, 16, v244
 s_waitcnt vmcnt(9)
 v_mfma_f32_16x16x32_bf16 v[156:159], v[188:191], v[56:59], v[156:159]
 ds_read_b128 v[176:179], v1 offset:56320
 buffer_load_dwordx4 v[44:47], v0, s[8:11], s18 offen offset:3072 sc1
 s_add_u32 s18, s18, 4096
 v_sub_f32 v247, v14, v247
 v_mfma_f32_16x16x32_bf16 v[160:163], v[192:195], v[56:59], v[160:163]
 buffer_load_dwordx2 v[104:105], v0, s[4:7], s34 offen sc1
 v_cvt_pk_bf16_f32 v245, v247, v247
 v_cndmask_b32 v14, v248, v249, s[44:45]
 v_mfma_f32_16x16x32_bf16 v[164:167], v[196:199], v[56:59], v[164:167]
 ds_read_b128 v[180:183], v1 offset:57344
 v_cvt_pk_bf16_f32 v248, v14, v14
 v_lshlrev_b32 v251, 16, v248
 s_waitcnt vmcnt(10) lgkmcnt(2)
 v_mfma_f32_16x16x32_bf16 v[144:147], v[200:203], v[60:63], v[144:147]
 buffer_load_dwordx4 v[48:51], v0, s[8:11], s19 offen offset:3072 sc1
 s_add_u32 s19, s19, 4096
 s_add_u32 s23, s34, 49152
 buffer_load_dwordx2 v[104:105], v0, s[4:7], s23 offen sc1
 v_mfma_f32_16x16x32_bf16 v[148:151], v[204:207], v[60:63], v[148:151]
 ds_read_b128 v[184:187], v1 offset:58368
 v_sub_f32 v251, v14, v251
 v_cvt_pk_bf16_f32 v249, v251, v251
 s_mul_i32 s29, s53, 81920
 v_mfma_f32_16x16x32_bf16 v[152:155], v[208:211], v[60:63], v[152:155]
 buffer_load_dwordx2 v[104:105], v7, s[4:7], s35 offen offset:1024 sc1
 s_lshl_b32 s30, s58, 1
 s_waitcnt vmcnt(10)
 v_mfma_f32_16x16x32_bf16 v[156:159], v[200:203], v[64:67], v[156:159]
 ds_read_b128 v[188:191], v1 offset:59392
 buffer_load_dwordx4 v[52:55], v0, s[8:11], s18 offen sc1
 s_add_u32 s30, s30, s59
 s_lshl_b32 s62, s3, 7
 v_mfma_f32_16x16x32_bf16 v[160:163], v[204:207], v[64:67], v[160:163]
 s_add_u32 s62, s62, 0
 v_bfe_u32 v168, v0, 4, 3
 v_mul_u32_u24 v168, 16, v168
 v_mfma_f32_16x16x32_bf16 v[164:167], v[208:211], v[64:67], v[164:167]
 ds_read_b128 v[192:195], v1 offset:60416
 v_bfe_u32 v14, v0, 7, 1
 v_lshl_add_u32 v168, v14, 11, v168
 s_waitcnt vmcnt(10) lgkmcnt(2)
 v_mfma_f32_16x16x32_bf16 v[144:147], v[176:179], v[68:71], v[144:147]
 buffer_load_dwordx4 v[56:59], v0, s[8:11], s19 offen sc1
 v_bfe_u32 v14, v0, 8, 2
 v_lshl_add_u32 v168, v14, 9, v168
 v_mfma_f32_16x16x32_bf16 v[148:151], v[180:183], v[68:71], v[148:151]
 ds_read_b128 v[196:199], v1 offset:61440
 v_bfe_u32 v169, v0, 4, 3
 v_mul_u32_u24 v169, 16, v169
 v_bfe_u32 v14, v0, 7, 1
 v_mfma_f32_16x16x32_bf16 v[152:155], v[184:187], v[68:71], v[152:155]
 s_add_u32 s56, s52, 3
 buffer_load_dword v12, v171, s[4:7], s28 offen sc1
 s_waitcnt vmcnt(11)
 v_mfma_f32_16x16x32_bf16 v[156:159], v[176:179], v[72:75], v[156:159]
 ds_read_b128 v[200:203], v1 offset:62464
 buffer_load_dwordx4 v[60:63], v0, s[8:11], s18 offen offset:1024 sc1
 v_lshl_add_u32 v169, v14, 2, v169
 v_bfe_u32 v14, v0, 8, 1
 v_mfma_f32_16x16x32_bf16 v[160:163], v[180:183], v[72:75], v[160:163]
 v_lshl_add_u32 v169, v14, 3, v169
 v_bfe_u32 v14, v0, 9, 1
 v_lshl_add_u32 v169, v14, 9, v169
 v_mfma_f32_16x16x32_bf16 v[164:167], v[184:187], v[72:75], v[164:167]
 ds_read_b128 v[204:207], v1 offset:63488
 s_add_u32 s29, s29, s62
 s_lshl_b32 s30, s30, 10
 s_waitcnt vmcnt(10) lgkmcnt(2)
 v_mfma_f32_16x16x32_bf16 v[144:147], v[188:191], v[76:79], v[144:147]
 buffer_load_dwordx4 v[64:67], v0, s[8:11], s19 offen offset:1024 sc1
 s_add_u32 s30, s30, s29
 s_lshl_b32 s62, s57, 11
 v_mfma_f32_16x16x32_bf16 v[148:151], v[192:195], v[76:79], v[148:151]
 ds_read_b128 v[208:211], v1 offset:64512
 s_add_u32 s29, s29, s62
 v_bfe_u32 v170, v0, 4, 3
 v_mul_u32_u24 v170, 16, v170
 v_mfma_f32_16x16x32_bf16 v[152:155], v[196:199], v[76:79], v[152:155]
 v_bfe_u32 v14, v0, 7, 1
 v_lshl_add_u32 v170, v14, 30, v170
 s_waitcnt vmcnt(10)
 v_mfma_f32_16x16x32_bf16 v[156:159], v[188:191], v[80:83], v[156:159]
 ds_read_b128 v[176:179], v2
 buffer_load_dwordx4 v[68:71], v0, s[8:11], s18 offen offset:2048 sc1
 v_bfe_u32 v14, v0, 8, 1
 v_lshl_add_u32 v170, v14, 29, v170
 v_mfma_f32_16x16x32_bf16 v[160:163], v[192:195], v[80:83], v[160:163]
 v_bfe_u32 v14, v0, 9, 1
 v_lshl_add_u32 v170, v14, 9, v170
 s_lshl_b32 s31, s53, 2
 v_mfma_f32_16x16x32_bf16 v[164:167], v[196:199], v[80:83], v[164:167]
 ds_read_b128 v[180:183], v2 offset:1024
 s_lshr_b32 s62, s3, 1
 s_add_u32 s31, s31, s62
 s_waitcnt vmcnt(10) lgkmcnt(2)
 v_mfma_f32_16x16x32_bf16 v[144:147], v[200:203], v[44:47], v[144:147]
 buffer_load_dwordx4 v[72:75], v0, s[8:11], s19 offen offset:2048 sc1
 s_lshl_b32 s31, s31, 2
 s_lshr_b32 s62, s51, 2
 v_mfma_f32_16x16x32_bf16 v[148:151], v[204:207], v[44:47], v[148:151]
 ds_read_b128 v[184:187], v2 offset:2048
 s_add_u32 s31, s31, s62
 s_lshl_b32 s31, s31, 1
 s_and_b32 s62, s3, 1
 v_mfma_f32_16x16x32_bf16 v[152:155], v[208:211], v[44:47], v[152:155]
 s_add_u32 s31, s31, s62
 s_lshl_b32 s31, s31, 5
 s_waitcnt vmcnt(9)
 v_mfma_f32_16x16x32_bf16 v[156:159], v[200:203], v[48:51], v[156:159]
 ds_read_b128 v[188:191], v2 offset:3072
 buffer_load_dwordx4 v[76:79], v0, s[8:11], s18 offen offset:3072 sc1
 s_add_u32 s18, s18, 4096
 s_and_b32 s62, s51, 3
 v_mfma_f32_16x16x32_bf16 v[160:163], v[204:207], v[48:51], v[160:163]
 s_add_u32 s31, s31, s62
 s_lshl_b32 s31, s31, 2
 s_add_u32 s31, s31, 24641536
 v_mfma_f32_16x16x32_bf16 v[164:167], v[208:211], v[48:51], v[164:167]
 ds_read_b128 v[192:195], v2 offset:4096
 s_lshl_b32 s32, s53, 3
 s_add_u32 s32, s32, s51
 s_waitcnt vmcnt(7) lgkmcnt(2)
 v_mfma_f32_16x16x32_bf16 v[144:147], v[176:179], v[52:55], v[144:147]
 buffer_load_dwordx4 v[80:83], v0, s[8:11], s19 offen offset:3072 sc1
 s_add_u32 s19, s19, 4096
 s_lshl_b32 s32, s32, 2
 v_mfma_f32_16x16x32_bf16 v[148:151], v[180:183], v[52:55], v[148:151]
 ds_read_b128 v[196:199], v2 offset:5120
 s_add_u32 s32, s32, s3
 s_lshl_b32 s32, s32, 2
 s_add_u32 s32, s32, 7733248
 v_mfma_f32_16x16x32_bf16 v[152:155], v[184:187], v[52:55], v[152:155]
 s_waitcnt vmcnt(6)
 v_cmp_ne_u32 vcc, s56, v12
 s_cbranch_vccnz Lretry_47
Lback_48:
 s_add_u32 s28, s28, 4096
 v_mfma_f32_16x16x32_bf16 v[156:159], v[176:179], v[56:59], v[156:159]
 ds_read_b128 v[200:203], v2 offset:6144
 buffer_load_dwordx4 v[44:47], v0, s[4:7], s24 offen sc1
 v_lshlrev_b32 v14, 16, v252
 v_add_f32 v16, v16, v14
 v_mfma_f32_16x16x32_bf16 v[160:163], v[180:183], v[56:59], v[160:163]
 v_add_f32 v26, v26, v14
 v_and_b32 v14, 0xffff0000, v252
 v_add_f32 v17, v17, v14
 v_mfma_f32_16x16x32_bf16 v[164:167], v[184:187], v[56:59], v[164:167]
 ds_read_b128 v[204:207], v2 offset:7168
 v_add_f32 v27, v27, v14
 v_lshlrev_b32 v14, 16, v253
 s_waitcnt vmcnt(6) lgkmcnt(2)
 v_mfma_f32_16x16x32_bf16 v[144:147], v[188:191], v[60:63], v[144:147]
 buffer_load_dwordx4 v[48:51], v0, s[4:7], s24 offen offset:1024 sc1
 v_add_f32 v18, v18, v14
 v_add_f32 v28, v28, v14
 v_mfma_f32_16x16x32_bf16 v[148:151], v[192:195], v[60:63], v[148:151]
 ds_read_b128 v[208:211], v2 offset:8192
 v_and_b32 v14, 0xffff0000, v253
 v_add_f32 v19, v19, v14
 v_add_f32 v29, v29, v14
 v_mfma_f32_16x16x32_bf16 v[152:155], v[196:199], v[60:63], v[152:155]
 v_lshlrev_b32 v14, 16, v254
 v_add_f32 v20, v20, v14
 s_waitcnt vmcnt(6)
 v_mfma_f32_16x16x32_bf16 v[156:159], v[188:191], v[64:67], v[156:159]
 ds_read_b128 v[176:179], v2 offset:9216
 buffer_load_dwordx4 v[52:55], v0, s[4:7], s24 offen offset:2048 sc1
 v_add_f32 v30, v30, v14
 v_and_b32 v14, 0xffff0000, v254
 v_mfma_f32_16x16x32_bf16 v[160:163], v[192:195], v[64:67], v[160:163]
 v_add_f32 v21, v21, v14
 v_add_f32 v31, v31, v14
 v_lshlrev_b32 v14, 16, v255
 v_mfma_f32_16x16x32_bf16 v[164:167], v[196:199], v[64:67], v[164:167]
 ds_read_b128 v[180:183], v2 offset:10240
 v_add_f32 v22, v22, v14
 v_add_f32 v32, v32, v14
 s_waitcnt vmcnt(6) lgkmcnt(2)
 v_mfma_f32_16x16x32_bf16 v[144:147], v[200:203], v[68:71], v[144:147]
 buffer_load_dwordx4 v[56:59], v0, s[4:7], s24 offen offset:3072 sc1
 s_add_u32 s24, s24, 4096
 v_and_b32 v14, 0xffff0000, v255
 v_mfma_f32_16x16x32_bf16 v[148:151], v[204:207], v[68:71], v[148:151]
 ds_read_b128 v[184:187], v2 offset:11264
 v_add_f32 v23, v23, v14
 v_add_f32 v33, v33, v14
 v_lshlrev_b32 v14, 16, v173
 v_mfma_f32_16x16x32_bf16 v[152:155], v[208:211], v[68:71], v[152:155]
 v_add_f32 v24, v24, v14
 v_add_f32 v34, v34, v14
 s_waitcnt vmcnt(6)
 v_mfma_f32_16x16x32_bf16 v[156:159], v[200:203], v[72:75], v[156:159]
 buffer_load_dwordx4 v[60:63], v0, s[4:7], s24 offen sc1
 v_and_b32 v14, 0xffff0000, v173
 v_add_f32 v25, v25, v14
 v_add_f32 v35, v35, v14
 v_mfma_f32_16x16x32_bf16 v[160:163], v[204:207], v[72:75], v[160:163]
 v_mfma_f32_16x16x32_bf16 v[164:167], v[208:211], v[72:75], v[164:167]
 s_waitcnt vmcnt(6) lgkmcnt(0)
 v_mfma_f32_16x16x32_bf16 v[144:147], v[176:179], v[76:79], v[144:147]
 buffer_load_dwordx4 v[64:67], v0, s[4:7], s24 offen offset:1024 sc1
 v_mfma_f32_16x16x32_bf16 v[148:151], v[180:183], v[76:79], v[148:151]
 v_mfma_f32_16x16x32_bf16 v[152:155], v[184:187], v[76:79], v[152:155]
 s_waitcnt vmcnt(6)
 v_mfma_f32_16x16x32_bf16 v[156:159], v[176:179], v[80:83], v[156:159]
 buffer_load_dwordx4 v[68:71], v0, s[4:7], s24 offen offset:2048 sc1
 v_mfma_f32_16x16x32_bf16 v[160:163], v[180:183], v[80:83], v[160:163]
 v_mfma_f32_16x16x32_bf16 v[164:167], v[184:187], v[80:83], v[164:167]
 s_waitcnt vmcnt(6)
 v_mfma_f32_16x16x32_bf16 v[84:87], a[0:3], v[44:47], 0
 buffer_load_dwordx4 v[72:75], v0, s[4:7], s24 offen offset:3072 sc1
 s_add_u32 s24, s24, 4096
 v_mfma_f32_16x16x16_bf16 v[144:147], a[244:245], v[244:245], v[144:147]
 v_mfma_f32_16x16x16_bf16 v[148:151], a[246:247], v[244:245], v[148:151]
 v_mfma_f32_16x16x16_bf16 v[152:155], a[248:249], v[244:245], v[152:155]
 v_mfma_f32_16x16x32_bf16 v[88:91], a[4:7], v[44:47], 0
 v_mfma_f32_16x16x16_bf16 v[156:159], a[244:245], v[248:249], v[156:159]
 v_mfma_f32_16x16x16_bf16 v[160:163], a[246:247], v[248:249], v[160:163]
 v_mfma_f32_16x16x16_bf16 v[164:167], a[248:249], v[248:249], v[164:167]
 v_mfma_f32_16x16x32_bf16 v[92:95], a[8:11], v[44:47], 0
 v_mfma_f32_16x16x32_bf16 v[96:99], a[12:15], v[44:47], 0
 v_mfma_f32_16x16x32_bf16 v[100:103], a[16:19], v[44:47], 0
 v_mul_f32 v144, v144, v246
 s_waitcnt vmcnt(6)
 v_mfma_f32_16x16x32_bf16 v[84:87], a[20:23], v[48:51], v[84:87]
 buffer_load_dwordx4 v[76:79], v0, s[4:7], s24 offen sc1
 v_mul_f32 v144, v144, abs(v144)
 v_mul_f32 v145, v145, v246
 v_mfma_f32_16x16x32_bf16 v[88:91], a[24:27], v[48:51], v[88:91]
 v_mul_f32 v145, v145, abs(v145)
 v_cvt_pk_bf16_f32 v124, v144, v145
 v_mfma_f32_16x16x32_bf16 v[92:95], a[28:31], v[48:51], v[92:95]
 v_pk_max_i16 v124, v124, 0
 v_mul_f32 v146, v146, v246
 v_mfma_f32_16x16x32_bf16 v[96:99], a[32:35], v[48:51], v[96:99]
 v_mul_f32 v146, v146, abs(v146)
 v_mul_f32 v147, v147, v246
 v_mul_f32 v147, v147, abs(v147)
 v_mfma_f32_16x16x32_bf16 v[100:103], a[36:39], v[48:51], v[100:103]
 v_cvt_pk_bf16_f32 v125, v146, v147
 s_waitcnt vmcnt(6)
 v_mfma_f32_16x16x32_bf16 v[84:87], a[40:43], v[52:55], v[84:87]
 buffer_load_dwordx4 v[80:83], v0, s[4:7], s24 offen offset:1024 sc1
 v_pk_max_i16 v125, v125, 0
 v_mfma_f32_16x16x32_bf16 v[88:91], a[44:47], v[52:55], v[88:91]
 v_mul_f32 v148, v148, v246
 v_mul_f32 v148, v148, abs(v148)
 v_mul_f32 v149, v149, v246
 v_mfma_f32_16x16x32_bf16 v[92:95], a[48:51], v[52:55], v[92:95]
 v_mul_f32 v149, v149, abs(v149)
 v_cvt_pk_bf16_f32 v126, v148, v149
 v_mfma_f32_16x16x32_bf16 v[96:99], a[52:55], v[52:55], v[96:99]
 v_pk_max_i16 v126, v126, 0
 v_mul_f32 v150, v150, v246
 v_mul_f32 v150, v150, abs(v150)
 v_mfma_f32_16x16x32_bf16 v[100:103], a[56:59], v[52:55], v[100:103]
 v_mul_f32 v151, v151, v246
 s_waitcnt vmcnt(6)
 v_mfma_f32_16x16x32_bf16 v[84:87], a[60:63], v[56:59], v[84:87]
 buffer_load_dwordx4 v[44:47], v0, s[4:7], s24 offen offset:2048 sc1
 v_mul_f32 v151, v151, abs(v151)
 v_mfma_f32_16x16x32_bf16 v[88:91], a[64:67], v[56:59], v[88:91]
 v_cvt_pk_bf16_f32 v127, v150, v151
 v_pk_max_i16 v127, v127, 0
 v_mfma_f32_16x16x32_bf16 v[92:95], a[68:71], v[56:59], v[92:95]
 buffer_store_dwordx4 v[124:127], v0, s[4:7], s34 offen sc1
 v_mfma_f32_16x16x32_bf16 v[96:99], a[72:75], v[56:59], v[96:99]
 s_add_u32 s34, s34, 49152
 v_mul_f32 v152, v152, v246
 v_mfma_f32_16x16x32_bf16 v[100:103], a[76:79], v[56:59], v[100:103]
 v_mul_f32 v152, v152, abs(v152)
 v_mul_f32 v153, v153, v246
 s_waitcnt vmcnt(7)
 v_mfma_f32_16x16x32_bf16 v[84:87], a[80:83], v[60:63], v[84:87]
 buffer_load_dwordx4 v[48:51], v0, s[4:7], s24 offen offset:3072 sc1
 v_mul_f32 v153, v153, abs(v153)
 v_mfma_f32_16x16x32_bf16 v[88:91], a[84:87], v[60:63], v[88:91]
 v_cvt_pk_bf16_f32 v132, v152, v153
 v_pk_max_i16 v132, v132, 0
 v_mul_f32 v154, v154, v246
 v_mfma_f32_16x16x32_bf16 v[92:95], a[88:91], v[60:63], v[92:95]
 v_mul_f32 v154, v154, abs(v154)
 v_mul_f32 v155, v155, v246
 v_mfma_f32_16x16x32_bf16 v[96:99], a[92:95], v[60:63], v[96:99]
 v_mul_f32 v155, v155, abs(v155)
 v_cvt_pk_bf16_f32 v133, v154, v155
 v_mfma_f32_16x16x32_bf16 v[100:103], a[96:99], v[60:63], v[100:103]
 v_pk_max_i16 v133, v133, 0
 v_mul_f32 v156, v156, v250
 s_waitcnt vmcnt(7)
 v_mfma_f32_16x16x32_bf16 v[84:87], a[100:103], v[64:67], v[84:87]
 buffer_load_dwordx4 v[52:55], v0, s[4:7], s25 offen sc1
 v_mul_f32 v156, v156, abs(v156)
 v_mfma_f32_16x16x32_bf16 v[88:91], a[104:107], v[64:67], v[88:91]
 v_mul_f32 v157, v157, v250
 v_mul_f32 v157, v157, abs(v157)
 v_mfma_f32_16x16x32_bf16 v[92:95], a[108:111], v[64:67], v[92:95]
 v_cvt_pk_bf16_f32 v128, v156, v157
 v_pk_max_i16 v128, v128, 0
 v_mul_f32 v158, v158, v250
 v_mfma_f32_16x16x32_bf16 v[96:99], a[112:115], v[64:67], v[96:99]
 v_mul_f32 v158, v158, abs(v158)
 v_mul_f32 v159, v159, v250
 v_mfma_f32_16x16x32_bf16 v[100:103], a[116:119], v[64:67], v[100:103]
 v_mul_f32 v159, v159, abs(v159)
 v_cvt_pk_bf16_f32 v129, v158, v159
 s_waitcnt vmcnt(7)
 v_mfma_f32_16x16x32_bf16 v[84:87], a[120:123], v[68:71], v[84:87]
 buffer_load_dwordx4 v[56:59], v0, s[4:7], s25 offen offset:1024 sc1
 v_pk_max_i16 v129, v129, 0
 v_mfma_f32_16x16x32_bf16 v[88:91], a[124:127], v[68:71], v[88:91]
 v_mul_f32 v160, v160, v250
 v_mul_f32 v160, v160, abs(v160)
 v_mfma_f32_16x16x32_bf16 v[92:95], a[128:131], v[68:71], v[92:95]
 v_mul_f32 v161, v161, v250
 v_mul_f32 v161, v161, abs(v161)
 v_cvt_pk_bf16_f32 v130, v160, v161
 v_mfma_f32_16x16x32_bf16 v[96:99], a[132:135], v[68:71], v[96:99]
 v_pk_max_i16 v130, v130, 0
 v_mul_f32 v162, v162, v250
 v_mfma_f32_16x16x32_bf16 v[100:103], a[136:139], v[68:71], v[100:103]
 v_mul_f32 v162, v162, abs(v162)
 s_waitcnt vmcnt(7)
 v_mfma_f32_16x16x32_bf16 v[84:87], a[140:143], v[72:75], v[84:87]
 buffer_load_dwordx4 v[60:63], v0, s[4:7], s25 offen offset:2048 sc1
 v_mul_f32 v163, v163, v250
 v_mul_f32 v163, v163, abs(v163)
 v_mfma_f32_16x16x32_bf16 v[88:91], a[144:147], v[72:75], v[88:91]
 v_cvt_pk_bf16_f32 v131, v162, v163
 v_pk_max_i16 v131, v131, 0
 v_mfma_f32_16x16x32_bf16 v[92:95], a[148:151], v[72:75], v[92:95]
 buffer_store_dwordx4 v[128:131], v0, s[4:7], s34 offen sc1
 v_mfma_f32_16x16x32_bf16 v[96:99], a[152:155], v[72:75], v[96:99]
 s_add_u32 s34, s34, 49152
 v_mul_f32 v164, v164, v250
 v_mfma_f32_16x16x32_bf16 v[100:103], a[156:159], v[72:75], v[100:103]
 v_mul_f32 v164, v164, abs(v164)
 s_waitcnt vmcnt(8)
 v_mfma_f32_16x16x32_bf16 v[84:87], a[160:163], v[76:79], v[84:87]
 buffer_load_dwordx4 v[64:67], v0, s[4:7], s25 offen offset:3072 sc1
 s_add_u32 s25, s25, 4096
 v_mul_f32 v165, v165, v250
 v_mfma_f32_16x16x32_bf16 v[88:91], a[164:167], v[76:79], v[88:91]
 v_mul_f32 v165, v165, abs(v165)
 v_cvt_pk_bf16_f32 v134, v164, v165
 v_mfma_f32_16x16x32_bf16 v[92:95], a[168:171], v[76:79], v[92:95]
 v_pk_max_i16 v134, v134, 0
 v_mul_f32 v166, v166, v250
 v_mfma_f32_16x16x32_bf16 v[96:99], a[172:175], v[76:79], v[96:99]
 v_mul_f32 v166, v166, abs(v166)
 v_mul_f32 v167, v167, v250
 v_mul_f32 v167, v167, abs(v167)
 v_mfma_f32_16x16x32_bf16 v[100:103], a[176:179], v[76:79], v[100:103]
 v_cvt_pk_bf16_f32 v135, v166, v167
 s_waitcnt vmcnt(8)
 v_mfma_f32_16x16x32_bf16 v[84:87], a[180:183], v[80:83], v[84:87]
 buffer_load_dwordx4 v[68:71], v0, s[4:7], s25 offen sc1
 v_pk_max_i16 v135, v135, 0
 v_mfma_f32_16x16x32_bf16 v[88:91], a[184:187], v[80:83], v[88:91]
 v_permlane16_swap_b32 v132, v134
 v_mfma_f32_16x16x32_bf16 v[92:95], a[188:191], v[80:83], v[92:95]
 v_permlane16_swap_b32 v133, v135
 v_mfma_f32_16x16x32_bf16 v[96:99], a[192:195], v[80:83], v[96:99]
 buffer_store_dwordx4 v[132:135], v7, s[4:7], s35 offen offset:1024 sc1
 v_mfma_f32_16x16x32_bf16 v[100:103], a[196:199], v[80:83], v[100:103]
 s_add_u32 s35, s35, 98304
 s_waitcnt vmcnt(9)
 v_mfma_f32_16x16x32_bf16 v[84:87], a[200:203], v[44:47], v[84:87]
 buffer_load_dwordx4 v[72:75], v0, s[4:7], s25 offen offset:1024 sc1
 v_mfma_f32_16x16x32_bf16 v[88:91], a[204:207], v[44:47], v[88:91]
 v_mfma_f32_16x16x32_bf16 v[92:95], a[208:211], v[44:47], v[92:95]
 v_mfma_f32_16x16x32_bf16 v[96:99], a[212:215], v[44:47], v[96:99]
 v_mfma_f32_16x16x32_bf16 v[100:103], a[216:219], v[44:47], v[100:103]
 s_waitcnt vmcnt(8)
 v_mfma_f32_16x16x32_bf16 v[84:87], a[220:223], v[48:51], v[84:87]
 buffer_load_dwordx4 v[76:79], v0, s[4:7], s25 offen offset:2048 sc1
 v_mfma_f32_16x16x32_bf16 v[88:91], a[224:227], v[48:51], v[88:91]
 v_mfma_f32_16x16x32_bf16 v[92:95], a[228:231], v[48:51], v[92:95]
 v_mfma_f32_16x16x32_bf16 v[96:99], a[232:235], v[48:51], v[96:99]
 v_mfma_f32_16x16x32_bf16 v[100:103], a[236:239], v[48:51], v[100:103]
 s_waitcnt vmcnt(8)
 v_mfma_f32_16x16x32_bf16 v[104:107], a[0:3], v[52:55], 0
 buffer_load_dwordx4 v[80:83], v0, s[4:7], s25 offen offset:3072 sc1
 s_add_u32 s25, s25, 4096
 s_getpc_b64 s[22:23]
Lpc_53:
 s_lshl_b32 s21, s49, 2
 s_add_u32 s21, s21, s3
 s_lshl_b32 s21, s21, 8
 v_lshl_add_u32 v14, v0, 3, s21
 v_min_u32 v14, Lslow_end-Lpc_53, v14
 s_mov_b64 exec, 3
 global_load_dword v14, v14, s[22:23]
 s_mov_b64 exec, -1
 v_mfma_f32_16x16x32_bf16 v[108:111], a[4:7], v[52:55], 0
 s_waitcnt lgkmcnt(0)
 s_barrier
 v_mfma_f32_16x16x32_bf16 v[112:115], a[8:11], v[52:55], 0
 ds_write_b128 v3, v[84:87] offset:12288
 v_mfma_f32_16x16x32_bf16 v[116:119], a[12:15], v[52:55], 0
 v_mov_b32 v15, 3
 v_add_u32 v15, s52, v15
 s_waitcnt vmcnt(4)
 s_mov_b64 exec, 1
 buffer_store_dword v15, v0, s[4:7], s36 offen sc1
 s_mov_b64 exec, -1
 v_mfma_f32_16x16x32_bf16 v[120:123], a[16:19], v[52:55], 0
 v_mfma_f32_16x16x32_bf16 v[104:107], a[20:23], v[56:59], v[104:107]
 buffer_load_dwordx4 v[44:47], v0, s[4:7], s25 offen sc1
 v_mfma_f32_16x16x32_bf16 v[108:111], a[24:27], v[56:59], v[108:111]
 ds_write_b128 v3, v[88:91] offset:13312
 v_mfma_f32_16x16x32_bf16 v[112:115], a[28:31], v[56:59], v[112:115]
 v_mfma_f32_16x16x32_bf16 v[116:119], a[32:35], v[56:59], v[116:119]
 v_mfma_f32_16x16x32_bf16 v[120:123], a[36:39], v[56:59], v[120:123]
 v_mfma_f32_16x16x32_bf16 v[104:107], a[40:43], v[60:63], v[104:107]
 buffer_load_dwordx4 v[48:51], v0, s[4:7], s25 offen offset:1024 sc1
 v_mfma_f32_16x16x32_bf16 v[108:111], a[44:47], v[60:63], v[108:111]
 ds_write_b128 v3, v[92:95] offset:14336
 v_mfma_f32_16x16x32_bf16 v[112:115], a[48:51], v[60:63], v[112:115]
 v_mfma_f32_16x16x32_bf16 v[116:119], a[52:55], v[60:63], v[116:119]
 ds_write_b128 v3, v[96:99] offset:15360
 v_mfma_f32_16x16x32_bf16 v[120:123], a[56:59], v[60:63], v[120:123]
 v_mfma_f32_16x16x32_bf16 v[104:107], a[60:63], v[64:67], v[104:107]
 buffer_load_dwordx4 v[52:55], v0, s[4:7], s25 offen offset:2048 sc1
 v_mfma_f32_16x16x32_bf16 v[108:111], a[64:67], v[64:67], v[108:111]
 v_mfma_f32_16x16x32_bf16 v[112:115], a[68:71], v[64:67], v[112:115]
 ds_write_b128 v3, v[100:103] offset:16384
 v_mfma_f32_16x16x32_bf16 v[116:119], a[72:75], v[64:67], v[116:119]
 v_mfma_f32_16x16x32_bf16 v[120:123], a[76:79], v[64:67], v[120:123]
 v_mfma_f32_16x16x32_bf16 v[104:107], a[80:83], v[68:71], v[104:107]
 buffer_load_dwordx4 v[56:59], v0, s[4:7], s25 offen offset:3072 sc1
 v_mfma_f32_16x16x32_bf16 v[108:111], a[84:87], v[68:71], v[108:111]
 v_mfma_f32_16x16x32_bf16 v[112:115], a[88:91], v[68:71], v[112:115]
 s_add_u32 s56, s52, 3
 buffer_load_dword v12, v171, s[4:7], s28 offen sc1
 s_waitcnt lgkmcnt(0)
 s_barrier
 v_mfma_f32_16x16x32_bf16 v[116:119], a[92:95], v[68:71], v[116:119]
 ds_read_b128 v[124:127], v5 offset:12288
 v_mfma_f32_16x16x32_bf16 v[120:123], a[96:99], v[68:71], v[120:123]
 ds_read_b128 v[128:131], v5 offset:13312
 s_waitcnt vmcnt(9)
 v_mfma_f32_16x16x32_bf16 v[104:107], a[100:103], v[72:75], v[104:107]
 ds_read_b64 v[132:133], v6 offset:16384
 v_mfma_f32_16x16x32_bf16 v[108:111], a[104:107], v[72:75], v[108:111]
 ds_read_b128 v[134:137], v5 offset:17408
 v_mfma_f32_16x16x32_bf16 v[112:115], a[108:111], v[72:75], v[112:115]
 ds_read_b128 v[138:141], v5 offset:18432
 v_mfma_f32_16x16x32_bf16 v[116:119], a[112:115], v[72:75], v[116:119]
 ds_read_b64 v[142:143], v6 offset:21504
 v_mfma_f32_16x16x32_bf16 v[120:123], a[116:119], v[72:75], v[120:123]
 s_waitcnt vmcnt(8)
 v_mfma_f32_16x16x32_bf16 v[104:107], a[120:123], v[76:79], v[104:107]
 v_mfma_f32_16x16x32_bf16 v[108:111], a[124:127], v[76:79], v[108:111]
 s_waitcnt lgkmcnt(5)
 v_add_f32 v16, v16, v124
 v_add_f32 v17, v17, v125
 v_mfma_f32_16x16x32_bf16 v[112:115], a[128:131], v[76:79], v[112:115]
 v_add_f32 v18, v18, v126
 v_add_f32 v19, v19, v127
 v_mfma_f32_16x16x32_bf16 v[116:119], a[132:135], v[76:79], v[116:119]
 s_waitcnt lgkmcnt(4)
 v_add_f32 v20, v20, v128
 v_add_f32 v21, v21, v129
 v_mfma_f32_16x16x32_bf16 v[120:123], a[136:139], v[76:79], v[120:123]
 v_add_f32 v22, v22, v130
 s_waitcnt vmcnt(7)
 v_mfma_f32_16x16x32_bf16 v[104:107], a[140:143], v[80:83], v[104:107]
 v_add_f32 v23, v23, v131
 s_waitcnt lgkmcnt(3)
 v_add_f32 v24, v24, v132
 v_mfma_f32_16x16x32_bf16 v[108:111], a[144:147], v[80:83], v[108:111]
 v_add_f32 v25, v25, v133
 s_waitcnt lgkmcnt(2)
 v_add_f32 v16, v16, v134
 v_mfma_f32_16x16x32_bf16 v[112:115], a[148:151], v[80:83], v[112:115]
 v_add_f32 v17, v17, v135
 v_add_f32 v18, v18, v136
 v_mfma_f32_16x16x32_bf16 v[116:119], a[152:155], v[80:83], v[116:119]
 s_waitcnt vmcnt(0)
 v_cmp_ne_u32 vcc, s56, v12
 s_cbranch_vccnz Lretry_50
Lback_51:
 buffer_load_dwordx4 v[60:63], v0, s[4:7], s26 offen sc1
 v_mfma_f32_16x16x32_bf16 v[120:123], a[156:159], v[80:83], v[120:123]
 buffer_load_dwordx4 v[64:67], v0, s[4:7], s26 offen offset:1024 sc1
 v_mfma_f32_16x16x32_bf16 v[104:107], a[160:163], v[44:47], v[104:107]
 buffer_load_dwordx4 v[68:71], v0, s[4:7], s26 offen offset:2048 sc1
 v_add_f32 v19, v19, v137
 v_mfma_f32_16x16x32_bf16 v[108:111], a[164:167], v[44:47], v[108:111]
 buffer_load_dwordx4 v[72:75], v0, s[4:7], s26 offen offset:3072 sc1
 s_add_u32 s26, s26, 4096
 v_mfma_f32_16x16x32_bf16 v[112:115], a[168:171], v[44:47], v[112:115]
 s_waitcnt lgkmcnt(1)
 v_add_f32 v20, v20, v138
 v_add_f32 v21, v21, v139
 v_mfma_f32_16x16x32_bf16 v[116:119], a[172:175], v[44:47], v[116:119]
 v_add_f32 v22, v22, v140
 v_add_f32 v23, v23, v141
 v_mfma_f32_16x16x32_bf16 v[120:123], a[176:179], v[44:47], v[120:123]
 s_waitcnt lgkmcnt(0)
 v_add_f32 v24, v24, v142
 v_mfma_f32_16x16x32_bf16 v[104:107], a[180:183], v[48:51], v[104:107]
 buffer_load_dwordx4 v[76:79], v0, s[4:7], s26 offen sc1
 v_add_f32 v25, v25, v143
 v_mfma_f32_16x16x32_bf16 v[108:111], a[184:187], v[48:51], v[108:111]
 v_mfma_f32_16x16x32_bf16 v[112:115], a[188:191], v[48:51], v[112:115]
 v_mfma_f32_16x16x32_bf16 v[116:119], a[192:195], v[48:51], v[116:119]
 v_mfma_f32_16x16x32_bf16 v[120:123], a[196:199], v[48:51], v[120:123]
 v_mfma_f32_16x16x32_bf16 v[104:107], a[200:203], v[52:55], v[104:107]
 buffer_load_dwordx4 v[80:83], v0, s[4:7], s26 offen offset:1024 sc1
 v_mfma_f32_16x16x32_bf16 v[108:111], a[204:207], v[52:55], v[108:111]
 v_mfma_f32_16x16x32_bf16 v[112:115], a[208:211], v[52:55], v[112:115]
 v_mfma_f32_16x16x32_bf16 v[116:119], a[212:215], v[52:55], v[116:119]
 v_mfma_f32_16x16x32_bf16 v[120:123], a[216:219], v[52:55], v[120:123]
 v_mfma_f32_16x16x32_bf16 v[104:107], a[220:223], v[56:59], v[104:107]
 buffer_load_dwordx4 v[44:47], v0, s[4:7], s26 offen offset:2048 sc1
 v_mfma_f32_16x16x32_bf16 v[108:111], a[224:227], v[56:59], v[108:111]
 v_mfma_f32_16x16x32_bf16 v[112:115], a[228:231], v[56:59], v[112:115]
 v_mfma_f32_16x16x32_bf16 v[116:119], a[232:235], v[56:59], v[116:119]
 v_mfma_f32_16x16x32_bf16 v[120:123], a[236:239], v[56:59], v[120:123]
 s_waitcnt vmcnt(6)
 v_mfma_f32_16x16x32_bf16 v[84:87], a[0:3], v[60:63], 0
 buffer_load_dwordx4 v[48:51], v0, s[4:7], s26 offen offset:3072 sc1
 s_add_u32 s26, s26, 4096
 v_mfma_f32_16x16x32_bf16 v[88:91], a[4:7], v[60:63], 0
 s_waitcnt lgkmcnt(0)
 s_barrier
 v_mfma_f32_16x16x32_bf16 v[92:95], a[8:11], v[60:63], 0
 ds_write_b128 v4, v[104:107] offset:12288
 v_mfma_f32_16x16x32_bf16 v[96:99], a[12:15], v[60:63], 0
 v_mfma_f32_16x16x32_bf16 v[100:103], a[16:19], v[60:63], 0
 s_waitcnt vmcnt(6)
 v_mfma_f32_16x16x32_bf16 v[84:87], a[20:23], v[64:67], v[84:87]
 buffer_load_dwordx4 v[52:55], v0, s[4:7], s26 offen sc1
 v_mfma_f32_16x16x32_bf16 v[88:91], a[24:27], v[64:67], v[88:91]
 ds_write_b128 v4, v[108:111] offset:13312
 v_mfma_f32_16x16x32_bf16 v[92:95], a[28:31], v[64:67], v[92:95]
 v_mfma_f32_16x16x32_bf16 v[96:99], a[32:35], v[64:67], v[96:99]
 v_mfma_f32_16x16x32_bf16 v[100:103], a[36:39], v[64:67], v[100:103]
 s_waitcnt vmcnt(6)
 v_mfma_f32_16x16x32_bf16 v[84:87], a[40:43], v[68:71], v[84:87]
 buffer_load_dwordx4 v[56:59], v0, s[4:7], s26 offen offset:1024 sc1
 v_mfma_f32_16x16x32_bf16 v[88:91], a[44:47], v[68:71], v[88:91]
 ds_write_b128 v4, v[112:115] offset:14336
 v_mfma_f32_16x16x32_bf16 v[92:95], a[48:51], v[68:71], v[92:95]
 v_mfma_f32_16x16x32_bf16 v[96:99], a[52:55], v[68:71], v[96:99]
 ds_write_b128 v4, v[116:119] offset:15360
 v_mfma_f32_16x16x32_bf16 v[100:103], a[56:59], v[68:71], v[100:103]
 s_waitcnt vmcnt(6)
 v_mfma_f32_16x16x32_bf16 v[84:87], a[60:63], v[72:75], v[84:87]
 buffer_load_dwordx4 v[60:63], v0, s[4:7], s26 offen offset:2048 sc1
 v_mfma_f32_16x16x32_bf16 v[88:91], a[64:67], v[72:75], v[88:91]
 v_mfma_f32_16x16x32_bf16 v[92:95], a[68:71], v[72:75], v[92:95]
 ds_write_b128 v4, v[120:123] offset:16384
 v_mfma_f32_16x16x32_bf16 v[96:99], a[72:75], v[72:75], v[96:99]
 v_mfma_f32_16x16x32_bf16 v[100:103], a[76:79], v[72:75], v[100:103]
 s_waitcnt vmcnt(6)
 v_mfma_f32_16x16x32_bf16 v[84:87], a[80:83], v[76:79], v[84:87]
 buffer_load_dwordx4 v[64:67], v0, s[4:7], s26 offen offset:3072 sc1
 v_mfma_f32_16x16x32_bf16 v[88:91], a[84:87], v[76:79], v[88:91]
 v_mfma_f32_16x16x32_bf16 v[92:95], a[88:91], v[76:79], v[92:95]
 s_waitcnt lgkmcnt(0)
 s_barrier
 v_mfma_f32_16x16x32_bf16 v[96:99], a[92:95], v[76:79], v[96:99]
 ds_read_b128 v[124:127], v5 offset:12288
 v_mfma_f32_16x16x32_bf16 v[100:103], a[96:99], v[76:79], v[100:103]
 ds_read_b128 v[128:131], v5 offset:13312
 s_waitcnt vmcnt(6)
 v_mfma_f32_16x16x32_bf16 v[84:87], a[100:103], v[80:83], v[84:87]
 buffer_load_dwordx4 v[68:71], v0, s[4:7], s27 offen sc1
 ds_read_b64 v[132:133], v6 offset:16384
 v_mfma_f32_16x16x32_bf16 v[88:91], a[104:107], v[80:83], v[88:91]
 ds_read_b128 v[134:137], v5 offset:17408
 v_mfma_f32_16x16x32_bf16 v[92:95], a[108:111], v[80:83], v[92:95]
 ds_read_b128 v[138:141], v5 offset:18432
 v_mfma_f32_16x16x32_bf16 v[96:99], a[112:115], v[80:83], v[96:99]
 ds_read_b64 v[142:143], v6 offset:21504
 v_mfma_f32_16x16x32_bf16 v[100:103], a[116:119], v[80:83], v[100:103]
 s_waitcnt vmcnt(6)
 v_mfma_f32_16x16x32_bf16 v[84:87], a[120:123], v[44:47], v[84:87]
 buffer_load_dwordx4 v[72:75], v0, s[4:7], s27 offen offset:1024 sc1
 v_mfma_f32_16x16x32_bf16 v[88:91], a[124:127], v[44:47], v[88:91]
 s_waitcnt lgkmcnt(5)
 v_add_f32 v16, v16, v124
 v_add_f32 v17, v17, v125
 v_add_f32 v18, v18, v126
 v_mfma_f32_16x16x32_bf16 v[92:95], a[128:131], v[44:47], v[92:95]
 v_add_f32 v19, v19, v127
 s_waitcnt lgkmcnt(4)
 v_add_f32 v20, v20, v128
 v_mfma_f32_16x16x32_bf16 v[96:99], a[132:135], v[44:47], v[96:99]
 v_add_f32 v21, v21, v129
 v_add_f32 v22, v22, v130
 v_add_f32 v23, v23, v131
 v_mfma_f32_16x16x32_bf16 v[100:103], a[136:139], v[44:47], v[100:103]
 s_waitcnt lgkmcnt(3)
 v_add_f32 v24, v24, v132
 s_waitcnt vmcnt(6)
 v_mfma_f32_16x16x32_bf16 v[84:87], a[140:143], v[48:51], v[84:87]
 buffer_load_dwordx4 v[76:79], v0, s[4:7], s27 offen offset:2048 sc1
 v_add_f32 v25, v25, v133
 s_waitcnt lgkmcnt(2)
 v_add_f32 v16, v16, v134
 v_mfma_f32_16x16x32_bf16 v[88:91], a[144:147], v[48:51], v[88:91]
 v_add_f32 v17, v17, v135
 v_add_f32 v18, v18, v136
 v_mfma_f32_16x16x32_bf16 v[92:95], a[148:151], v[48:51], v[92:95]
 v_add_f32 v19, v19, v137
 s_waitcnt lgkmcnt(1)
 v_add_f32 v20, v20, v138
 v_add_f32 v21, v21, v139
 v_mfma_f32_16x16x32_bf16 v[96:99], a[152:155], v[48:51], v[96:99]
 v_add_f32 v22, v22, v140
 v_add_f32 v23, v23, v141
 v_mfma_f32_16x16x32_bf16 v[100:103], a[156:159], v[48:51], v[100:103]
 s_waitcnt lgkmcnt(0)
 v_add_f32 v24, v24, v142
 v_add_f32 v25, v25, v143
 s_waitcnt vmcnt(6)
 v_mfma_f32_16x16x32_bf16 v[84:87], a[160:163], v[52:55], v[84:87]
 buffer_load_dwordx4 v[80:83], v0, s[4:7], s27 offen offset:3072 sc1
 s_add_u32 s27, s27, 4096
 v_mfma_f32_16x16x32_bf16 v[88:91], a[164:167], v[52:55], v[88:91]
 v_cvt_pk_bf16_f32 v124, v16, v17
 v_cvt_pk_bf16_f32 v125, v18, v19
 v_cvt_pk_bf16_f32 v126, v20, v21
 v_mfma_f32_16x16x32_bf16 v[92:95], a[168:171], v[52:55], v[92:95]
 v_cvt_pk_bf16_f32 v127, v22, v23
 v_cvt_pk_bf16_f32 v128, v24, v25
 v_mfma_f32_16x16x32_bf16 v[96:99], a[172:175], v[52:55], v[96:99]
 buffer_store_dwordx4 v[124:127], v168, s[8:11], s29 offen sc1
 v_mfma_f32_16x16x32_bf16 v[100:103], a[176:179], v[52:55], v[100:103]
 s_waitcnt vmcnt(7)
 v_mfma_f32_16x16x32_bf16 v[84:87], a[180:183], v[56:59], v[84:87]
 buffer_load_dwordx4 v[44:47], v0, s[4:7], s27 offen sc1
 buffer_store_dword v128, v169, s[8:11], s30 offen sc1
 v_mfma_f32_16x16x32_bf16 v[88:91], a[184:187], v[56:59], v[88:91]
 v_add_f32 v130, v16, v17
 v_mul_f32 v132, v16, v16
 v_mfma_f32_16x16x32_bf16 v[92:95], a[188:191], v[56:59], v[92:95]
 v_fmac_f32 v132, v17, v17
 v_add_f32 v130, v130, v18
 v_fmac_f32 v132, v18, v18
 v_mfma_f32_16x16x32_bf16 v[96:99], a[192:195], v[56:59], v[96:99]
 v_add_f32 v130, v130, v19
 v_fmac_f32 v132, v19, v19
 v_mfma_f32_16x16x32_bf16 v[100:103], a[196:199], v[56:59], v[100:103]
 v_add_f32 v130, v130, v20
 v_fmac_f32 v132, v20, v20
 s_waitcnt vmcnt(8)
 v_mfma_f32_16x16x32_bf16 v[84:87], a[200:203], v[60:63], v[84:87]
 buffer_load_dwordx4 v[48:51], v0, s[4:7], s27 offen offset:1024 sc1
 v_add_f32 v130, v130, v21
 v_mfma_f32_16x16x32_bf16 v[88:91], a[204:207], v[60:63], v[88:91]
 v_fmac_f32 v132, v21, v21
 v_add_f32 v130, v130, v22
 v_fmac_f32 v132, v22, v22
 v_mfma_f32_16x16x32_bf16 v[92:95], a[208:211], v[60:63], v[92:95]
 v_add_f32 v130, v130, v23
 v_fmac_f32 v132, v23, v23
 v_mfma_f32_16x16x32_bf16 v[96:99], a[212:215], v[60:63], v[96:99]
 v_add_f32 v130, v130, v24
 v_fmac_f32 v132, v24, v24
 v_add_f32 v130, v130, v25
 v_mfma_f32_16x16x32_bf16 v[100:103], a[216:219], v[60:63], v[100:103]
 v_fmac_f32 v132, v25, v25
 s_waitcnt vmcnt(8)
 v_mfma_f32_16x16x32_bf16 v[84:87], a[220:223], v[64:67], v[84:87]
 buffer_load_dwordx4 v[52:55], v0, s[4:7], s27 offen offset:2048 sc1
 v_permlane32_swap_b32 v130, v132
 v_mfma_f32_16x16x32_bf16 v[88:91], a[224:227], v[64:67], v[88:91]
 v_add_f32 v131, v130, v132
 v_add_f32 v130, v130, v132
 v_mfma_f32_16x16x32_bf16 v[92:95], a[228:231], v[64:67], v[92:95]
 s_nop 0
 v_permlane16_swap_b32 v130, v131
 v_add_f32 v130, v130, v131
 v_mfma_f32_16x16x32_bf16 v[96:99], a[232:235], v[64:67], v[96:99]
 s_nop 0
 v_add_f32_dpp v130, v130, v130 row_ror:8 row_mask:0xf bank_mask:0xf
 v_mfma_f32_16x16x32_bf16 v[100:103], a[236:239], v[64:67], v[100:103]
 buffer_store_dword v130, v170, s[4:7], s31 offen sc1
 s_waitcnt vmcnt(9)
 v_mfma_f32_16x16x32_bf16 v[104:107], a[0:3], v[68:71], 0
 buffer_load_dwordx4 v[56:59], v0, s[4:7], s27 offen offset:3072 sc1
 s_add_u32 s27, s27, 4096
 v_mfma_f32_16x16x32_bf16 v[108:111], a[4:7], v[68:71], 0
 s_waitcnt lgkmcnt(0)
 s_barrier
 s_add_u32 s29, s29, 40960
 v_mfma_f32_16x16x32_bf16 v[112:115], a[8:11], v[68:71], 0
 ds_write_b128 v3, v[84:87] offset:12288
 v_mfma_f32_16x16x32_bf16 v[116:119], a[12:15], v[68:71], 0
 s_add_u32 s30, s30, 40960
 s_add_u32 s31, s31, 2048
 v_mfma_f32_16x16x32_bf16 v[120:123], a[16:19], v[68:71], 0
 s_mul_i32 s16, s54, 81920
 s_waitcnt vmcnt(9)
 v_mfma_f32_16x16x32_bf16 v[104:107], a[20:23], v[72:75], v[104:107]
 buffer_load_dwordx4 v[60:63], v0, s[4:7], s27 offen sc1
 s_add_u32 s16, s16, 0
 v_mfma_f32_16x16x32_bf16 v[108:111], a[24:27], v[72:75], v[108:111]
 ds_write_b128 v3, v[88:91] offset:13312
 v_mfma_f32_16x16x32_bf16 v[112:115], a[28:31], v[72:75], v[112:115]
 s_lshl_b32 s17, s54, 12
 s_add_u32 s17, s17, 24641536
 v_mfma_f32_16x16x32_bf16 v[116:119], a[32:35], v[72:75], v[116:119]
 v_mfma_f32_16x16x32_bf16 v[120:123], a[36:39], v[72:75], v[120:123]
 s_waitcnt vmcnt(9)
 v_mfma_f32_16x16x32_bf16 v[104:107], a[40:43], v[76:79], v[104:107]
 buffer_load_dwordx4 v[64:67], v0, s[4:7], s27 offen offset:1024 sc1
 v_mfma_f32_16x16x32_bf16 v[108:111], a[44:47], v[76:79], v[108:111]
 ds_write_b128 v3, v[92:95] offset:14336
 v_mfma_f32_16x16x32_bf16 v[112:115], a[48:51], v[76:79], v[112:115]
 v_mfma_f32_16x16x32_bf16 v[116:119], a[52:55], v[76:79], v[116:119]
 ds_write_b128 v3, v[96:99] offset:15360
 v_mfma_f32_16x16x32_bf16 v[120:123], a[56:59], v[76:79], v[120:123]
 s_waitcnt vmcnt(9)
 v_mfma_f32_16x16x32_bf16 v[104:107], a[60:63], v[80:83], v[104:107]
 buffer_load_dwordx4 v[68:71], v0, s[4:7], s27 offen offset:2048 sc1
 v_mfma_f32_16x16x32_bf16 v[108:111], a[64:67], v[80:83], v[108:111]
 v_mfma_f32_16x16x32_bf16 v[112:115], a[68:71], v[80:83], v[112:115]
 ds_write_b128 v3, v[100:103] offset:16384
 v_mfma_f32_16x16x32_bf16 v[116:119], a[72:75], v[80:83], v[116:119]
 v_mfma_f32_16x16x32_bf16 v[120:123], a[76:79], v[80:83], v[120:123]
 s_waitcnt vmcnt(8)
 v_mfma_f32_16x16x32_bf16 v[104:107], a[80:83], v[44:47], v[104:107]
 buffer_load_dwordx4 v[72:75], v0, s[4:7], s27 offen offset:3072 sc1
 v_mfma_f32_16x16x32_bf16 v[108:111], a[84:87], v[44:47], v[108:111]
 v_mfma_f32_16x16x32_bf16 v[112:115], a[88:91], v[44:47], v[112:115]
 s_waitcnt lgkmcnt(0)
 s_barrier
 v_mfma_f32_16x16x32_bf16 v[116:119], a[92:95], v[44:47], v[116:119]
 ds_read_b128 v[124:127], v5 offset:12288
 v_mfma_f32_16x16x32_bf16 v[120:123], a[96:99], v[44:47], v[120:123]
 ds_read_b128 v[128:131], v5 offset:13312
 v_mov_b32 v15, 4
 v_add_u32 v15, s52, v15
 s_waitcnt vmcnt(5)
 s_mov_b64 exec, 1
 buffer_store_dword v15, v0, s[4:7], s32 offen sc1
 s_mov_b64 exec, -1
 s_add_u32 s32, s32, 12288
 v_mfma_f32_16x16x32_bf16 v[104:107], a[100:103], v[48:51], v[104:107]
 ds_read_b64 v[132:133], v6 offset:16384
 v_mfma_f32_16x16x32_bf16 v[108:111], a[104:107], v[48:51], v[108:111]
 ds_read_b128 v[134:137], v5 offset:17408
 v_mfma_f32_16x16x32_bf16 v[112:115], a[108:111], v[48:51], v[112:115]
 ds_read_b128 v[138:141], v5 offset:18432
 v_mfma_f32_16x16x32_bf16 v[116:119], a[112:115], v[48:51], v[116:119]
 ds_read_b64 v[142:143], v6 offset:21504
 v_mfma_f32_16x16x32_bf16 v[120:123], a[116:119], v[48:51], v[120:123]
 v_mfma_f32_16x16x32_bf16 v[104:107], a[120:123], v[52:55], v[104:107]
 v_mfma_f32_16x16x32_bf16 v[108:111], a[124:127], v[52:55], v[108:111]
 s_waitcnt lgkmcnt(5)
 v_add_f32 v26, v26, v124
 v_add_f32 v27, v27, v125
 v_mfma_f32_16x16x32_bf16 v[112:115], a[128:131], v[52:55], v[112:115]
 v_add_f32 v28, v28, v126
 v_add_f32 v29, v29, v127
 v_mfma_f32_16x16x32_bf16 v[116:119], a[132:135], v[52:55], v[116:119]
 s_waitcnt lgkmcnt(4)
 v_add_f32 v30, v30, v128
 v_add_f32 v31, v31, v129
 v_mfma_f32_16x16x32_bf16 v[120:123], a[136:139], v[52:55], v[120:123]
 v_add_f32 v32, v32, v130
 s_waitcnt vmcnt(5)
 v_mfma_f32_16x16x32_bf16 v[104:107], a[140:143], v[56:59], v[104:107]
 v_add_f32 v33, v33, v131
 s_waitcnt lgkmcnt(3)
 v_add_f32 v34, v34, v132
 v_mfma_f32_16x16x32_bf16 v[108:111], a[144:147], v[56:59], v[108:111]
 v_add_f32 v35, v35, v133
 s_waitcnt lgkmcnt(2)
 v_add_f32 v26, v26, v134
 v_mfma_f32_16x16x32_bf16 v[112:115], a[148:151], v[56:59], v[112:115]
 v_add_f32 v27, v27, v135
 v_add_f32 v28, v28, v136
 v_mfma_f32_16x16x32_bf16 v[116:119], a[152:155], v[56:59], v[116:119]
 v_add_f32 v29, v29, v137
 s_waitcnt lgkmcnt(1)
 v_add_f32 v30, v30, v138
 v_mfma_f32_16x16x32_bf16 v[120:123], a[156:159], v[56:59], v[120:123]
 v_add_f32 v31, v31, v139
 s_waitcnt vmcnt(4)
 v_mfma_f32_16x16x32_bf16 v[104:107], a[160:163], v[60:63], v[104:107]
 v_add_f32 v32, v32, v140
 v_add_f32 v33, v33, v141
 v_mfma_f32_16x16x32_bf16 v[108:111], a[164:167], v[60:63], v[108:111]
 s_waitcnt lgkmcnt(0)
 v_add_f32 v34, v34, v142
 v_add_f32 v35, v35, v143
 v_mfma_f32_16x16x32_bf16 v[112:115], a[168:171], v[60:63], v[112:115]
 v_mfma_f32_16x16x32_bf16 v[116:119], a[172:175], v[60:63], v[116:119]
 v_mfma_f32_16x16x32_bf16 v[120:123], a[176:179], v[60:63], v[120:123]
 s_waitcnt vmcnt(3)
 v_mfma_f32_16x16x32_bf16 v[104:107], a[180:183], v[64:67], v[104:107]
 v_mfma_f32_16x16x32_bf16 v[108:111], a[184:187], v[64:67], v[108:111]
 v_mfma_f32_16x16x32_bf16 v[112:115], a[188:191], v[64:67], v[112:115]
 v_mfma_f32_16x16x32_bf16 v[116:119], a[192:195], v[64:67], v[116:119]
 s_lshl_b32 s33, s54, 7
 s_add_u32 s33, s33, 7733248
 s_add_u32 s56, s52, 4
 buffer_load_dword v12, v172, s[4:7], s33 offen sc1
 v_mfma_f32_16x16x32_bf16 v[120:123], a[196:199], v[64:67], v[120:123]
 s_waitcnt vmcnt(3)
 v_mfma_f32_16x16x32_bf16 v[104:107], a[200:203], v[68:71], v[104:107]
 v_mfma_f32_16x16x32_bf16 v[108:111], a[204:207], v[68:71], v[108:111]
 v_mfma_f32_16x16x32_bf16 v[112:115], a[208:211], v[68:71], v[112:115]
 v_mfma_f32_16x16x32_bf16 v[116:119], a[212:215], v[68:71], v[116:119]
 v_mfma_f32_16x16x32_bf16 v[120:123], a[216:219], v[68:71], v[120:123]
 s_waitcnt vmcnt(2)
 v_mfma_f32_16x16x32_bf16 v[104:107], a[220:223], v[72:75], v[104:107]
 v_mfma_f32_16x16x32_bf16 v[108:111], a[224:227], v[72:75], v[108:111]
 v_mfma_f32_16x16x32_bf16 v[112:115], a[228:231], v[72:75], v[112:115]
 v_mfma_f32_16x16x32_bf16 v[116:119], a[232:235], v[72:75], v[116:119]
 v_mfma_f32_16x16x32_bf16 v[120:123], a[236:239], v[72:75], v[120:123]
 s_waitcnt vmcnt(0)
 v_cmp_ne_u32 vcc, s56, v12
 s_cbranch_vccz Lgate_54
 s_mov_b32 s55, 0
Lpoll_55:
 buffer_load_dword v12, v172, s[4:7], s33 offen sc1
 s_add_u32 s55, s55, 1
 s_cmp_gt_u32 s55, 0x80000
 s_cbranch_scc1 Lend
 s_waitcnt vmcnt(0)
 v_cmp_ne_u32 vcc, s56, v12
 s_cbranch_vccnz Lpoll_55
Lgate_54:
 s_add_u32 s33, s33, 12288
 buffer_load_dwordx4 v[176:179], v0, s[8:11], s16 offen sc1
 buffer_load_dwordx4 v[180:183], v0, s[8:11], s16 offen offset:1024 sc1
 s_waitcnt lgkmcnt(0)
 s_barrier
 ds_write_b128 v4, v[104:107] offset:12288
 buffer_load_dwordx4 v[184:187], v0, s[8:11], s16 offen offset:2048 sc1
 ds_read_b128 v[224:227], v0
 ds_write_b128 v4, v[108:111] offset:13312
 buffer_load_dwordx4 v[188:191], v0, s[8:11], s16 offen offset:3072 sc1
 s_add_u32 s16, s16, 4096
 ds_read_b128 v[228:231], v0 offset:1024
 ds_write_b128 v4, v[112:115] offset:14336
 buffer_load_dwordx4 v[192:195], v0, s[8:11], s16 offen sc1
 ds_read_b128 v[232:235], v0 offset:2048
 ds_write_b128 v4, v[116:119] offset:15360
 buffer_load_dwordx4 v[196:199], v0, s[8:11], s16 offen offset:1024 sc1
 ds_read_b128 v[236:239], v0 offset:3072
 ds_write_b128 v4, v[120:123] offset:16384
 buffer_load_dwordx4 v[200:203], v0, s[8:11], s16 offen offset:2048 sc1
 ds_read_b128 v[240:243], v0 offset:4096
 s_waitcnt lgkmcnt(0)
 s_barrier
 ds_read_b128 v[124:127], v5 offset:12288
 ds_read_b128 v[128:131], v5 offset:13312
 ds_read_b64 v[132:133], v6 offset:16384
 ds_read_b128 v[134:137], v5 offset:17408
 ds_read_b128 v[138:141], v5 offset:18432
 ds_read_b64 v[142:143], v6 offset:21504
 buffer_load_dwordx4 v[204:207], v0, s[8:11], s16 offen offset:3072 sc1
 s_add_u32 s16, s16, 4096
 buffer_load_dwordx4 v[208:211], v0, s[8:11], s16 offen sc1
 buffer_load_dwordx4 v[212:215], v0, s[8:11], s16 offen offset:1024 sc1
 s_waitcnt vmcnt(9)
 v_mfma_f32_32x32x16_bf16 v[44:59], v[224:227], v[176:179], 0
 ds_read_b128 v[244:247], v0 offset:5120
 v_mfma_f32_32x32x16_bf16 v[76:91], v[228:231], v[176:179], 0
 ds_read_b128 v[248:251], v0 offset:6144
 s_waitcnt vmcnt(8)
 v_mfma_f32_32x32x16_bf16 v[44:59], v[232:235], v[180:183], v[44:59]
 ds_read_b128 v[252:255], v0 offset:7168
 s_waitcnt lgkmcnt(8)
 v_add_f32 v26, v26, v124
 v_add_f32 v27, v27, v125
 v_add_f32 v28, v28, v126
 v_add_f32 v29, v29, v127
 s_waitcnt lgkmcnt(7)
 v_add_f32 v30, v30, v128
 v_mfma_f32_32x32x16_bf16 v[76:91], v[236:239], v[180:183], v[76:91]
 ds_read_b128 v[224:227], v0 offset:8192
 v_add_f32 v31, v31, v129
 v_add_f32 v32, v32, v130
 v_add_f32 v33, v33, v131
 s_waitcnt lgkmcnt(7)
 v_add_f32 v34, v34, v132
 s_waitcnt vmcnt(7) lgkmcnt(3)
 v_mfma_f32_32x32x16_bf16 v[44:59], v[240:243], v[184:187], v[44:59]
 ds_read_b128 v[228:231], v0 offset:9216
 v_add_f32 v35, v35, v133
 v_add_f32 v26, v26, v134
 v_add_f32 v27, v27, v135
 v_add_f32 v28, v28, v136
 v_add_f32 v29, v29, v137
 v_mfma_f32_32x32x16_bf16 v[76:91], v[244:247], v[184:187], v[76:91]
 ds_read_b128 v[232:235], v0 offset:10240
 v_add_f32 v30, v30, v138
 v_add_f32 v31, v31, v139
 v_add_f32 v32, v32, v140
 v_add_f32 v33, v33, v141
 v_add_f32 v34, v34, v142
 s_waitcnt vmcnt(6) lgkmcnt(3)
 v_mfma_f32_32x32x16_bf16 v[44:59], v[248:251], v[188:191], v[44:59]
 buffer_load_dwordx4 v[216:219], v0, s[8:11], s16 offen offset:2048 sc1
 ds_read_b128 v[236:239], v0 offset:11264
 v_add_f32 v35, v35, v143
 v_cvt_pk_bf16_f32 v124, v26, v27
 v_cvt_pk_bf16_f32 v125, v28, v29
 v_cvt_pk_bf16_f32 v126, v30, v31
 v_mfma_f32_32x32x16_bf16 v[76:91], v[252:255], v[188:191], v[76:91]
 ds_read_b128 v[240:243], v0 offset:12288
 v_cvt_pk_bf16_f32 v127, v32, v33
 v_cvt_pk_bf16_f32 v128, v34, v35
 s_waitcnt vmcnt(6) lgkmcnt(3)
 v_mfma_f32_32x32x16_bf16 v[44:59], v[224:227], v[192:195], v[44:59]
 buffer_load_dwordx4 v[220:223], v0, s[8:11], s16 offen offset:3072 sc1
 s_add_u32 s16, s16, 4096
 ds_read_b128 v[244:247], v0 offset:13312
 v_mfma_f32_32x32x16_bf16 v[76:91], v[228:231], v[192:195], v[76:91]
 buffer_load_dwordx4 v[144:147], v0, s[4:7], s17 offen sc1
 ds_read_b128 v[248:251], v0 offset:14336
 s_waitcnt vmcnt(7) lgkmcnt(3)
 v_mfma_f32_32x32x16_bf16 v[44:59], v[232:235], v[196:199], v[44:59]
 buffer_load_dwordx4 v[176:179], v0, s[8:11], s16 offen sc1
 ds_read_b128 v[252:255], v0 offset:15360
 v_mfma_f32_32x32x16_bf16 v[76:91], v[236:239], v[196:199], v[76:91]
 ds_read_b128 v[224:227], v0 offset:16384
 s_waitcnt vmcnt(7) lgkmcnt(3)
 v_mfma_f32_32x32x16_bf16 v[44:59], v[240:243], v[200:203], v[44:59]
 buffer_load_dwordx4 v[180:183], v0, s[8:11], s16 offen offset:1024 sc1
 ds_read_b128 v[228:231], v0 offset:17408
 v_mfma_f32_32x32x16_bf16 v[76:91], v[244:247], v[200:203], v[76:91]
 ds_read_b128 v[232:235], v0 offset:18432
 buffer_store_dwordx4 v[124:127], v168, s[8:11], s29 offen sc1
 s_waitcnt vmcnt(8) lgkmcnt(3)
 v_mfma_f32_32x32x16_bf16 v[44:59], v[248:251], v[204:207], v[44:59]
 buffer_load_dwordx4 v[184:187], v0, s[8:11], s16 offen offset:2048 sc1
 ds_read_b128 v[236:239], v0 offset:19456
 buffer_store_dword v128, v169, s[8:11], s30 offen sc1
 v_add_f32 v130, v26, v27
 v_mul_f32 v132, v26, v26
 v_mfma_f32_32x32x16_bf16 v[76:91], v[252:255], v[204:207], v[76:91]
 buffer_load_dwordx4 v[148:151], v0, s[4:7], s17 offen offset:1024 sc1
 ds_read_b128 v[240:243], v0 offset:20480
 v_fmac_f32 v132, v27, v27
 v_add_f32 v130, v130, v28
 v_fmac_f32 v132, v28, v28
 s_waitcnt vmcnt(10) lgkmcnt(3)
 v_mfma_f32_32x32x16_bf16 v[44:59], v[224:227], v[208:211], v[44:59]
 buffer_load_dwordx4 v[188:191], v0, s[8:11], s16 offen offset:3072 sc1
 s_add_u32 s16, s16, 4096
 ds_read_b128 v[244:247], v0 offset:21504
 v_add_f32 v130, v130, v29
 v_fmac_f32 v132, v29, v29
 v_add_f32 v130, v130, v30
 v_mfma_f32_32x32x16_bf16 v[76:91], v[228:231], v[208:211], v[76:91]
 ds_read_b128 v[248:251], v0 offset:22528
 v_fmac_f32 v132, v30, v30
 v_add_f32 v130, v130, v31
 v_fmac_f32 v132, v31, v31
 v_add_f32 v130, v130, v32
 s_waitcnt vmcnt(10) lgkmcnt(3)
 v_mfma_f32_32x32x16_bf16 v[44:59], v[232:235], v[212:215], v[44:59]
 buffer_load_dwordx4 v[192:195], v0, s[8:11], s16 offen sc1
 ds_read_b128 v[252:255], v0 offset:23552
 v_fmac_f32 v132, v32, v32
 v_add_f32 v130, v130, v33
 v_fmac_f32 v132, v33, v33
 v_add_f32 v130, v130, v34
 v_mfma_f32_32x32x16_bf16 v[76:91], v[236:239], v[212:215], v[76:91]
 ds_read_b128 v[224:227], v0 offset:24576
 v_fmac_f32 v132, v34, v34
 v_add_f32 v130, v130, v35
 v_fmac_f32 v132, v35, v35
 s_waitcnt vmcnt(10) lgkmcnt(3)
 v_mfma_f32_32x32x16_bf16 v[44:59], v[240:243], v[216:219], v[44:59]
 buffer_load_dwordx4 v[196:199], v0, s[8:11], s16 offen offset:1024 sc1
 ds_read_b128 v[228:231], v0 offset:25600
 v_permlane32_swap_b32 v130, v132
 v_add_f32 v131, v130, v132
 v_add_f32 v130, v130, v132
 v_mfma_f32_32x32x16_bf16 v[76:91], v[244:247], v[216:219], v[76:91]
 ds_read_b128 v[232:235], v0 offset:26624
 v_permlane16_swap_b32 v130, v131
 v_add_f32 v130, v130, v131
 s_nop 1
 v_add_f32_dpp v130, v130, v130 row_ror:8 row_mask:0xf bank_mask:0xf
 s_waitcnt vmcnt(10) lgkmcnt(3)
 v_mfma_f32_32x32x16_bf16 v[44:59], v[248:251], v[220:223], v[44:59]
 buffer_load_dwordx4 v[200:203], v0, s[8:11], s16 offen offset:2048 sc1
 ds_read_b128 v[236:239], v0 offset:27648
 buffer_store_dword v130, v170, s[4:7], s31 offen sc1
 v_mfma_f32_32x32x16_bf16 v[76:91], v[252:255], v[220:223], v[76:91]
 ds_read_b128 v[240:243], v0 offset:28672
 s_waitcnt vmcnt(10) lgkmcnt(3)
 v_mfma_f32_32x32x16_bf16 v[44:59], v[224:227], v[176:179], v[44:59]
 buffer_load_dwordx4 v[204:207], v0, s[8:11], s16 offen offset:3072 sc1
 s_add_u32 s16, s16, 4096
 ds_read_b128 v[244:247], v0 offset:29696
 v_mfma_f32_32x32x16_bf16 v[76:91], v[228:231], v[176:179], v[76:91]
 ds_read_b128 v[248:251], v0 offset:30720
 s_waitcnt vmcnt(10) lgkmcnt(3)
 v_mfma_f32_32x32x16_bf16 v[44:59], v[232:235], v[180:183], v[44:59]
 buffer_load_dwordx4 v[208:211], v0, s[8:11], s16 offen sc1
 ds_read_b128 v[252:255], v0 offset:31744
 v_mfma_f32_32x32x16_bf16 v[76:91], v[236:239], v[180:183], v[76:91]
 ds_read_b128 v[224:227], v0 offset:32768
 s_waitcnt vmcnt(9) lgkmcnt(3)
 v_mfma_f32_32x32x16_bf16 v[44:59], v[240:243], v[184:187], v[44:59]
 buffer_load_dwordx4 v[212:215], v0, s[8:11], s16 offen offset:1024 sc1
 ds_read_b128 v[228:231], v0 offset:33792
 v_mfma_f32_32x32x16_bf16 v[76:91], v[244:247], v[184:187], v[76:91]
 ds_read_b128 v[232:235], v0 offset:34816
 s_waitcnt vmcnt(7) lgkmcnt(3)
 v_mfma_f32_32x32x16_bf16 v[44:59], v[248:251], v[188:191], v[44:59]
 buffer_load_dwordx4 v[216:219], v0, s[8:11], s16 offen offset:2048 sc1
 ds_read_b128 v[236:239], v0 offset:35840
 v_mfma_f32_32x32x16_bf16 v[76:91], v[252:255], v[188:191], v[76:91]
 ds_read_b128 v[240:243], v0 offset:36864
 s_waitcnt vmcnt(7) lgkmcnt(3)
 v_mfma_f32_32x32x16_bf16 v[44:59], v[224:227], v[192:195], v[44:59]
 buffer_load_dwordx4 v[220:223], v0, s[8:11], s16 offen offset:3072 sc1
 s_add_u32 s16, s16, 4096
 ds_read_b128 v[244:247], v0 offset:37888
 v_mov_b32 v15, 4
 v_add_u32 v15, s52, v15
 s_waitcnt vmcnt(5)
 s_mov_b64 exec, 1
 buffer_store_dword v15, v0, s[4:7], s32 offen sc1
 s_mov_b64 exec, -1
 v_mfma_f32_32x32x16_bf16 v[76:91], v[228:231], v[192:195], v[76:91]
 ds_read_b128 v[248:251], v0 offset:38912
 s_barrier
 v_add_f32 v144, v144, v145
 v_add_f32 v148, v148, v149
 s_waitcnt lgkmcnt(3)
 v_mfma_f32_32x32x16_bf16 v[44:59], v[232:235], v[196:199], v[44:59]
 buffer_load_dwordx4 v[176:179], v0, s[8:11], s16 offen sc1
 ds_read_b128 v[252:255], v0 offset:39936
 v_add_f32 v144, v144, v146
 v_add_f32 v148, v148, v150
 v_add_f32 v144, v144, v147
 s_mul_i32 s18, s51, 102400
 v_mfma_f32_32x32x16_bf16 v[76:91], v[236:239], v[196:199], v[76:91]
 ds_read_b128 v[224:227], v0 offset:40960
 v_add_f32 v148, v148, v151
 s_nop 1
 v_permlane16_swap_b32 v144, v148
 s_mul_i32 s19, s3, 25600
 s_waitcnt lgkmcnt(3)
 v_mfma_f32_32x32x16_bf16 v[44:59], v[240:243], v[200:203], v[44:59]
 buffer_load_dwordx4 v[180:183], v0, s[8:11], s16 offen offset:1024 sc1
 ds_read_b128 v[228:231], v0 offset:41984
 v_add_f32 v144, v144, v148
 v_mov_b32 v145, v144
 s_add_u32 s18, s18, s19
 s_add_u32 s18, s18, 6553600
 v_mfma_f32_32x32x16_bf16 v[76:91], v[244:247], v[200:203], v[76:91]
 ds_read_b128 v[232:235], v0 offset:43008
 v_permlane32_swap_b32 v144, v145
 v_mul_f32 v144, 0xbacccccd, v144
 s_mul_i32 s20, s54, 196608
 s_waitcnt vmcnt(7) lgkmcnt(3)
 v_mfma_f32_32x32x16_bf16 v[44:59], v[248:251], v[204:207], v[44:59]
 buffer_load_dwordx4 v[184:187], v0, s[8:11], s16 offen offset:2048 sc1
 ds_read_b128 v[236:239], v0 offset:44032
 v_mul_f32 v145, 0x3acccccd, v145
 v_fma_f32 v145, -v144, v144, v145
 v_max_f32 v145, 0, v145
 s_add_u32 s20, s20, 18350080
 v_mfma_f32_32x32x16_bf16 v[76:91], v[252:255], v[204:207], v[76:91]
 ds_read_b128 v[240:243], v0 offset:45056
 v_add_f32 v145, 0x3727c5ac, v145
 v_rsq_f32 v146, v145
 s_mul_i32 s21, s50, 5120
 s_waitcnt vmcnt(7) lgkmcnt(3)
 v_mfma_f32_32x32x16_bf16 v[44:59], v[224:227], v[208:211], v[44:59]
 buffer_load_dwordx4 v[188:191], v0, s[8:11], s16 offen offset:3072 sc1
 s_add_u32 s16, s16, 4096
 ds_read_b128 v[244:247], v0 offset:46080
 v_cvt_pk_bf16_f32 v160, v144, v144
 v_lshlrev_b32 v147, 16, v160
 s_add_u32 s20, s20, s21
 v_mfma_f32_32x32x16_bf16 v[76:91], v[228:231], v[208:211], v[76:91]
 ds_read_b128 v[248:251], v0 offset:47104
 v_sub_f32 v147, v144, v147
 v_cvt_pk_bf16_f32 v161, v147, v147
 v_mov_b32 v170, v146
 s_lshr_b32 s22, s51, 1
 s_waitcnt vmcnt(7) lgkmcnt(3)
 v_mfma_f32_32x32x16_bf16 v[44:59], v[232:235], v[212:215], v[44:59]
 buffer_load_dwordx4 v[192:195], v0, s[8:11], s16 offen sc1
 ds_read_b128 v[252:255], v0 offset:48128
 v_mul_f32 v168, 0x3fb8aa3b, v146
 v_mul_f32 v169, 0xbfb8aa3b, v146
 s_lshl_b32 s22, s22, 5
 s_add_u32 s22, s22, s59
 v_mfma_f32_32x32x16_bf16 v[76:91], v[236:239], v[212:215], v[76:91]
 ds_read_b128 v[224:227], v0 offset:49152
 s_lshl_b32 s22, s22, 3
 s_add_u32 s22, s22, s20
 s_add_u32 s22, s22, 4096
 s_lshl_b32 s21, s51, 9
 s_waitcnt vmcnt(7) lgkmcnt(3)
 v_mfma_f32_32x32x16_bf16 v[44:59], v[240:243], v[216:219], v[44:59]
 buffer_load_dwordx4 v[196:199], v0, s[8:11], s16 offen offset:1024 sc1
 ds_read_b128 v[228:231], v0 offset:50176
 s_add_u32 s20, s20, s21
 s_add_u32 s21, s20, 40960
 s_lshl_b32 s23, s54, 7
 s_add_u32 s23, s23, 7737344
 v_mfma_f32_32x32x16_bf16 v[76:91], v[244:247], v[216:219], v[76:91]
 ds_read_b128 v[232:235], v0 offset:51200
 s_lshl_b32 s24, s49, 2
 s_add_u32 s23, s23, s24
 s_add_u32 s24, s24, s3
 s_mul_i32 s24, s24, 6144
 s_waitcnt vmcnt(7) lgkmcnt(3)
 v_mfma_f32_32x32x16_bf16 v[44:59], v[248:251], v[220:223], v[44:59]
 buffer_load_dwordx4 v[200:203], v0, s[8:11], s16 offen offset:2048 sc1
 ds_read_b128 v[236:239], v0 offset:52224
 s_add_u32 s24, s24, 9437184
 s_xor_b32 s25, s48, 1
 s_mul_i32 s25, s25, 768
 s_add_u32 s25, s25, s24
 v_mfma_f32_32x32x16_bf16 v[76:91], v[252:255], v[220:223], v[76:91]
 ds_read_b128 v[240:243], v0 offset:53248
 s_xor_b32 s26, s48, 2
 s_mul_i32 s26, s26, 768
 s_add_u32 s26, s26, s24
 s_xor_b32 s27, s48, 3
 s_waitcnt vmcnt(6) lgkmcnt(3)
 v_mfma_f32_32x32x16_bf16 v[44:59], v[224:227], v[176:179], v[44:59]
 buffer_load_dwordx4 v[204:207], v0, s[8:11], s16 offen offset:3072 sc1
 s_add_u32 s16, s16, 4096
 ds_read_b128 v[244:247], v0 offset:54272
 s_mul_i32 s27, s27, 768
 s_add_u32 s27, s27, s24
 s_xor_b32 s28, s48, 4
 v_mfma_f32_32x32x16_bf16 v[76:91], v[228:231], v[176:179], v[76:91]
 ds_read_b128 v[248:251], v0 offset:55296
 s_mul_i32 s28, s28, 768
 s_add_u32 s28, s28, s24
 s_xor_b32 s29, s48, 5
 s_mul_i32 s29, s29, 768
 s_waitcnt vmcnt(6) lgkmcnt(3)
 v_mfma_f32_32x32x16_bf16 v[44:59], v[232:235], v[180:183], v[44:59]
 buffer_load_dwordx4 v[208:211], v0, s[8:11], s16 offen sc1
 ds_read_b128 v[252:255], v0 offset:56320
 s_add_u32 s29, s29, s24
 s_xor_b32 s30, s48, 6
 s_mul_i32 s30, s30, 768
 s_add_u32 s30, s30, s24
 v_mfma_f32_32x32x16_bf16 v[76:91], v[236:239], v[180:183], v[76:91]
 ds_read_b128 v[224:227], v0 offset:57344
 s_xor_b32 s31, s48, 7
 s_mul_i32 s31, s31, 768
 s_add_u32 s31, s31, s24
 s_mul_i32 s32, s48, 768
 s_waitcnt vmcnt(6) lgkmcnt(3)
 v_mfma_f32_32x32x16_bf16 v[44:59], v[240:243], v[184:187], v[44:59]
 s_add_u32 s56, s52, 4
 buffer_load_dword v12, v172, s[4:7], s33 offen sc1
 buffer_load_dwordx4 v[212:215], v0, s[8:11], s16 offen offset:1024 sc1
 ds_read_b128 v[228:231], v0 offset:58368
 s_add_u32 s24, s24, s32
 v_mfma_f32_32x32x16_bf16 v[76:91], v[244:247], v[184:187], v[76:91]
 ds_read_b128 v[232:235], v0 offset:59392
 s_waitcnt vmcnt(7) lgkmcnt(3)
 v_mfma_f32_32x32x16_bf16 v[44:59], v[248:251], v[188:191], v[44:59]
 buffer_load_dwordx4 v[216:219], v0, s[8:11], s16 offen offset:2048 sc1
 ds_read_b128 v[236:239], v0 offset:60416
 v_mfma_f32_32x32x16_bf16 v[76:91], v[252:255], v[188:191], v[76:91]
 ds_read_b128 v[240:243], v0 offset:61440
 s_waitcnt vmcnt(7) lgkmcnt(3)
 v_mfma_f32_32x32x16_bf16 v[44:59], v[224:227], v[192:195], v[44:59]
 buffer_load_dwordx4 v[220:223], v0, s[8:11], s16 offen offset:3072 sc1
 s_add_u32 s16, s16, 4096
 ds_read_b128 v[244:247], v0 offset:62464
 v_mfma_f32_32x32x16_bf16 v[76:91], v[228:231], v[192:195], v[76:91]
 ds_read_b128 v[248:251], v0 offset:63488
 s_waitcnt vmcnt(7) lgkmcnt(3)
 v_mfma_f32_32x32x16_bf16 v[44:59], v[232:235], v[196:199], v[44:59]
 buffer_load_dwordx4 v[176:179], v0, s[8:11], s16 offen sc1
 ds_read_b128 v[252:255], v0 offset:64512
 v_mfma_f32_32x32x16_bf16 v[76:91], v[236:239], v[196:199], v[76:91]
 ds_read_b128 v[224:227], v1
 s_waitcnt vmcnt(7) lgkmcnt(3)
 v_mfma_f32_32x32x16_bf16 v[44:59], v[240:243], v[200:203], v[44:59]
 buffer_load_dwordx4 v[180:183], v0, s[8:11], s16 offen offset:1024 sc1
 ds_read_b128 v[228:231], v1 offset:1024
 v_mfma_f32_32x32x16_bf16 v[76:91], v[244:247], v[200:203], v[76:91]
 ds_read_b128 v[232:235], v1 offset:2048
 s_waitcnt vmcnt(7) lgkmcnt(3)
 v_mfma_f32_32x32x16_bf16 v[44:59], v[248:251], v[204:207], v[44:59]
 buffer_load_dwordx4 v[184:187], v0, s[8:11], s16 offen offset:2048 sc1
 ds_read_b128 v[236:239], v1 offset:3072
 v_mfma_f32_32x32x16_bf16 v[76:91], v[252:255], v[204:207], v[76:91]
 ds_read_b128 v[240:243], v1 offset:4096
 s_waitcnt vmcnt(7) lgkmcnt(3)
 v_mfma_f32_32x32x16_bf16 v[44:59], v[224:227], v[208:211], v[44:59]
 s_waitcnt vmcnt(6)
 v_cmp_ne_u32 vcc, s56, v12
 s_cbranch_vccnz Lretry_56
Lback_57:
 buffer_load_dwordx4 v[188:191], v0, s[8:11], s16 offen offset:3072 sc1
 s_add_u32 s16, s16, 4096
 ds_read_b128 v[244:247], v1 offset:5120
 v_mfma_f32_32x32x16_bf16 v[76:91], v[228:231], v[208:211], v[76:91]
 ds_read_b128 v[248:251], v1 offset:6144
 s_waitcnt vmcnt(6) lgkmcnt(3)
 v_mfma_f32_32x32x16_bf16 v[44:59], v[232:235], v[212:215], v[44:59]
 buffer_load_dwordx4 v[192:195], v0, s[8:11], s16 offen sc1
 ds_read_b128 v[252:255], v1 offset:7168
 v_mfma_f32_32x32x16_bf16 v[76:91], v[236:239], v[212:215], v[76:91]
 ds_read_b128 v[224:227], v1 offset:8192
 s_waitcnt vmcnt(6) lgkmcnt(3)
 v_mfma_f32_32x32x16_bf16 v[44:59], v[240:243], v[216:219], v[44:59]
 buffer_load_dwordx4 v[196:199], v0, s[8:11], s16 offen offset:1024 sc1
 ds_read_b128 v[228:231], v1 offset:9216
 v_mfma_f32_32x32x16_bf16 v[76:91], v[244:247], v[216:219], v[76:91]
 ds_read_b128 v[232:235], v1 offset:10240
 s_waitcnt vmcnt(6) lgkmcnt(3)
 v_mfma_f32_32x32x16_bf16 v[44:59], v[248:251], v[220:223], v[44:59]
 buffer_load_dwordx4 v[200:203], v0, s[8:11], s16 offen offset:2048 sc1
 ds_read_b128 v[236:239], v1 offset:11264
 v_mfma_f32_32x32x16_bf16 v[76:91], v[252:255], v[220:223], v[76:91]
 ds_read_b128 v[240:243], v1 offset:12288
 s_waitcnt vmcnt(6) lgkmcnt(3)
 v_mfma_f32_32x32x16_bf16 v[44:59], v[224:227], v[176:179], v[44:59]
 buffer_load_dwordx4 v[204:207], v0, s[8:11], s16 offen offset:3072 sc1
 s_add_u32 s16, s16, 4096
 ds_read_b128 v[244:247], v1 offset:13312
 v_mfma_f32_32x32x16_bf16 v[76:91], v[228:231], v[176:179], v[76:91]
 buffer_load_dwordx4 v[152:155], v0, s[4:7], s17 offen offset:2048 sc1
 ds_read_b128 v[248:251], v1 offset:14336
 s_waitcnt vmcnt(7) lgkmcnt(3)
 v_mfma_f32_32x32x16_bf16 v[44:59], v[232:235], v[180:183], v[44:59]
 buffer_load_dwordx4 v[208:211], v0, s[8:11], s16 offen sc1
 ds_read_b128 v[252:255], v1 offset:15360
 v_mfma_f32_32x32x16_bf16 v[76:91], v[236:239], v[180:183], v[76:91]
 buffer_load_dwordx4 v[156:159], v0, s[4:7], s17 offen offset:3072 sc1
 ds_read_b128 v[224:227], v0
 s_waitcnt vmcnt(8) lgkmcnt(3)
 v_mfma_f32_32x32x16_bf16 v[44:59], v[240:243], v[184:187], v[44:59]
 buffer_load_dwordx4 v[212:215], v0, s[8:11], s16 offen offset:1024 sc1
 ds_read_b128 v[228:231], v0 offset:1024
 v_mfma_f32_32x32x16_bf16 v[76:91], v[244:247], v[184:187], v[76:91]
 ds_read_b128 v[232:235], v0 offset:2048
 s_waitcnt vmcnt(8) lgkmcnt(3)
 v_mfma_f32_32x32x16_bf16 v[44:59], v[248:251], v[188:191], v[44:59]
 buffer_load_dwordx4 v[216:219], v0, s[8:11], s16 offen offset:2048 sc1
 ds_read_b128 v[236:239], v0 offset:3072
 v_mfma_f32_32x32x16_bf16 v[76:91], v[252:255], v[188:191], v[76:91]
 ds_read_b128 v[240:243], v0 offset:4096
 s_waitcnt vmcnt(8) lgkmcnt(3)
 v_mfma_f32_32x32x16_bf16 v[60:75], v[224:227], v[192:195], 0
 buffer_load_dwordx4 v[220:223], v0, s[8:11], s16 offen offset:3072 sc1
 s_add_u32 s16, s16, 4096
 ds_read_b128 v[244:247], v0 offset:5120
 v_mfma_f32_32x32x16_bf16 v[92:107], v[228:231], v[192:195], 0
 ds_read_b128 v[248:251], v0 offset:6144
 s_waitcnt vmcnt(8) lgkmcnt(3)
 v_mfma_f32_32x32x16_bf16 v[60:75], v[232:235], v[196:199], v[60:75]
 buffer_load_dwordx4 v[176:179], v0, s[8:11], s16 offen sc1
 ds_read_b128 v[252:255], v0 offset:7168
 v_mfma_f32_32x32x8_bf16 v[44:59], a[240:241], v[160:161], v[44:59]
 v_mfma_f32_32x32x16_bf16 v[92:107], v[236:239], v[196:199], v[92:107]
 ds_read_b128 v[224:227], v0 offset:8192
 v_mfma_f32_32x32x8_bf16 v[76:91], a[242:243], v[160:161], v[76:91]
 s_waitcnt vmcnt(8) lgkmcnt(3)
 v_mfma_f32_32x32x16_bf16 v[60:75], v[240:243], v[200:203], v[60:75]
 buffer_load_dwordx4 v[180:183], v0, s[8:11], s16 offen offset:1024 sc1
 ds_read_b128 v[228:231], v0 offset:9216
 v_mfma_f32_32x32x16_bf16 v[92:107], v[244:247], v[200:203], v[92:107]
 ds_read_b128 v[232:235], v0 offset:10240
 s_waitcnt vmcnt(8) lgkmcnt(3)
 v_mfma_f32_32x32x16_bf16 v[60:75], v[248:251], v[204:207], v[60:75]
 buffer_load_dwordx4 v[184:187], v0, s[8:11], s16 offen offset:2048 sc1
 ds_read_b128 v[236:239], v0 offset:11264
 s_waitcnt vmcnt(8)
 v_add_f32 v152, v152, v153
 s_waitcnt vmcnt(6)
 v_add_f32 v156, v156, v157
 v_add_f32 v152, v152, v154
 v_add_f32 v156, v156, v158
 v_mfma_f32_32x32x16_bf16 v[92:107], v[252:255], v[204:207], v[92:107]
 ds_read_b128 v[240:243], v0 offset:12288
 v_add_f32 v152, v152, v155
 v_add_f32 v156, v156, v159
 s_nop 1
 v_permlane16_swap_b32 v152, v156
 v_add_f32 v152, v152, v156
 s_waitcnt lgkmcnt(3)
 v_mfma_f32_32x32x16_bf16 v[60:75], v[224:227], v[208:211], v[60:75]
 buffer_load_dwordx4 v[188:191], v0, s[8:11], s16 offen offset:3072 sc1
 s_add_u32 s16, s16, 4096
 ds_read_b128 v[244:247], v0 offset:13312
 v_mov_b32 v153, v152
 s_nop 1
 v_permlane32_swap_b32 v152, v153
 v_mfma_f32_32x32x16_bf16 v[92:107], v[228:231], v[208:211], v[92:107]
 ds_read_b128 v[248:251], v0 offset:14336
 v_mul_f32 v152, 0xbacccccd, v152
 v_mul_f32 v153, 0x3acccccd, v153
 v_fma_f32 v153, -v152, v152, v153
 v_max_f32 v153, 0, v153
 v_add_f32 v153, 0x3727c5ac, v153
 s_waitcnt vmcnt(6) lgkmcnt(3)
 v_mfma_f32_32x32x16_bf16 v[60:75], v[232:235], v[212:215], v[60:75]
 buffer_load_dwordx4 v[192:195], v0, s[8:11], s16 offen sc1
 ds_read_b128 v[252:255], v0 offset:15360
 v_rsq_f32 v154, v153
 v_cvt_pk_bf16_f32 v162, v152, v152
 v_lshlrev_b32 v155, 16, v162
 v_mfma_f32_32x32x16_bf16 v[92:107], v[236:239], v[212:215], v[92:107]
 ds_read_b128 v[224:227], v0 offset:16384
 v_sub_f32 v155, v152, v155
 v_cvt_pk_bf16_f32 v163, v155, v155
 v_mov_b32 v174, v154
 v_mul_f32 v172, 0x3fb8aa3b, v154
 v_mul_f32 v173, 0xbfb8aa3b, v154
 s_waitcnt vmcnt(6) lgkmcnt(3)
 v_mfma_f32_32x32x16_bf16 v[60:75], v[240:243], v[216:219], v[60:75]
 buffer_load_dwordx4 v[196:199], v0, s[8:11], s16 offen offset:1024 sc1
 ds_read_b128 v[228:231], v0 offset:17408
 v_mov_b32 v143, s60
 v_max3_f32 v12, v44, v45, v46
 v_max3_f32 v13, -v44, -v45, -v46
 v_max3_f32 v12, v12, v47, v48
 v_mfma_f32_32x32x16_bf16 v[92:107], v[244:247], v[216:219], v[92:107]
 ds_read_b128 v[232:235], v0 offset:18432
 v_max3_f32 v13, v13, -v47, -v48
 v_max3_f32 v12, v12, v49, v50
 v_max3_f32 v13, v13, -v49, -v50
 v_max3_f32 v12, v12, v51, v52
 v_max3_f32 v13, v13, -v51, -v52
 s_waitcnt vmcnt(6) lgkmcnt(3)
 v_mfma_f32_32x32x16_bf16 v[60:75], v[248:251], v[220:223], v[60:75]
 buffer_load_dwordx4 v[200:203], v0, s[8:11], s16 offen offset:2048 sc1
 ds_read_b128 v[236:239], v0 offset:19456
 v_max_f32 v12, v12, v53
 v_max_f32 v13, v13, -v53
 s_nop 1
 v_permlane32_swap_b32 v12, v13
 v_mfma_f32_32x32x16_bf16 v[92:107], v[252:255], v[220:223], v[92:107]
 ds_read_b128 v[240:243], v0 offset:20480
 v_max_f32 v12, v12, v13
 v_mul_f32 v13, v12, v169
 v_mul_f32 v12, v12, v169
 s_nop 1
 v_permlane32_swap_b32 v12, v13
 s_waitcnt vmcnt(6) lgkmcnt(3)
 v_mfma_f32_32x32x16_bf16 v[60:75], v[224:227], v[176:179], v[60:75]
 buffer_load_dwordx4 v[204:207], v0, s[8:11], s16 offen offset:3072 sc1
 s_add_u32 s16, s16, 4096
 ds_read_b128 v[244:247], v0 offset:21504
 v_fma_f32 v108, v44, v168, v12
 v_fma_f32 v109, v44, v169, v13
 v_fma_f32 v110, v45, v168, v12
 v_mfma_f32_32x32x16_bf16 v[92:107], v[228:231], v[176:179], v[92:107]
 ds_read_b128 v[248:251], v0 offset:22528
 v_fma_f32 v111, v45, v169, v13
 v_fma_f32 v112, v46, v168, v12
 v_fma_f32 v113, v46, v169, v13
 v_fma_f32 v114, v47, v168, v12
 v_fma_f32 v115, v47, v169, v13
 s_waitcnt vmcnt(6) lgkmcnt(3)
 v_mfma_f32_32x32x16_bf16 v[60:75], v[232:235], v[180:183], v[60:75]
 buffer_load_dwordx4 v[208:211], v0, s[8:11], s16 offen sc1
 ds_read_b128 v[252:255], v0 offset:23552
 v_fma_f32 v116, v48, v168, v12
 v_fma_f32 v117, v48, v169, v13
 v_fma_f32 v118, v49, v168, v12
 v_fma_f32 v119, v49, v169, v13
 v_mfma_f32_32x32x16_bf16 v[92:107], v[236:239], v[180:183], v[92:107]
 ds_read_b128 v[224:227], v0 offset:24576
 v_fma_f32 v120, v50, v168, v12
 v_fma_f32 v121, v50, v169, v13
 v_fma_f32 v122, v51, v168, v12
 v_fma_f32 v123, v51, v169, v13
 v_fma_f32 v124, v52, v168, v12
 s_waitcnt vmcnt(6) lgkmcnt(3)
 v_mfma_f32_32x32x16_bf16 v[60:75], v[240:243], v[184:187], v[60:75]
 buffer_load_dwordx4 v[212:215], v0, s[8:11], s16 offen offset:1024 sc1
 ds_read_b128 v[228:231], v0 offset:25600
 v_fma_f32 v125, v52, v169, v13
 v_fma_f32 v126, v53, v168, v12
 v_fma_f32 v127, v53, v169, v13
 v_mfma_f32_32x32x16_bf16 v[92:107], v[244:247], v[184:187], v[92:107]
 ds_read_b128 v[232:235], v0 offset:26624
 v_exp_f32 v108, v108
 v_exp_f32 v109, v109
 s_waitcnt vmcnt(6) lgkmcnt(3)
 v_mfma_f32_32x32x16_bf16 v[60:75], v[248:251], v[188:191], v[60:75]
 buffer_load_dwordx4 v[216:219], v0, s[8:11], s16 offen offset:2048 sc1
 ds_read_b128 v[236:239], v0 offset:27648
 v_exp_f32 v110, v110
 v_exp_f32 v111, v111
 v_mfma_f32_32x32x16_bf16 v[92:107], v[252:255], v[188:191], v[92:107]
 ds_read_b128 v[240:243], v0 offset:28672
 v_exp_f32 v112, v112
 v_exp_f32 v113, v113
 s_waitcnt vmcnt(6) lgkmcnt(3)
 v_mfma_f32_32x32x16_bf16 v[60:75], v[224:227], v[192:195], v[60:75]
 buffer_load_dwordx4 v[220:223], v0, s[8:11], s16 offen offset:3072 sc1
 s_add_u32 s16, s16, 4096
 ds_read_b128 v[244:247], v0 offset:29696
 v_exp_f32 v114, v114
 v_mfma_f32_32x32x16_bf16 v[92:107], v[228:231], v[192:195], v[92:107]
 ds_read_b128 v[248:251], v0 offset:30720
 v_exp_f32 v115, v115
 v_exp_f32 v116, v116
 s_waitcnt vmcnt(6) lgkmcnt(3)
 v_mfma_f32_32x32x16_bf16 v[60:75], v[232:235], v[196:199], v[60:75]
 buffer_load_dwordx4 v[176:179], v0, s[8:11], s16 offen sc1
 ds_read_b128 v[252:255], v0 offset:31744
 v_exp_f32 v117, v117
 v_exp_f32 v118, v118
 v_mfma_f32_32x32x16_bf16 v[92:107], v[236:239], v[196:199], v[92:107]
 ds_read_b128 v[224:227], v0 offset:32768
 v_exp_f32 v119, v119
 v_exp_f32 v120, v120
 s_waitcnt vmcnt(6) lgkmcnt(3)
 v_mfma_f32_32x32x16_bf16 v[60:75], v[240:243], v[200:203], v[60:75]
 buffer_load_dwordx4 v[180:183], v0, s[8:11], s16 offen offset:1024 sc1
 ds_read_b128 v[228:231], v0 offset:33792
 v_exp_f32 v121, v121
 v_exp_f32 v122, v122
 v_mfma_f32_32x32x16_bf16 v[92:107], v[244:247], v[200:203], v[92:107]
 ds_read_b128 v[232:235], v0 offset:34816
 v_exp_f32 v123, v123
 v_exp_f32 v124, v124
 s_waitcnt vmcnt(6) lgkmcnt(3)
 v_mfma_f32_32x32x16_bf16 v[60:75], v[248:251], v[204:207], v[60:75]
 buffer_load_dwordx4 v[184:187], v0, s[8:11], s16 offen offset:2048 sc1
 ds_read_b128 v[236:239], v0 offset:35840
 v_exp_f32 v125, v125
 v_exp_f32 v126, v126
 v_mfma_f32_32x32x16_bf16 v[92:107], v[252:255], v[204:207], v[92:107]
 ds_read_b128 v[240:243], v0 offset:36864
 v_exp_f32 v127, v127
 v_add_f32 v14, v108, v110
 v_add_f32 v15, v109, v111
 v_add_f32 v14, v14, v112
 s_waitcnt vmcnt(6) lgkmcnt(3)
 v_mfma_f32_32x32x16_bf16 v[60:75], v[224:227], v[208:211], v[60:75]
 buffer_load_dwordx4 v[188:191], v0, s[8:11], s16 offen offset:3072 sc1
 s_add_u32 s16, s16, 4096
 ds_read_b128 v[244:247], v0 offset:37888
 v_add_f32 v15, v15, v113
 v_add_f32 v14, v14, v114
 v_add_f32 v15, v15, v115
 v_mfma_f32_32x32x16_bf16 v[92:107], v[228:231], v[208:211], v[92:107]
 ds_read_b128 v[248:251], v0 offset:38912
 v_add_f32 v14, v14, v116
 v_add_f32 v15, v15, v117
 v_add_f32 v14, v14, v118
 v_add_f32 v15, v15, v119
 v_add_f32 v14, v14, v120
 s_waitcnt vmcnt(6) lgkmcnt(3)
 v_mfma_f32_32x32x16_bf16 v[60:75], v[232:235], v[212:215], v[60:75]
 buffer_load_dwordx4 v[192:195], v0, s[8:11], s16 offen sc1
 ds_read_b128 v[252:255], v0 offset:39936
 v_add_f32 v15, v15, v121
 v_add_f32 v14, v14, v122
 v_add_f32 v15, v15, v123
 v_add_f32 v14, v14, v124
 v_mfma_f32_32x32x16_bf16 v[92:107], v[236:239], v[212:215], v[92:107]
 ds_read_b128 v[224:227], v0 offset:40960
 v_add_f32 v15, v15, v125
 v_add_f32 v14, v14, v126
 v_add_f32 v15, v15, v127
 s_nop 1
 v_permlane32_swap_b32 v14, v15
 s_waitcnt vmcnt(6) lgkmcnt(3)
 v_mfma_f32_32x32x16_bf16 v[60:75], v[240:243], v[216:219], v[60:75]
 buffer_load_dwordx4 v[196:199], v0, s[8:11], s16 offen offset:1024 sc1
 ds_read_b128 v[228:231], v0 offset:41984
 v_add_f32 v14, v14, v15
 v_rcp_f32 v14, v14
 s_nop 0
 v_mov_b32 v15, v14
 v_mfma_f32_32x32x16_bf16 v[92:107], v[244:247], v[216:219], v[92:107]
 ds_read_b128 v[232:235], v0 offset:43008
 v_permlane32_swap_b32 v14, v15
 v_mul_f32 v108, v108, v14
 v_mul_f32 v109, v109, v15
 v_cvt_pk_bf16_f32 v128, v108, v109
 s_waitcnt vmcnt(6) lgkmcnt(3)
 v_mfma_f32_32x32x16_bf16 v[60:75], v[248:251], v[220:223], v[60:75]
 buffer_load_dwordx4 v[200:203], v0, s[8:11], s16 offen offset:2048 sc1
 ds_read_b128 v[236:239], v0 offset:44032
 v_mul_f32 v110, v110, v14
 v_mul_f32 v111, v111, v15
 v_cvt_pk_bf16_f32 v129, v110, v111
 v_mul_f32 v112, v112, v14
 v_mfma_f32_32x32x16_bf16 v[92:107], v[252:255], v[220:223], v[92:107]
 ds_read_b128 v[240:243], v0 offset:45056
 v_mul_f32 v113, v113, v15
 v_cvt_pk_bf16_f32 v130, v112, v113
 v_mul_f32 v114, v114, v14
 v_mul_f32 v115, v115, v15
 v_cvt_pk_bf16_f32 v131, v114, v115
 s_waitcnt vmcnt(6) lgkmcnt(3)
 v_mfma_f32_32x32x16_bf16 v[60:75], v[224:227], v[176:179], v[60:75]
 buffer_load_dwordx4 v[204:207], v0, s[8:11], s16 offen offset:3072 sc1
 s_add_u32 s16, s16, 4096
 ds_read_b128 v[244:247], v0 offset:46080
 v_mul_f32 v116, v116, v14
 v_mul_f32 v117, v117, v15
 v_cvt_pk_bf16_f32 v132, v116, v117
 v_mfma_f32_32x32x16_bf16 v[92:107], v[228:231], v[176:179], v[92:107]
 ds_read_b128 v[248:251], v0 offset:47104
 v_mul_f32 v118, v118, v14
 v_mul_f32 v119, v119, v15
 v_cvt_pk_bf16_f32 v133, v118, v119
 v_mul_f32 v120, v120, v14
 v_mul_f32 v121, v121, v15
 s_waitcnt vmcnt(6) lgkmcnt(3)
 v_mfma_f32_32x32x16_bf16 v[60:75], v[232:235], v[180:183], v[60:75]
 buffer_load_dwordx4 v[208:211], v0, s[8:11], s16 offen sc1
 ds_read_b128 v[252:255], v0 offset:48128
 v_cvt_pk_bf16_f32 v134, v120, v121
 v_mul_f32 v122, v122, v14
 v_mul_f32 v123, v123, v15
 v_cvt_pk_bf16_f32 v135, v122, v123
 v_mfma_f32_32x32x16_bf16 v[92:107], v[236:239], v[180:183], v[92:107]
 ds_read_b128 v[224:227], v0 offset:49152
 v_mul_f32 v124, v124, v14
 v_mul_f32 v125, v125, v15
 v_cvt_pk_bf16_f32 v136, v124, v125
 v_mul_f32 v126, v126, v14
 v_mul_f32 v127, v127, v15
 s_waitcnt vmcnt(6) lgkmcnt(3)
 v_mfma_f32_32x32x16_bf16 v[60:75], v[240:243], v[184:187], v[60:75]
 buffer_load_dwordx4 v[212:215], v0, s[8:11], s16 offen offset:1024 sc1
 ds_read_b128 v[228:231], v0 offset:50176
 v_cvt_pk_bf16_f32 v137, v126, v127
 v_mfma_f32_32x32x16_bf16 v[108:123], v[128:131], v[36:39], 0
 v_mfma_f32_32x32x16_bf16 v[92:107], v[244:247], v[184:187], v[92:107]
 ds_read_b128 v[232:235], v0 offset:51200
 v_mfma_f32_32x32x16_bf16 v[108:123], v[132:135], v[40:43], v[108:123]
 v_mul_f32 v54, v54, v170
 v_mul_f32 v55, v55, v170
 v_cvt_pk_bf16_f32 v138, v54, v55
 v_mul_f32 v56, v56, v170
 v_mul_f32 v57, v57, v170
 v_cvt_pk_bf16_f32 v139, v56, v57
 v_mul_f32 v58, v58, v170
 s_waitcnt vmcnt(6) lgkmcnt(3)
 v_mfma_f32_32x32x16_bf16 v[60:75], v[248:251], v[188:191], v[60:75]
 buffer_load_dwordx4 v[216:219], v0, s[8:11], s16 offen offset:2048 sc1
 ds_read_b128 v[236:239], v0 offset:52224
 v_mul_f32 v59, v59, v170
 v_cvt_pk_bf16_f32 v140, v58, v59
 v_mul_f32 v86, v86, v170
 v_mul_f32 v87, v87, v170
 v_mfma_f32_32x32x16_bf16 v[92:107], v[252:255], v[188:191], v[92:107]
 ds_read_b128 v[240:243], v0 offset:53248
 v_cvt_pk_bf16_f32 v141, v86, v87
 v_mul_f32 v88, v88, v170
 v_mul_f32 v89, v89, v170
 v_cvt_pk_bf16_f32 v142, v88, v89
 s_waitcnt vmcnt(6) lgkmcnt(3)
 v_mfma_f32_32x32x16_bf16 v[60:75], v[224:227], v[192:195], v[60:75]
 buffer_load_dwordx4 v[220:223], v0, s[8:11], s16 offen offset:3072 sc1
 s_add_u32 s16, s16, 4096
 ds_read_b128 v[244:247], v0 offset:54272
 v_mfma_f32_32x32x16_bf16 v[44:59], v[136:139], v[36:39], 0
 v_mfma_f32_32x32x16_bf16 v[92:107], v[228:231], v[192:195], v[92:107]
 ds_read_b128 v[248:251], v0 offset:55296
 v_mfma_f32_32x32x16_bf16 v[44:59], v[140:143], v[40:43], v[44:59]
 v_cvt_pk_bf16_f32 v128, v108, v109
 v_cvt_pk_bf16_f32 v129, v110, v111
 v_cvt_pk_bf16_f32 v130, v112, v113
 v_cvt_pk_bf16_f32 v131, v114, v115
 v_cvt_pk_bf16_f32 v132, v116, v117
 v_cvt_pk_bf16_f32 v133, v118, v119
 v_cvt_pk_bf16_f32 v134, v120, v121
 s_waitcnt vmcnt(6) lgkmcnt(3)
 v_mfma_f32_32x32x16_bf16 v[60:75], v[232:235], v[196:199], v[60:75]
 buffer_load_dwordx4 v[176:179], v0, s[8:11], s16 offen sc1
 ds_read_b128 v[252:255], v0 offset:56320
 v_cvt_pk_bf16_f32 v135, v122, v123
 v_mfma_f32_32x32x16_bf16 v[92:107], v[236:239], v[196:199], v[92:107]
 ds_read_b128 v[224:227], v0 offset:57344
 s_waitcnt vmcnt(6) lgkmcnt(3)
 v_mfma_f32_32x32x16_bf16 v[60:75], v[240:243], v[200:203], v[60:75]
 buffer_load_dwordx4 v[180:183], v0, s[8:11], s16 offen offset:1024 sc1
 ds_read_b128 v[228:231], v0 offset:58368
 v_cvt_pk_bf16_f32 v136, v44, v45
 v_cvt_pk_bf16_f32 v137, v46, v47
 v_cvt_pk_bf16_f32 v138, v48, v49
 v_cvt_pk_bf16_f32 v139, v50, v51
 v_mfma_f32_32x32x16_bf16 v[92:107], v[244:247], v[200:203], v[92:107]
 ds_read_b128 v[232:235], v0 offset:59392
 v_cvt_pk_bf16_f32 v140, v52, v53
 v_cvt_pk_bf16_f32 v141, v54, v55
 v_cvt_pk_bf16_f32 v142, v56, v57
 v_cvt_pk_bf16_f32 v143, v58, v59
 s_waitcnt vmcnt(6) lgkmcnt(3)
 v_mfma_f32_32x32x16_bf16 v[60:75], v[248:251], v[204:207], v[60:75]
 buffer_load_dwordx4 v[184:187], v0, s[8:11], s16 offen offset:2048 sc1
 ds_read_b128 v[236:239], v0 offset:60416
 v_mfma_f32_32x32x16_bf16 v[144:159], v[128:131], v[136:139], 0
 v_mfma_f32_32x32x16_bf16 v[92:107], v[252:255], v[204:207], v[92:107]
 ds_read_b128 v[240:243], v0 offset:61440
 v_mfma_f32_32x32x16_bf16 v[144:159], v[132:135], v[140:143], v[144:159]
 s_waitcnt vmcnt(6) lgkmcnt(3)
 v_mfma_f32_32x32x16_bf16 v[60:75], v[224:227], v[208:211], v[60:75]
 buffer_load_dwordx4 v[188:191], v0, s[8:11], s16 offen offset:3072 sc1
 s_add_u32 s16, s16, 4096
 ds_read_b128 v[244:247], v0 offset:62464
 v_mfma_f32_32x32x16_bf16 v[44:59], v[136:139], v[136:139], 0
 v_mfma_f32_32x32x16_bf16 v[92:107], v[228:231], v[208:211], v[92:107]
 ds_read_b128 v[248:251], v0 offset:63488
 v_mfma_f32_32x32x16_bf16 v[44:59], v[140:143], v[140:143], v[44:59]
 s_waitcnt vmcnt(6) lgkmcnt(3)
 v_mfma_f32_32x32x16_bf16 v[60:75], v[232:235], v[212:215], v[60:75]
 buffer_load_dwordx4 v[192:195], v0, s[8:11], s16 offen sc1
 ds_read_b128 v[252:255], v0 offset:64512
 v_mfma_f32_32x32x16_bf16 v[92:107], v[236:239], v[212:215], v[92:107]
 ds_read_b128 v[224:227], v1
 s_waitcnt vmcnt(6) lgkmcnt(3)
 v_mfma_f32_32x32x16_bf16 v[60:75], v[240:243], v[216:219], v[60:75]
 buffer_load_dwordx4 v[196:199], v0, s[8:11], s16 offen offset:1024 sc1
 ds_read_b128 v[228:231], v1 offset:1024
 v_mfma_f32_32x32x16_bf16 v[92:107], v[244:247], v[216:219], v[92:107]
 ds_read_b128 v[232:235], v1 offset:2048
 s_waitcnt vmcnt(6) lgkmcnt(3)
 v_mfma_f32_32x32x16_bf16 v[60:75], v[248:251], v[220:223], v[60:75]
 buffer_load_dwordx4 v[200:203], v0, s[8:11], s16 offen offset:2048 sc1
 ds_read_b128 v[236:239], v1 offset:3072
 v_mfma_f32_32x32x16_bf16 v[92:107], v[252:255], v[220:223], v[92:107]
 ds_read_b128 v[240:243], v1 offset:4096
 s_waitcnt vmcnt(6) lgkmcnt(3)
 v_mfma_f32_32x32x16_bf16 v[60:75], v[224:227], v[176:179], v[60:75]
 buffer_load_dwordx4 v[204:207], v0, s[8:11], s16 offen offset:3072 sc1
 s_add_u32 s16, s16, 4096
 ds_read_b128 v[244:247], v1 offset:5120
 v_mfma_f32_32x32x16_bf16 v[92:107], v[228:231], v[176:179], v[92:107]
 ds_read_b128 v[248:251], v1 offset:6144
 s_waitcnt vmcnt(6) lgkmcnt(3)
 v_mfma_f32_32x32x16_bf16 v[60:75], v[232:235], v[180:183], v[60:75]
 ds_read_b128 v[252:255], v1 offset:7168
 v_mfma_f32_32x32x16_bf16 v[92:107], v[236:239], v[180:183], v[92:107]
 ds_read_b128 v[224:227], v1 offset:8192
 s_waitcnt vmcnt(5) lgkmcnt(3)
 v_mfma_f32_32x32x16_bf16 v[60:75], v[240:243], v[184:187], v[60:75]
 ds_read_b128 v[228:231], v1 offset:9216
 v_mfma_f32_32x32x16_bf16 v[92:107], v[244:247], v[184:187], v[92:107]
 ds_read_b128 v[232:235], v1 offset:10240
 s_waitcnt vmcnt(4) lgkmcnt(3)
 v_mfma_f32_32x32x16_bf16 v[60:75], v[248:251], v[188:191], v[60:75]
 ds_read_b128 v[236:239], v1 offset:11264
 v_mfma_f32_32x32x16_bf16 v[92:107], v[252:255], v[188:191], v[92:107]
 ds_read_b128 v[240:243], v1 offset:12288
 s_waitcnt vmcnt(3) lgkmcnt(3)
 v_mfma_f32_32x32x16_bf16 v[60:75], v[224:227], v[192:195], v[60:75]
 ds_read_b128 v[244:247], v1 offset:13312
 v_mfma_f32_32x32x16_bf16 v[92:107], v[228:231], v[192:195], v[92:107]
 ds_read_b128 v[248:251], v1 offset:14336
 s_waitcnt vmcnt(2) lgkmcnt(3)
 v_mfma_f32_32x32x16_bf16 v[60:75], v[232:235], v[196:199], v[60:75]
 ds_read_b128 v[252:255], v1 offset:15360
 v_mfma_f32_32x32x16_bf16 v[92:107], v[236:239], v[196:199], v[92:107]
 s_waitcnt vmcnt(1) lgkmcnt(2)
 v_mfma_f32_32x32x16_bf16 v[60:75], v[240:243], v[200:203], v[60:75]
 v_mfma_f32_32x32x16_bf16 v[92:107], v[244:247], v[200:203], v[92:107]
 s_waitcnt vmcnt(0) lgkmcnt(0)
 v_mfma_f32_32x32x16_bf16 v[60:75], v[248:251], v[204:207], v[60:75]
 v_mfma_f32_32x32x16_bf16 v[92:107], v[252:255], v[204:207], v[92:107]
 s_nop 8
 v_mfma_f32_32x32x8_bf16 v[60:75], a[240:241], v[162:163], v[60:75]
 v_mfma_f32_32x32x8_bf16 v[92:107], a[242:243], v[162:163], v[92:107]
 v_mov_b32 v143, s60
 s_nop 9
 v_max3_f32 v12, v60, v61, v62
 buffer_load_dwordx4 v[176:179], v0, s[4:7], s18 offen sc1
 v_max3_f32 v13, -v60, -v61, -v62
 v_max3_f32 v12, v12, v63, v64
 v_max3_f32 v13, v13, -v63, -v64
 v_max3_f32 v12, v12, v65, v66
 v_max3_f32 v13, v13, -v65, -v66
 v_max3_f32 v12, v12, v67, v68
 buffer_load_dwordx4 v[180:183], v0, s[4:7], s18 offen offset:1024 sc1
 v_max3_f32 v13, v13, -v67, -v68
 v_max_f32 v12, v12, v69
 v_max_f32 v13, v13, -v69
 s_nop 1
 v_permlane32_swap_b32 v12, v13
 v_max_f32 v12, v12, v13
 v_mul_f32 v13, v12, v173
 v_mul_f32 v12, v12, v173
 buffer_load_dwordx4 v[184:187], v0, s[4:7], s18 offen offset:2048 sc1
 s_nop 0
 v_permlane32_swap_b32 v12, v13
 v_pk_fma_f32 v[108:109], v[60:61], v[172:173], v[12:13] op_sel:[0,0,0] op_sel_hi:[0,1,1]
 v_pk_fma_f32 v[110:111], v[60:61], v[172:173], v[12:13] op_sel:[1,0,0] op_sel_hi:[1,1,1]
 v_pk_fma_f32 v[112:113], v[62:63], v[172:173], v[12:13] op_sel:[0,0,0] op_sel_hi:[0,1,1]
 v_pk_fma_f32 v[114:115], v[62:63], v[172:173], v[12:13] op_sel:[1,0,0] op_sel_hi:[1,1,1]
 v_pk_fma_f32 v[116:117], v[64:65], v[172:173], v[12:13] op_sel:[0,0,0] op_sel_hi:[0,1,1]
 v_pk_fma_f32 v[118:119], v[64:65], v[172:173], v[12:13] op_sel:[1,0,0] op_sel_hi:[1,1,1]
 buffer_load_dwordx4 v[188:191], v0, s[4:7], s18 offen offset:3072 sc1
 s_add_u32 s18, s18, 4096
 v_pk_fma_f32 v[120:121], v[66:67], v[172:173], v[12:13] op_sel:[0,0,0] op_sel_hi:[0,1,1]
 v_pk_fma_f32 v[122:123], v[66:67], v[172:173], v[12:13] op_sel:[1,0,0] op_sel_hi:[1,1,1]
 v_pk_fma_f32 v[124:125], v[68:69], v[172:173], v[12:13] op_sel:[0,0,0] op_sel_hi:[0,1,1]
 v_pk_fma_f32 v[126:127], v[68:69], v[172:173], v[12:13] op_sel:[1,0,0] op_sel_hi:[1,1,1]
 v_exp_f32 v108, v108
 v_exp_f32 v109, v109
 v_exp_f32 v110, v110
 buffer_load_dwordx4 v[192:195], v0, s[4:7], s18 offen sc1
 v_exp_f32 v111, v111
 v_exp_f32 v112, v112
 v_exp_f32 v113, v113
 v_exp_f32 v114, v114
 v_exp_f32 v115, v115
 v_exp_f32 v116, v116
 v_exp_f32 v117, v117
 buffer_load_dwordx4 v[196:199], v0, s[4:7], s18 offen offset:1024 sc1
 v_exp_f32 v118, v118
 v_exp_f32 v119, v119
 v_exp_f32 v120, v120
 v_exp_f32 v121, v121
 v_exp_f32 v122, v122
 v_exp_f32 v123, v123
 v_exp_f32 v124, v124
 buffer_load_dwordx4 v[200:203], v0, s[4:7], s18 offen offset:2048 sc1
 v_exp_f32 v125, v125
 v_exp_f32 v126, v126
 v_exp_f32 v127, v127
 v_pk_add_f32 v[14:15], v[108:109], v[110:111]
 v_pk_add_f32 v[14:15], v[14:15], v[112:113]
 v_pk_add_f32 v[14:15], v[14:15], v[114:115]
 v_pk_add_f32 v[14:15], v[14:15], v[116:117]
 buffer_load_dwordx4 v[204:207], v0, s[4:7], s18 offen offset:3072 sc1
 s_add_u32 s18, s18, 4096
 v_pk_add_f32 v[14:15], v[14:15], v[118:119]
 v_pk_add_f32 v[14:15], v[14:15], v[120:121]
 v_pk_add_f32 v[14:15], v[14:15], v[122:123]
 v_pk_add_f32 v[14:15], v[14:15], v[124:125]
 v_pk_add_f32 v[14:15], v[14:15], v[126:127]
 s_nop 1
 v_permlane32_swap_b32 v14, v15
 v_add_f32 v14, v14, v15
 buffer_load_dwordx4 v[208:211], v0, s[4:7], s18 offen sc1
 v_rcp_f32 v14, v14
 s_nop 0
 v_mov_b32 v15, v14
 s_nop 1
 v_permlane32_swap_b32 v14, v15
 v_pk_mul_f32 v[108:109], v[108:109], v[14:15]
 v_cvt_pk_bf16_f32 v128, v108, v109
 v_pk_mul_f32 v[110:111], v[110:111], v[14:15]
 buffer_load_dwordx4 v[212:215], v0, s[4:7], s18 offen offset:1024 sc1
 v_cvt_pk_bf16_f32 v129, v110, v111
 v_pk_mul_f32 v[112:113], v[112:113], v[14:15]
 v_cvt_pk_bf16_f32 v130, v112, v113
 v_pk_mul_f32 v[114:115], v[114:115], v[14:15]
 v_cvt_pk_bf16_f32 v131, v114, v115
 v_pk_mul_f32 v[116:117], v[116:117], v[14:15]
 v_cvt_pk_bf16_f32 v132, v116, v117
 buffer_load_dwordx4 v[216:219], v0, s[4:7], s18 offen offset:2048 sc1
 v_pk_mul_f32 v[118:119], v[118:119], v[14:15]
 v_cvt_pk_bf16_f32 v133, v118, v119
 v_pk_mul_f32 v[120:121], v[120:121], v[14:15]
 v_cvt_pk_bf16_f32 v134, v120, v121
 v_pk_mul_f32 v[122:123], v[122:123], v[14:15]
 v_cvt_pk_bf16_f32 v135, v122, v123
 v_pk_mul_f32 v[124:125], v[124:125], v[14:15]
 buffer_load_dwordx4 v[220:223], v0, s[4:7], s18 offen offset:3072 sc1
 s_add_u32 s18, s18, 4096
 v_cvt_pk_bf16_f32 v136, v124, v125
 v_pk_mul_f32 v[126:127], v[126:127], v[14:15]
 v_cvt_pk_bf16_f32 v137, v126, v127
 v_mfma_f32_32x32x16_bf16 v[108:123], v[128:131], v[36:39], 0
 v_mfma_f32_32x32x16_bf16 v[108:123], v[132:135], v[40:43], v[108:123]
 v_mul_f32 v70, v70, v174
 v_mul_f32 v71, v71, v174
 buffer_load_dwordx4 v[224:227], v0, s[4:7], s18 offen sc1
 v_cvt_pk_bf16_f32 v138, v70, v71
 v_mul_f32 v72, v72, v174
 v_mul_f32 v73, v73, v174
 v_cvt_pk_bf16_f32 v139, v72, v73
 v_mul_f32 v74, v74, v174
 v_mul_f32 v75, v75, v174
 v_cvt_pk_bf16_f32 v140, v74, v75
 buffer_load_dwordx4 v[228:231], v0, s[4:7], s18 offen offset:1024 sc1
 v_mul_f32 v102, v102, v174
 v_mul_f32 v103, v103, v174
 v_cvt_pk_bf16_f32 v141, v102, v103
 v_mul_f32 v104, v104, v174
 v_mul_f32 v105, v105, v174
 v_cvt_pk_bf16_f32 v142, v104, v105
 v_mfma_f32_32x32x16_bf16 v[60:75], v[136:139], v[36:39], 0
 buffer_load_dwordx4 v[232:235], v0, s[4:7], s18 offen offset:2048 sc1
 v_mfma_f32_32x32x16_bf16 v[60:75], v[140:143], v[40:43], v[60:75]
 v_cvt_pk_bf16_f32 v128, v108, v109
 v_cvt_pk_bf16_f32 v129, v110, v111
 v_cvt_pk_bf16_f32 v130, v112, v113
 v_cvt_pk_bf16_f32 v131, v114, v115
 v_cvt_pk_bf16_f32 v132, v116, v117
 v_cvt_pk_bf16_f32 v133, v118, v119
 buffer_load_dwordx4 v[236:239], v0, s[4:7], s18 offen offset:3072 sc1
 s_add_u32 s18, s18, 4096
 v_cvt_pk_bf16_f32 v134, v120, v121
 v_cvt_pk_bf16_f32 v135, v122, v123
 s_nop 1
 v_cvt_pk_bf16_f32 v136, v60, v61
 v_cvt_pk_bf16_f32 v137, v62, v63
 v_cvt_pk_bf16_f32 v138, v64, v65
 v_cvt_pk_bf16_f32 v139, v66, v67
 v_cvt_pk_bf16_f32 v140, v68, v69
 v_cvt_pk_bf16_f32 v141, v70, v71
 v_cvt_pk_bf16_f32 v142, v72, v73
 v_cvt_pk_bf16_f32 v143, v74, v75
 v_mfma_f32_32x32x16_bf16 v[144:159], v[128:131], v[136:139], v[144:159]
 s_nop 0
 v_mfma_f32_32x32x16_bf16 v[144:159], v[132:135], v[140:143], v[144:159]
 v_mfma_f32_32x32x16_bf16 v[44:59], v[136:139], v[136:139], v[44:59]
 v_mfma_f32_32x32x16_bf16 v[44:59], v[140:143], v[140:143], v[44:59]
 s_lshl_b32 s33, s3, 10
 v_add_u32 v13, s33, v2
 s_lshl_b32 s33, s3, 2
 v_add_u32 v14, s33, v2
 s_add_u32 s56, s52, 10
 v_mov_b32 v131, s56
 s_nop 3
 ds_write_b128 v3, v[144:147] offset:12288
 ds_write_b128 v3, v[148:151] offset:13312
 ds_write_b128 v3, v[152:155] offset:14336
 ds_write_b128 v3, v[156:159] offset:15360
 ds_write_b128 v3, v[44:47] offset:16384
 s_waitcnt lgkmcnt(0)
 s_barrier
 ds_read_b128 v[108:111], v13 offset:12288
 ds_read_b32 v124, v14 offset:16384
 ds_read_b128 v[112:115], v13 offset:17408
 ds_read_b32 v125, v14 offset:21504
 ds_read_b128 v[116:119], v13 offset:22528
 ds_read_b32 v126, v14 offset:26624
 ds_read_b128 v[120:123], v13 offset:27648
 ds_read_b32 v127, v14 offset:31744
 s_waitcnt lgkmcnt(5)
 v_pk_add_f32 v[108:109], v[108:109], v[112:113]
 v_pk_add_f32 v[110:111], v[110:111], v[114:115]
 s_waitcnt lgkmcnt(1)
 v_pk_add_f32 v[116:117], v[116:117], v[120:121]
 v_pk_add_f32 v[118:119], v[118:119], v[122:123]
 s_waitcnt lgkmcnt(0)
 v_pk_add_f32 v[124:125], v[124:125], v[126:127]
 v_pk_add_f32 v[108:109], v[108:109], v[116:117]
 v_pk_add_f32 v[110:111], v[110:111], v[118:119]
 v_add_f32 v124, v124, v125
 v_cvt_pk_bf16_f32 v128, v108, v109
 v_cvt_pk_bf16_f32 v129, v110, v111
 v_cvt_pk_bf16_f32 v130, v124, 0
 buffer_store_dwordx4 v[128:131], v10, s[4:7], s24 offen sc1
 s_barrier
 v_max3_f32 v12, v76, v77, v78
 buffer_load_dwordx4 v[240:243], v0, s[4:7], s18 offen sc1
 v_max3_f32 v13, -v76, -v77, -v78
 v_max3_f32 v12, v12, v79, v80
 v_max3_f32 v13, v13, -v79, -v80
 v_max3_f32 v12, v12, v81, v82
 v_max3_f32 v13, v13, -v81, -v82
 v_max3_f32 v12, v12, v83, v84
 v_max3_f32 v13, v13, -v83, -v84
 v_max_f32 v12, v12, v85
 v_max_f32 v13, v13, -v85
 s_nop 1
 v_permlane32_swap_b32 v12, v13
 v_max_f32 v12, v12, v13
 v_mul_f32 v13, v12, v169
 v_mul_f32 v12, v12, v169
 s_nop 1
 v_permlane32_swap_b32 v12, v13
 v_pk_fma_f32 v[108:109], v[76:77], v[168:169], v[12:13] op_sel:[0,0,0] op_sel_hi:[0,1,1]
 buffer_load_dwordx4 v[244:247], v0, s[4:7], s18 offen offset:1024 sc1
 v_pk_fma_f32 v[110:111], v[76:77], v[168:169], v[12:13] op_sel:[1,0,0] op_sel_hi:[1,1,1]
 v_pk_fma_f32 v[112:113], v[78:79], v[168:169], v[12:13] op_sel:[0,0,0] op_sel_hi:[0,1,1]
 v_pk_fma_f32 v[114:115], v[78:79], v[168:169], v[12:13] op_sel:[1,0,0] op_sel_hi:[1,1,1]
 v_pk_fma_f32 v[116:117], v[80:81], v[168:169], v[12:13] op_sel:[0,0,0] op_sel_hi:[0,1,1]
 v_pk_fma_f32 v[118:119], v[80:81], v[168:169], v[12:13] op_sel:[1,0,0] op_sel_hi:[1,1,1]
 v_pk_fma_f32 v[120:121], v[82:83], v[168:169], v[12:13] op_sel:[0,0,0] op_sel_hi:[0,1,1]
 v_pk_fma_f32 v[122:123], v[82:83], v[168:169], v[12:13] op_sel:[1,0,0] op_sel_hi:[1,1,1]
 v_pk_fma_f32 v[124:125], v[84:85], v[168:169], v[12:13] op_sel:[0,0,0] op_sel_hi:[0,1,1]
 v_pk_fma_f32 v[126:127], v[84:85], v[168:169], v[12:13] op_sel:[1,0,0] op_sel_hi:[1,1,1]
 v_exp_f32 v108, v108
 v_exp_f32 v109, v109
 v_exp_f32 v110, v110
 v_exp_f32 v111, v111
 v_exp_f32 v112, v112
 v_exp_f32 v113, v113
 buffer_load_dwordx4 v[248:251], v0, s[4:7], s18 offen offset:2048 sc1
 v_exp_f32 v114, v114
 v_exp_f32 v115, v115
 v_exp_f32 v116, v116
 v_exp_f32 v117, v117
 v_exp_f32 v118, v118
 v_exp_f32 v119, v119
 v_exp_f32 v120, v120
 v_exp_f32 v121, v121
 v_exp_f32 v122, v122
 v_exp_f32 v123, v123
 v_exp_f32 v124, v124
 v_exp_f32 v125, v125
 v_exp_f32 v126, v126
 v_exp_f32 v127, v127
 v_pk_add_f32 v[14:15], v[108:109], v[110:111]
 v_pk_add_f32 v[14:15], v[14:15], v[112:113]
 buffer_load_dwordx4 v[252:255], v0, s[4:7], s18 offen offset:3072 sc1
 s_add_u32 s18, s18, 4096
 v_pk_add_f32 v[14:15], v[14:15], v[114:115]
 v_pk_add_f32 v[14:15], v[14:15], v[116:117]
 v_pk_add_f32 v[14:15], v[14:15], v[118:119]
 v_pk_add_f32 v[14:15], v[14:15], v[120:121]
 v_pk_add_f32 v[14:15], v[14:15], v[122:123]
 v_pk_add_f32 v[14:15], v[14:15], v[124:125]
 v_pk_add_f32 v[14:15], v[14:15], v[126:127]
 s_nop 1
 v_permlane32_swap_b32 v14, v15
 v_add_f32 v14, v14, v15
 v_rcp_f32 v14, v14
 s_nop 0
 v_mov_b32 v15, v14
 s_nop 1
 v_permlane32_swap_b32 v14, v15
 v_pk_mul_f32 v[108:109], v[108:109], v[14:15]
 v_cvt_pk_bf16_f32 v76, v108, v109
 v_pk_mul_f32 v[110:111], v[110:111], v[14:15]
 buffer_load_dwordx4 v[144:147], v0, s[4:7], s18 offen sc1
 v_cvt_pk_bf16_f32 v77, v110, v111
 v_pk_mul_f32 v[112:113], v[112:113], v[14:15]
 v_cvt_pk_bf16_f32 v78, v112, v113
 v_pk_mul_f32 v[114:115], v[114:115], v[14:15]
 v_cvt_pk_bf16_f32 v79, v114, v115
 v_pk_mul_f32 v[116:117], v[116:117], v[14:15]
 v_cvt_pk_bf16_f32 v80, v116, v117
 v_pk_mul_f32 v[118:119], v[118:119], v[14:15]
 v_cvt_pk_bf16_f32 v81, v118, v119
 v_pk_mul_f32 v[120:121], v[120:121], v[14:15]
 v_cvt_pk_bf16_f32 v82, v120, v121
 v_pk_mul_f32 v[122:123], v[122:123], v[14:15]
 v_cvt_pk_bf16_f32 v83, v122, v123
 v_pk_mul_f32 v[124:125], v[124:125], v[14:15]
 v_cvt_pk_bf16_f32 v84, v124, v125
 buffer_load_dwordx4 v[148:151], v0, s[4:7], s18 offen offset:1024 sc1
 v_pk_mul_f32 v[126:127], v[126:127], v[14:15]
 v_cvt_pk_bf16_f32 v85, v126, v127
 v_max3_f32 v12, v92, v93, v94
 v_max3_f32 v13, -v92, -v93, -v94
 v_max3_f32 v12, v12, v95, v96
 v_max3_f32 v13, v13, -v95, -v96
 v_max3_f32 v12, v12, v97, v98
 v_max3_f32 v13, v13, -v97, -v98
 v_max3_f32 v12, v12, v99, v100
 v_max3_f32 v13, v13, -v99, -v100
 v_max_f32 v12, v12, v101
 v_max_f32 v13, v13, -v101
 s_nop 1
 v_permlane32_swap_b32 v12, v13
 v_max_f32 v12, v12, v13
 v_mul_f32 v13, v12, v173
 v_mul_f32 v12, v12, v173
 buffer_load_dwordx4 v[152:155], v0, s[4:7], s18 offen offset:2048 sc1
 s_nop 0
 v_permlane32_swap_b32 v12, v13
 v_pk_fma_f32 v[108:109], v[92:93], v[172:173], v[12:13] op_sel:[0,0,0] op_sel_hi:[0,1,1]
 v_pk_fma_f32 v[110:111], v[92:93], v[172:173], v[12:13] op_sel:[1,0,0] op_sel_hi:[1,1,1]
 v_pk_fma_f32 v[112:113], v[94:95], v[172:173], v[12:13] op_sel:[0,0,0] op_sel_hi:[0,1,1]
 v_pk_fma_f32 v[114:115], v[94:95], v[172:173], v[12:13] op_sel:[1,0,0] op_sel_hi:[1,1,1]
 v_pk_fma_f32 v[116:117], v[96:97], v[172:173], v[12:13] op_sel:[0,0,0] op_sel_hi:[0,1,1]
 v_pk_fma_f32 v[118:119], v[96:97], v[172:173], v[12:13] op_sel:[1,0,0] op_sel_hi:[1,1,1]
 v_pk_fma_f32 v[120:121], v[98:99], v[172:173], v[12:13] op_sel:[0,0,0] op_sel_hi:[0,1,1]
 v_pk_fma_f32 v[122:123], v[98:99], v[172:173], v[12:13] op_sel:[1,0,0] op_sel_hi:[1,1,1]
 v_pk_fma_f32 v[124:125], v[100:101], v[172:173], v[12:13] op_sel:[0,0,0] op_sel_hi:[0,1,1]
 v_pk_fma_f32 v[126:127], v[100:101], v[172:173], v[12:13] op_sel:[1,0,0] op_sel_hi:[1,1,1]
 v_exp_f32 v108, v108
 v_exp_f32 v109, v109
 v_exp_f32 v110, v110
 v_exp_f32 v111, v111
 buffer_load_dwordx4 v[156:159], v0, s[4:7], s18 offen offset:3072 sc1
 s_add_u32 s18, s18, 4096
 v_exp_f32 v112, v112
 v_exp_f32 v113, v113
 v_exp_f32 v114, v114
 v_exp_f32 v115, v115
 v_exp_f32 v116, v116
 v_exp_f32 v117, v117
 v_exp_f32 v118, v118
 v_exp_f32 v119, v119
 v_exp_f32 v120, v120
 v_exp_f32 v121, v121
 v_exp_f32 v122, v122
 v_exp_f32 v123, v123
 v_exp_f32 v124, v124
 v_exp_f32 v125, v125
 v_exp_f32 v126, v126
 buffer_load_dwordx4 v[160:163], v0, s[4:7], s18 offen sc1
 v_exp_f32 v127, v127
 v_pk_add_f32 v[14:15], v[108:109], v[110:111]
 v_pk_add_f32 v[14:15], v[14:15], v[112:113]
 v_pk_add_f32 v[14:15], v[14:15], v[114:115]
 v_pk_add_f32 v[14:15], v[14:15], v[116:117]
 v_pk_add_f32 v[14:15], v[14:15], v[118:119]
 v_pk_add_f32 v[14:15], v[14:15], v[120:121]
 v_pk_add_f32 v[14:15], v[14:15], v[122:123]
 v_pk_add_f32 v[14:15], v[14:15], v[124:125]
 v_pk_add_f32 v[14:15], v[14:15], v[126:127]
 s_nop 1
 v_permlane32_swap_b32 v14, v15
 v_add_f32 v14, v14, v15
 v_rcp_f32 v14, v14
 s_nop 0
 v_mov_b32 v15, v14
 s_nop 1
 v_permlane32_swap_b32 v14, v15
 v_pk_mul_f32 v[108:109], v[108:109], v[14:15]
 v_cvt_pk_bf16_f32 v92, v108, v109
 v_pk_mul_f32 v[110:111], v[110:111], v[14:15]
 v_cvt_pk_bf16_f32 v93, v110, v111
 v_pk_mul_f32 v[112:113], v[112:113], v[14:15]
 v_cvt_pk_bf16_f32 v94, v112, v113
 v_pk_mul_f32 v[114:115], v[114:115], v[14:15]
 v_cvt_pk_bf16_f32 v95, v114, v115
 v_pk_mul_f32 v[116:117], v[116:117], v[14:15]
 v_cvt_pk_bf16_f32 v96, v116, v117
 v_pk_mul_f32 v[118:119], v[118:119], v[14:15]
 v_cvt_pk_bf16_f32 v97, v118, v119
 v_pk_mul_f32 v[120:121], v[120:121], v[14:15]
 v_cvt_pk_bf16_f32 v98, v120, v121
 v_pk_mul_f32 v[122:123], v[122:123], v[14:15]
 v_cvt_pk_bf16_f32 v99, v122, v123
 v_pk_mul_f32 v[124:125], v[124:125], v[14:15]
 v_cvt_pk_bf16_f32 v100, v124, v125
 v_pk_mul_f32 v[126:127], v[126:127], v[14:15]
 v_cvt_pk_bf16_f32 v101, v126, v127
 s_lshr_b32 s33, s3, 1
 s_lshl_b32 s33, s33, 10
 s_and_b32 s34, s3, 1
 s_lshl_b32 s34, s34, 3
 s_add_u32 s33, s33, s34
 v_add_u32 v118, s33, v2
 v_lshrrev_b32 v119, 1, v0
 v_add_u32 v119, 145408, v119
 s_lshl_b32 s33, s3, 1
 v_add_u32 v120, s33, v119
 s_mov_b32 s55, 0
Lkv_59:
 buffer_load_dwordx4 v[44:47], v11, s[4:7], s25 offen sc1
 buffer_load_dwordx4 v[48:51], v11, s[4:7], s26 offen sc1
 buffer_load_dwordx4 v[52:55], v11, s[4:7], s27 offen sc1
 buffer_load_dwordx4 v[56:59], v11, s[4:7], s28 offen sc1
 buffer_load_dwordx4 v[60:63], v11, s[4:7], s29 offen sc1
 buffer_load_dwordx4 v[64:67], v11, s[4:7], s30 offen sc1
 buffer_load_dwordx4 v[68:71], v11, s[4:7], s31 offen sc1
 s_add_u32 s55, s55, 1
 s_cmp_gt_u32 s55, 0x40000
 s_cbranch_scc1 Lend
 v_lshlrev_b32 v108, 16, v128
 v_and_b32 v109, 0xffff0000, v128
 v_lshlrev_b32 v110, 16, v129
 v_and_b32 v111, 0xffff0000, v129
 v_lshlrev_b32 v112, 16, v130
 v_mov_b32 v12, 0
 s_waitcnt vmcnt(6)
 v_dot2c_f32_bf16 v108, s60, v44
 v_dot2c_f32_bf16 v109, s61, v44
 v_dot2c_f32_bf16 v110, s60, v45
 v_dot2c_f32_bf16 v111, s61, v45
 v_dot2c_f32_bf16 v112, s60, v46
 v_bitop3_b32 v12, v12, v47, s56 bitop3:0xf6
 s_waitcnt vmcnt(5)
 v_dot2c_f32_bf16 v108, s60, v48
 v_dot2c_f32_bf16 v109, s61, v48
 v_dot2c_f32_bf16 v110, s60, v49
 v_dot2c_f32_bf16 v111, s61, v49
 v_dot2c_f32_bf16 v112, s60, v50
 v_bitop3_b32 v12, v12, v51, s56 bitop3:0xf6
 s_waitcnt vmcnt(4)
 v_dot2c_f32_bf16 v108, s60, v52
 v_dot2c_f32_bf16 v109, s61, v52
 v_dot2c_f32_bf16 v110, s60, v53
 v_dot2c_f32_bf16 v111, s61, v53
 v_dot2c_f32_bf16 v112, s60, v54
 v_bitop3_b32 v12, v12, v55, s56 bitop3:0xf6
 s_waitcnt vmcnt(3)
 v_dot2c_f32_bf16 v108, s60, v56
 v_dot2c_f32_bf16 v109, s61, v56
 v_dot2c_f32_bf16 v110, s60, v57
 v_dot2c_f32_bf16 v111, s61, v57
 v_dot2c_f32_bf16 v112, s60, v58
 v_bitop3_b32 v12, v12, v59, s56 bitop3:0xf6
 s_waitcnt vmcnt(2)
 v_dot2c_f32_bf16 v108, s60, v60
 v_dot2c_f32_bf16 v109, s61, v60
 v_dot2c_f32_bf16 v110, s60, v61
 v_dot2c_f32_bf16 v111, s61, v61
 v_dot2c_f32_bf16 v112, s60, v62
 v_bitop3_b32 v12, v12, v63, s56 bitop3:0xf6
 s_waitcnt vmcnt(1)
 v_dot2c_f32_bf16 v108, s60, v64
 v_dot2c_f32_bf16 v109, s61, v64
 v_dot2c_f32_bf16 v110, s60, v65
 v_dot2c_f32_bf16 v111, s61, v65
 v_dot2c_f32_bf16 v112, s60, v66
 v_bitop3_b32 v12, v12, v67, s56 bitop3:0xf6
 s_waitcnt vmcnt(0)
 v_dot2c_f32_bf16 v108, s60, v68
 v_dot2c_f32_bf16 v109, s61, v68
 v_dot2c_f32_bf16 v110, s60, v69
 v_dot2c_f32_bf16 v111, s61, v69
 v_dot2c_f32_bf16 v112, s60, v70
 v_bitop3_b32 v12, v12, v71, s56 bitop3:0xf6
 v_cmp_ne_u32 vcc, 0, v12
 s_cbranch_vccnz Lkv_59
 v_cvt_pk_bf16_f32 v114, v108, v109
 v_cvt_pk_bf16_f32 v115, v110, v111
 v_cvt_pk_bf16_f32 v116, v112, v112
 ds_write_b64 v118, v[114:115] offset:12288
 ds_write_b16 v120, v116
 s_mul_i32 s24, s53, 196608
 s_add_u32 s24, s24, 18350080
 s_mul_i32 s25, s3, 5120
 s_add_u32 s24, s24, s25
 s_lshr_b32 s26, s3, 1
 s_mul_i32 s26, s26, 20480
 s_add_u32 s25, s24, 20480
 s_sub_u32 s25, s25, s26
 s_waitcnt lgkmcnt(0)
 s_barrier
 ds_read_b64 v[136:137], v119
 ds_read_b128 v[128:131], v2 offset:12288
 ds_read_b128 v[132:135], v2 offset:13312
 s_add_u32 s24, s24, s26
 s_add_u32 s26, s24, 40960
 s_add_u32 s27, s25, 40960
 s_lshl_b32 s28, s53, 7
 s_add_u32 s28, s28, 7737344
 s_lshl_b32 s62, s3, 5
 s_add_u32 s28, s28, s62
 v_lshrrev_b32 v172, 2, v0
 v_and_b32 v171, 28, v172
 v_and_b32 v172, 124, v172
 s_waitcnt lgkmcnt(2)
 v_mfma_f32_32x32x8_bf16 v[44:59], v[136:137], v[84:85], 0
 v_mfma_f32_32x32x8_bf16 v[60:75], v[136:137], v[100:101], 0
 s_waitcnt lgkmcnt(1)
 s_nop 7
 v_mfma_f32_32x32x16_bf16 v[44:59], v[128:131], v[76:79], v[44:59]
 s_waitcnt lgkmcnt(0)
 v_mfma_f32_32x32x16_bf16 v[44:59], v[132:135], v[80:83], v[44:59]
 v_mfma_f32_32x32x16_bf16 v[60:75], v[128:131], v[92:95], v[60:75]
 v_mfma_f32_32x32x16_bf16 v[60:75], v[132:135], v[96:99], v[60:75]
 s_nop 9
 v_add_f32 v58, 0x358637bd, v58
 v_rcp_f32 v58, v58
 s_nop 0
 v_mul_f32 v48, v48, v58
 v_mul_f32 v49, v49, v58
 v_mul_f32 v50, v50, v58
 v_mul_f32 v51, v51, v58
 v_mul_f32 v52, v52, v58
 v_mul_f32 v53, v53, v58
 v_mul_f32 v54, v54, v58
 v_mul_f32 v55, v55, v58
 v_mul_f32 v56, v56, v58
 v_mul_f32 v57, v57, v58
 v_cvt_pk_bf16_f32 v108, v48, v49
 v_cvt_pk_bf16_f32 v109, v50, v51
 v_cvt_pk_bf16_f32 v110, v52, v53
 v_cvt_pk_bf16_f32 v111, v54, v55
 v_cvt_pk_bf16_f32 v116, v56, v57
 buffer_store_dwordx4 v[108:111], v8, s[4:7], s20 offen sc1
 v_add_f32 v74, 0x358637bd, v74
 v_rcp_f32 v74, v74
 s_nop 0
 v_pk_mul_f32 v[64:65], v[64:65], v[74:75] op_sel_hi:[1,0]
 v_pk_mul_f32 v[66:67], v[66:67], v[74:75] op_sel_hi:[1,0]
 v_pk_mul_f32 v[68:69], v[68:69], v[74:75] op_sel_hi:[1,0]
 v_pk_mul_f32 v[70:71], v[70:71], v[74:75] op_sel_hi:[1,0]
 v_pk_mul_f32 v[72:73], v[72:73], v[74:75] op_sel_hi:[1,0]
 v_cvt_pk_bf16_f32 v112, v64, v65
 v_cvt_pk_bf16_f32 v113, v66, v67
 v_cvt_pk_bf16_f32 v114, v68, v69
 v_cvt_pk_bf16_f32 v115, v70, v71
 v_cvt_pk_bf16_f32 v117, v72, v73
 buffer_store_dwordx4 v[112:115], v8, s[4:7], s21 offen sc1
 s_nop 0
 v_permlane32_swap_b32 v116, v117
 buffer_store_dwordx2 v[116:117], v9, s[4:7], s22 offen sc1
 s_mul_i32 s29, s53, 81920
 s_lshl_b32 s30, s58, 1
 s_add_u32 s30, s30, s59
 s_lshr_b32 s62, s3, 1
 s_mul_i32 s62, s62, 20224
 s_lshl_b32 s63, s3, 7
 s_add_u32 s62, s62, s63
 s_add_u32 s62, s62, 0
 v_bfe_u32 v168, v0, 4, 3
 v_mul_u32_u24 v168, 16, v168
 v_bfe_u32 v14, v0, 7, 1
 v_lshl_add_u32 v168, v14, 10, v168
 v_bfe_u32 v14, v0, 8, 2
 v_lshl_add_u32 v168, v14, 8, v168
 v_bfe_u32 v169, v0, 4, 3
 v_mul_u32_u24 v169, 16, v169
 v_bfe_u32 v14, v0, 7, 1
 v_lshl_add_u32 v169, v14, 2, v169
 v_bfe_u32 v14, v0, 8, 1
 v_lshl_add_u32 v169, v14, 3, v169
 v_bfe_u32 v14, v0, 9, 1
 v_lshl_add_u32 v169, v14, 8, v169
 s_add_u32 s29, s29, s62
 s_lshl_b32 s30, s30, 9
 s_add_u32 s30, s30, s29
 s_lshl_b32 s62, s57, 10
 s_add_u32 s29, s29, s62
 v_bfe_u32 v170, v0, 4, 3
 v_mul_u32_u24 v170, 16, v170
 v_bfe_u32 v14, v0, 7, 1
 v_lshl_add_u32 v170, v14, 30, v170
 v_bfe_u32 v14, v0, 8, 1
 v_lshl_add_u32 v170, v14, 29, v170
 v_bfe_u32 v14, v0, 9, 1
 v_lshl_add_u32 v170, v14, 9, v170
 s_lshl_b32 s31, s53, 2
 s_lshr_b32 s62, s3, 1
 s_add_u32 s31, s31, s62
 s_lshl_b32 s31, s31, 2
 s_lshr_b32 s62, s51, 2
 s_add_u32 s31, s31, s62
 s_lshl_b32 s31, s31, 1
 s_and_b32 s62, s3, 1
 s_add_u32 s31, s31, s62
 s_lshl_b32 s31, s31, 5
 s_and_b32 s62, s51, 3
 s_add_u32 s31, s31, s62
 s_lshl_b32 s31, s31, 2
 s_add_u32 s31, s31, 24641536
 s_lshl_b32 s32, s53, 3
 s_add_u32 s32, s32, s51
 s_lshl_b32 s32, s32, 2
 s_add_u32 s32, s32, s3
 s_lshl_b32 s32, s32, 2
 s_add_u32 s32, s32, 7733248
 v_mov_b32 v12, 5
 v_add_u32 v12, s52, v12
 s_waitcnt vmcnt(0)
 s_mov_b64 exec, 1
 buffer_store_dword v12, v0, s[4:7], s23 offen sc1
 s_mov_b64 exec, -1
 s_add_u32 s56, s52, 5
 s_mov_b32 s55, 0
Lpoll_60:
 buffer_load_dword v12, v171, s[4:7], s28 offen sc1
 s_add_u32 s55, s55, 1
 s_cmp_gt_u32 s55, 0x80000
 s_cbranch_scc1 Lend
 s_waitcnt vmcnt(0)
 v_cmp_ne_u32 vcc, s56, v12
 s_cbranch_vccnz Lpoll_60
 buffer_load_dwordx4 v[44:47], v0, s[4:7], s24 offen sc1
 buffer_load_dwordx4 v[48:51], v0, s[4:7], s24 offen offset:1024 sc1
 buffer_load_dwordx4 v[52:55], v0, s[4:7], s24 offen offset:2048 sc1
 buffer_load_dwordx4 v[56:59], v0, s[4:7], s24 offen offset:3072 sc1
 s_add_u32 s24, s24, 4096
 buffer_load_dwordx4 v[60:63], v0, s[4:7], s24 offen sc1
 s_mul_i32 s16, s54, 81920
 s_add_u32 s16, s16, 0
 s_add_u32 s17, s16, 20480
 s_add_u32 s18, s16, 40960
 s_add_u32 s19, s16, 61440
 s_lshl_b32 s20, s54, 12
 s_add_u32 s20, s20, 24641536
 s_waitcnt vmcnt(4)
 v_mfma_f32_16x16x32_bf16 v[84:87], v[176:179], v[44:47], 0
 buffer_load_dwordx4 v[64:67], v0, s[4:7], s25 offen sc1
 v_mfma_f32_16x16x32_bf16 v[88:91], v[180:183], v[44:47], 0
 v_mfma_f32_16x16x32_bf16 v[92:95], v[184:187], v[44:47], 0
 v_mfma_f32_16x16x32_bf16 v[96:99], v[188:191], v[44:47], 0
 v_mfma_f32_16x16x32_bf16 v[100:103], v[192:195], v[44:47], 0
 s_waitcnt vmcnt(4)
 v_mfma_f32_16x16x32_bf16 v[84:87], v[196:199], v[48:51], v[84:87]
 buffer_load_dwordx4 v[68:71], v0, s[4:7], s25 offen offset:1024 sc1
 v_mfma_f32_16x16x32_bf16 v[88:91], v[200:203], v[48:51], v[88:91]
 v_mfma_f32_16x16x32_bf16 v[92:95], v[204:207], v[48:51], v[92:95]
 v_mfma_f32_16x16x32_bf16 v[96:99], v[208:211], v[48:51], v[96:99]
 v_mfma_f32_16x16x32_bf16 v[100:103], v[212:215], v[48:51], v[100:103]
 s_waitcnt vmcnt(4)
 v_mfma_f32_16x16x32_bf16 v[84:87], v[216:219], v[52:55], v[84:87]
 buffer_load_dwordx4 v[72:75], v0, s[4:7], s25 offen offset:2048 sc1
 v_mfma_f32_16x16x32_bf16 v[88:91], v[220:223], v[52:55], v[88:91]
 v_mfma_f32_16x16x32_bf16 v[92:95], v[224:227], v[52:55], v[92:95]
 v_mfma_f32_16x16x32_bf16 v[96:99], v[228:231], v[52:55], v[96:99]
 v_mfma_f32_16x16x32_bf16 v[100:103], v[232:235], v[52:55], v[100:103]
 s_waitcnt vmcnt(4)
 v_mfma_f32_16x16x32_bf16 v[84:87], v[236:239], v[56:59], v[84:87]
 buffer_load_dwordx4 v[76:79], v0, s[4:7], s25 offen offset:3072 sc1
 s_add_u32 s25, s25, 4096
 v_mfma_f32_16x16x32_bf16 v[88:91], v[240:243], v[56:59], v[88:91]
 v_mfma_f32_16x16x32_bf16 v[92:95], v[244:247], v[56:59], v[92:95]
 v_mfma_f32_16x16x32_bf16 v[96:99], v[248:251], v[56:59], v[96:99]
 v_mfma_f32_16x16x32_bf16 v[100:103], v[252:255], v[56:59], v[100:103]
 s_waitcnt vmcnt(4)
 v_mfma_f32_16x16x32_bf16 v[84:87], v[144:147], v[60:63], v[84:87]
 buffer_load_dwordx4 v[80:83], v0, s[4:7], s25 offen sc1
 v_mfma_f32_16x16x32_bf16 v[88:91], v[148:151], v[60:63], v[88:91]
 v_mfma_f32_16x16x32_bf16 v[92:95], v[152:155], v[60:63], v[92:95]
 v_mfma_f32_16x16x32_bf16 v[96:99], v[156:159], v[60:63], v[96:99]
 v_mfma_f32_16x16x32_bf16 v[100:103], v[160:163], v[60:63], v[100:103]
 s_waitcnt vmcnt(4)
 v_mfma_f32_16x16x32_bf16 v[104:107], v[176:179], v[64:67], 0
 buffer_load_dwordx4 v[44:47], v0, s[4:7], s26 offen sc1
 v_mfma_f32_16x16x32_bf16 v[108:111], v[180:183], v[64:67], 0
 s_waitcnt lgkmcnt(0)
 s_barrier
 v_mfma_f32_16x16x32_bf16 v[112:115], v[184:187], v[64:67], 0
 ds_write_b128 v3, v[84:87] offset:12288
 v_mfma_f32_16x16x32_bf16 v[116:119], v[188:191], v[64:67], 0
 v_mfma_f32_16x16x32_bf16 v[120:123], v[192:195], v[64:67], 0
 s_waitcnt vmcnt(4)
 v_mfma_f32_16x16x32_bf16 v[104:107], v[196:199], v[68:71], v[104:107]
 buffer_load_dwordx4 v[48:51], v0, s[4:7], s26 offen offset:1024 sc1
 v_mfma_f32_16x16x32_bf16 v[108:111], v[200:203], v[68:71], v[108:111]
 ds_write_b128 v3, v[88:91] offset:13312
 v_mfma_f32_16x16x32_bf16 v[112:115], v[204:207], v[68:71], v[112:115]
 v_mfma_f32_16x16x32_bf16 v[116:119], v[208:211], v[68:71], v[116:119]
 ds_write_b128 v3, v[92:95] offset:14336
 v_mfma_f32_16x16x32_bf16 v[120:123], v[212:215], v[68:71], v[120:123]
 s_waitcnt vmcnt(4)
 v_mfma_f32_16x16x32_bf16 v[104:107], v[216:219], v[72:75], v[104:107]
 buffer_load_dwordx4 v[52:55], v0, s[4:7], s26 offen offset:2048 sc1
 v_mfma_f32_16x16x32_bf16 v[108:111], v[220:223], v[72:75], v[108:111]
 ds_write_b128 v3, v[96:99] offset:15360
 v_mfma_f32_16x16x32_bf16 v[112:115], v[224:227], v[72:75], v[112:115]
 v_mfma_f32_16x16x32_bf16 v[116:119], v[228:231], v[72:75], v[116:119]
 ds_write_b128 v3, v[100:103] offset:16384
 v_mfma_f32_16x16x32_bf16 v[120:123], v[232:235], v[72:75], v[120:123]
 s_waitcnt vmcnt(4)
 v_mfma_f32_16x16x32_bf16 v[104:107], v[236:239], v[76:79], v[104:107]
 buffer_load_dwordx4 v[56:59], v0, s[4:7], s26 offen offset:3072 sc1
 s_add_u32 s26, s26, 4096
 v_mfma_f32_16x16x32_bf16 v[108:111], v[240:243], v[76:79], v[108:111]
 v_mfma_f32_16x16x32_bf16 v[112:115], v[244:247], v[76:79], v[112:115]
 v_mfma_f32_16x16x32_bf16 v[116:119], v[248:251], v[76:79], v[116:119]
 s_waitcnt lgkmcnt(0)
 s_barrier
 v_mfma_f32_16x16x32_bf16 v[120:123], v[252:255], v[76:79], v[120:123]
 ds_read_b128 v[124:127], v5 offset:12288
 s_waitcnt vmcnt(4)
 v_mfma_f32_16x16x32_bf16 v[104:107], v[144:147], v[80:83], v[104:107]
 ds_read_b128 v[128:131], v5 offset:13312
 buffer_load_dwordx4 v[60:63], v0, s[4:7], s26 offen sc1
 v_mfma_f32_16x16x32_bf16 v[108:111], v[148:151], v[80:83], v[108:111]
 ds_read_b64 v[132:133], v6 offset:16384
 v_mfma_f32_16x16x32_bf16 v[112:115], v[152:155], v[80:83], v[112:115]
 ds_read_b128 v[134:137], v5 offset:17408
 v_mfma_f32_16x16x32_bf16 v[116:119], v[156:159], v[80:83], v[116:119]
 ds_read_b128 v[138:141], v5 offset:18432
 v_mfma_f32_16x16x32_bf16 v[120:123], v[160:163], v[80:83], v[120:123]
 ds_read_b64 v[142:143], v6 offset:21504
 s_waitcnt lgkmcnt(0)
 s_barrier
 ds_write_b128 v4, v[104:107] offset:12288
 v_pk_add_f32 v[16:17], v[16:17], v[124:125]
 v_pk_add_f32 v[18:19], v[18:19], v[126:127]
 v_pk_add_f32 v[20:21], v[20:21], v[128:129]
 ds_write_b128 v4, v[108:111] offset:13312
 v_pk_add_f32 v[22:23], v[22:23], v[130:131]
 v_pk_add_f32 v[24:25], v[24:25], v[132:133]
 v_pk_add_f32 v[16:17], v[16:17], v[134:135]
 ds_write_b128 v4, v[112:115] offset:14336
 v_pk_add_f32 v[18:19], v[18:19], v[136:137]
 v_pk_add_f32 v[20:21], v[20:21], v[138:139]
 v_pk_add_f32 v[22:23], v[22:23], v[140:141]
 ds_write_b128 v4, v[116:119] offset:15360
 v_pk_add_f32 v[24:25], v[24:25], v[142:143]
 buffer_load_dwordx4 v[64:67], v0, s[4:7], s27 offen sc1
 buffer_load_dwordx4 v[68:71], v0, s[4:7], s27 offen offset:1024 sc1
 ds_write_b128 v4, v[120:123] offset:16384
 buffer_load_dwordx4 v[72:75], v0, s[4:7], s27 offen offset:2048 sc1
 buffer_load_dwordx4 v[76:79], v0, s[4:7], s27 offen offset:3072 sc1
 s_add_u32 s27, s27, 4096
 buffer_load_dwordx4 v[80:83], v0, s[4:7], s27 offen sc1
 s_waitcnt lgkmcnt(0)
 s_barrier
 ds_read_b128 v[124:127], v5 offset:12288
 ds_read_b128 v[128:131], v5 offset:13312
 ds_read_b64 v[132:133], v6 offset:16384
 ds_read_b128 v[134:137], v5 offset:17408
 ds_read_b128 v[138:141], v5 offset:18432
 ds_read_b64 v[142:143], v6 offset:21504
 s_waitcnt lgkmcnt(5)
 v_pk_add_f32 v[16:17], v[16:17], v[124:125]
 v_pk_add_f32 v[18:19], v[18:19], v[126:127]
 s_waitcnt lgkmcnt(4)
 v_pk_add_f32 v[20:21], v[20:21], v[128:129]
 v_pk_add_f32 v[22:23], v[22:23], v[130:131]
 s_waitcnt lgkmcnt(3)
 v_pk_add_f32 v[24:25], v[24:25], v[132:133]
 s_waitcnt lgkmcnt(2)
 v_pk_add_f32 v[16:17], v[16:17], v[134:135]
 v_pk_add_f32 v[18:19], v[18:19], v[136:137]
 s_waitcnt lgkmcnt(1)
 v_pk_add_f32 v[20:21], v[20:21], v[138:139]
 v_pk_add_f32 v[22:23], v[22:23], v[140:141]
 s_waitcnt lgkmcnt(0)
 v_pk_add_f32 v[24:25], v[24:25], v[142:143]
 v_cvt_pk_bf16_f32 v124, v16, v17
 v_cvt_pk_bf16_f32 v125, v18, v19
 v_cvt_pk_bf16_f32 v126, v20, v21
 v_cvt_pk_bf16_f32 v127, v22, v23
 v_cvt_pk_bf16_f32 v128, v24, v25
 buffer_store_dwordx4 v[124:127], v168, s[8:11], s29 offen sc1
 buffer_store_dword v128, v169, s[8:11], s30 offen sc1
 v_pk_add_f32 v[130:131], v[16:17], v[18:19]
 v_pk_mul_f32 v[132:133], v[16:17], v[16:17]
 v_pk_fma_f32 v[132:133], v[18:19], v[18:19], v[132:133]
 v_pk_add_f32 v[130:131], v[130:131], v[20:21]
 v_pk_fma_f32 v[132:133], v[20:21], v[20:21], v[132:133]
 v_pk_add_f32 v[130:131], v[130:131], v[22:23]
 v_pk_fma_f32 v[132:133], v[22:23], v[22:23], v[132:133]
 v_pk_add_f32 v[130:131], v[130:131], v[24:25]
 v_pk_fma_f32 v[132:133], v[24:25], v[24:25], v[132:133]
 v_add_f32 v130, v130, v131
 v_add_f32 v132, v132, v133
 s_nop 1
 v_permlane32_swap_b32 v130, v132
 v_add_f32 v131, v130, v132
 v_add_f32 v130, v130, v132
 s_nop 1
 v_permlane16_swap_b32 v130, v131
 v_add_f32 v130, v130, v131
 s_nop 1
 v_add_f32_dpp v130, v130, v130 row_ror:8 row_mask:0xf bank_mask:0xf
 buffer_store_dword v130, v170, s[4:7], s31 offen sc1
 s_add_u32 s29, s29, 40960
 s_add_u32 s30, s30, 40960
 s_add_u32 s31, s31, 2048
 s_waitcnt vmcnt(12)
 v_mfma_f32_16x16x32_bf16 v[84:87], v[176:179], v[44:47], 0
 v_mfma_f32_16x16x32_bf16 v[88:91], v[180:183], v[44:47], 0
 v_mfma_f32_16x16x32_bf16 v[92:95], v[184:187], v[44:47], 0
 v_mfma_f32_16x16x32_bf16 v[96:99], v[188:191], v[44:47], 0
 v_mfma_f32_16x16x32_bf16 v[100:103], v[192:195], v[44:47], 0
 s_waitcnt vmcnt(11)
 v_mfma_f32_16x16x32_bf16 v[84:87], v[196:199], v[48:51], v[84:87]
 v_mfma_f32_16x16x32_bf16 v[88:91], v[200:203], v[48:51], v[88:91]
 v_mfma_f32_16x16x32_bf16 v[92:95], v[204:207], v[48:51], v[92:95]
 v_mfma_f32_16x16x32_bf16 v[96:99], v[208:211], v[48:51], v[96:99]
 v_mfma_f32_16x16x32_bf16 v[100:103], v[212:215], v[48:51], v[100:103]
 s_waitcnt vmcnt(10)
 v_mfma_f32_16x16x32_bf16 v[84:87], v[216:219], v[52:55], v[84:87]
 v_mfma_f32_16x16x32_bf16 v[88:91], v[220:223], v[52:55], v[88:91]
 v_mfma_f32_16x16x32_bf16 v[92:95], v[224:227], v[52:55], v[92:95]
 v_mfma_f32_16x16x32_bf16 v[96:99], v[228:231], v[52:55], v[96:99]
 v_mfma_f32_16x16x32_bf16 v[100:103], v[232:235], v[52:55], v[100:103]
 s_waitcnt vmcnt(9)
 v_mfma_f32_16x16x32_bf16 v[84:87], v[236:239], v[56:59], v[84:87]
 v_mfma_f32_16x16x32_bf16 v[88:91], v[240:243], v[56:59], v[88:91]
 v_mfma_f32_16x16x32_bf16 v[92:95], v[244:247], v[56:59], v[92:95]
 v_mfma_f32_16x16x32_bf16 v[96:99], v[248:251], v[56:59], v[96:99]
 v_mfma_f32_16x16x32_bf16 v[100:103], v[252:255], v[56:59], v[100:103]
 s_waitcnt vmcnt(8)
 v_mfma_f32_16x16x32_bf16 v[84:87], v[144:147], v[60:63], v[84:87]
 v_mfma_f32_16x16x32_bf16 v[88:91], v[148:151], v[60:63], v[88:91]
 v_mfma_f32_16x16x32_bf16 v[92:95], v[152:155], v[60:63], v[92:95]
 v_mfma_f32_16x16x32_bf16 v[96:99], v[156:159], v[60:63], v[96:99]
 v_mfma_f32_16x16x32_bf16 v[100:103], v[160:163], v[60:63], v[100:103]
 v_mov_b32 v15, 6
 v_add_u32 v15, s52, v15
 s_waitcnt vmcnt(0)
 s_mov_b64 exec, 1
 buffer_store_dword v15, v0, s[4:7], s32 offen sc1
 s_mov_b64 exec, -1
 s_add_u32 s32, s32, 12288
 v_mfma_f32_16x16x32_bf16 v[104:107], v[176:179], v[64:67], 0
 v_mfma_f32_16x16x32_bf16 v[108:111], v[180:183], v[64:67], 0
 s_waitcnt lgkmcnt(0)
 s_barrier
 v_mfma_f32_16x16x32_bf16 v[112:115], v[184:187], v[64:67], 0
 ds_write_b128 v3, v[84:87] offset:12288
 v_mfma_f32_16x16x32_bf16 v[116:119], v[188:191], v[64:67], 0
 v_mfma_f32_16x16x32_bf16 v[120:123], v[192:195], v[64:67], 0
 v_mfma_f32_16x16x32_bf16 v[104:107], v[196:199], v[68:71], v[104:107]
 v_mfma_f32_16x16x32_bf16 v[108:111], v[200:203], v[68:71], v[108:111]
 ds_write_b128 v3, v[88:91] offset:13312
 v_mfma_f32_16x16x32_bf16 v[112:115], v[204:207], v[68:71], v[112:115]
 v_mfma_f32_16x16x32_bf16 v[116:119], v[208:211], v[68:71], v[116:119]
 ds_write_b128 v3, v[92:95] offset:14336
 v_mfma_f32_16x16x32_bf16 v[120:123], v[212:215], v[68:71], v[120:123]
 v_mfma_f32_16x16x32_bf16 v[104:107], v[216:219], v[72:75], v[104:107]
 v_mfma_f32_16x16x32_bf16 v[108:111], v[220:223], v[72:75], v[108:111]
 ds_write_b128 v3, v[96:99] offset:15360
 v_mfma_f32_16x16x32_bf16 v[112:115], v[224:227], v[72:75], v[112:115]
 v_mfma_f32_16x16x32_bf16 v[116:119], v[228:231], v[72:75], v[116:119]
 ds_write_b128 v3, v[100:103] offset:16384
 v_mfma_f32_16x16x32_bf16 v[120:123], v[232:235], v[72:75], v[120:123]
 v_mfma_f32_16x16x32_bf16 v[104:107], v[236:239], v[76:79], v[104:107]
 v_mfma_f32_16x16x32_bf16 v[108:111], v[240:243], v[76:79], v[108:111]
 v_mfma_f32_16x16x32_bf16 v[112:115], v[244:247], v[76:79], v[112:115]
 v_mfma_f32_16x16x32_bf16 v[116:119], v[248:251], v[76:79], v[116:119]
 s_waitcnt lgkmcnt(0)
 s_barrier
 v_mfma_f32_16x16x32_bf16 v[120:123], v[252:255], v[76:79], v[120:123]
 ds_read_b128 v[124:127], v5 offset:12288
 v_mfma_f32_16x16x32_bf16 v[104:107], v[144:147], v[80:83], v[104:107]
 ds_read_b128 v[128:131], v5 offset:13312
 v_mfma_f32_16x16x32_bf16 v[108:111], v[148:151], v[80:83], v[108:111]
 ds_read_b64 v[132:133], v6 offset:16384
 s_lshl_b32 s33, s54, 7
 s_add_u32 s33, s33, 7733248
 s_add_u32 s56, s52, 6
 buffer_load_dword v12, v172, s[4:7], s33 offen sc1
 v_mfma_f32_16x16x32_bf16 v[112:115], v[152:155], v[80:83], v[112:115]
 ds_read_b128 v[134:137], v5 offset:17408
 v_mfma_f32_16x16x32_bf16 v[116:119], v[156:159], v[80:83], v[116:119]
 ds_read_b128 v[138:141], v5 offset:18432
 v_mfma_f32_16x16x32_bf16 v[120:123], v[160:163], v[80:83], v[120:123]
 ds_read_b64 v[142:143], v6 offset:21504
 s_waitcnt lgkmcnt(0)
 s_barrier
 ds_write_b128 v4, v[104:107] offset:12288
 v_pk_add_f32 v[26:27], v[26:27], v[124:125]
 v_pk_add_f32 v[28:29], v[28:29], v[126:127]
 v_pk_add_f32 v[30:31], v[30:31], v[128:129]
 ds_write_b128 v4, v[108:111] offset:13312
 v_pk_add_f32 v[32:33], v[32:33], v[130:131]
 v_pk_add_f32 v[34:35], v[34:35], v[132:133]
 v_pk_add_f32 v[26:27], v[26:27], v[134:135]
 ds_write_b128 v4, v[112:115] offset:14336
 v_pk_add_f32 v[28:29], v[28:29], v[136:137]
 v_pk_add_f32 v[30:31], v[30:31], v[138:139]
 v_pk_add_f32 v[32:33], v[32:33], v[140:141]
 ds_write_b128 v4, v[116:119] offset:15360
 v_pk_add_f32 v[34:35], v[34:35], v[142:143]
 ds_read_b128 v[176:179], v1 offset:16384
 ds_read_b128 v[180:183], v1 offset:17408
 s_waitcnt vmcnt(0)
 v_cmp_ne_u32 vcc, s56, v12
 s_cbranch_vccz Lgate_61
 s_mov_b32 s55, 0
Lpoll_62:
 buffer_load_dword v12, v172, s[4:7], s33 offen sc1
 s_add_u32 s55, s55, 1
 s_cmp_gt_u32 s55, 0x80000
 s_cbranch_scc1 Lend
 s_waitcnt vmcnt(0)
 v_cmp_ne_u32 vcc, s56, v12
 s_cbranch_vccnz Lpoll_62
Lgate_61:
 s_add_u32 s33, s33, 12288
 buffer_load_dwordx4 v[44:47], v0, s[8:11], s16 offen sc1
 buffer_load_dwordx4 v[48:51], v0, s[8:11], s17 offen sc1
 ds_write_b128 v4, v[120:123] offset:16384
 buffer_load_dwordx4 v[52:55], v0, s[8:11], s16 offen offset:1024 sc1
 buffer_load_dwordx4 v[56:59], v0, s[8:11], s17 offen offset:1024 sc1
 buffer_load_dwordx4 v[60:63], v0, s[8:11], s16 offen offset:2048 sc1
 buffer_load_dwordx4 v[64:67], v0, s[8:11], s17 offen offset:2048 sc1
 buffer_load_dwordx4 v[68:71], v0, s[8:11], s16 offen offset:3072 sc1
 s_add_u32 s16, s16, 4096
 ds_read_b128 v[184:187], v1 offset:18432
 ds_read_b128 v[188:191], v1 offset:19456
 ds_read_b128 v[192:195], v1 offset:20480
 s_waitcnt lgkmcnt(0)
 s_barrier
 ds_read_b128 v[124:127], v5 offset:12288
 ds_read_b128 v[128:131], v5 offset:13312
 ds_read_b64 v[132:133], v6 offset:16384
 ds_read_b128 v[134:137], v5 offset:17408
 ds_read_b128 v[138:141], v5 offset:18432
 ds_read_b64 v[142:143], v6 offset:21504
 buffer_load_dwordx4 v[72:75], v0, s[8:11], s17 offen offset:3072 sc1
 s_add_u32 s17, s17, 4096
 buffer_load_dwordx4 v[76:79], v0, s[8:11], s16 offen sc1
 buffer_load_dwordx4 v[80:83], v0, s[8:11], s17 offen sc1
 s_waitcnt vmcnt(9)
 v_mfma_f32_16x16x32_bf16 v[212:215], v[176:179], v[44:47], 0
 v_mfma_f32_16x16x32_bf16 v[216:219], v[180:183], v[44:47], 0
 ds_read_b128 v[196:199], v1 offset:21504
 v_mfma_f32_16x16x32_bf16 v[220:223], v[184:187], v[44:47], 0
 s_waitcnt lgkmcnt(6)
 v_add_f32 v26, v26, v124
 v_add_f32 v27, v27, v125
 s_waitcnt vmcnt(8)
 v_mfma_f32_16x16x32_bf16 v[224:227], v[176:179], v[48:51], 0
 ds_read_b128 v[200:203], v1 offset:22528
 v_add_f32 v28, v28, v126
 v_add_f32 v29, v29, v127
 s_waitcnt lgkmcnt(6)
 v_add_f32 v30, v30, v128
 v_mfma_f32_16x16x32_bf16 v[228:231], v[180:183], v[48:51], 0
 v_add_f32 v31, v31, v129
 v_add_f32 v32, v32, v130
 v_add_f32 v33, v33, v131
 v_mfma_f32_16x16x32_bf16 v[232:235], v[184:187], v[48:51], 0
 ds_read_b128 v[204:207], v1 offset:23552
 s_waitcnt lgkmcnt(6)
 v_add_f32 v34, v34, v132
 v_add_f32 v35, v35, v133
 s_waitcnt vmcnt(7) lgkmcnt(2)
 v_mfma_f32_16x16x32_bf16 v[212:215], v[188:191], v[52:55], v[212:215]
 v_add_f32 v26, v26, v134
 v_add_f32 v27, v27, v135
 v_add_f32 v28, v28, v136
 v_mfma_f32_16x16x32_bf16 v[216:219], v[192:195], v[52:55], v[216:219]
 ds_read_b128 v[208:211], v1 offset:24576
 v_add_f32 v29, v29, v137
 v_add_f32 v30, v30, v138
 v_add_f32 v31, v31, v139
 v_mfma_f32_16x16x32_bf16 v[220:223], v[196:199], v[52:55], v[220:223]
 v_add_f32 v32, v32, v140
 v_add_f32 v33, v33, v141
 s_waitcnt vmcnt(6)
 v_mfma_f32_16x16x32_bf16 v[224:227], v[188:191], v[56:59], v[224:227]
 ds_read_b128 v[176:179], v1 offset:25600
 buffer_load_dwordx4 v[44:47], v0, s[8:11], s16 offen offset:1024 sc1
 v_add_f32 v34, v34, v142
 v_add_f32 v35, v35, v143
 v_mfma_f32_16x16x32_bf16 v[228:231], v[192:195], v[56:59], v[228:231]
 v_cvt_pk_bf16_f32 v124, v26, v27
 v_cvt_pk_bf16_f32 v125, v28, v29
 v_cvt_pk_bf16_f32 v126, v30, v31
 v_mfma_f32_16x16x32_bf16 v[232:235], v[196:199], v[56:59], v[232:235]
 ds_read_b128 v[180:183], v1 offset:26624
 v_cvt_pk_bf16_f32 v127, v32, v33
 v_cvt_pk_bf16_f32 v128, v34, v35
 s_waitcnt vmcnt(6) lgkmcnt(2)
 v_mfma_f32_16x16x32_bf16 v[212:215], v[200:203], v[60:63], v[212:215]
 buffer_load_dwordx4 v[48:51], v0, s[8:11], s17 offen offset:1024 sc1
 v_mfma_f32_16x16x32_bf16 v[216:219], v[204:207], v[60:63], v[216:219]
 ds_read_b128 v[184:187], v1 offset:27648
 v_mfma_f32_16x16x32_bf16 v[220:223], v[208:211], v[60:63], v[220:223]
 buffer_load_dwordx4 v[236:239], v0, s[4:7], s20 offen sc1
 s_waitcnt vmcnt(7)
 v_mfma_f32_16x16x32_bf16 v[224:227], v[200:203], v[64:67], v[224:227]
 ds_read_b128 v[188:191], v1 offset:28672
 buffer_load_dwordx4 v[52:55], v0, s[8:11], s16 offen offset:2048 sc1
 v_mfma_f32_16x16x32_bf16 v[228:231], v[204:207], v[64:67], v[228:231]
 buffer_store_dwordx4 v[124:127], v168, s[8:11], s29 offen sc1
 v_mfma_f32_16x16x32_bf16 v[232:235], v[208:211], v[64:67], v[232:235]
 ds_read_b128 v[192:195], v1 offset:29696
 buffer_store_dword v128, v169, s[8:11], s30 offen sc1
 s_waitcnt vmcnt(9) lgkmcnt(2)
 v_mfma_f32_16x16x32_bf16 v[212:215], v[176:179], v[68:71], v[212:215]
 buffer_load_dwordx4 v[56:59], v0, s[8:11], s17 offen offset:2048 sc1
 v_add_f32 v130, v26, v27
 v_mul_f32 v132, v26, v26
 v_mfma_f32_16x16x32_bf16 v[216:219], v[180:183], v[68:71], v[216:219]
 ds_read_b128 v[196:199], v1 offset:30720
 v_fmac_f32 v132, v27, v27
 v_add_f32 v130, v130, v28
 v_fmac_f32 v132, v28, v28
 v_mfma_f32_16x16x32_bf16 v[220:223], v[184:187], v[68:71], v[220:223]
 buffer_load_dwordx4 v[240:243], v0, s[4:7], s20 offen offset:1024 sc1
 v_add_f32 v130, v130, v29
 s_waitcnt vmcnt(10)
 v_mfma_f32_16x16x32_bf16 v[224:227], v[176:179], v[72:75], v[224:227]
 ds_read_b128 v[200:203], v1 offset:31744
 buffer_load_dwordx4 v[60:63], v0, s[8:11], s16 offen offset:3072 sc1
 s_add_u32 s16, s16, 4096
 v_fmac_f32 v132, v29, v29
 v_mfma_f32_16x16x32_bf16 v[228:231], v[180:183], v[72:75], v[228:231]
 v_add_f32 v130, v130, v30
 v_fmac_f32 v132, v30, v30
 v_add_f32 v130, v130, v31
 v_mfma_f32_16x16x32_bf16 v[232:235], v[184:187], v[72:75], v[232:235]
 ds_read_b128 v[204:207], v1 offset:32768
 v_fmac_f32 v132, v31, v31
 v_add_f32 v130, v130, v32
 s_waitcnt vmcnt(10) lgkmcnt(2)
 v_mfma_f32_16x16x32_bf16 v[212:215], v[188:191], v[76:79], v[212:215]
 buffer_load_dwordx4 v[64:67], v0, s[8:11], s17 offen offset:3072 sc1
 s_add_u32 s17, s17, 4096
 v_fmac_f32 v132, v32, v32
 v_mfma_f32_16x16x32_bf16 v[216:219], v[192:195], v[76:79], v[216:219]
 ds_read_b128 v[208:211], v1 offset:33792
 v_add_f32 v130, v130, v33
 v_fmac_f32 v132, v33, v33
 v_add_f32 v130, v130, v34
 v_mfma_f32_16x16x32_bf16 v[220:223], v[196:199], v[76:79], v[220:223]
 v_fmac_f32 v132, v34, v34
 v_add_f32 v130, v130, v35
 s_mul_i32 s35, s54, 196608
 s_waitcnt vmcnt(10)
 v_mfma_f32_16x16x32_bf16 v[224:227], v[188:191], v[80:83], v[224:227]
 ds_read_b128 v[176:179], v1 offset:34816
 buffer_load_dwordx4 v[68:71], v0, s[8:11], s16 offen sc1
 v_fmac_f32 v132, v35, v35
 s_add_u32 s35, s35, 18350080
 v_mfma_f32_16x16x32_bf16 v[228:231], v[192:195], v[80:83], v[228:231]
 v_permlane32_swap_b32 v130, v132
 v_add_f32 v131, v130, v132
 s_lshr_b32 s34, s49, 1
 v_mfma_f32_16x16x32_bf16 v[232:235], v[196:199], v[80:83], v[232:235]
 ds_read_b128 v[180:183], v1 offset:35840
 v_add_f32 v130, v130, v132
 s_mul_i32 s34, s34, 3072
 s_waitcnt vmcnt(10) lgkmcnt(2)
 v_mfma_f32_16x16x32_bf16 v[212:215], v[200:203], v[44:47], v[212:215]
 buffer_load_dwordx4 v[72:75], v0, s[8:11], s17 offen sc1
 v_permlane16_swap_b32 v130, v131
 s_add_u32 s35, s35, s34
 v_mfma_f32_16x16x32_bf16 v[216:219], v[204:207], v[44:47], v[216:219]
 ds_read_b128 v[184:187], v1 offset:36864
 v_add_f32 v130, v130, v131
 s_nop 1
 v_add_f32_dpp v130, v130, v130 row_ror:8 row_mask:0xf bank_mask:0xf
 s_lshl_b32 s34, s59, 11
 v_mfma_f32_16x16x32_bf16 v[220:223], v[208:211], v[44:47], v[220:223]
 buffer_store_dword v130, v170, s[4:7], s31 offen sc1
 s_add_u32 s34, s34, s35
 s_waitcnt vmcnt(11)
 v_mfma_f32_16x16x32_bf16 v[224:227], v[200:203], v[48:51], v[224:227]
 ds_read_b128 v[188:191], v1 offset:37888
 buffer_load_dwordx4 v[76:79], v0, s[8:11], s16 offen offset:1024 sc1
 s_lshl_b32 s36, s59, 9
 s_add_u32 s35, s35, s36
 v_mfma_f32_16x16x32_bf16 v[228:231], v[204:207], v[48:51], v[228:231]
 s_lshl_b32 s36, s54, 7
 s_add_u32 s36, s36, 7737344
 s_lshl_b32 s21, s49, 2
 s_add_u32 s36, s36, s21
 v_mfma_f32_16x16x32_bf16 v[232:235], v[208:211], v[48:51], v[232:235]
 ds_read_b128 v[192:195], v1 offset:38912
 s_mul_i32 s24, s53, 196608
 s_add_u32 s24, s24, 18350080
 s_waitcnt vmcnt(10) lgkmcnt(2)
 v_mfma_f32_16x16x32_bf16 v[212:215], v[176:179], v[52:55], v[212:215]
 buffer_load_dwordx4 v[80:83], v0, s[8:11], s17 offen offset:1024 sc1
 s_mul_i32 s25, s3, 12288
 s_add_u32 s24, s24, s25
 s_lshr_b32 s26, s3, 1
 v_mfma_f32_16x16x32_bf16 v[216:219], v[180:183], v[52:55], v[216:219]
 ds_read_b128 v[196:199], v1 offset:39936
 s_mul_i32 s26, s26, 49152
 s_add_u32 s25, s24, 49152
 s_sub_u32 s25, s25, s26
 v_mfma_f32_16x16x32_bf16 v[220:223], v[184:187], v[52:55], v[220:223]
 s_add_u32 s24, s24, s26
 s_add_u32 s26, s24, 98304
 s_add_u32 s27, s25, 98304
 s_waitcnt vmcnt(8)
 v_mfma_f32_16x16x32_bf16 v[224:227], v[176:179], v[56:59], v[224:227]
 ds_read_b128 v[200:203], v1 offset:40960
 buffer_load_dwordx4 v[44:47], v0, s[8:11], s16 offen offset:2048 sc1
 s_mov_b32 s44, 0
 s_mov_b32 s45, 0xffff0000
 v_mfma_f32_16x16x32_bf16 v[228:231], v[180:183], v[56:59], v[228:231]
 v_mfma_f32_16x16x32_bf16 v[232:235], v[184:187], v[56:59], v[232:235]
 ds_read_b128 v[204:207], v1 offset:41984
 s_waitcnt vmcnt(7) lgkmcnt(2)
 v_mfma_f32_16x16x32_bf16 v[212:215], v[188:191], v[60:63], v[212:215]
 buffer_load_dwordx4 v[48:51], v0, s[8:11], s17 offen offset:2048 sc1
 v_mfma_f32_16x16x32_bf16 v[216:219], v[192:195], v[60:63], v[216:219]
 ds_read_b128 v[208:211], v1 offset:43008
 v_mfma_f32_16x16x32_bf16 v[220:223], v[196:199], v[60:63], v[220:223]
 s_waitcnt vmcnt(7)
 v_mfma_f32_16x16x32_bf16 v[224:227], v[188:191], v[64:67], v[224:227]
 ds_read_b128 v[176:179], v1 offset:44032
 buffer_load_dwordx4 v[52:55], v0, s[8:11], s16 offen offset:3072 sc1
 s_add_u32 s16, s16, 4096
 v_mfma_f32_16x16x32_bf16 v[228:231], v[192:195], v[64:67], v[228:231]
 v_mfma_f32_16x16x32_bf16 v[232:235], v[196:199], v[64:67], v[232:235]
 ds_read_b128 v[180:183], v1 offset:45056
 s_waitcnt vmcnt(7) lgkmcnt(2)
 v_mfma_f32_16x16x32_bf16 v[212:215], v[200:203], v[68:71], v[212:215]
 buffer_load_dwordx4 v[56:59], v0, s[8:11], s17 offen offset:3072 sc1
 s_add_u32 s17, s17, 4096
 v_mov_b32 v15, 6
 v_add_u32 v15, s52, v15
 s_waitcnt vmcnt(6)
 s_mov_b64 exec, 1
 buffer_store_dword v15, v0, s[4:7], s32 offen sc1
 s_mov_b64 exec, -1
 v_mfma_f32_16x16x32_bf16 v[216:219], v[204:207], v[68:71], v[216:219]
 ds_read_b128 v[184:187], v1 offset:46080
 v_mfma_f32_16x16x32_bf16 v[220:223], v[208:211], v[68:71], v[220:223]
 v_mfma_f32_16x16x32_bf16 v[224:227], v[200:203], v[72:75], v[224:227]
 ds_read_b128 v[188:191], v1 offset:47104
 buffer_load_dwordx4 v[60:63], v0, s[8:11], s16 offen sc1
 v_mfma_f32_16x16x32_bf16 v[228:231], v[204:207], v[72:75], v[228:231]
 v_mfma_f32_16x16x32_bf16 v[232:235], v[208:211], v[72:75], v[232:235]
 ds_read_b128 v[192:195], v1 offset:48128
 s_waitcnt vmcnt(7) lgkmcnt(2)
 v_mfma_f32_16x16x32_bf16 v[212:215], v[176:179], v[76:79], v[212:215]
 buffer_load_dwordx4 v[64:67], v0, s[8:11], s17 offen sc1
 v_mfma_f32_16x16x32_bf16 v[216:219], v[180:183], v[76:79], v[216:219]
 ds_read_b128 v[196:199], v1 offset:49152
 v_mfma_f32_16x16x32_bf16 v[220:223], v[184:187], v[76:79], v[220:223]
 s_waitcnt vmcnt(7)
 v_mfma_f32_16x16x32_bf16 v[224:227], v[176:179], v[80:83], v[224:227]
 ds_read_b128 v[200:203], v1 offset:50176
 buffer_load_dwordx4 v[68:71], v0, s[8:11], s16 offen offset:1024 sc1
 v_mfma_f32_16x16x32_bf16 v[228:231], v[180:183], v[80:83], v[228:231]
 v_mfma_f32_16x16x32_bf16 v[232:235], v[184:187], v[80:83], v[232:235]
 ds_read_b128 v[204:207], v1 offset:51200
 s_waitcnt vmcnt(7) lgkmcnt(2)
 v_mfma_f32_16x16x32_bf16 v[212:215], v[188:191], v[44:47], v[212:215]
 buffer_load_dwordx4 v[72:75], v0, s[8:11], s17 offen offset:1024 sc1
 v_mfma_f32_16x16x32_bf16 v[216:219], v[192:195], v[44:47], v[216:219]
 ds_read_b128 v[208:211], v1 offset:52224
 v_mfma_f32_16x16x32_bf16 v[220:223], v[196:199], v[44:47], v[220:223]
 s_waitcnt vmcnt(7)
 v_mfma_f32_16x16x32_bf16 v[224:227], v[188:191], v[48:51], v[224:227]
 ds_read_b128 v[176:179], v1 offset:53248
 buffer_load_dwordx4 v[76:79], v0, s[8:11], s16 offen offset:2048 sc1
 v_mfma_f32_16x16x32_bf16 v[228:231], v[192:195], v[48:51], v[228:231]
 v_mfma_f32_16x16x32_bf16 v[232:235], v[196:199], v[48:51], v[232:235]
 ds_read_b128 v[180:183], v1 offset:54272
 s_waitcnt vmcnt(7) lgkmcnt(2)
 v_mfma_f32_16x16x32_bf16 v[212:215], v[200:203], v[52:55], v[212:215]
 buffer_load_dwordx4 v[80:83], v0, s[8:11], s17 offen offset:2048 sc1
 v_mfma_f32_16x16x32_bf16 v[216:219], v[204:207], v[52:55], v[216:219]
 ds_read_b128 v[184:187], v1 offset:55296
 v_mfma_f32_16x16x32_bf16 v[220:223], v[208:211], v[52:55], v[220:223]
 s_waitcnt vmcnt(7)
 v_mfma_f32_16x16x32_bf16 v[224:227], v[200:203], v[56:59], v[224:227]
 ds_read_b128 v[188:191], v1 offset:56320
 buffer_load_dwordx4 v[44:47], v0, s[8:11], s16 offen offset:3072 sc1
 s_add_u32 s16, s16, 4096
 v_mfma_f32_16x16x32_bf16 v[228:231], v[204:207], v[56:59], v[228:231]
 v_mfma_f32_16x16x32_bf16 v[232:235], v[208:211], v[56:59], v[232:235]
 ds_read_b128 v[192:195], v1 offset:57344
 s_waitcnt vmcnt(6) lgkmcnt(2)
 v_mfma_f32_16x16x32_bf16 v[212:215], v[176:179], v[60:63], v[212:215]
 buffer_load_dwordx4 v[48:51], v0, s[8:11], s17 offen offset:3072 sc1
 s_add_u32 s17, s17, 4096
 v_mfma_f32_16x16x32_bf16 v[216:219], v[180:183], v[60:63], v[216:219]
 ds_read_b128 v[196:199], v1 offset:58368
 v_mfma_f32_16x16x32_bf16 v[220:223], v[184:187], v[60:63], v[220:223]
 s_waitcnt vmcnt(6)
 v_mfma_f32_16x16x32_bf16 v[224:227], v[176:179], v[64:67], v[224:227]
 ds_read_b128 v[200:203], v1 offset:59392
 buffer_load_dwordx4 v[52:55], v0, s[8:11], s16 offen sc1
 v_mfma_f32_16x16x32_bf16 v[228:231], v[180:183], v[64:67], v[228:231]
 v_mfma_f32_16x16x32_bf16 v[232:235], v[184:187], v[64:67], v[232:235]
 ds_read_b128 v[204:207], v1 offset:60416
 s_waitcnt vmcnt(6) lgkmcnt(2)
 v_mfma_f32_16x16x32_bf16 v[212:215], v[188:191], v[68:71], v[212:215]
 buffer_load_dwordx4 v[56:59], v0, s[8:11], s17 offen sc1
 v_mfma_f32_16x16x32_bf16 v[216:219], v[192:195], v[68:71], v[216:219]
 ds_read_b128 v[208:211], v1 offset:61440
 v_mfma_f32_16x16x32_bf16 v[220:223], v[196:199], v[68:71], v[220:223]
 v_add_f32 v236, v236, v237
 v_add_f32 v240, v240, v241
 s_waitcnt vmcnt(6)
 v_mfma_f32_16x16x32_bf16 v[224:227], v[188:191], v[72:75], v[224:227]
 ds_read_b128 v[176:179], v1 offset:62464
 buffer_load_dwordx4 v[60:63], v0, s[8:11], s16 offen offset:1024 sc1
 v_add_f32 v236, v236, v238
 v_add_f32 v240, v240, v242
 v_mfma_f32_16x16x32_bf16 v[228:231], v[192:195], v[72:75], v[228:231]
 v_add_f32 v236, v236, v239
 v_add_f32 v240, v240, v243
 v_mfma_f32_16x16x32_bf16 v[232:235], v[196:199], v[72:75], v[232:235]
 ds_read_b128 v[180:183], v1 offset:63488
 v_permlane16_swap_b32 v236, v240
 s_waitcnt vmcnt(6) lgkmcnt(2)
 v_mfma_f32_16x16x32_bf16 v[212:215], v[200:203], v[76:79], v[212:215]
 s_add_u32 s56, s52, 6
 buffer_load_dword v12, v172, s[4:7], s33 offen sc1
 buffer_load_dwordx4 v[64:67], v0, s[8:11], s17 offen offset:1024 sc1
 v_mfma_f32_16x16x32_bf16 v[216:219], v[204:207], v[76:79], v[216:219]
 ds_read_b128 v[184:187], v1 offset:64512
 v_add_f32 v236, v236, v240
 v_mov_b32 v237, v236
 v_mfma_f32_16x16x32_bf16 v[220:223], v[208:211], v[76:79], v[220:223]
 s_nop 0
 v_permlane32_swap_b32 v236, v237
 s_waitcnt vmcnt(7)
 v_mfma_f32_16x16x32_bf16 v[224:227], v[200:203], v[80:83], v[224:227]
 ds_read_b128 v[188:191], v2
 buffer_load_dwordx4 v[68:71], v0, s[8:11], s16 offen offset:2048 sc1
 v_mul_f32 v236, 0xbacccccd, v236
 v_mul_f32 v237, 0x3acccccd, v237
 v_mfma_f32_16x16x32_bf16 v[228:231], v[204:207], v[80:83], v[228:231]
 v_fma_f32 v237, -v236, v236, v237
 v_max_f32 v237, 0, v237
 v_add_f32 v237, 0x3727c5ac, v237
 v_mfma_f32_16x16x32_bf16 v[232:235], v[208:211], v[80:83], v[232:235]
 ds_read_b128 v[192:195], v2 offset:1024
 v_rsq_f32 v238, v237
 s_waitcnt vmcnt(7) lgkmcnt(2)
 v_mfma_f32_16x16x32_bf16 v[212:215], v[176:179], v[44:47], v[212:215]
 buffer_load_dwordx4 v[72:75], v0, s[8:11], s17 offen offset:2048 sc1
 v_mul_f32 v237, v237, v238
 v_mov_b32 v240, v236
 v_mfma_f32_16x16x32_bf16 v[216:219], v[180:183], v[44:47], v[216:219]
 ds_read_b128 v[196:199], v2 offset:2048
 v_mov_b32 v241, v237
 v_mov_b32 v242, v238
 v_mfma_f32_16x16x32_bf16 v[220:223], v[184:187], v[44:47], v[220:223]
 v_permlane16_swap_b32 v236, v240
 s_waitcnt vmcnt(7)
 v_mfma_f32_16x16x32_bf16 v[224:227], v[176:179], v[48:51], v[224:227]
 ds_read_b128 v[200:203], v2 offset:3072
 buffer_load_dwordx4 v[76:79], v0, s[8:11], s16 offen offset:3072 sc1
 s_add_u32 s16, s16, 4096
 v_mfma_f32_16x16x32_bf16 v[228:231], v[180:183], v[48:51], v[228:231]
 v_permlane16_swap_b32 v237, v241
 v_mfma_f32_16x16x32_bf16 v[232:235], v[184:187], v[48:51], v[232:235]
 ds_read_b128 v[204:207], v2 offset:4096
 v_permlane16_swap_b32 v238, v242
 s_waitcnt vmcnt(7) lgkmcnt(2)
 v_mfma_f32_16x16x32_bf16 v[212:215], v[188:191], v[52:55], v[212:215]
 buffer_load_dwordx4 v[80:83], v0, s[8:11], s17 offen offset:3072 sc1
 s_add_u32 s17, s17, 4096
 v_cndmask_b32 v14, v236, v237, s[44:45]
 v_mfma_f32_16x16x32_bf16 v[216:219], v[192:195], v[52:55], v[216:219]
 ds_read_b128 v[208:211], v2 offset:5120
 v_cvt_pk_bf16_f32 v236, v14, v14
 v_lshlrev_b32 v239, 16, v236
 v_sub_f32 v239, v14, v239
 v_mfma_f32_16x16x32_bf16 v[220:223], v[196:199], v[52:55], v[220:223]
 s_waitcnt vmcnt(5)
 v_cmp_ne_u32 vcc, s56, v12
 s_cbranch_vccnz Lretry_63
Lback_64:
 v_mfma_f32_16x16x32_bf16 v[224:227], v[188:191], v[56:59], v[224:227]
 ds_read_b128 v[176:179], v2 offset:6144
 buffer_load_dwordx4 v[44:47], v0, s[8:11], s18 offen sc1
 v_cvt_pk_bf16_f32 v237, v239, v239
 v_cndmask_b32 v14, v240, v241, s[44:45]
 v_mfma_f32_16x16x32_bf16 v[228:231], v[192:195], v[56:59], v[228:231]
 v_cvt_pk_bf16_f32 v240, v14, v14
 v_lshlrev_b32 v243, 16, v240
 v_sub_f32 v243, v14, v243
 v_mfma_f32_16x16x32_bf16 v[232:235], v[196:199], v[56:59], v[232:235]
 ds_read_b128 v[180:183], v2 offset:7168
 v_cvt_pk_bf16_f32 v241, v243, v243
 s_waitcnt lgkmcnt(2)
 v_mfma_f32_16x16x32_bf16 v[212:215], v[200:203], v[60:63], v[212:215]
 buffer_load_dwordx4 v[48:51], v0, s[8:11], s19 offen sc1
 v_mfma_f32_16x16x32_bf16 v[216:219], v[204:207], v[60:63], v[216:219]
 ds_read_b128 v[184:187], v2 offset:8192
 v_mfma_f32_16x16x32_bf16 v[220:223], v[208:211], v[60:63], v[220:223]
 s_waitcnt vmcnt(6)
 v_mfma_f32_16x16x32_bf16 v[224:227], v[200:203], v[64:67], v[224:227]
 ds_read_b128 v[188:191], v2 offset:9216
 buffer_load_dwordx4 v[52:55], v0, s[8:11], s18 offen offset:1024 sc1
 v_mfma_f32_16x16x32_bf16 v[228:231], v[204:207], v[64:67], v[228:231]
 v_mfma_f32_16x16x32_bf16 v[232:235], v[208:211], v[64:67], v[232:235]
 ds_read_b128 v[192:195], v2 offset:10240
 s_waitcnt vmcnt(6) lgkmcnt(2)
 v_mfma_f32_16x16x32_bf16 v[212:215], v[176:179], v[68:71], v[212:215]
 buffer_load_dwordx4 v[56:59], v0, s[8:11], s19 offen offset:1024 sc1
 v_mfma_f32_16x16x32_bf16 v[216:219], v[180:183], v[68:71], v[216:219]
 ds_read_b128 v[196:199], v2 offset:11264
 v_mfma_f32_16x16x32_bf16 v[220:223], v[184:187], v[68:71], v[220:223]
 s_waitcnt vmcnt(6)
 v_mfma_f32_16x16x32_bf16 v[224:227], v[176:179], v[72:75], v[224:227]
 ds_read_b128 v[200:203], v1 offset:16384
 buffer_load_dwordx4 v[60:63], v0, s[8:11], s18 offen offset:2048 sc1
 v_mfma_f32_16x16x32_bf16 v[228:231], v[180:183], v[72:75], v[228:231]
 buffer_load_dwordx4 v[244:247], v0, s[4:7], s20 offen offset:2048 sc1
 v_mfma_f32_16x16x32_bf16 v[232:235], v[184:187], v[72:75], v[232:235]
 ds_read_b128 v[204:207], v1 offset:17408
 s_waitcnt vmcnt(7) lgkmcnt(2)
 v_mfma_f32_16x16x32_bf16 v[212:215], v[188:191], v[76:79], v[212:215]
 buffer_load_dwordx4 v[64:67], v0, s[8:11], s19 offen offset:2048 sc1
 v_mfma_f32_16x16x32_bf16 v[216:219], v[192:195], v[76:79], v[216:219]
 ds_read_b128 v[208:211], v1 offset:18432
 v_mfma_f32_16x16x32_bf16 v[220:223], v[196:199], v[76:79], v[220:223]
 s_waitcnt vmcnt(7)
 v_mfma_f32_16x16x32_bf16 v[224:227], v[188:191], v[80:83], v[224:227]
 ds_read_b128 v[176:179], v1 offset:19456
 buffer_load_dwordx4 v[68:71], v0, s[8:11], s18 offen offset:3072 sc1
 s_add_u32 s18, s18, 4096
 v_mfma_f32_16x16x32_bf16 v[228:231], v[192:195], v[80:83], v[228:231]
 buffer_load_dwordx4 v[248:251], v0, s[4:7], s20 offen offset:3072 sc1
 v_mfma_f32_16x16x32_bf16 v[232:235], v[196:199], v[80:83], v[232:235]
 ds_read_b128 v[180:183], v1 offset:20480
 s_waitcnt vmcnt(8) lgkmcnt(2)
 v_mfma_f32_16x16x32_bf16 v[144:147], v[200:203], v[44:47], 0
 buffer_load_dwordx4 v[72:75], v0, s[8:11], s19 offen offset:3072 sc1
 s_add_u32 s19, s19, 4096
 v_mfma_f32_16x16x32_bf16 v[148:151], v[204:207], v[44:47], 0
 ds_read_b128 v[184:187], v1 offset:21504
 v_mfma_f32_16x16x16_bf16 v[212:215], a[244:245], v[236:237], v[212:215]
 v_mfma_f32_16x16x16_bf16 v[216:219], a[246:247], v[236:237], v[216:219]
 v_mfma_f32_16x16x16_bf16 v[220:223], a[248:249], v[236:237], v[220:223]
 v_mfma_f32_16x16x32_bf16 v[152:155], v[208:211], v[44:47], 0
 v_mfma_f32_16x16x16_bf16 v[224:227], a[244:245], v[240:241], v[224:227]
 v_mfma_f32_16x16x16_bf16 v[228:231], a[246:247], v[240:241], v[228:231]
 v_mfma_f32_16x16x16_bf16 v[232:235], a[248:249], v[240:241], v[232:235]
 s_waitcnt vmcnt(8)
 v_mfma_f32_16x16x32_bf16 v[156:159], v[200:203], v[48:51], 0
 ds_read_b128 v[188:191], v1 offset:22528
 buffer_load_dwordx4 v[76:79], v0, s[8:11], s18 offen sc1
 v_mfma_f32_16x16x32_bf16 v[160:163], v[204:207], v[48:51], 0
 v_mfma_f32_16x16x32_bf16 v[164:167], v[208:211], v[48:51], 0
 ds_read_b128 v[192:195], v1 offset:23552
 v_mul_f32 v212, v212, v238
 v_mul_f32 v212, v212, abs(v212)
 v_mul_f32 v213, v213, v238
 s_waitcnt vmcnt(8) lgkmcnt(2)
 v_mfma_f32_16x16x32_bf16 v[144:147], v[176:179], v[52:55], v[144:147]
 buffer_load_dwordx4 v[80:83], v0, s[8:11], s19 offen sc1
 v_mul_f32 v213, v213, abs(v213)
 v_cvt_pk_bf16_f32 v124, v212, v213
 v_pk_max_i16 v124, v124, 0
 v_mfma_f32_16x16x32_bf16 v[148:151], v[180:183], v[52:55], v[148:151]
 ds_read_b128 v[196:199], v1 offset:24576
 v_mul_f32 v214, v214, v238
 v_mul_f32 v214, v214, abs(v214)
 v_mul_f32 v215, v215, v238
 v_mul_f32 v215, v215, abs(v215)
 v_mfma_f32_16x16x32_bf16 v[152:155], v[184:187], v[52:55], v[152:155]
 v_cvt_pk_bf16_f32 v125, v214, v215
 v_pk_max_i16 v125, v125, 0
 v_mul_f32 v216, v216, v238
 v_mul_f32 v216, v216, abs(v216)
 s_waitcnt vmcnt(8)
 v_mfma_f32_16x16x32_bf16 v[156:159], v[176:179], v[56:59], v[156:159]
 ds_read_b128 v[200:203], v1 offset:25600
 buffer_load_dwordx4 v[44:47], v0, s[8:11], s18 offen offset:1024 sc1
 v_mul_f32 v217, v217, v238
 v_mul_f32 v217, v217, abs(v217)
 v_cvt_pk_bf16_f32 v126, v216, v217
 v_mfma_f32_16x16x32_bf16 v[160:163], v[180:183], v[56:59], v[160:163]
 v_pk_max_i16 v126, v126, 0
 v_mul_f32 v218, v218, v238
 v_mul_f32 v218, v218, abs(v218)
 v_mul_f32 v219, v219, v238
 v_mul_f32 v219, v219, abs(v219)
 v_mfma_f32_16x16x32_bf16 v[164:167], v[184:187], v[56:59], v[164:167]
 ds_read_b128 v[204:207], v1 offset:26624
 v_cvt_pk_bf16_f32 v127, v218, v219
 v_pk_max_i16 v127, v127, 0
 s_waitcnt vmcnt(8) lgkmcnt(2)
 v_mfma_f32_16x16x32_bf16 v[144:147], v[188:191], v[60:63], v[144:147]
 buffer_load_dwordx4 v[48:51], v0, s[8:11], s19 offen offset:1024 sc1
 v_mfma_f32_16x16x32_bf16 v[148:151], v[192:195], v[60:63], v[148:151]
 ds_read_b128 v[208:211], v1 offset:27648
 v_mfma_f32_16x16x32_bf16 v[152:155], v[196:199], v[60:63], v[152:155]
 s_waitcnt vmcnt(7)
 v_mfma_f32_16x16x32_bf16 v[156:159], v[188:191], v[64:67], v[156:159]
 ds_read_b128 v[176:179], v1 offset:28672
 buffer_load_dwordx4 v[52:55], v0, s[8:11], s18 offen offset:2048 sc1
 v_mfma_f32_16x16x32_bf16 v[160:163], v[192:195], v[64:67], v[160:163]
 buffer_store_dwordx4 v[124:127], v0, s[4:7], s34 offen sc1
 v_mfma_f32_16x16x32_bf16 v[164:167], v[196:199], v[64:67], v[164:167]
 ds_read_b128 v[180:183], v1 offset:29696
 s_add_u32 s34, s34, 49152
 v_mul_f32 v220, v220, v238
 v_mul_f32 v220, v220, abs(v220)
 s_waitcnt vmcnt(8) lgkmcnt(2)
 v_mfma_f32_16x16x32_bf16 v[144:147], v[200:203], v[68:71], v[144:147]
 buffer_load_dwordx4 v[56:59], v0, s[8:11], s19 offen offset:2048 sc1
 v_mul_f32 v221, v221, v238
 v_mul_f32 v221, v221, abs(v221)
 v_cvt_pk_bf16_f32 v132, v220, v221
 v_pk_max_i16 v132, v132, 0
 v_mfma_f32_16x16x32_bf16 v[148:151], v[204:207], v[68:71], v[148:151]
 ds_read_b128 v[184:187], v1 offset:30720
 v_mul_f32 v222, v222, v238
 v_mul_f32 v222, v222, abs(v222)
 v_mul_f32 v223, v223, v238
 v_mul_f32 v223, v223, abs(v223)
 v_mfma_f32_16x16x32_bf16 v[152:155], v[208:211], v[68:71], v[152:155]
 v_cvt_pk_bf16_f32 v133, v222, v223
 v_pk_max_i16 v133, v133, 0
 v_mul_f32 v224, v224, v242
 v_mul_f32 v224, v224, abs(v224)
 s_waitcnt vmcnt(7)
 v_mfma_f32_16x16x32_bf16 v[156:159], v[200:203], v[72:75], v[156:159]
 ds_read_b128 v[188:191], v1 offset:31744
 buffer_load_dwordx4 v[60:63], v0, s[8:11], s18 offen offset:3072 sc1
 s_add_u32 s18, s18, 4096
 v_mul_f32 v225, v225, v242
 v_mul_f32 v225, v225, abs(v225)
 v_mfma_f32_16x16x32_bf16 v[160:163], v[204:207], v[72:75], v[160:163]
 v_cvt_pk_bf16_f32 v128, v224, v225
 v_pk_max_i16 v128, v128, 0
 v_mul_f32 v226, v226, v242
 v_mul_f32 v226, v226, abs(v226)
 v_mfma_f32_16x16x32_bf16 v[164:167], v[208:211], v[72:75], v[164:167]
 ds_read_b128 v[192:195], v1 offset:32768
 v_mul_f32 v227, v227, v242
 v_mul_f32 v227, v227, abs(v227)
 v_cvt_pk_bf16_f32 v129, v226, v227
 s_waitcnt vmcnt(7) lgkmcnt(2)
 v_mfma_f32_16x16x32_bf16 v[144:147], v[176:179], v[76:79], v[144:147]
 buffer_load_dwordx4 v[64:67], v0, s[8:11], s19 offen offset:3072 sc1
 s_add_u32 s19, s19, 4096
 v_pk_max_i16 v129, v129, 0
 v_mul_f32 v228, v228, v242
 v_mul_f32 v228, v228, abs(v228)
 v_mfma_f32_16x16x32_bf16 v[148:151], v[180:183], v[76:79], v[148:151]
 ds_read_b128 v[196:199], v1 offset:33792
 v_mul_f32 v229, v229, v242
 v_mul_f32 v229, v229, abs(v229)
 v_cvt_pk_bf16_f32 v130, v228, v229
 v_pk_max_i16 v130, v130, 0
 v_mfma_f32_16x16x32_bf16 v[152:155], v[184:187], v[76:79], v[152:155]
 v_mul_f32 v230, v230, v242
 v_mul_f32 v230, v230, abs(v230)
 v_mul_f32 v231, v231, v242
 v_mul_f32 v231, v231, abs(v231)
 s_waitcnt vmcnt(7)
 v_mfma_f32_16x16x32_bf16 v[156:159], v[176:179], v[80:83], v[156:159]
 ds_read_b128 v[200:203], v1 offset:34816
 buffer_load_dwordx4 v[68:71], v0, s[8:11], s18 offen sc1
 v_cvt_pk_bf16_f32 v131, v230, v231
 v_pk_max_i16 v131, v131, 0
 v_mfma_f32_16x16x32_bf16 v[160:163], v[180:183], v[80:83], v[160:163]
 buffer_store_dwordx4 v[128:131], v0, s[4:7], s34 offen sc1
 v_mfma_f32_16x16x32_bf16 v[164:167], v[184:187], v[80:83], v[164:167]
 ds_read_b128 v[204:207], v1 offset:35840
 s_add_u32 s34, s34, 49152
 v_mul_f32 v232, v232, v242
 v_mul_f32 v232, v232, abs(v232)
 s_waitcnt vmcnt(8) lgkmcnt(2)
 v_mfma_f32_16x16x32_bf16 v[144:147], v[188:191], v[44:47], v[144:147]
 buffer_load_dwordx4 v[72:75], v0, s[8:11], s19 offen sc1
 v_mul_f32 v233, v233, v242
 v_mul_f32 v233, v233, abs(v233)
 v_cvt_pk_bf16_f32 v134, v232, v233
 v_mfma_f32_16x16x32_bf16 v[148:151], v[192:195], v[44:47], v[148:151]
 ds_read_b128 v[208:211], v1 offset:36864
 v_pk_max_i16 v134, v134, 0
 v_mul_f32 v234, v234, v242
 v_mul_f32 v234, v234, abs(v234)
 v_mul_f32 v235, v235, v242
 v_mfma_f32_16x16x32_bf16 v[152:155], v[196:199], v[44:47], v[152:155]
 v_mul_f32 v235, v235, abs(v235)
 v_cvt_pk_bf16_f32 v135, v234, v235
 v_pk_max_i16 v135, v135, 0
 s_waitcnt vmcnt(8)
 v_mfma_f32_16x16x32_bf16 v[156:159], v[188:191], v[48:51], v[156:159]
 ds_read_b128 v[176:179], v1 offset:37888
 buffer_load_dwordx4 v[76:79], v0, s[8:11], s18 offen offset:1024 sc1
 v_permlane16_swap_b32 v132, v134
 v_mfma_f32_16x16x32_bf16 v[160:163], v[192:195], v[48:51], v[160:163]
 v_permlane16_swap_b32 v133, v135
 v_mfma_f32_16x16x32_bf16 v[164:167], v[196:199], v[48:51], v[164:167]
 ds_read_b128 v[180:183], v1 offset:38912
 s_waitcnt vmcnt(8) lgkmcnt(2)
 v_mfma_f32_16x16x32_bf16 v[144:147], v[200:203], v[52:55], v[144:147]
 buffer_load_dwordx4 v[80:83], v0, s[8:11], s19 offen offset:1024 sc1
 v_mfma_f32_16x16x32_bf16 v[148:151], v[204:207], v[52:55], v[148:151]
 ds_read_b128 v[184:187], v1 offset:39936
 v_mfma_f32_16x16x32_bf16 v[152:155], v[208:211], v[52:55], v[152:155]
 s_waitcnt vmcnt(7)
 v_mfma_f32_16x16x32_bf16 v[156:159], v[200:203], v[56:59], v[156:159]
 ds_read_b128 v[188:191], v1 offset:40960
 buffer_load_dwordx4 v[44:47], v0, s[8:11], s18 offen offset:2048 sc1
 v_mfma_f32_16x16x32_bf16 v[160:163], v[204:207], v[56:59], v[160:163]
 buffer_store_dwordx4 v[132:135], v7, s[4:7], s35 offen offset:1024 sc1
 v_mfma_f32_16x16x32_bf16 v[164:167], v[208:211], v[56:59], v[164:167]
 ds_read_b128 v[192:195], v1 offset:41984
 s_add_u32 s35, s35, 98304
 s_waitcnt vmcnt(8) lgkmcnt(2)
 v_mfma_f32_16x16x32_bf16 v[144:147], v[176:179], v[60:63], v[144:147]
 buffer_load_dwordx4 v[48:51], v0, s[8:11], s19 offen offset:2048 sc1
 v_mfma_f32_16x16x32_bf16 v[148:151], v[180:183], v[60:63], v[148:151]
 ds_read_b128 v[196:199], v1 offset:43008
 v_mfma_f32_16x16x32_bf16 v[152:155], v[184:187], v[60:63], v[152:155]
 s_waitcnt vmcnt(8)
 v_mfma_f32_16x16x32_bf16 v[156:159], v[176:179], v[64:67], v[156:159]
 ds_read_b128 v[200:203], v1 offset:44032
 buffer_load_dwordx4 v[52:55], v0, s[8:11], s18 offen offset:3072 sc1
 s_add_u32 s18, s18, 4096
 s_lshl_b32 s21, s57, 6
 v_mfma_f32_16x16x32_bf16 v[160:163], v[180:183], v[64:67], v[160:163]
 s_lshl_b32 s22, s58, 1
 s_add_u32 s22, s22, s59
 s_lshl_b32 s22, s22, 5
 v_mfma_f32_16x16x32_bf16 v[164:167], v[184:187], v[64:67], v[164:167]
 ds_read_b128 v[204:207], v1 offset:45056
 v_bfe_u32 v252, v0, 4, 3
 v_mul_u32_u24 v252, 0, v252
 s_waitcnt vmcnt(8) lgkmcnt(2)
 v_mfma_f32_16x16x32_bf16 v[144:147], v[188:191], v[68:71], v[144:147]
 buffer_load_dwordx4 v[56:59], v0, s[8:11], s19 offen offset:3072 sc1
 s_add_u32 s19, s19, 4096
 v_bfe_u32 v14, v0, 7, 1
 v_mfma_f32_16x16x32_bf16 v[148:151], v[192:195], v[68:71], v[148:151]
 ds_read_b128 v[208:211], v1 offset:46080
 v_lshl_add_u32 v252, v14, 6, v252
 v_bfe_u32 v14, v0, 8, 2
 v_lshl_add_u32 v252, v14, 4, v252
 v_mfma_f32_16x16x32_bf16 v[152:155], v[196:199], v[68:71], v[152:155]
 v_bfe_u32 v173, v0, 4, 3
 v_mul_u32_u24 v173, 0, v173
 s_waitcnt vmcnt(7)
 v_mfma_f32_16x16x32_bf16 v[156:159], v[188:191], v[72:75], v[156:159]
 ds_read_b128 v[176:179], v1 offset:47104
 buffer_load_dwordx4 v[60:63], v0, s[8:11], s18 offen sc1
 v_bfe_u32 v14, v0, 7, 1
 v_lshl_add_u32 v173, v14, 2, v173
 v_mfma_f32_16x16x32_bf16 v[160:163], v[192:195], v[72:75], v[160:163]
 v_bfe_u32 v14, v0, 8, 2
 v_lshl_add_u32 v173, v14, 3, v173
 buffer_load_dwordx4 v[252:255], v252, s[12:15], s21 offen
 v_mfma_f32_16x16x32_bf16 v[164:167], v[196:199], v[72:75], v[164:167]
 ds_read_b128 v[180:183], v1 offset:48128
 buffer_load_dword v173, v173, s[12:15], s22 offen
 v_add_f32 v244, v244, v245
 s_waitcnt vmcnt(9) lgkmcnt(2)
 v_mfma_f32_16x16x32_bf16 v[144:147], v[200:203], v[76:79], v[144:147]
 buffer_load_dwordx4 v[64:67], v0, s[8:11], s19 offen sc1
 v_add_f32 v248, v248, v249
 v_add_f32 v244, v244, v246
 v_mfma_f32_16x16x32_bf16 v[148:151], v[204:207], v[76:79], v[148:151]
 ds_read_b128 v[184:187], v1 offset:49152
 v_add_f32 v248, v248, v250
 v_add_f32 v244, v244, v247
 v_add_f32 v248, v248, v251
 v_mfma_f32_16x16x32_bf16 v[152:155], v[208:211], v[76:79], v[152:155]
 s_nop 0
 v_permlane16_swap_b32 v244, v248
 s_waitcnt vmcnt(9)
 v_mfma_f32_16x16x32_bf16 v[156:159], v[200:203], v[80:83], v[156:159]
 ds_read_b128 v[188:191], v1 offset:50176
 buffer_load_dwordx4 v[68:71], v0, s[8:11], s18 offen offset:1024 sc1
 v_add_f32 v244, v244, v248
 v_mov_b32 v245, v244
 v_mfma_f32_16x16x32_bf16 v[160:163], v[204:207], v[80:83], v[160:163]
 s_nop 0
 v_permlane32_swap_b32 v244, v245
 v_mul_f32 v244, 0xbacccccd, v244
 v_mfma_f32_16x16x32_bf16 v[164:167], v[208:211], v[80:83], v[164:167]
 ds_read_b128 v[192:195], v1 offset:51200
 v_mul_f32 v245, 0x3acccccd, v245
 v_fma_f32 v245, -v244, v244, v245
 s_waitcnt vmcnt(9) lgkmcnt(2)
 v_mfma_f32_16x16x32_bf16 v[144:147], v[176:179], v[44:47], v[144:147]
 buffer_load_dwordx4 v[72:75], v0, s[8:11], s19 offen offset:1024 sc1
 v_mov_b32 v15, 7
 v_add_u32 v15, s52, v15
 s_waitcnt vmcnt(9)
 s_mov_b64 exec, 1
 buffer_store_dword v15, v0, s[4:7], s36 offen sc1
 s_mov_b64 exec, -1
 s_add_u32 s36, s36, 4096
 v_mfma_f32_16x16x32_bf16 v[148:151], v[180:183], v[44:47], v[148:151]
 ds_read_b128 v[196:199], v1 offset:52224
 v_max_f32 v245, 0, v245
 v_add_f32 v245, 0x3727c5ac, v245
 v_mfma_f32_16x16x32_bf16 v[152:155], v[184:187], v[44:47], v[152:155]
 v_rsq_f32 v246, v245
 s_waitcnt vmcnt(9)
 v_mfma_f32_16x16x32_bf16 v[156:159], v[176:179], v[48:51], v[156:159]
 ds_read_b128 v[200:203], v1 offset:53248
 buffer_load_dwordx4 v[76:79], v0, s[8:11], s18 offen offset:2048 sc1
 v_mul_f32 v245, v245, v246
 v_mov_b32 v248, v244
 v_mfma_f32_16x16x32_bf16 v[160:163], v[180:183], v[48:51], v[160:163]
 v_mov_b32 v249, v245
 v_mov_b32 v250, v246
 v_mfma_f32_16x16x32_bf16 v[164:167], v[184:187], v[48:51], v[164:167]
 ds_read_b128 v[204:207], v1 offset:54272
 v_permlane16_swap_b32 v244, v248
 s_waitcnt vmcnt(9) lgkmcnt(2)
 v_mfma_f32_16x16x32_bf16 v[144:147], v[188:191], v[52:55], v[144:147]
 buffer_load_dwordx4 v[80:83], v0, s[8:11], s19 offen offset:2048 sc1
 v_permlane16_swap_b32 v245, v249
 v_mfma_f32_16x16x32_bf16 v[148:151], v[192:195], v[52:55], v[148:151]
 ds_read_b128 v[208:211], v1 offset:55296
 v_permlane16_swap_b32 v246, v250
 v_cndmask_b32 v14, v244, v245, s[44:45]
 v_mfma_f32_16x16x32_bf16 v[152:155], v[196:199], v[52:55], v[152:155]
 v_cvt_pk_bf16_f32 v244, v14, v14
 v_lshlrev_b32 v247, 16, v244
 s_waitcnt vmcnt(9)
 v_mfma_f32_16x16x32_bf16 v[156:159], v[188:191], v[56:59], v[156:159]
 ds_read_b128 v[176:179], v1 offset:56320
 buffer_load_dwordx4 v[44:47], v0, s[8:11], s18 offen offset:3072 sc1
 s_add_u32 s18, s18, 4096
 v_sub_f32 v247, v14, v247
 v_mfma_f32_16x16x32_bf16 v[160:163], v[192:195], v[56:59], v[160:163]
 v_cvt_pk_bf16_f32 v245, v247, v247
 v_cndmask_b32 v14, v248, v249, s[44:45]
 v_cvt_pk_bf16_f32 v248, v14, v14
 v_mfma_f32_16x16x32_bf16 v[164:167], v[196:199], v[56:59], v[164:167]
 ds_read_b128 v[180:183], v1 offset:57344
 v_lshlrev_b32 v251, 16, v248
 v_sub_f32 v251, v14, v251
 s_waitcnt vmcnt(9) lgkmcnt(2)
 v_mfma_f32_16x16x32_bf16 v[144:147], v[200:203], v[60:63], v[144:147]
 buffer_load_dwordx4 v[48:51], v0, s[8:11], s19 offen offset:3072 sc1
 s_add_u32 s19, s19, 4096
 v_cvt_pk_bf16_f32 v249, v251, v251
 v_mfma_f32_16x16x32_bf16 v[148:151], v[204:207], v[60:63], v[148:151]
 ds_read_b128 v[184:187], v1 offset:58368
 s_mul_i32 s29, s53, 81920
 s_lshl_b32 s30, s58, 1
 s_add_u32 s30, s30, s59
 v_mfma_f32_16x16x32_bf16 v[152:155], v[208:211], v[60:63], v[152:155]
 s_mul_i32 s62, s3, 10240
 v_bfe_u32 v168, v0, 4, 3
 s_waitcnt vmcnt(7)
 v_mfma_f32_16x16x32_bf16 v[156:159], v[200:203], v[64:67], v[156:159]
 ds_read_b128 v[188:191], v1 offset:59392
 buffer_load_dwordx4 v[52:55], v0, s[8:11], s18 offen sc1
 v_mul_u32_u24 v168, 1280, v168
 v_bfe_u32 v14, v0, 7, 1
 v_mfma_f32_16x16x32_bf16 v[160:163], v[204:207], v[64:67], v[160:163]
 v_lshl_add_u32 v168, v14, 6, v168
 v_bfe_u32 v14, v0, 8, 2
 v_lshl_add_u32 v168, v14, 4, v168
 v_mfma_f32_16x16x32_bf16 v[164:167], v[208:211], v[64:67], v[164:167]
 ds_read_b128 v[192:195], v1 offset:60416
 v_bfe_u32 v169, v0, 4, 3
 v_mul_u32_u24 v169, 1280, v169
 s_waitcnt vmcnt(7) lgkmcnt(2)
 v_mfma_f32_16x16x32_bf16 v[144:147], v[176:179], v[68:71], v[144:147]
 buffer_load_dwordx4 v[56:59], v0, s[8:11], s19 offen sc1
 v_bfe_u32 v14, v0, 7, 1
 v_lshl_add_u32 v169, v14, 2, v169
 v_mfma_f32_16x16x32_bf16 v[148:151], v[180:183], v[68:71], v[148:151]
 ds_read_b128 v[196:199], v1 offset:61440
 v_bfe_u32 v14, v0, 8, 2
 v_lshl_add_u32 v169, v14, 3, v169
 s_add_u32 s29, s29, s62
 v_mfma_f32_16x16x32_bf16 v[152:155], v[184:187], v[68:71], v[152:155]
 s_add_u32 s56, s52, 7
 buffer_load_dword v12, v171, s[4:7], s28 offen sc1
 s_waitcnt vmcnt(8)
 v_mfma_f32_16x16x32_bf16 v[156:159], v[176:179], v[72:75], v[156:159]
 ds_read_b128 v[200:203], v1 offset:62464
 buffer_load_dwordx4 v[60:63], v0, s[8:11], s18 offen offset:1024 sc1
 s_lshl_b32 s30, s30, 5
 s_add_u32 s30, s30, s29
 v_mfma_f32_16x16x32_bf16 v[160:163], v[180:183], v[72:75], v[160:163]
 s_lshl_b32 s62, s57, 6
 s_add_u32 s29, s29, s62
 v_lshlrev_b32 v14, 16, v252
 v_mfma_f32_16x16x32_bf16 v[164:167], v[184:187], v[72:75], v[164:167]
 ds_read_b128 v[204:207], v1 offset:63488
 v_add_f32 v16, v16, v14
 v_add_f32 v26, v26, v14
 s_waitcnt vmcnt(7) lgkmcnt(2)
 v_mfma_f32_16x16x32_bf16 v[144:147], v[188:191], v[76:79], v[144:147]
 buffer_load_dwordx4 v[64:67], v0, s[8:11], s19 offen offset:1024 sc1
 v_and_b32 v14, 0xffff0000, v252
 v_add_f32 v17, v17, v14
 v_mfma_f32_16x16x32_bf16 v[148:151], v[192:195], v[76:79], v[148:151]
 ds_read_b128 v[208:211], v1 offset:64512
 v_add_f32 v27, v27, v14
 v_lshlrev_b32 v14, 16, v253
 v_add_f32 v18, v18, v14
 v_mfma_f32_16x16x32_bf16 v[152:155], v[196:199], v[76:79], v[152:155]
 v_add_f32 v28, v28, v14
 v_and_b32 v14, 0xffff0000, v253
 s_waitcnt vmcnt(7)
 v_mfma_f32_16x16x32_bf16 v[156:159], v[188:191], v[80:83], v[156:159]
 ds_read_b128 v[176:179], v2
 buffer_load_dwordx4 v[68:71], v0, s[8:11], s18 offen offset:2048 sc1
 v_add_f32 v19, v19, v14
 v_add_f32 v29, v29, v14
 v_mfma_f32_16x16x32_bf16 v[160:163], v[192:195], v[80:83], v[160:163]
 v_lshlrev_b32 v14, 16, v254
 v_add_f32 v20, v20, v14
 v_add_f32 v30, v30, v14
 v_mfma_f32_16x16x32_bf16 v[164:167], v[196:199], v[80:83], v[164:167]
 ds_read_b128 v[180:183], v2 offset:1024
 v_and_b32 v14, 0xffff0000, v254
 v_add_f32 v21, v21, v14
 s_waitcnt vmcnt(7) lgkmcnt(2)
 v_mfma_f32_16x16x32_bf16 v[144:147], v[200:203], v[44:47], v[144:147]
 buffer_load_dwordx4 v[72:75], v0, s[8:11], s19 offen offset:2048 sc1
 v_add_f32 v31, v31, v14
 v_lshlrev_b32 v14, 16, v255
 v_mfma_f32_16x16x32_bf16 v[148:151], v[204:207], v[44:47], v[148:151]
 ds_read_b128 v[184:187], v2 offset:2048
 v_add_f32 v22, v22, v14
 v_add_f32 v32, v32, v14
 v_and_b32 v14, 0xffff0000, v255
 v_mfma_f32_16x16x32_bf16 v[152:155], v[208:211], v[44:47], v[152:155]
 v_add_f32 v23, v23, v14
 v_add_f32 v33, v33, v14
 s_waitcnt vmcnt(7)
 v_mfma_f32_16x16x32_bf16 v[156:159], v[200:203], v[48:51], v[156:159]
 ds_read_b128 v[188:191], v2 offset:3072
 buffer_load_dwordx4 v[76:79], v0, s[8:11], s18 offen offset:3072 sc1
 s_add_u32 s18, s18, 4096
 v_lshlrev_b32 v14, 16, v173
 v_mfma_f32_16x16x32_bf16 v[160:163], v[204:207], v[48:51], v[160:163]
 v_add_f32 v24, v24, v14
 v_add_f32 v34, v34, v14
 v_and_b32 v14, 0xffff0000, v173
 v_mfma_f32_16x16x32_bf16 v[164:167], v[208:211], v[48:51], v[164:167]
 ds_read_b128 v[192:195], v2 offset:4096
 v_add_f32 v25, v25, v14
 v_add_f32 v35, v35, v14
 s_waitcnt vmcnt(7) lgkmcnt(2)
 v_mfma_f32_16x16x32_bf16 v[144:147], v[176:179], v[52:55], v[144:147]
 buffer_load_dwordx4 v[80:83], v0, s[8:11], s19 offen offset:3072 sc1
 s_add_u32 s19, s19, 4096
 v_mfma_f32_16x16x32_bf16 v[148:151], v[180:183], v[52:55], v[148:151]
 ds_read_b128 v[196:199], v2 offset:5120
 v_mfma_f32_16x16x32_bf16 v[152:155], v[184:187], v[52:55], v[152:155]
 s_waitcnt vmcnt(6)
 v_cmp_ne_u32 vcc, s56, v12
 s_cbranch_vccnz Lretry_66
Lback_67:
 s_add_u32 s28, s28, 4096
 v_mfma_f32_16x16x32_bf16 v[156:159], v[176:179], v[56:59], v[156:159]
 ds_read_b128 v[200:203], v2 offset:6144
 buffer_load_dwordx4 v[44:47], v0, s[4:7], s24 offen sc1
 v_mfma_f32_16x16x32_bf16 v[160:163], v[180:183], v[56:59], v[160:163]
 v_mfma_f32_16x16x32_bf16 v[164:167], v[184:187], v[56:59], v[164:167]
 ds_read_b128 v[204:207], v2 offset:7168
 s_waitcnt vmcnt(6) lgkmcnt(2)
 v_mfma_f32_16x16x32_bf16 v[144:147], v[188:191], v[60:63], v[144:147]
 buffer_load_dwordx4 v[48:51], v0, s[4:7], s24 offen offset:1024 sc1
 v_mfma_f32_16x16x32_bf16 v[148:151], v[192:195], v[60:63], v[148:151]
 ds_read_b128 v[208:211], v2 offset:8192
 v_mfma_f32_16x16x32_bf16 v[152:155], v[196:199], v[60:63], v[152:155]
 s_waitcnt vmcnt(6)
 v_mfma_f32_16x16x32_bf16 v[156:159], v[188:191], v[64:67], v[156:159]
 ds_read_b128 v[176:179], v2 offset:9216
 buffer_load_dwordx4 v[52:55], v0, s[4:7], s24 offen offset:2048 sc1
 v_mfma_f32_16x16x32_bf16 v[160:163], v[192:195], v[64:67], v[160:163]
 v_mfma_f32_16x16x32_bf16 v[164:167], v[196:199], v[64:67], v[164:167]
 ds_read_b128 v[180:183], v2 offset:10240
 s_waitcnt vmcnt(6) lgkmcnt(2)
 v_mfma_f32_16x16x32_bf16 v[144:147], v[200:203], v[68:71], v[144:147]
 buffer_load_dwordx4 v[56:59], v0, s[4:7], s24 offen offset:3072 sc1
 s_add_u32 s24, s24, 4096
 v_mfma_f32_16x16x32_bf16 v[148:151], v[204:207], v[68:71], v[148:151]
 ds_read_b128 v[184:187], v2 offset:11264
 v_mfma_f32_16x16x32_bf16 v[152:155], v[208:211], v[68:71], v[152:155]
 s_waitcnt vmcnt(6)
 v_mfma_f32_16x16x32_bf16 v[156:159], v[200:203], v[72:75], v[156:159]
 buffer_load_dwordx4 v[60:63], v0, s[4:7], s24 offen sc1
 v_mfma_f32_16x16x32_bf16 v[160:163], v[204:207], v[72:75], v[160:163]
 v_mfma_f32_16x16x32_bf16 v[164:167], v[208:211], v[72:75], v[164:167]
 s_waitcnt vmcnt(6) lgkmcnt(0)
 v_mfma_f32_16x16x32_bf16 v[144:147], v[176:179], v[76:79], v[144:147]
 buffer_load_dwordx4 v[64:67], v0, s[4:7], s24 offen offset:1024 sc1
 v_mfma_f32_16x16x32_bf16 v[148:151], v[180:183], v[76:79], v[148:151]
 v_mfma_f32_16x16x32_bf16 v[152:155], v[184:187], v[76:79], v[152:155]
 s_waitcnt vmcnt(6)
 v_mfma_f32_16x16x32_bf16 v[156:159], v[176:179], v[80:83], v[156:159]
 buffer_load_dwordx4 v[68:71], v0, s[4:7], s24 offen offset:2048 sc1
 v_mfma_f32_16x16x32_bf16 v[160:163], v[180:183], v[80:83], v[160:163]
 v_mfma_f32_16x16x32_bf16 v[164:167], v[184:187], v[80:83], v[164:167]
 s_waitcnt vmcnt(6)
 v_mfma_f32_16x16x32_bf16 v[84:87], a[0:3], v[44:47], 0
 buffer_load_dwordx4 v[72:75], v0, s[4:7], s24 offen offset:3072 sc1
 s_add_u32 s24, s24, 4096
 v_mfma_f32_16x16x16_bf16 v[144:147], a[244:245], v[244:245], v[144:147]
 v_mfma_f32_16x16x16_bf16 v[148:151], a[246:247], v[244:245], v[148:151]
 v_mfma_f32_16x16x16_bf16 v[152:155], a[248:249], v[244:245], v[152:155]
 v_mfma_f32_16x16x32_bf16 v[88:91], a[4:7], v[44:47], 0
 v_mfma_f32_16x16x16_bf16 v[156:159], a[244:245], v[248:249], v[156:159]
 v_mfma_f32_16x16x16_bf16 v[160:163], a[246:247], v[248:249], v[160:163]
 v_mfma_f32_16x16x16_bf16 v[164:167], a[248:249], v[248:249], v[164:167]
 v_mfma_f32_16x16x32_bf16 v[92:95], a[8:11], v[44:47], 0
 v_mfma_f32_16x16x32_bf16 v[96:99], a[12:15], v[44:47], 0
 v_mfma_f32_16x16x32_bf16 v[100:103], a[16:19], v[44:47], 0
 v_mul_f32 v144, v144, v246
 s_waitcnt vmcnt(6)
 v_mfma_f32_16x16x32_bf16 v[84:87], a[20:23], v[48:51], v[84:87]
 buffer_load_dwordx4 v[76:79], v0, s[4:7], s24 offen sc1
 v_mul_f32 v144, v144, abs(v144)
 v_mul_f32 v145, v145, v246
 v_mfma_f32_16x16x32_bf16 v[88:91], a[24:27], v[48:51], v[88:91]
 v_mul_f32 v145, v145, abs(v145)
 v_cvt_pk_bf16_f32 v124, v144, v145
 v_mfma_f32_16x16x32_bf16 v[92:95], a[28:31], v[48:51], v[92:95]
 v_pk_max_i16 v124, v124, 0
 v_mul_f32 v146, v146, v246
 v_mfma_f32_16x16x32_bf16 v[96:99], a[32:35], v[48:51], v[96:99]
 v_mul_f32 v146, v146, abs(v146)
 v_mul_f32 v147, v147, v246
 v_mul_f32 v147, v147, abs(v147)
 v_mfma_f32_16x16x32_bf16 v[100:103], a[36:39], v[48:51], v[100:103]
 v_cvt_pk_bf16_f32 v125, v146, v147
 s_waitcnt vmcnt(6)
 v_mfma_f32_16x16x32_bf16 v[84:87], a[40:43], v[52:55], v[84:87]
 buffer_load_dwordx4 v[80:83], v0, s[4:7], s24 offen offset:1024 sc1
 v_pk_max_i16 v125, v125, 0
 v_mfma_f32_16x16x32_bf16 v[88:91], a[44:47], v[52:55], v[88:91]
 v_mul_f32 v148, v148, v246
 v_mul_f32 v148, v148, abs(v148)
 v_mul_f32 v149, v149, v246
 v_mfma_f32_16x16x32_bf16 v[92:95], a[48:51], v[52:55], v[92:95]
 v_mul_f32 v149, v149, abs(v149)
 v_cvt_pk_bf16_f32 v126, v148, v149
 v_mfma_f32_16x16x32_bf16 v[96:99], a[52:55], v[52:55], v[96:99]
 v_pk_max_i16 v126, v126, 0
 v_mul_f32 v150, v150, v246
 v_mul_f32 v150, v150, abs(v150)
 v_mfma_f32_16x16x32_bf16 v[100:103], a[56:59], v[52:55], v[100:103]
 v_mul_f32 v151, v151, v246
 s_waitcnt vmcnt(6)
 v_mfma_f32_16x16x32_bf16 v[84:87], a[60:63], v[56:59], v[84:87]
 buffer_load_dwordx4 v[44:47], v0, s[4:7], s24 offen offset:2048 sc1
 v_mul_f32 v151, v151, abs(v151)
 v_mfma_f32_16x16x32_bf16 v[88:91], a[64:67], v[56:59], v[88:91]
 v_cvt_pk_bf16_f32 v127, v150, v151
 v_pk_max_i16 v127, v127, 0
 v_mfma_f32_16x16x32_bf16 v[92:95], a[68:71], v[56:59], v[92:95]
 buffer_store_dwordx4 v[124:127], v0, s[4:7], s34 offen sc1
 v_mfma_f32_16x16x32_bf16 v[96:99], a[72:75], v[56:59], v[96:99]
 s_add_u32 s34, s34, 49152
 v_mul_f32 v152, v152, v246
 v_mfma_f32_16x16x32_bf16 v[100:103], a[76:79], v[56:59], v[100:103]
 v_mul_f32 v152, v152, abs(v152)
 v_mul_f32 v153, v153, v246
 s_waitcnt vmcnt(7)
 v_mfma_f32_16x16x32_bf16 v[84:87], a[80:83], v[60:63], v[84:87]
 buffer_load_dwordx4 v[48:51], v0, s[4:7], s24 offen offset:3072 sc1
 v_mul_f32 v153, v153, abs(v153)
 v_mfma_f32_16x16x32_bf16 v[88:91], a[84:87], v[60:63], v[88:91]
 v_cvt_pk_bf16_f32 v132, v152, v153
 v_pk_max_i16 v132, v132, 0
 v_mul_f32 v154, v154, v246
 v_mfma_f32_16x16x32_bf16 v[92:95], a[88:91], v[60:63], v[92:95]
 v_mul_f32 v154, v154, abs(v154)
 v_mul_f32 v155, v155, v246
 v_mfma_f32_16x16x32_bf16 v[96:99], a[92:95], v[60:63], v[96:99]
 v_mul_f32 v155, v155, abs(v155)
 v_cvt_pk_bf16_f32 v133, v154, v155
 v_mfma_f32_16x16x32_bf16 v[100:103], a[96:99], v[60:63], v[100:103]
 v_pk_max_i16 v133, v133, 0
 v_mul_f32 v156, v156, v250
 s_waitcnt vmcnt(7)
 v_mfma_f32_16x16x32_bf16 v[84:87], a[100:103], v[64:67], v[84:87]
 buffer_load_dwordx4 v[52:55], v0, s[4:7], s25 offen sc1
 v_mul_f32 v156, v156, abs(v156)
 v_mfma_f32_16x16x32_bf16 v[88:91], a[104:107], v[64:67], v[88:91]
 v_mul_f32 v157, v157, v250
 v_mul_f32 v157, v157, abs(v157)
 v_mfma_f32_16x16x32_bf16 v[92:95], a[108:111], v[64:67], v[92:95]
 v_cvt_pk_bf16_f32 v128, v156, v157
 v_pk_max_i16 v128, v128, 0
 v_mul_f32 v158, v158, v250
 v_mfma_f32_16x16x32_bf16 v[96:99], a[112:115], v[64:67], v[96:99]
 v_mul_f32 v158, v158, abs(v158)
 v_mul_f32 v159, v159, v250
 v_mfma_f32_16x16x32_bf16 v[100:103], a[116:119], v[64:67], v[100:103]
 v_mul_f32 v159, v159, abs(v159)
 v_cvt_pk_bf16_f32 v129, v158, v159
 s_waitcnt vmcnt(7)
 v_mfma_f32_16x16x32_bf16 v[84:87], a[120:123], v[68:71], v[84:87]
 buffer_load_dwordx4 v[56:59], v0, s[4:7], s25 offen offset:1024 sc1
 v_pk_max_i16 v129, v129, 0
 v_mfma_f32_16x16x32_bf16 v[88:91], a[124:127], v[68:71], v[88:91]
 v_mul_f32 v160, v160, v250
 v_mul_f32 v160, v160, abs(v160)
 v_mfma_f32_16x16x32_bf16 v[92:95], a[128:131], v[68:71], v[92:95]
 v_mul_f32 v161, v161, v250
 v_mul_f32 v161, v161, abs(v161)
 v_cvt_pk_bf16_f32 v130, v160, v161
 v_mfma_f32_16x16x32_bf16 v[96:99], a[132:135], v[68:71], v[96:99]
 v_pk_max_i16 v130, v130, 0
 v_mul_f32 v162, v162, v250
 v_mfma_f32_16x16x32_bf16 v[100:103], a[136:139], v[68:71], v[100:103]
 v_mul_f32 v162, v162, abs(v162)
 s_waitcnt vmcnt(7)
 v_mfma_f32_16x16x32_bf16 v[84:87], a[140:143], v[72:75], v[84:87]
 buffer_load_dwordx4 v[60:63], v0, s[4:7], s25 offen offset:2048 sc1
 v_mul_f32 v163, v163, v250
 v_mul_f32 v163, v163, abs(v163)
 v_mfma_f32_16x16x32_bf16 v[88:91], a[144:147], v[72:75], v[88:91]
 v_cvt_pk_bf16_f32 v131, v162, v163
 v_pk_max_i16 v131, v131, 0
 v_mfma_f32_16x16x32_bf16 v[92:95], a[148:151], v[72:75], v[92:95]
 buffer_store_dwordx4 v[128:131], v0, s[4:7], s34 offen sc1
 v_mfma_f32_16x16x32_bf16 v[96:99], a[152:155], v[72:75], v[96:99]
 s_add_u32 s34, s34, 49152
 v_mul_f32 v164, v164, v250
 v_mfma_f32_16x16x32_bf16 v[100:103], a[156:159], v[72:75], v[100:103]
 v_mul_f32 v164, v164, abs(v164)
 s_waitcnt vmcnt(8)
 v_mfma_f32_16x16x32_bf16 v[84:87], a[160:163], v[76:79], v[84:87]
 buffer_load_dwordx4 v[64:67], v0, s[4:7], s25 offen offset:3072 sc1
 s_add_u32 s25, s25, 4096
 v_mul_f32 v165, v165, v250
 v_mfma_f32_16x16x32_bf16 v[88:91], a[164:167], v[76:79], v[88:91]
 v_mul_f32 v165, v165, abs(v165)
 v_cvt_pk_bf16_f32 v134, v164, v165
 v_mfma_f32_16x16x32_bf16 v[92:95], a[168:171], v[76:79], v[92:95]
 v_pk_max_i16 v134, v134, 0
 v_mul_f32 v166, v166, v250
 v_mfma_f32_16x16x32_bf16 v[96:99], a[172:175], v[76:79], v[96:99]
 v_mul_f32 v166, v166, abs(v166)
 v_mul_f32 v167, v167, v250
 v_mul_f32 v167, v167, abs(v167)
 v_mfma_f32_16x16x32_bf16 v[100:103], a[176:179], v[76:79], v[100:103]
 v_cvt_pk_bf16_f32 v135, v166, v167
 s_waitcnt vmcnt(8)
 v_mfma_f32_16x16x32_bf16 v[84:87], a[180:183], v[80:83], v[84:87]
 buffer_load_dwordx4 v[68:71], v0, s[4:7], s25 offen sc1
 v_pk_max_i16 v135, v135, 0
 v_mfma_f32_16x16x32_bf16 v[88:91], a[184:187], v[80:83], v[88:91]
 v_permlane16_swap_b32 v132, v134
 v_mfma_f32_16x16x32_bf16 v[92:95], a[188:191], v[80:83], v[92:95]
 v_permlane16_swap_b32 v133, v135
 v_mfma_f32_16x16x32_bf16 v[96:99], a[192:195], v[80:83], v[96:99]
 buffer_store_dwordx4 v[132:135], v7, s[4:7], s35 offen offset:1024 sc1
 v_mfma_f32_16x16x32_bf16 v[100:103], a[196:199], v[80:83], v[100:103]
 s_add_u32 s35, s35, 98304
 s_waitcnt vmcnt(9)
 v_mfma_f32_16x16x32_bf16 v[84:87], a[200:203], v[44:47], v[84:87]
 buffer_load_dwordx4 v[72:75], v0, s[4:7], s25 offen offset:1024 sc1
 v_mfma_f32_16x16x32_bf16 v[88:91], a[204:207], v[44:47], v[88:91]
 v_mfma_f32_16x16x32_bf16 v[92:95], a[208:211], v[44:47], v[92:95]
 v_mfma_f32_16x16x32_bf16 v[96:99], a[212:215], v[44:47], v[96:99]
 v_mfma_f32_16x16x32_bf16 v[100:103], a[216:219], v[44:47], v[100:103]
 s_waitcnt vmcnt(8)
 v_mfma_f32_16x16x32_bf16 v[84:87], a[220:223], v[48:51], v[84:87]
 buffer_load_dwordx4 v[76:79], v0, s[4:7], s25 offen offset:2048 sc1
 v_mfma_f32_16x16x32_bf16 v[88:91], a[224:227], v[48:51], v[88:91]
 v_mfma_f32_16x16x32_bf16 v[92:95], a[228:231], v[48:51], v[92:95]
 v_mfma_f32_16x16x32_bf16 v[96:99], a[232:235], v[48:51], v[96:99]
 v_mfma_f32_16x16x32_bf16 v[100:103], a[236:239], v[48:51], v[100:103]
 s_waitcnt vmcnt(8)
 v_mfma_f32_16x16x32_bf16 v[104:107], a[0:3], v[52:55], 0
 buffer_load_dwordx4 v[80:83], v0, s[4:7], s25 offen offset:3072 sc1
 s_add_u32 s25, s25, 4096
 v_mfma_f32_16x16x32_bf16 v[108:111], a[4:7], v[52:55], 0
 s_waitcnt lgkmcnt(0)
 s_barrier
 v_mfma_f32_16x16x32_bf16 v[112:115], a[8:11], v[52:55], 0
 ds_write_b128 v3, v[84:87] offset:12288
 v_mfma_f32_16x16x32_bf16 v[116:119], a[12:15], v[52:55], 0
 v_mov_b32 v15, 7
 v_add_u32 v15, s52, v15
 s_waitcnt vmcnt(3)
 s_mov_b64 exec, 1
 buffer_store_dword v15, v0, s[4:7], s36 offen sc1
 s_mov_b64 exec, -1
 v_mfma_f32_16x16x32_bf16 v[120:123], a[16:19], v[52:55], 0
 v_mfma_f32_16x16x32_bf16 v[104:107], a[20:23], v[56:59], v[104:107]
 buffer_load_dwordx4 v[44:47], v0, s[4:7], s25 offen sc1
 v_mfma_f32_16x16x32_bf16 v[108:111], a[24:27], v[56:59], v[108:111]
 ds_write_b128 v3, v[88:91] offset:13312
 v_mfma_f32_16x16x32_bf16 v[112:115], a[28:31], v[56:59], v[112:115]
 v_mfma_f32_16x16x32_bf16 v[116:119], a[32:35], v[56:59], v[116:119]
 v_mfma_f32_16x16x32_bf16 v[120:123], a[36:39], v[56:59], v[120:123]
 v_mfma_f32_16x16x32_bf16 v[104:107], a[40:43], v[60:63], v[104:107]
 buffer_load_dwordx4 v[48:51], v0, s[4:7], s25 offen offset:1024 sc1
 v_mfma_f32_16x16x32_bf16 v[108:111], a[44:47], v[60:63], v[108:111]
 ds_write_b128 v3, v[92:95] offset:14336
 v_mfma_f32_16x16x32_bf16 v[112:115], a[48:51], v[60:63], v[112:115]
 v_mfma_f32_16x16x32_bf16 v[116:119], a[52:55], v[60:63], v[116:119]
 ds_write_b128 v3, v[96:99] offset:15360
 v_mfma_f32_16x16x32_bf16 v[120:123], a[56:59], v[60:63], v[120:123]
 v_mfma_f32_16x16x32_bf16 v[104:107], a[60:63], v[64:67], v[104:107]
 buffer_load_dwordx4 v[52:55], v0, s[4:7], s25 offen offset:2048 sc1
 v_mfma_f32_16x16x32_bf16 v[108:111], a[64:67], v[64:67], v[108:111]
 v_mfma_f32_16x16x32_bf16 v[112:115], a[68:71], v[64:67], v[112:115]
 ds_write_b128 v3, v[100:103] offset:16384
 v_mfma_f32_16x16x32_bf16 v[116:119], a[72:75], v[64:67], v[116:119]
 v_mfma_f32_16x16x32_bf16 v[120:123], a[76:79], v[64:67], v[120:123]
 v_mfma_f32_16x16x32_bf16 v[104:107], a[80:83], v[68:71], v[104:107]
 buffer_load_dwordx4 v[56:59], v0, s[4:7], s25 offen offset:3072 sc1
 v_mfma_f32_16x16x32_bf16 v[108:111], a[84:87], v[68:71], v[108:111]
 v_mfma_f32_16x16x32_bf16 v[112:115], a[88:91], v[68:71], v[112:115]
 s_add_u32 s56, s52, 7
 buffer_load_dword v12, v171, s[4:7], s28 offen sc1
 s_waitcnt lgkmcnt(0)
 s_barrier
 v_mfma_f32_16x16x32_bf16 v[116:119], a[92:95], v[68:71], v[116:119]
 ds_read_b128 v[124:127], v5 offset:12288
 v_mfma_f32_16x16x32_bf16 v[120:123], a[96:99], v[68:71], v[120:123]
 ds_read_b128 v[128:131], v5 offset:13312
 s_waitcnt vmcnt(8)
 v_mfma_f32_16x16x32_bf16 v[104:107], a[100:103], v[72:75], v[104:107]
 ds_read_b64 v[132:133], v6 offset:16384
 v_mfma_f32_16x16x32_bf16 v[108:111], a[104:107], v[72:75], v[108:111]
 ds_read_b128 v[134:137], v5 offset:17408
 v_mfma_f32_16x16x32_bf16 v[112:115], a[108:111], v[72:75], v[112:115]
 ds_read_b128 v[138:141], v5 offset:18432
 v_mfma_f32_16x16x32_bf16 v[116:119], a[112:115], v[72:75], v[116:119]
 ds_read_b64 v[142:143], v6 offset:21504
 v_mfma_f32_16x16x32_bf16 v[120:123], a[116:119], v[72:75], v[120:123]
 s_waitcnt vmcnt(7)
 v_mfma_f32_16x16x32_bf16 v[104:107], a[120:123], v[76:79], v[104:107]
 v_mfma_f32_16x16x32_bf16 v[108:111], a[124:127], v[76:79], v[108:111]
 s_waitcnt lgkmcnt(5)
 v_add_f32 v16, v16, v124
 v_add_f32 v17, v17, v125
 v_mfma_f32_16x16x32_bf16 v[112:115], a[128:131], v[76:79], v[112:115]
 v_add_f32 v18, v18, v126
 v_add_f32 v19, v19, v127
 v_mfma_f32_16x16x32_bf16 v[116:119], a[132:135], v[76:79], v[116:119]
 s_waitcnt lgkmcnt(4)
 v_add_f32 v20, v20, v128
 v_add_f32 v21, v21, v129
 v_mfma_f32_16x16x32_bf16 v[120:123], a[136:139], v[76:79], v[120:123]
 v_add_f32 v22, v22, v130
 s_waitcnt vmcnt(6)
 v_mfma_f32_16x16x32_bf16 v[104:107], a[140:143], v[80:83], v[104:107]
 v_add_f32 v23, v23, v131
 s_waitcnt lgkmcnt(3)
 v_add_f32 v24, v24, v132
 v_mfma_f32_16x16x32_bf16 v[108:111], a[144:147], v[80:83], v[108:111]
 v_add_f32 v25, v25, v133
 s_waitcnt lgkmcnt(2)
 v_add_f32 v16, v16, v134
 v_mfma_f32_16x16x32_bf16 v[112:115], a[148:151], v[80:83], v[112:115]
 v_add_f32 v17, v17, v135
 v_add_f32 v18, v18, v136
 v_mfma_f32_16x16x32_bf16 v[116:119], a[152:155], v[80:83], v[116:119]
 s_waitcnt vmcnt(0)
 v_cmp_ne_u32 vcc, s56, v12
 s_cbranch_vccnz Lretry_69
Lback_70:
 buffer_load_dwordx4 v[60:63], v0, s[4:7], s26 offen sc1
 v_mfma_f32_16x16x32_bf16 v[120:123], a[156:159], v[80:83], v[120:123]
 buffer_load_dwordx4 v[64:67], v0, s[4:7], s26 offen offset:1024 sc1
 v_mfma_f32_16x16x32_bf16 v[104:107], a[160:163], v[44:47], v[104:107]
 buffer_load_dwordx4 v[68:71], v0, s[4:7], s26 offen offset:2048 sc1
 v_add_f32 v19, v19, v137
 v_mfma_f32_16x16x32_bf16 v[108:111], a[164:167], v[44:47], v[108:111]
 buffer_load_dwordx4 v[72:75], v0, s[4:7], s26 offen offset:3072 sc1
 s_add_u32 s26, s26, 4096
 v_mfma_f32_16x16x32_bf16 v[112:115], a[168:171], v[44:47], v[112:115]
 s_waitcnt lgkmcnt(1)
 v_add_f32 v20, v20, v138
 v_add_f32 v21, v21, v139
 v_mfma_f32_16x16x32_bf16 v[116:119], a[172:175], v[44:47], v[116:119]
 v_add_f32 v22, v22, v140
 v_add_f32 v23, v23, v141
 v_mfma_f32_16x16x32_bf16 v[120:123], a[176:179], v[44:47], v[120:123]
 s_waitcnt lgkmcnt(0)
 v_add_f32 v24, v24, v142
 v_mfma_f32_16x16x32_bf16 v[104:107], a[180:183], v[48:51], v[104:107]
 buffer_load_dwordx4 v[76:79], v0, s[4:7], s26 offen sc1
 v_add_f32 v25, v25, v143
 v_mfma_f32_16x16x32_bf16 v[108:111], a[184:187], v[48:51], v[108:111]
 v_mfma_f32_16x16x32_bf16 v[112:115], a[188:191], v[48:51], v[112:115]
 v_mfma_f32_16x16x32_bf16 v[116:119], a[192:195], v[48:51], v[116:119]
 v_mfma_f32_16x16x32_bf16 v[120:123], a[196:199], v[48:51], v[120:123]
 v_mfma_f32_16x16x32_bf16 v[104:107], a[200:203], v[52:55], v[104:107]
 buffer_load_dwordx4 v[80:83], v0, s[4:7], s26 offen offset:1024 sc1
 v_mfma_f32_16x16x32_bf16 v[108:111], a[204:207], v[52:55], v[108:111]
 v_mfma_f32_16x16x32_bf16 v[112:115], a[208:211], v[52:55], v[112:115]
 v_mfma_f32_16x16x32_bf16 v[116:119], a[212:215], v[52:55], v[116:119]
 v_mfma_f32_16x16x32_bf16 v[120:123], a[216:219], v[52:55], v[120:123]
 v_mfma_f32_16x16x32_bf16 v[104:107], a[220:223], v[56:59], v[104:107]
 buffer_load_dwordx4 v[44:47], v0, s[4:7], s26 offen offset:2048 sc1
 v_mfma_f32_16x16x32_bf16 v[108:111], a[224:227], v[56:59], v[108:111]
 v_mfma_f32_16x16x32_bf16 v[112:115], a[228:231], v[56:59], v[112:115]
 v_mfma_f32_16x16x32_bf16 v[116:119], a[232:235], v[56:59], v[116:119]
 v_mfma_f32_16x16x32_bf16 v[120:123], a[236:239], v[56:59], v[120:123]
 s_waitcnt vmcnt(6)
 v_mfma_f32_16x16x32_bf16 v[84:87], a[0:3], v[60:63], 0
 buffer_load_dwordx4 v[48:51], v0, s[4:7], s26 offen offset:3072 sc1
 s_add_u32 s26, s26, 4096
 v_mfma_f32_16x16x32_bf16 v[88:91], a[4:7], v[60:63], 0
 s_waitcnt lgkmcnt(0)
 s_barrier
 v_mfma_f32_16x16x32_bf16 v[92:95], a[8:11], v[60:63], 0
 ds_write_b128 v4, v[104:107] offset:12288
 v_mfma_f32_16x16x32_bf16 v[96:99], a[12:15], v[60:63], 0
 v_mfma_f32_16x16x32_bf16 v[100:103], a[16:19], v[60:63], 0
 s_waitcnt vmcnt(6)
 v_mfma_f32_16x16x32_bf16 v[84:87], a[20:23], v[64:67], v[84:87]
 buffer_load_dwordx4 v[52:55], v0, s[4:7], s26 offen sc1
 v_mfma_f32_16x16x32_bf16 v[88:91], a[24:27], v[64:67], v[88:91]
 ds_write_b128 v4, v[108:111] offset:13312
 v_mfma_f32_16x16x32_bf16 v[92:95], a[28:31], v[64:67], v[92:95]
 v_mfma_f32_16x16x32_bf16 v[96:99], a[32:35], v[64:67], v[96:99]
 v_mfma_f32_16x16x32_bf16 v[100:103], a[36:39], v[64:67], v[100:103]
 s_waitcnt vmcnt(6)
 v_mfma_f32_16x16x32_bf16 v[84:87], a[40:43], v[68:71], v[84:87]
 buffer_load_dwordx4 v[56:59], v0, s[4:7], s26 offen offset:1024 sc1
 v_mfma_f32_16x16x32_bf16 v[88:91], a[44:47], v[68:71], v[88:91]
 ds_write_b128 v4, v[112:115] offset:14336
 v_mfma_f32_16x16x32_bf16 v[92:95], a[48:51], v[68:71], v[92:95]
 v_mfma_f32_16x16x32_bf16 v[96:99], a[52:55], v[68:71], v[96:99]
 ds_write_b128 v4, v[116:119] offset:15360
 v_mfma_f32_16x16x32_bf16 v[100:103], a[56:59], v[68:71], v[100:103]
 s_waitcnt vmcnt(6)
 v_mfma_f32_16x16x32_bf16 v[84:87], a[60:63], v[72:75], v[84:87]
 buffer_load_dwordx4 v[60:63], v0, s[4:7], s26 offen offset:2048 sc1
 v_mfma_f32_16x16x32_bf16 v[88:91], a[64:67], v[72:75], v[88:91]
 v_mfma_f32_16x16x32_bf16 v[92:95], a[68:71], v[72:75], v[92:95]
 ds_write_b128 v4, v[120:123] offset:16384
 v_mfma_f32_16x16x32_bf16 v[96:99], a[72:75], v[72:75], v[96:99]
 v_mfma_f32_16x16x32_bf16 v[100:103], a[76:79], v[72:75], v[100:103]
 s_waitcnt vmcnt(6)
 v_mfma_f32_16x16x32_bf16 v[84:87], a[80:83], v[76:79], v[84:87]
 buffer_load_dwordx4 v[64:67], v0, s[4:7], s26 offen offset:3072 sc1
 v_mfma_f32_16x16x32_bf16 v[88:91], a[84:87], v[76:79], v[88:91]
 v_mfma_f32_16x16x32_bf16 v[92:95], a[88:91], v[76:79], v[92:95]
 s_waitcnt lgkmcnt(0)
 s_barrier
 v_mfma_f32_16x16x32_bf16 v[96:99], a[92:95], v[76:79], v[96:99]
 ds_read_b128 v[124:127], v5 offset:12288
 v_mfma_f32_16x16x32_bf16 v[100:103], a[96:99], v[76:79], v[100:103]
 ds_read_b128 v[128:131], v5 offset:13312
 s_waitcnt vmcnt(6)
 v_mfma_f32_16x16x32_bf16 v[84:87], a[100:103], v[80:83], v[84:87]
 buffer_load_dwordx4 v[68:71], v0, s[4:7], s27 offen sc1
 ds_read_b64 v[132:133], v6 offset:16384
 v_mfma_f32_16x16x32_bf16 v[88:91], a[104:107], v[80:83], v[88:91]
 ds_read_b128 v[134:137], v5 offset:17408
 v_mfma_f32_16x16x32_bf16 v[92:95], a[108:111], v[80:83], v[92:95]
 ds_read_b128 v[138:141], v5 offset:18432
 v_mfma_f32_16x16x32_bf16 v[96:99], a[112:115], v[80:83], v[96:99]
 ds_read_b64 v[142:143], v6 offset:21504
 v_mfma_f32_16x16x32_bf16 v[100:103], a[116:119], v[80:83], v[100:103]
 s_waitcnt vmcnt(6)
 v_mfma_f32_16x16x32_bf16 v[84:87], a[120:123], v[44:47], v[84:87]
 buffer_load_dwordx4 v[72:75], v0, s[4:7], s27 offen offset:1024 sc1
 v_mfma_f32_16x16x32_bf16 v[88:91], a[124:127], v[44:47], v[88:91]
 s_waitcnt lgkmcnt(5)
 v_add_f32 v16, v16, v124
 v_add_f32 v17, v17, v125
 v_mfma_f32_16x16x32_bf16 v[92:95], a[128:131], v[44:47], v[92:95]
 v_add_f32 v18, v18, v126
 v_add_f32 v19, v19, v127
 v_mfma_f32_16x16x32_bf16 v[96:99], a[132:135], v[44:47], v[96:99]
 s_waitcnt lgkmcnt(4)
 v_add_f32 v20, v20, v128
 v_add_f32 v21, v21, v129
 v_mfma_f32_16x16x32_bf16 v[100:103], a[136:139], v[44:47], v[100:103]
 v_add_f32 v22, v22, v130
 s_waitcnt vmcnt(6)
 v_mfma_f32_16x16x32_bf16 v[84:87], a[140:143], v[48:51], v[84:87]
 buffer_load_dwordx4 v[76:79], v0, s[4:7], s27 offen offset:2048 sc1
 v_add_f32 v23, v23, v131
 v_mfma_f32_16x16x32_bf16 v[88:91], a[144:147], v[48:51], v[88:91]
 s_waitcnt lgkmcnt(3)
 v_add_f32 v24, v24, v132
 v_add_f32 v25, v25, v133
 v_mfma_f32_16x16x32_bf16 v[92:95], a[148:151], v[48:51], v[92:95]
 s_waitcnt lgkmcnt(2)
 v_add_f32 v16, v16, v134
 v_add_f32 v17, v17, v135
 v_mfma_f32_16x16x32_bf16 v[96:99], a[152:155], v[48:51], v[96:99]
 v_add_f32 v18, v18, v136
 v_add_f32 v19, v19, v137
 v_mfma_f32_16x16x32_bf16 v[100:103], a[156:159], v[48:51], v[100:103]
 s_waitcnt lgkmcnt(1)
 v_add_f32 v20, v20, v138
 s_waitcnt vmcnt(6)
 v_mfma_f32_16x16x32_bf16 v[84:87], a[160:163], v[52:55], v[84:87]
 buffer_load_dwordx4 v[80:83], v0, s[4:7], s27 offen offset:3072 sc1
 s_add_u32 s27, s27, 4096
 v_mfma_f32_16x16x32_bf16 v[88:91], a[164:167], v[52:55], v[88:91]
 v_add_f32 v21, v21, v139
 v_add_f32 v22, v22, v140
 v_mfma_f32_16x16x32_bf16 v[92:95], a[168:171], v[52:55], v[92:95]
 v_add_f32 v23, v23, v141
 s_waitcnt lgkmcnt(0)
 v_add_f32 v24, v24, v142
 v_mfma_f32_16x16x32_bf16 v[96:99], a[172:175], v[52:55], v[96:99]
 v_add_f32 v25, v25, v143
 v_cvt_pk_bf16_f32 v124, v16, v17
 v_mfma_f32_16x16x32_bf16 v[100:103], a[176:179], v[52:55], v[100:103]
 v_cvt_pk_bf16_f32 v125, v18, v19
 s_waitcnt vmcnt(6)
 v_mfma_f32_16x16x32_bf16 v[84:87], a[180:183], v[56:59], v[84:87]
 buffer_load_dwordx4 v[44:47], v0, s[4:7], s27 offen sc1
 v_cvt_pk_bf16_f32 v126, v20, v21
 v_mfma_f32_16x16x32_bf16 v[88:91], a[184:187], v[56:59], v[88:91]
 v_cvt_pk_bf16_f32 v127, v22, v23
 v_cvt_pk_bf16_f32 v128, v24, v25
 v_mfma_f32_16x16x32_bf16 v[92:95], a[188:191], v[56:59], v[92:95]
 buffer_store_dwordx4 v[124:127], v168, s[8:11], s29 offen sc1
 v_mfma_f32_16x16x32_bf16 v[96:99], a[192:195], v[56:59], v[96:99]
 buffer_store_dword v128, v169, s[8:11], s30 offen sc1
 v_mfma_f32_16x16x32_bf16 v[100:103], a[196:199], v[56:59], v[100:103]
 s_add_u32 s29, s29, 40960
 s_waitcnt vmcnt(8)
 v_mfma_f32_16x16x32_bf16 v[84:87], a[200:203], v[60:63], v[84:87]
 buffer_load_dwordx4 v[48:51], v0, s[4:7], s27 offen offset:1024 sc1
 s_add_u32 s30, s30, 40960
 v_mfma_f32_16x16x32_bf16 v[88:91], a[204:207], v[60:63], v[88:91]
 v_mfma_f32_16x16x32_bf16 v[92:95], a[208:211], v[60:63], v[92:95]
 v_mfma_f32_16x16x32_bf16 v[96:99], a[212:215], v[60:63], v[96:99]
 v_mfma_f32_16x16x32_bf16 v[100:103], a[216:219], v[60:63], v[100:103]
 s_waitcnt vmcnt(8)
 v_mfma_f32_16x16x32_bf16 v[84:87], a[220:223], v[64:67], v[84:87]
 buffer_load_dwordx4 v[52:55], v0, s[4:7], s27 offen offset:2048 sc1
 v_mfma_f32_16x16x32_bf16 v[88:91], a[224:227], v[64:67], v[88:91]
 v_mfma_f32_16x16x32_bf16 v[92:95], a[228:231], v[64:67], v[92:95]
 v_mfma_f32_16x16x32_bf16 v[96:99], a[232:235], v[64:67], v[96:99]
 v_mfma_f32_16x16x32_bf16 v[100:103], a[236:239], v[64:67], v[100:103]
 s_waitcnt vmcnt(8)
 v_mfma_f32_16x16x32_bf16 v[104:107], a[0:3], v[68:71], 0
 buffer_load_dwordx4 v[56:59], v0, s[4:7], s27 offen offset:3072 sc1
 s_add_u32 s27, s27, 4096
 v_mfma_f32_16x16x32_bf16 v[108:111], a[4:7], v[68:71], 0
 s_waitcnt lgkmcnt(0)
 s_barrier
 v_mfma_f32_16x16x32_bf16 v[112:115], a[8:11], v[68:71], 0
 ds_write_b128 v3, v[84:87] offset:12288
 v_mfma_f32_16x16x32_bf16 v[116:119], a[12:15], v[68:71], 0
 v_mfma_f32_16x16x32_bf16 v[120:123], a[16:19], v[68:71], 0
 s_waitcnt vmcnt(8)
 v_mfma_f32_16x16x32_bf16 v[104:107], a[20:23], v[72:75], v[104:107]
 buffer_load_dwordx4 v[60:63], v0, s[4:7], s27 offen sc1
 v_mfma_f32_16x16x32_bf16 v[108:111], a[24:27], v[72:75], v[108:111]
 ds_write_b128 v3, v[88:91] offset:13312
 v_mfma_f32_16x16x32_bf16 v[112:115], a[28:31], v[72:75], v[112:115]
 v_mfma_f32_16x16x32_bf16 v[116:119], a[32:35], v[72:75], v[116:119]
 v_mfma_f32_16x16x32_bf16 v[120:123], a[36:39], v[72:75], v[120:123]
 s_waitcnt vmcnt(8)
 v_mfma_f32_16x16x32_bf16 v[104:107], a[40:43], v[76:79], v[104:107]
 buffer_load_dwordx4 v[64:67], v0, s[4:7], s27 offen offset:1024 sc1
 v_mfma_f32_16x16x32_bf16 v[108:111], a[44:47], v[76:79], v[108:111]
 ds_write_b128 v3, v[92:95] offset:14336
 v_mfma_f32_16x16x32_bf16 v[112:115], a[48:51], v[76:79], v[112:115]
 v_mfma_f32_16x16x32_bf16 v[116:119], a[52:55], v[76:79], v[116:119]
 ds_write_b128 v3, v[96:99] offset:15360
 v_mfma_f32_16x16x32_bf16 v[120:123], a[56:59], v[76:79], v[120:123]
 s_waitcnt vmcnt(8)
 v_mfma_f32_16x16x32_bf16 v[104:107], a[60:63], v[80:83], v[104:107]
 buffer_load_dwordx4 v[68:71], v0, s[4:7], s27 offen offset:2048 sc1
 v_mfma_f32_16x16x32_bf16 v[108:111], a[64:67], v[80:83], v[108:111]
 v_mfma_f32_16x16x32_bf16 v[112:115], a[68:71], v[80:83], v[112:115]
 ds_write_b128 v3, v[100:103] offset:16384
 v_mfma_f32_16x16x32_bf16 v[116:119], a[72:75], v[80:83], v[116:119]
 v_mfma_f32_16x16x32_bf16 v[120:123], a[76:79], v[80:83], v[120:123]
 s_waitcnt vmcnt(8)
 v_mfma_f32_16x16x32_bf16 v[104:107], a[80:83], v[44:47], v[104:107]
 buffer_load_dwordx4 v[72:75], v0, s[4:7], s27 offen offset:3072 sc1
 v_mfma_f32_16x16x32_bf16 v[108:111], a[84:87], v[44:47], v[108:111]
 v_mfma_f32_16x16x32_bf16 v[112:115], a[88:91], v[44:47], v[112:115]
 s_waitcnt lgkmcnt(0)
 s_barrier
 v_mfma_f32_16x16x32_bf16 v[116:119], a[92:95], v[44:47], v[116:119]
 ds_read_b128 v[124:127], v5 offset:12288
 v_mfma_f32_16x16x32_bf16 v[120:123], a[96:99], v[44:47], v[120:123]
 ds_read_b128 v[128:131], v5 offset:13312
 s_waitcnt vmcnt(6)
 v_mfma_f32_16x16x32_bf16 v[104:107], a[100:103], v[48:51], v[104:107]
 ds_read_b64 v[132:133], v6 offset:16384
 v_mfma_f32_16x16x32_bf16 v[108:111], a[104:107], v[48:51], v[108:111]
 ds_read_b128 v[134:137], v5 offset:17408
 v_mfma_f32_16x16x32_bf16 v[112:115], a[108:111], v[48:51], v[112:115]
 ds_read_b128 v[138:141], v5 offset:18432
 v_mfma_f32_16x16x32_bf16 v[116:119], a[112:115], v[48:51], v[116:119]
 ds_read_b64 v[142:143], v6 offset:21504
 v_mfma_f32_16x16x32_bf16 v[120:123], a[116:119], v[48:51], v[120:123]
 s_waitcnt vmcnt(5)
 v_mfma_f32_16x16x32_bf16 v[104:107], a[120:123], v[52:55], v[104:107]
 v_mfma_f32_16x16x32_bf16 v[108:111], a[124:127], v[52:55], v[108:111]
 s_waitcnt lgkmcnt(5)
 v_add_f32 v26, v26, v124
 v_add_f32 v27, v27, v125
 v_mfma_f32_16x16x32_bf16 v[112:115], a[128:131], v[52:55], v[112:115]
 v_add_f32 v28, v28, v126
 v_add_f32 v29, v29, v127
 v_mfma_f32_16x16x32_bf16 v[116:119], a[132:135], v[52:55], v[116:119]
 s_waitcnt lgkmcnt(4)
 v_add_f32 v30, v30, v128
 v_add_f32 v31, v31, v129
 v_mfma_f32_16x16x32_bf16 v[120:123], a[136:139], v[52:55], v[120:123]
 v_add_f32 v32, v32, v130
 s_waitcnt vmcnt(4)
 v_mfma_f32_16x16x32_bf16 v[104:107], a[140:143], v[56:59], v[104:107]
 v_add_f32 v33, v33, v131
 s_waitcnt lgkmcnt(3)
 v_add_f32 v34, v34, v132
 v_mfma_f32_16x16x32_bf16 v[108:111], a[144:147], v[56:59], v[108:111]
 v_add_f32 v35, v35, v133
 s_waitcnt lgkmcnt(2)
 v_add_f32 v26, v26, v134
 v_mfma_f32_16x16x32_bf16 v[112:115], a[148:151], v[56:59], v[112:115]
 v_add_f32 v27, v27, v135
 v_add_f32 v28, v28, v136
 v_mfma_f32_16x16x32_bf16 v[116:119], a[152:155], v[56:59], v[116:119]
 v_add_f32 v29, v29, v137
 s_waitcnt lgkmcnt(1)
 v_add_f32 v30, v30, v138
 v_mfma_f32_16x16x32_bf16 v[120:123], a[156:159], v[56:59], v[120:123]
 v_add_f32 v31, v31, v139
 s_waitcnt vmcnt(3)
 v_mfma_f32_16x16x32_bf16 v[104:107], a[160:163], v[60:63], v[104:107]
 v_add_f32 v32, v32, v140
 v_add_f32 v33, v33, v141
 v_mfma_f32_16x16x32_bf16 v[108:111], a[164:167], v[60:63], v[108:111]
 s_waitcnt lgkmcnt(0)
 v_add_f32 v34, v34, v142
 v_add_f32 v35, v35, v143
 v_mfma_f32_16x16x32_bf16 v[112:115], a[168:171], v[60:63], v[112:115]
 v_mfma_f32_16x16x32_bf16 v[116:119], a[172:175], v[60:63], v[116:119]
 v_mfma_f32_16x16x32_bf16 v[120:123], a[176:179], v[60:63], v[120:123]
 s_waitcnt vmcnt(2)
 v_mfma_f32_16x16x32_bf16 v[104:107], a[180:183], v[64:67], v[104:107]
 v_mfma_f32_16x16x32_bf16 v[108:111], a[184:187], v[64:67], v[108:111]
 v_mfma_f32_16x16x32_bf16 v[112:115], a[188:191], v[64:67], v[112:115]
 v_mfma_f32_16x16x32_bf16 v[116:119], a[192:195], v[64:67], v[116:119]
 v_mfma_f32_16x16x32_bf16 v[120:123], a[196:199], v[64:67], v[120:123]
 s_waitcnt vmcnt(1)
 v_mfma_f32_16x16x32_bf16 v[104:107], a[200:203], v[68:71], v[104:107]
 v_mfma_f32_16x16x32_bf16 v[108:111], a[204:207], v[68:71], v[108:111]
 v_mfma_f32_16x16x32_bf16 v[112:115], a[208:211], v[68:71], v[112:115]
 v_mfma_f32_16x16x32_bf16 v[116:119], a[212:215], v[68:71], v[116:119]
 v_mfma_f32_16x16x32_bf16 v[120:123], a[216:219], v[68:71], v[120:123]
 s_waitcnt vmcnt(0)
 v_mfma_f32_16x16x32_bf16 v[104:107], a[220:223], v[72:75], v[104:107]
 v_mfma_f32_16x16x32_bf16 v[108:111], a[224:227], v[72:75], v[108:111]
 v_mfma_f32_16x16x32_bf16 v[112:115], a[228:231], v[72:75], v[112:115]
 v_mfma_f32_16x16x32_bf16 v[116:119], a[232:235], v[72:75], v[116:119]
 v_mfma_f32_16x16x32_bf16 v[120:123], a[236:239], v[72:75], v[120:123]
 s_waitcnt lgkmcnt(0)
 s_barrier
 s_nop 1
 ds_write_b128 v4, v[104:107] offset:12288
 ds_write_b128 v4, v[108:111] offset:13312
 ds_write_b128 v4, v[112:115] offset:14336
 ds_write_b128 v4, v[116:119] offset:15360
 ds_write_b128 v4, v[120:123] offset:16384
 s_waitcnt lgkmcnt(0)
 s_barrier
 ds_read_b128 v[124:127], v5 offset:12288
 ds_read_b128 v[128:131], v5 offset:13312
 ds_read_b64 v[132:133], v6 offset:16384
 ds_read_b128 v[134:137], v5 offset:17408
 ds_read_b128 v[138:141], v5 offset:18432
 ds_read_b64 v[142:143], v6 offset:21504
 s_waitcnt lgkmcnt(5)
 v_pk_add_f32 v[26:27], v[26:27], v[124:125]
 v_pk_add_f32 v[28:29], v[28:29], v[126:127]
 s_waitcnt lgkmcnt(4)
 v_pk_add_f32 v[30:31], v[30:31], v[128:129]
 v_pk_add_f32 v[32:33], v[32:33], v[130:131]
 s_waitcnt lgkmcnt(3)
 v_pk_add_f32 v[34:35], v[34:35], v[132:133]
 s_waitcnt lgkmcnt(2)
 v_pk_add_f32 v[26:27], v[26:27], v[134:135]
 v_pk_add_f32 v[28:29], v[28:29], v[136:137]
 s_waitcnt lgkmcnt(1)
 v_pk_add_f32 v[30:31], v[30:31], v[138:139]
 v_pk_add_f32 v[32:33], v[32:33], v[140:141]
 s_waitcnt lgkmcnt(0)
 v_pk_add_f32 v[34:35], v[34:35], v[142:143]
 v_cvt_pk_bf16_f32 v124, v26, v27
 v_cvt_pk_bf16_f32 v125, v28, v29
 v_cvt_pk_bf16_f32 v126, v30, v31
 v_cvt_pk_bf16_f32 v127, v32, v33
 v_cvt_pk_bf16_f32 v128, v34, v35
 buffer_store_dwordx4 v[124:127], v168, s[8:11], s29 offen sc1
 buffer_store_dword v128, v169, s[8:11], s30 offen sc1
 s_add_u32 s56, s52, 16
 v_mov_b32 v12, s56
 s_mov_b32 s16, 7782400
 s_or_b32 s17, s2, s3
 s_cmp_eq_u32 s17, 0
 s_cselect_b32 s17, 0, 1073741824
 v_mov_b32 v13, s17
 s_mov_b64 exec, 1
 buffer_store_dword v12, v13, s[4:7], s16 offen sc1
 s_mov_b64 exec, -1
 s_endpgm
Lretry_37:
 s_nop 7
 s_nop 3
 s_mov_b32 s55, 0
Lpoll_39:
 buffer_load_dword v12, v205, s[4:7], s39 offen sc1
 s_add_u32 s55, s55, 1
 s_cmp_gt_u32 s55, 0x80000
 s_cbranch_scc1 Lend
 s_waitcnt vmcnt(0)
 v_cmp_ne_u32 vcc, s56, v12
 s_cbranch_vccnz Lpoll_39
 s_branch Lback_38
Lretry_44:
 s_nop 7
 s_nop 3
 s_mov_b32 s55, 0
Lpoll_46:
 buffer_load_dword v12, v172, s[4:7], s33 offen sc1
 s_add_u32 s55, s55, 1
 s_cmp_gt_u32 s55, 0x80000
 s_cbranch_scc1 Lend
 s_waitcnt vmcnt(0)
 v_cmp_ne_u32 vcc, s56, v12
 s_cbranch_vccnz Lpoll_46
 s_branch Lback_45
Lretry_47:
 s_nop 7
 s_nop 3
 s_mov_b32 s55, 0
Lpoll_49:
 buffer_load_dword v12, v171, s[4:7], s28 offen sc1
 s_add_u32 s55, s55, 1
 s_cmp_gt_u32 s55, 0x80000
 s_cbranch_scc1 Lend
 s_waitcnt vmcnt(0)
 v_cmp_ne_u32 vcc, s56, v12
 s_cbranch_vccnz Lpoll_49
 s_branch Lback_48
Lretry_50:
 s_nop 7
 s_nop 3
 s_mov_b32 s55, 0
Lpoll_52:
 buffer_load_dword v12, v171, s[4:7], s28 offen sc1
 s_add_u32 s55, s55, 1
 s_cmp_gt_u32 s55, 0x80000
 s_cbranch_scc1 Lend
 s_waitcnt vmcnt(0)
 v_cmp_ne_u32 vcc, s56, v12
 s_cbranch_vccnz Lpoll_52
 s_branch Lback_51
Lretry_56:
 s_nop 7
 s_nop 3
 s_mov_b32 s55, 0
Lpoll_58:
 buffer_load_dword v12, v172, s[4:7], s33 offen sc1
 s_add_u32 s55, s55, 1
 s_cmp_gt_u32 s55, 0x80000
 s_cbranch_scc1 Lend
 s_waitcnt vmcnt(0)
 v_cmp_ne_u32 vcc, s56, v12
 s_cbranch_vccnz Lpoll_58
 s_branch Lback_57
Lretry_63:
 s_nop 7
 s_nop 3
 s_mov_b32 s55, 0
Lpoll_65:
 buffer_load_dword v12, v172, s[4:7], s33 offen sc1
 s_add_u32 s55, s55, 1
 s_cmp_gt_u32 s55, 0x80000
 s_cbranch_scc1 Lend
 s_waitcnt vmcnt(0)
 v_cmp_ne_u32 vcc, s56, v12
 s_cbranch_vccnz Lpoll_65
 s_branch Lback_64
Lretry_66:
 s_nop 7
 s_nop 3
 s_mov_b32 s55, 0
Lpoll_68:
 buffer_load_dword v12, v171, s[4:7], s28 offen sc1
 s_add_u32 s55, s55, 1
 s_cmp_gt_u32 s55, 0x80000
 s_cbranch_scc1 Lend
 s_waitcnt vmcnt(0)
 v_cmp_ne_u32 vcc, s56, v12
 s_cbranch_vccnz Lpoll_68
 s_branch Lback_67
Lretry_69:
 s_nop 7
 s_nop 3
 s_mov_b32 s55, 0
Lpoll_71:
 buffer_load_dword v12, v171, s[4:7], s28 offen sc1
 s_add_u32 s55, s55, 1
 s_cmp_gt_u32 s55, 0x80000
 s_cbranch_scc1 Lend
 s_waitcnt vmcnt(0)
 v_cmp_ne_u32 vcc, s56, v12
 s_cbranch_vccnz Lpoll_71
 s_branch Lback_70
Lslow_end:
 s_endpgm
.section .rodata,"a"
.p2align 6
.amdhsa_kernel interleave_layers__linear_kernel_hedgehog__dense_activation_squared_relu__prompt_kernel
  .amdhsa_next_free_vgpr 512
  .amdhsa_next_free_sgpr 102
  .amdhsa_accum_offset 256
  .amdhsa_group_segment_fixed_size 0
  .amdhsa_kernarg_size 96
  .amdhsa_user_sgpr_count 2
  .amdhsa_user_sgpr_kernarg_segment_ptr 1
  .amdhsa_system_sgpr_workgroup_id_x 1
.end_amdhsa_kernel
```
